```python
import torch

def _softmax(x, axis=-1):
    return torch.softmax(x, dim=axis)
def _gelu(x):
    return torch.nn.functional.gelu(x, approximate="tanh")
def _silu(x):
    return torch.nn.functional.silu(x)
def _sigmoid(x):
    return torch.sigmoid(x)
def _layernorm(x, axis=-1, eps=1e-5):
    m = x.mean(dim=axis, keepdim=True)
    v = x.var(dim=axis, keepdim=True, unbiased=False)
    return (x - m) / torch.sqrt(v + eps)
def _scatter_add(tgt, idx, src, axis=0):
    return tgt.clone().index_add_(axis, idx, src)
def _segment_sum(src, seg, n):
    out = torch.zeros((n,) + src.shape[1:], dtype=src.dtype)
    return out.index_add_(0, seg, src)
def _pad(x, pw):
    flat = tuple(v for pair in reversed(pw) for v in pair)
    return torch.nn.functional.pad(x, flat)

kernel_name = 'recurrent_scan__ssm_conv_s5__dense_activation_gelu__prompt'

def setup_inputs():

    _w = (lambda a: (lambda t: t.to(torch.bfloat16) if t.is_floating_point() else t)(torch.as_tensor(a)))
    def _A_setup():
        B, S, D = 1, 2048, 576
        P = D
        Lambda_re = -0.5 * (lambda _x: torch.exp(torch.as_tensor(_x)))((lambda *s: torch.randn(*s, dtype=torch.bfloat16) * 0.4)(P))
        Lambda_im = (lambda *s: torch.randn(*s, dtype=torch.bfloat16) * 0.8)(P) * 1.0
        B_re = (lambda *s: torch.randn(*s, dtype=torch.bfloat16) * 0.8)(P, D) * (D ** -0.5)
        B_im = (lambda *s: torch.randn(*s, dtype=torch.bfloat16) * 0.8)(P, D) * (D ** -0.5)
        C_re = (lambda *s: torch.randn(*s, dtype=torch.bfloat16) * 0.8)(D, P) * (P ** -0.5)
        C_im = (lambda *s: torch.randn(*s, dtype=torch.bfloat16) * 0.8)(D, P) * (P ** -0.5)
        log_dt = (lambda *s: torch.randn(*s, dtype=torch.bfloat16) * 0.4)(P) * 0.3 - 2.0
        Dskip = (lambda *s: torch.randn(*s, dtype=torch.bfloat16) * 0.2)(D)
        return {
            "x": _w((lambda *s: torch.randn(*s, dtype=torch.bfloat16) * 0.05)(B, S, D)),
            "Lambda_re": _w(Lambda_re),
            "Lambda_im": _w(Lambda_im),
            "B_re": _w(B_re),
            "B_im": _w(B_im),
            "C_re": _w(C_re),
            "C_im": _w(C_im),
            "log_dt": _w(log_dt),
            "Dskip": _w(Dskip),
        }
    _A_in = _A_setup()

    def _B_setup():
        B, S, D, F = 1, 2048, 576, 4608
        return {
            "x": _w((lambda *s: torch.randn(*s, dtype=torch.bfloat16) * 0.05)(B, S, D)),
            "w1": _w((lambda *s: torch.randn(*s, dtype=torch.bfloat16) * 0.8)(D, F) * (D ** -0.5)),
            "b1": _w((lambda *s: torch.randn(*s, dtype=torch.bfloat16) * 12.8)(F) * 0.01),
            "w2": _w((lambda *s: torch.randn(*s, dtype=torch.bfloat16) * 0.8)(F, D) * (F ** -0.5)),
            "b2": _w((lambda *s: torch.randn(*s, dtype=torch.bfloat16) * 6.4)(D) * 0.01),
        }
    _B_in = _B_setup()

    return {
        "A_x": _A_in["x"],
        "A_Lambda_re": _A_in["Lambda_re"],
        "A_Lambda_im": _A_in["Lambda_im"],
        "A_B_re": _A_in["B_re"],
        "A_B_im": _A_in["B_im"],
        "A_C_re": _A_in["C_re"],
        "A_C_im": _A_in["C_im"],
        "A_log_dt": _A_in["log_dt"],
        "A_Dskip": _A_in["Dskip"],
        "B_x": _B_in["x"],
        "B_w1": _B_in["w1"],
        "B_b1": _B_in["b1"],
        "B_w2": _B_in["w2"],
        "B_b2": _B_in["b2"],
    }

def reference(A_x, A_Lambda_re, A_Lambda_im, A_B_re, A_B_im, A_C_re, A_C_im, A_log_dt, A_Dskip, B_x, B_w1, B_b1, B_w2, B_b2):
    def _A_ref(x, Lambda_re, Lambda_im, B_re, B_im, C_re, C_im, log_dt, Dskip):
        Bsz, L, H = x.shape
        Lam = Lambda_re + 1j * Lambda_im
        Bmat = B_re + 1j * B_im
        Cmat = C_re + 1j * C_im
        dt = torch.exp(log_dt)
        Lam_bar = torch.exp(dt * Lam)
        B_bar = ((Lam_bar - 1.0) / Lam)[:, None] * Bmat
        Bu = torch.einsum("bld,pd->blp", x + 0j, B_bar)
        h = torch.zeros_like(Bu[:, 0, :])
        hs = []
        for t in range(L):
            h = Lam_bar[None, :] * h + Bu[:, t, :]
            hs.append(h)
        hseq = torch.stack(hs, 1)
        y = 2.0 * torch.einsum("blp,dp->bld", hseq, Cmat).real + x * Dskip[None, None, :]
        return y

    def _B_ref(x, w1, b1, w2, b2):
        h = torch.einsum("bsd,df->bsf", x, w1) + b1
        h = _gelu(h)
        return torch.einsum("bsf,fd->bsd", h, w2) + b2

    x = A_x
    xn = _layernorm(x, axis=-1)
    s = _A_ref(xn, A_Lambda_re, A_Lambda_im, A_B_re, A_B_im, A_C_re, A_C_im, A_log_dt, A_Dskip)
    g = _silu(_B_ref(xn, B_w1, B_b1, B_w2, B_b2))
    return x + s * g
```

```asm
; @launch grid=(256,1,1) block=(256,1,1) lds=163840
.amdgcn_target "amdgcn-amd-amdhsa--gfx950"
.text
.globl recurrent_scan__ssm_conv_s5__dense_activation_gelu__prompt_kernel
.p2align 8
.type recurrent_scan__ssm_conv_s5__dense_activation_gelu__prompt_kernel,@function
recurrent_scan__ssm_conv_s5__dense_activation_gelu__prompt_kernel:
 s_load_dwordx2 s[16:17], s[0:1], 0
 s_cmp_ge_u32 s2, 256
 s_cbranch_scc1 kab_end
 s_getpc_b64 s[36:37]
 s_lshr_b32 s70, s2, 3
 s_lshl_b32 s70, s70, 12
 v_lshl_add_u32 v1, v0, 4, s70
 v_min_u32 v1, kab_end-recurrent_scan__ssm_conv_s5__dense_activation_gelu__prompt_kernel-256, v1
 global_load_dword v250, v1, s[36:37]
 s_load_dwordx8 s[72:79], s[0:1], 80
 s_load_dwordx16 s[52:67], s[0:1], 8
 s_load_dwordx2 s[4:5], s[0:1], 128
 s_load_dwordx4 s[20:23], s[0:1], 112
 v_lshrrev_b32 v1, 6, v0
 v_and_b32 v0, 63, v0
 v_readfirstlane_b32 s24, v1
 s_mov_b32 s18, 0x240000
 s_mov_b32 s19, 0x20000
 s_and_b32 s70, s2, 1
 s_lshl_b32 s70, s70, 3
 s_bfe_u32 s71, s2, 0x30003
 s_add_u32 s25, s70, s71
 s_lshr_b32 s27, s2, 6
 s_lshl_b32 s80, s25, 2
 s_add_u32 s80, s80, s24
 s_mul_i32 s38, s80, 36864
 v_lshrrev_b32 v24, 3, v0
 v_and_b32 v25, 7, v0
 v_lshrrev_b32 v27, 5, v0
 v_and_b32 v28, 3, v24
 v_lshl_add_u32 v28, v27, 4, v28
 v_mul_u32_u24 v28, 1152, v28
 v_lshrrev_b32 v26, 4, v0
 v_xor_b32 v27, v25, v26
 v_lshl_add_u32 v242, v27, 4, v28
 s_mul_i32 s32, s24, 24576
 s_lshl_b32 s49, s27, 1
 s_add_u32 s49, s49, s71
 s_sub_u32 s29, s49, 9
 s_min_u32 s49, s49, s29
 s_lshl_b32 s49, s49, 7
 s_add_u32 s29, s49, s38
 v_xor_b32 v27, 64, v242
 v_add_u32 v243, 3584, v27
 v_add_u32 v244, 7168, v242
 v_add_u32 v245, 10752, v27
 s_add_u32 s30, s38, 1152
 s_add_u32 m0, s32, 0x10000
 s_waitcnt lgkmcnt(0)
 buffer_load_dwordx4 v242, s[16:19], s29 offen offset:0 lds
 buffer_load_dwordx4 v243, s[16:19], s29 offen offset:1024 lds
 buffer_load_dwordx4 v244, s[16:19], s29 offen offset:2048 lds
 buffer_load_dwordx4 v245, s[16:19], s29 offen offset:3072 lds
 s_add_u32 s29, s29, 128
 s_cmp_eq_u32 s29, s30
 s_cselect_b32 s29, s38, s29
 s_add_u32 m0, s32, 0x11000
 s_nop 0
 buffer_load_dwordx4 v242, s[16:19], s29 offen offset:0 lds
 buffer_load_dwordx4 v243, s[16:19], s29 offen offset:1024 lds
 buffer_load_dwordx4 v244, s[16:19], s29 offen offset:2048 lds
 buffer_load_dwordx4 v245, s[16:19], s29 offen offset:3072 lds
 s_mov_b32 s6, 0x10000000
 s_mov_b32 s7, 0x20000
 s_mov_b32 s11, 0x20000
 s_mov_b32 s15, 0x20000
 s_mov_b64 s[34:35], s[22:23]
 s_bfe_u32 s26, s2, 0x20001
 s_lshl_b32 s28, s24, 11
 v_lshlrev_b32 v1, 4, v0
 s_cmp_eq_u32 s27, 3
 s_cbranch_scc1 kab_s
 s_mul_i32 s39, s49, 4608
 s_mul_i32 s81, s26, 3
 s_add_u32 s81, s81, s27
 s_mov_b64 s[8:9], s[72:73]
 s_mov_b32 s10, 0x510000
 v_and_b32 v27, 1, v26
 v_lshlrev_b32 v27, 2, v27
 v_xor_b32 v27, v27, v25
 s_lshl_b32 s83, s24, 4
 v_add_u32 v28, s83, v24
 v_mul_u32_u24 v29, 9216, v28
 v_lshl_add_u32 v29, v27, 4, v29
 s_mul_i32 s83, s81, 768
 s_and_b32 s33, s25, 7
 s_sub_u32 s69, s33, 6
 s_min_u32 s33, s33, s69
 s_lshl_b32 s33, s33, 7
 v_add_u32 v29, s33, v29
 v_add_u32 v4, s83, v29
 v_add_u32 v5, 0x11c00, v4
 s_lshl_b32 s84, s24, 6
 v_add_u32 v41, s84, v0
 v_min_u32 v41, 191, v41
 v_lshl_add_u32 v29, v41, 2, s33
 v_subrev_u32 v30, 768, v29
 v_min_u32 v29, v29, v30
 v_add_u32 v29, s83, v29
 global_load_dword v62, v29, s[74:75]
 s_and_b32 s84, s84, 64
 v_add_u32 v42, s84, v0
 v_min_u32 v42, 95, v42
 s_mul_i32 s84, s27, 384
 v_lshl_add_u32 v29, v42, 2, s84
 s_cmp_lt_u32 s24, 2
 s_cselect_b64 s[36:37], s[78:79], s[66:67]
 global_load_dword v63, v29, s[36:37]
 s_mov_b64 s[12:13], s[76:77]
 s_mov_b32 s14, 0x510000
 v_min_u32 v43, 35, v0
 s_and_b32 s70, s80, 31
 s_mul_i32 s69, s81, 442368
 s_mul_i32 s70, s70, 13824
 s_add_u32 s69, s69, s70
 v_mul_u32_u24 v29, 43, v43
 v_lshrrev_b32 v29, 7, v29
 v_mul_u32_u24 v29, 768, v29
 v_lshl_add_u32 v43, v43, 7, s69
 v_add_u32 v43, v43, v29
 v_and_b32 v247, 31, v0
 s_add_u32 s69, s32, 0x10000
 v_lshl_add_u32 v247, v247, 7, s69
 v_bfe_u32 v246, v0, 1, 3
 v_lshrrev_b32 v248, 5, v0
 v_xor_b32 v246, v246, v248
 v_lshl_add_u32 v246, v246, 4, v247
 v_xor_b32 v247, 32, v246
 v_xor_b32 v248, 64, v246
 v_xor_b32 v249, 96, v246
 s_mov_b32 s31, 0x3f803f80
 s_mov_b32 s36, 0x3f80
 s_mov_b32 s37, 0x3f800000
 v_lshlrev_b32 v36, 3, v41
 s_lshr_b32 s69, s24, 1
 s_lshl_b32 s69, s69, 10
 v_lshl_add_u32 v37, v42, 3, s69
 v_mul_u32_u24 v29, 1152, v28
 v_lshl_add_u32 v6, v27, 4, v29
 v_lshrrev_b32 v24, 5, v0
 v_bfe_u32 v25, v0, 2, 2
 v_lshlrev_b32 v25, 7, v25
 v_bfe_u32 v27, v0, 4, 1
 v_lshl_add_u32 v25, v27, 5, v25
 v_and_b32 v27, 3, v0
 v_lshl_add_u32 v25, v27, 3, v25
 v_bfe_u32 v27, v0, 3, 1
 v_lshl_add_u32 v25, v27, 6, v25
 v_add_u32 v14, 0x2000, v25
 v_lshl_add_u32 v8, v24, 10, v14
 v_xor_b32 v9, 64, v8
 v_lshlrev_b32 v20, 4, v24
 v_add_u32 v10, 0x10000, v8
 v_add_u32 v11, 0x10000, v9
 v_add_u32 v12, 0x20000, v8
 v_add_u32 v13, 0x20000, v9
 s_mul_i32 s69, s26, 1327104
 s_add_u32 s70, s69, s84
 v_add_u32 v6, s70, v6
 v_add_u32 v7, 0x2000, v6
 s_mul_i32 s0, s27, 48
 s_lshr_b32 s1, s49, 3
 s_sub_u32 s1, s0, s1
 s_lshl3_add_u32 s0, s26, s1
 s_lshr_b32 s71, s26, 1
 s_lshl_b32 s71, s71, 7
 s_mov_b32 s70, s27
 s_mul_i32 s65, s70, 25088
 s_mul_i32 s49, s70, 442368
 s_add_u32 s51, s49, s71
 s_xor_b32 s50, s51, 128
 s_add_u32 s49, s49, 256
 s_add_u32 s70, s70, 1
 s_cmp_eq_u32 s70, 3
 s_cselect_b32 s70, 0, s70
 s_mul_i32 s63, s70, 25088
 s_mul_i32 s52, s70, 442368
 s_add_u32 s54, s52, s71
 s_xor_b32 s53, s54, 128
 s_add_u32 s52, s52, 256
 s_add_u32 s70, s70, 1
 s_cmp_eq_u32 s70, 3
 s_cselect_b32 s70, 0, s70
 s_mul_i32 s64, s70, 25088
 s_mul_i32 s55, s70, 442368
 s_add_u32 s57, s55, s71
 s_xor_b32 s56, s57, 128
 s_add_u32 s55, s55, 256
 s_add_u32 s40, s39, 589824
 s_cmp_eq_u32 s40, s10
 s_cselect_b32 s40, 0, s40
 s_add_u32 s41, s40, 589824
 s_cmp_eq_u32 s41, s10
 s_cselect_b32 s41, 0, s41
 s_add_u32 s42, s41, 589824
 s_cmp_eq_u32 s42, s10
 s_cselect_b32 s42, 0, s42
 s_add_u32 s43, s42, 589824
 s_cmp_eq_u32 s43, s10
 s_cselect_b32 s43, 0, s43
 s_add_u32 s44, s43, 589824
 s_cmp_eq_u32 s44, s10
 s_cselect_b32 s44, 0, s44
 s_add_u32 s45, s44, 589824
 s_cmp_eq_u32 s45, s10
 s_cselect_b32 s45, 0, s45
 s_add_u32 s46, s45, 589824
 s_cmp_eq_u32 s46, s10
 s_cselect_b32 s46, 0, s46
 s_add_u32 s47, s46, 589824
 s_cmp_eq_u32 s47, s10
 s_cselect_b32 s47, 0, s47
 s_mul_i32 s33, s33, 576
 s_add_u32 s73, s33, 73728
 s_cmp_eq_u32 s73, 442368
 s_cselect_b32 s73, 0, s73
 s_add_u32 s74, s73, 73728
 s_cmp_eq_u32 s74, 442368
 s_cselect_b32 s74, 0, s74
 s_add_u32 s75, s74, 73728
 s_cmp_eq_u32 s75, 442368
 s_cselect_b32 s75, 0, s75
 s_add_u32 s83, s75, 73728
 s_cmp_eq_u32 s83, 442368
 s_cselect_b32 s83, 0, s83
 s_add_u32 s85, s83, 73728
 s_cmp_eq_u32 s85, 442368
 s_cselect_b32 s85, 0, s85
 v_mov_b32 v22, 0xc09d30fc
 v_mov_b32 v23, 1
 v_mov_b32 v44, -1
 v_mov_b32 v45, -1
 v_mov_b32 v46, -1
 v_mov_b32 v47, -1
 s_and_b32 s70, s26, 1
 s_xor_b32 s70, s70, 1
 s_lshl_b32 s71, s70, 6
 v_lshl_add_u32 v14, v20, 5, v14
 v_xor_b32 v14, s71, v14
 v_xor_b32 v15, 64, v14
 v_add_u32 v16, 0x10000, v14
 v_add_u32 v17, 0x10000, v15
 v_add_u32 v18, 0x20000, v14
 v_add_u32 v19, 0x20000, v15
 s_mov_b64 s[76:77], s[4:5]
 s_mov_b32 s78, 0
 s_mov_b32 s79, 0x20000
 s_mul_i32 s71, s26, 2176
 s_mul_i32 s69, s70, 17408
 s_add_u32 s69, s69, s71
 s_add_u32 s58, s69, 69632
 s_mul_i32 s69, s70, 34816
 s_sub_u32 s69, s58, s69
 s_add_u32 s59, s69, 17408
 s_xor_b32 s69, s26, 3
 s_mul_i32 s69, s69, 17408
 s_add_u32 s60, s69, 0
 s_xor_b32 s69, s26, 2
 s_mul_i32 s69, s69, 17408
 s_add_u32 s61, s69, 2176
 s_xor_b32 s69, s26, 1
 s_mul_i32 s69, s69, 17408
 s_add_u32 s62, s69, 4352
 s_mul_i32 s69, s80, 313344
 s_mul_i32 s70, s27, 104448
 s_add_u32 s69, s69, s70
 s_add_u32 s82, s69, 0x800000
 v_add_u32 v32, s82, v1
 s_lshl_b32 s69, s80, 2
 s_add_u32 s69, s69, s26
 s_mul_i32 s69, s69, 75264
 s_add_u32 s69, s69, 0x1c00000
 v_add_u32 v33, s69, v1
 s_add_u32 s69, s69, 24576
 s_add_u32 s70, s69, s65
 v_and_b32 v24, 31, v0
 v_lshl_add_u32 v34, v24, 2, s70
 s_add_u32 s70, s69, s63
 s_sub_u32 s71, s64, s63
 v_and_b32 v24, 1, v0
 v_mul_lo_u32 v24, v24, s71
 v_add_u32 v35, s70, v24
 v_mov_b32 v40, 0
 s_lshl_b32 s69, s25, 4
 s_add_u32 s70, s69, s81
 v_mov_b32 v39, s70
 v_and_b32 v24, 3, v0
 v_lshl_add_u32 v61, v24, 2, s69
 v_bfe_u32 v24, v0, 2, 1
 v_lshlrev_b32 v24, 4, v24
 v_bfe_u32 v25, v0, 3, 2
 v_lshl_add_u32 v24, v25, 2, v24
 v_and_b32 v25, 3, v0
 v_add_u32 v24, v24, v25
 v_mul_u32_u24 v24, 1152, v24
 v_lshrrev_b32 v25, 5, v0
 v_lshl_add_u32 v24, v25, 3, v24
 s_mul_i32 s69, s80, 36864
 s_lshl_b32 s70, s26, 6
 s_add_u32 s69, s69, s70
 s_add_u32 s69, s69, s84
 v_add_u32 v41, s69, v24
 v_lshlrev_b32 v42, 1, v41
 s_mov_b32 s22, 0x480000
 s_mov_b32 s23, 0x20000
 s_lshr_b32 s69, s26, 1
 s_mul_i32 s69, s69, 96
 s_sub_u32 s66, 256, s69
 s_lshr_b32 s1, s66, 3
 s_add_u32 s1, s1, s0
 s_add_u32 s69, s0, 144
 s_min_u32 s0, s0, s69
 s_add_u32 s69, s1, 144
 s_min_u32 s1, s1, s69
 v_and_b32 v24, 15, v0
 v_bfe_u32 v25, v0, 2, 1
 v_bfe_u32 v26, v0, 3, 1
 v_xor_b32 v25, v25, v26
 v_mul_u32_u24 v25, 12, v25
 v_xor_b32 v24, v24, v25
 v_lshrrev_b32 v25, 1, v20
 v_xor_b32 v24, v24, v25
 v_and_b32 v25, 16, v0
 v_or_b32 v24, v24, v25
 v_and_b32 v25, 1, v0
 v_lshlrev_b32 v25, 4, v25
 v_mov_b32 v26, 0x3f80
 v_lshlrev_b32 v25, v25, v26
 v_lshrrev_b32 v24, 1, v24
 v_cmp_eq_u32 vcc, 0, v24
 s_nop 1
 v_cndmask_b32 v26, 0, v25, vcc
 v_accvgpr_write_b32 a180, v26
 v_cmp_eq_u32 vcc, 1, v24
 s_nop 1
 v_cndmask_b32 v27, 0, v25, vcc
 v_accvgpr_write_b32 a181, v27
 v_cmp_eq_u32 vcc, 2, v24
 s_nop 1
 v_cndmask_b32 v26, 0, v25, vcc
 v_accvgpr_write_b32 a182, v26
 v_cmp_eq_u32 vcc, 3, v24
 s_nop 1
 v_cndmask_b32 v27, 0, v25, vcc
 v_accvgpr_write_b32 a183, v27
 v_cmp_eq_u32 vcc, 8, v24
 s_nop 1
 v_cndmask_b32 v26, 0, v25, vcc
 v_accvgpr_write_b32 a184, v26
 v_cmp_eq_u32 vcc, 9, v24
 s_nop 1
 v_cndmask_b32 v27, 0, v25, vcc
 v_accvgpr_write_b32 a185, v27
 v_cmp_eq_u32 vcc, 10, v24
 s_nop 1
 v_cndmask_b32 v26, 0, v25, vcc
 v_accvgpr_write_b32 a186, v26
 v_cmp_eq_u32 vcc, 11, v24
 s_nop 1
 v_cndmask_b32 v27, 0, v25, vcc
 v_accvgpr_write_b32 a187, v27
 s_add_u32 s29, s29, 128
 s_cmp_eq_u32 s29, s30
 s_cselect_b32 s29, s38, s29
 s_add_u32 m0, s32, 0x12000
 s_nop 0
 buffer_load_dwordx4 v242, s[16:19], s29 offen offset:0 lds
 buffer_load_dwordx4 v243, s[16:19], s29 offen offset:1024 lds
 buffer_load_dwordx4 v244, s[16:19], s29 offen offset:2048 lds
 buffer_load_dwordx4 v245, s[16:19], s29 offen offset:3072 lds
 s_add_u32 s29, s29, 128
 s_cmp_eq_u32 s29, s30
 s_cselect_b32 s29, s38, s29
 s_add_u32 m0, s32, 0x13000
 s_nop 0
 buffer_load_dwordx4 v242, s[16:19], s29 offen offset:0 lds
 buffer_load_dwordx4 v243, s[16:19], s29 offen offset:1024 lds
 buffer_load_dwordx4 v244, s[16:19], s29 offen offset:2048 lds
 buffer_load_dwordx4 v245, s[16:19], s29 offen offset:3072 lds
 s_waitcnt vmcnt(14)
 ds_read_b128 v[96:99], v246 offset:0
 ds_read_b128 v[100:103], v247 offset:0
 ds_read_b128 v[104:107], v248 offset:0
 ds_read_b128 v[108:111], v249 offset:0
 s_add_u32 s29, s29, 128
 s_cmp_eq_u32 s29, s30
 s_cselect_b32 s29, s38, s29
 s_add_u32 m0, s32, 0x14000
 s_nop 0
 buffer_load_dwordx4 v242, s[16:19], s29 offen offset:0 lds
 buffer_load_dwordx4 v243, s[16:19], s29 offen offset:1024 lds
 buffer_load_dwordx4 v244, s[16:19], s29 offen offset:2048 lds
 buffer_load_dwordx4 v245, s[16:19], s29 offen offset:3072 lds
 s_waitcnt vmcnt(14)
 ds_read_b128 v[112:115], v246 offset:4096
 ds_read_b128 v[116:119], v247 offset:4096
 ds_read_b128 v[120:123], v248 offset:4096
 ds_read_b128 v[124:127], v249 offset:4096
 s_waitcnt lgkmcnt(7)
 v_dot2_f32_bf16 v250, s31, v96, 0
 v_dot2_f32_bf16 v252, v96, v96, 0
 v_dot2_f32_bf16 v251, s31, v97, 0
 v_dot2_f32_bf16 v253, v97, v97, 0
 v_dot2c_f32_bf16 v250, s31, v98
 v_dot2c_f32_bf16 v252, v98, v98
 s_add_u32 s29, s29, 128
 s_cmp_eq_u32 s29, s30
 s_cselect_b32 s29, s38, s29
 s_add_u32 m0, s32, 0x15000
 s_nop 0
 buffer_load_dwordx4 v242, s[16:19], s29 offen offset:0 lds
 v_dot2c_f32_bf16 v251, s31, v99
 v_dot2c_f32_bf16 v253, v99, v99
 s_waitcnt lgkmcnt(6)
 v_dot2c_f32_bf16 v250, s31, v100
 v_dot2c_f32_bf16 v252, v100, v100
 v_dot2c_f32_bf16 v251, s31, v101
 v_dot2c_f32_bf16 v253, v101, v101
 buffer_load_dwordx4 v243, s[16:19], s29 offen offset:1024 lds
 v_dot2c_f32_bf16 v250, s31, v102
 v_dot2c_f32_bf16 v252, v102, v102
 v_dot2c_f32_bf16 v251, s31, v103
 v_dot2c_f32_bf16 v253, v103, v103
 s_waitcnt lgkmcnt(5)
 v_dot2c_f32_bf16 v250, s31, v104
 v_dot2c_f32_bf16 v252, v104, v104
 buffer_load_dwordx4 v244, s[16:19], s29 offen offset:2048 lds
 v_dot2c_f32_bf16 v251, s31, v105
 v_dot2c_f32_bf16 v253, v105, v105
 v_dot2c_f32_bf16 v250, s31, v106
 v_dot2c_f32_bf16 v252, v106, v106
 v_dot2c_f32_bf16 v251, s31, v107
 v_dot2c_f32_bf16 v253, v107, v107
 buffer_load_dwordx4 v245, s[16:19], s29 offen offset:3072 lds
 s_waitcnt lgkmcnt(4)
 v_dot2c_f32_bf16 v250, s31, v108
 v_dot2c_f32_bf16 v252, v108, v108
 v_dot2c_f32_bf16 v251, s31, v109
 v_dot2c_f32_bf16 v253, v109, v109
 v_dot2c_f32_bf16 v250, s31, v110
 v_dot2c_f32_bf16 v252, v110, v110
 v_dot2c_f32_bf16 v251, s31, v111
 v_dot2c_f32_bf16 v253, v111, v111
 s_waitcnt vmcnt(12)
 ds_read_b128 v[128:131], v246 offset:8192
 ds_read_b128 v[132:135], v247 offset:8192
 ds_read_b128 v[136:139], v248 offset:8192
 ds_read_b128 v[140:143], v249 offset:8192
 s_waitcnt lgkmcnt(7)
 v_dot2c_f32_bf16 v250, s31, v112
 v_dot2c_f32_bf16 v252, v112, v112
 v_dot2c_f32_bf16 v251, s31, v113
 v_dot2c_f32_bf16 v253, v113, v113
 v_dot2c_f32_bf16 v250, s31, v114
 v_dot2c_f32_bf16 v252, v114, v114
 s_add_u32 s29, s29, 128
 s_cmp_eq_u32 s29, s30
 s_cselect_b32 s29, s38, s29
 s_add_u32 m0, s32, 0x10000
 s_nop 0
 buffer_load_dwordx4 v242, s[16:19], s29 offen offset:0 lds
 v_dot2c_f32_bf16 v251, s31, v115
 v_dot2c_f32_bf16 v253, v115, v115
 s_waitcnt lgkmcnt(6)
 v_dot2c_f32_bf16 v250, s31, v116
 v_dot2c_f32_bf16 v252, v116, v116
 v_dot2c_f32_bf16 v251, s31, v117
 v_dot2c_f32_bf16 v253, v117, v117
 buffer_load_dwordx4 v243, s[16:19], s29 offen offset:1024 lds
 v_dot2c_f32_bf16 v250, s31, v118
 v_dot2c_f32_bf16 v252, v118, v118
 v_dot2c_f32_bf16 v251, s31, v119
 v_dot2c_f32_bf16 v253, v119, v119
 s_waitcnt lgkmcnt(5)
 v_dot2c_f32_bf16 v250, s31, v120
 v_dot2c_f32_bf16 v252, v120, v120
 buffer_load_dwordx4 v244, s[16:19], s29 offen offset:2048 lds
 v_dot2c_f32_bf16 v251, s31, v121
 v_dot2c_f32_bf16 v253, v121, v121
 v_dot2c_f32_bf16 v250, s31, v122
 v_dot2c_f32_bf16 v252, v122, v122
 v_dot2c_f32_bf16 v251, s31, v123
 v_dot2c_f32_bf16 v253, v123, v123
 buffer_load_dwordx4 v245, s[16:19], s29 offen offset:3072 lds
 s_waitcnt lgkmcnt(4)
 v_dot2c_f32_bf16 v250, s31, v124
 v_dot2c_f32_bf16 v252, v124, v124
 v_dot2c_f32_bf16 v251, s31, v125
 v_dot2c_f32_bf16 v253, v125, v125
 v_dot2c_f32_bf16 v250, s31, v126
 v_dot2c_f32_bf16 v252, v126, v126
 v_dot2c_f32_bf16 v251, s31, v127
 v_dot2c_f32_bf16 v253, v127, v127
 s_waitcnt vmcnt(12)
 ds_read_b128 v[144:147], v246 offset:12288
 ds_read_b128 v[148:151], v247 offset:12288
 ds_read_b128 v[152:155], v248 offset:12288
 ds_read_b128 v[156:159], v249 offset:12288
 s_waitcnt lgkmcnt(7)
 v_dot2c_f32_bf16 v250, s31, v128
 v_dot2c_f32_bf16 v252, v128, v128
 v_dot2c_f32_bf16 v251, s31, v129
 v_dot2c_f32_bf16 v253, v129, v129
 v_dot2c_f32_bf16 v250, s31, v130
 v_dot2c_f32_bf16 v252, v130, v130
 s_add_u32 s29, s29, 128
 s_cmp_eq_u32 s29, s30
 s_cselect_b32 s29, s38, s29
 s_add_u32 m0, s32, 0x11000
 s_nop 0
 buffer_load_dwordx4 v242, s[16:19], s29 offen offset:0 lds
 v_dot2c_f32_bf16 v251, s31, v131
 v_dot2c_f32_bf16 v253, v131, v131
 s_waitcnt lgkmcnt(6)
 v_dot2c_f32_bf16 v250, s31, v132
 v_dot2c_f32_bf16 v252, v132, v132
 v_dot2c_f32_bf16 v251, s31, v133
 v_dot2c_f32_bf16 v253, v133, v133
 buffer_load_dwordx4 v243, s[16:19], s29 offen offset:1024 lds
 v_dot2c_f32_bf16 v250, s31, v134
 v_dot2c_f32_bf16 v252, v134, v134
 v_dot2c_f32_bf16 v251, s31, v135
 v_dot2c_f32_bf16 v253, v135, v135
 s_waitcnt lgkmcnt(5)
 v_dot2c_f32_bf16 v250, s31, v136
 v_dot2c_f32_bf16 v252, v136, v136
 buffer_load_dwordx4 v244, s[16:19], s29 offen offset:2048 lds
 v_dot2c_f32_bf16 v251, s31, v137
 v_dot2c_f32_bf16 v253, v137, v137
 v_dot2c_f32_bf16 v250, s31, v138
 v_dot2c_f32_bf16 v252, v138, v138
 v_dot2c_f32_bf16 v251, s31, v139
 v_dot2c_f32_bf16 v253, v139, v139
 buffer_load_dwordx4 v245, s[16:19], s29 offen offset:3072 lds
 s_waitcnt lgkmcnt(4)
 v_dot2c_f32_bf16 v250, s31, v140
 v_dot2c_f32_bf16 v252, v140, v140
 v_dot2c_f32_bf16 v251, s31, v141
 v_dot2c_f32_bf16 v253, v141, v141
 v_dot2c_f32_bf16 v250, s31, v142
 v_dot2c_f32_bf16 v252, v142, v142
 v_dot2c_f32_bf16 v251, s31, v143
 v_dot2c_f32_bf16 v253, v143, v143
 s_waitcnt vmcnt(12)
 ds_read_b128 v[160:163], v246 offset:16384
 ds_read_b128 v[164:167], v247 offset:16384
 ds_read_b128 v[168:171], v248 offset:16384
 ds_read_b128 v[172:175], v249 offset:16384
 s_waitcnt lgkmcnt(7)
 v_dot2c_f32_bf16 v250, s31, v144
 v_dot2c_f32_bf16 v252, v144, v144
 v_dot2c_f32_bf16 v251, s31, v145
 v_dot2c_f32_bf16 v253, v145, v145
 v_dot2c_f32_bf16 v250, s31, v146
 v_dot2c_f32_bf16 v252, v146, v146
 s_add_u32 s29, s29, 128
 s_cmp_eq_u32 s29, s30
 s_cselect_b32 s29, s38, s29
 s_add_u32 m0, s32, 0x12000
 s_nop 0
 buffer_load_dwordx4 v242, s[16:19], s29 offen offset:0 lds
 v_dot2c_f32_bf16 v251, s31, v147
 v_dot2c_f32_bf16 v253, v147, v147
 s_waitcnt lgkmcnt(6)
 v_dot2c_f32_bf16 v250, s31, v148
 v_dot2c_f32_bf16 v252, v148, v148
 v_dot2c_f32_bf16 v251, s31, v149
 v_dot2c_f32_bf16 v253, v149, v149
 buffer_load_dwordx4 v243, s[16:19], s29 offen offset:1024 lds
 v_dot2c_f32_bf16 v250, s31, v150
 v_dot2c_f32_bf16 v252, v150, v150
 v_dot2c_f32_bf16 v251, s31, v151
 v_dot2c_f32_bf16 v253, v151, v151
 s_waitcnt lgkmcnt(5)
 v_dot2c_f32_bf16 v250, s31, v152
 v_dot2c_f32_bf16 v252, v152, v152
 buffer_load_dwordx4 v244, s[16:19], s29 offen offset:2048 lds
 v_dot2c_f32_bf16 v251, s31, v153
 v_dot2c_f32_bf16 v253, v153, v153
 v_dot2c_f32_bf16 v250, s31, v154
 v_dot2c_f32_bf16 v252, v154, v154
 v_dot2c_f32_bf16 v251, s31, v155
 v_dot2c_f32_bf16 v253, v155, v155
 buffer_load_dwordx4 v245, s[16:19], s29 offen offset:3072 lds
 s_waitcnt lgkmcnt(4)
 v_dot2c_f32_bf16 v250, s31, v156
 v_dot2c_f32_bf16 v252, v156, v156
 v_dot2c_f32_bf16 v251, s31, v157
 v_dot2c_f32_bf16 v253, v157, v157
 v_dot2c_f32_bf16 v250, s31, v158
 v_dot2c_f32_bf16 v252, v158, v158
 v_dot2c_f32_bf16 v251, s31, v159
 v_dot2c_f32_bf16 v253, v159, v159
 v_lshlrev_b32 v24, 16, v62
 v_and_b32 v25, 0xffff0000, v62
 v_lshlrev_b32 v26, 16, v63
 v_and_b32 v27, 0xffff0000, v63
 v_mul_f32 v24, 0x3eeff558, v24
 v_mul_f32 v25, 0x3eeff558, v25
 ds_write_b64 v36, v[24:25]
 ds_write_b64 v37, v[26:27] offset:2048
 s_mul_i32 s71, s26, 17408
 s_add_u32 s69, s82, s71
 v_add_u32 v36, s69, v1
 v_and_b32 v24, 3, v0
 v_mul_u32_u24 v24, 2176, v24
 v_add_u32 v38, s69, v24
 s_andn2_b32 s70, s26, 1
 s_sub_u32 s70, 4, s70
 s_mul_i32 s70, s70, 17408
 v_bfe_u32 v24, v0, 2, 1
 v_mad_u32_u24 v38, v24, s70, v38
 s_lshr_b32 s71, s26, 1
 s_lshl_b32 s71, s71, 10
 s_add_u32 s70, s70, s71
 v_add_u32 v37, s70, v36
 v_and_b32 v24, 31, v0
 v_lshl_add_u32 v24, v24, 2, s82
 v_lshrrev_b32 v25, 5, v0
 s_sub_u32 s69, s59, s58
 v_mul_lo_u32 v62, v25, s69
 v_add_u32 v62, v62, v24
 s_sub_u32 s69, s61, s60
 v_mul_lo_u32 v63, v25, s69
 v_add_u32 v63, v63, v24
 v_lshrrev_b32 v24, 3, v0
 v_mov_b32 v25, s58
 v_mov_b32 v26, s59
 v_cmp_eq_u32 vcc, 5, v24
 s_nop 1
 v_cndmask_b32 v25, v25, v26, vcc
 v_mov_b32 v26, s60
 v_cmp_eq_u32 vcc, 6, v24
 s_nop 1
 v_cndmask_b32 v25, v25, v26, vcc
 v_mov_b32 v26, s61
 v_cmp_eq_u32 vcc, 7, v24
 s_nop 1
 v_cndmask_b32 v25, v25, v26, vcc
 v_and_b32 v26, 0x70, v1
 s_add_u32 s69, s82, 2048
 v_add3_u32 v25, v25, v26, s69
 v_mad_u32_u24 v26, v0, 12, v34
 v_cmp_gt_u32 vcc, 32, v0
 s_nop 1
 v_cndmask_b32 v60, v25, v26, vcc
 s_waitcnt vmcnt(12)
 ds_read_b128 v[176:179], v246 offset:20480
 ds_read_b128 v[180:183], v247 offset:20480
 ds_read_b128 v[184:187], v248 offset:20480
 ds_read_b128 v[188:191], v249 offset:20480
 s_waitcnt lgkmcnt(9)
 v_dot2c_f32_bf16 v250, s31, v160
 v_dot2c_f32_bf16 v252, v160, v160
 v_dot2c_f32_bf16 v251, s31, v161
 v_dot2c_f32_bf16 v253, v161, v161
 v_dot2c_f32_bf16 v250, s31, v162
 v_dot2c_f32_bf16 v252, v162, v162
 v_dot2c_f32_bf16 v251, s31, v163
 v_dot2c_f32_bf16 v253, v163, v163
 s_waitcnt lgkmcnt(8)
 v_dot2c_f32_bf16 v250, s31, v164
 v_dot2c_f32_bf16 v252, v164, v164
 v_dot2c_f32_bf16 v251, s31, v165
 v_dot2c_f32_bf16 v253, v165, v165
 v_dot2c_f32_bf16 v250, s31, v166
 v_dot2c_f32_bf16 v252, v166, v166
 v_dot2c_f32_bf16 v251, s31, v167
 v_dot2c_f32_bf16 v253, v167, v167
 s_waitcnt lgkmcnt(7)
 v_dot2c_f32_bf16 v250, s31, v168
 v_dot2c_f32_bf16 v252, v168, v168
 v_dot2c_f32_bf16 v251, s31, v169
 v_dot2c_f32_bf16 v253, v169, v169
 v_dot2c_f32_bf16 v250, s31, v170
 v_dot2c_f32_bf16 v252, v170, v170
 v_dot2c_f32_bf16 v251, s31, v171
 v_dot2c_f32_bf16 v253, v171, v171
 s_waitcnt lgkmcnt(6)
 v_dot2c_f32_bf16 v250, s31, v172
 v_dot2c_f32_bf16 v252, v172, v172
 v_dot2c_f32_bf16 v251, s31, v173
 v_dot2c_f32_bf16 v253, v173, v173
 v_dot2c_f32_bf16 v250, s31, v174
 v_dot2c_f32_bf16 v252, v174, v174
 v_dot2c_f32_bf16 v251, s31, v175
 v_dot2c_f32_bf16 v253, v175, v175
 s_waitcnt vmcnt(8)
 ds_read_b128 v[192:195], v246 offset:0
 ds_read_b128 v[196:199], v247 offset:0
 ds_read_b128 v[200:203], v248 offset:0
 ds_read_b128 v[204:207], v249 offset:0
 s_waitcnt lgkmcnt(7)
 v_dot2c_f32_bf16 v250, s31, v176
 v_dot2c_f32_bf16 v252, v176, v176
 v_dot2c_f32_bf16 v251, s31, v177
 v_dot2c_f32_bf16 v253, v177, v177
 v_dot2c_f32_bf16 v250, s31, v178
 v_dot2c_f32_bf16 v252, v178, v178
 v_dot2c_f32_bf16 v251, s31, v179
 v_dot2c_f32_bf16 v253, v179, v179
 s_waitcnt lgkmcnt(6)
 v_dot2c_f32_bf16 v250, s31, v180
 v_dot2c_f32_bf16 v252, v180, v180
 s_add_u32 m0, s28, 0x2000
 s_nop 0
 buffer_load_dwordx4 v4, s[8:11], s39 offen offset:0 lds
 v_dot2c_f32_bf16 v251, s31, v181
 v_dot2c_f32_bf16 v253, v181, v181
 v_dot2c_f32_bf16 v250, s31, v182
 v_dot2c_f32_bf16 v252, v182, v182
 v_dot2c_f32_bf16 v251, s31, v183
 v_dot2c_f32_bf16 v253, v183, v183
 s_waitcnt lgkmcnt(5)
 v_dot2c_f32_bf16 v250, s31, v184
 v_dot2c_f32_bf16 v252, v184, v184
 v_dot2c_f32_bf16 v251, s31, v185
 v_dot2c_f32_bf16 v253, v185, v185
 s_add_u32 m0, s28, 0x2000
 s_nop 0
 buffer_load_dwordx4 v5, s[8:11], s39 offen offset:1024 lds
 v_dot2c_f32_bf16 v250, s31, v186
 v_dot2c_f32_bf16 v252, v186, v186
 v_dot2c_f32_bf16 v251, s31, v187
 v_dot2c_f32_bf16 v253, v187, v187
 s_waitcnt lgkmcnt(4)
 v_dot2c_f32_bf16 v250, s31, v188
 v_dot2c_f32_bf16 v252, v188, v188
 v_dot2c_f32_bf16 v251, s31, v189
 v_dot2c_f32_bf16 v253, v189, v189
 v_dot2c_f32_bf16 v250, s31, v190
 v_dot2c_f32_bf16 v252, v190, v190
 v_dot2c_f32_bf16 v251, s31, v191
 v_dot2c_f32_bf16 v253, v191, v191
 s_waitcnt vmcnt(6)
 ds_read_b128 v[208:211], v246 offset:4096
 ds_read_b128 v[212:215], v247 offset:4096
 ds_read_b128 v[216:219], v248 offset:4096
 ds_read_b128 v[220:223], v249 offset:4096
 s_waitcnt lgkmcnt(7)
 v_dot2c_f32_bf16 v250, s31, v192
 v_dot2c_f32_bf16 v252, v192, v192
 v_dot2c_f32_bf16 v251, s31, v193
 v_dot2c_f32_bf16 v253, v193, v193
 v_dot2c_f32_bf16 v250, s31, v194
 v_dot2c_f32_bf16 v252, v194, v194
 v_dot2c_f32_bf16 v251, s31, v195
 v_dot2c_f32_bf16 v253, v195, v195
 s_waitcnt lgkmcnt(6)
 v_dot2c_f32_bf16 v250, s31, v196
 v_dot2c_f32_bf16 v252, v196, v196
 s_add_u32 m0, s28, 0x4000
 s_nop 0
 buffer_load_dwordx4 v4, s[8:11], s40 offen offset:0 lds
 v_dot2c_f32_bf16 v251, s31, v197
 v_dot2c_f32_bf16 v253, v197, v197
 v_dot2c_f32_bf16 v250, s31, v198
 v_dot2c_f32_bf16 v252, v198, v198
 v_dot2c_f32_bf16 v251, s31, v199
 v_dot2c_f32_bf16 v253, v199, v199
 s_waitcnt lgkmcnt(5)
 v_dot2c_f32_bf16 v250, s31, v200
 v_dot2c_f32_bf16 v252, v200, v200
 v_dot2c_f32_bf16 v251, s31, v201
 v_dot2c_f32_bf16 v253, v201, v201
 s_add_u32 m0, s28, 0x4000
 s_nop 0
 buffer_load_dwordx4 v5, s[8:11], s40 offen offset:1024 lds
 v_dot2c_f32_bf16 v250, s31, v202
 v_dot2c_f32_bf16 v252, v202, v202
 v_dot2c_f32_bf16 v251, s31, v203
 v_dot2c_f32_bf16 v253, v203, v203
 s_waitcnt lgkmcnt(4)
 v_dot2c_f32_bf16 v250, s31, v204
 v_dot2c_f32_bf16 v252, v204, v204
 v_dot2c_f32_bf16 v251, s31, v205
 v_dot2c_f32_bf16 v253, v205, v205
 v_dot2c_f32_bf16 v250, s31, v206
 v_dot2c_f32_bf16 v252, v206, v206
 v_dot2c_f32_bf16 v251, s31, v207
 v_dot2c_f32_bf16 v253, v207, v207
 s_waitcnt vmcnt(4)
 ds_read_b128 v[224:227], v246 offset:8192
 ds_read_b128 v[228:231], v247 offset:8192
 ds_read_b128 v[232:235], v248 offset:8192
 ds_read_b128 v[236:239], v249 offset:8192
 s_waitcnt lgkmcnt(7)
 v_dot2c_f32_bf16 v250, s31, v208
 v_dot2c_f32_bf16 v252, v208, v208
 v_dot2c_f32_bf16 v251, s31, v209
 v_dot2c_f32_bf16 v253, v209, v209
 v_dot2c_f32_bf16 v250, s31, v210
 v_dot2c_f32_bf16 v252, v210, v210
 v_dot2c_f32_bf16 v251, s31, v211
 v_dot2c_f32_bf16 v253, v211, v211
 s_waitcnt lgkmcnt(6)
 v_dot2c_f32_bf16 v250, s31, v212
 v_dot2c_f32_bf16 v252, v212, v212
 s_add_u32 m0, s28, 0x6000
 s_nop 0
 buffer_load_dwordx4 v4, s[8:11], s41 offen offset:0 lds
 v_dot2c_f32_bf16 v251, s31, v213
 v_dot2c_f32_bf16 v253, v213, v213
 v_dot2c_f32_bf16 v250, s31, v214
 v_dot2c_f32_bf16 v252, v214, v214
 v_dot2c_f32_bf16 v251, s31, v215
 v_dot2c_f32_bf16 v253, v215, v215
 s_waitcnt lgkmcnt(5)
 v_dot2c_f32_bf16 v250, s31, v216
 v_dot2c_f32_bf16 v252, v216, v216
 v_dot2c_f32_bf16 v251, s31, v217
 v_dot2c_f32_bf16 v253, v217, v217
 s_add_u32 m0, s28, 0x6000
 s_nop 0
 buffer_load_dwordx4 v5, s[8:11], s41 offen offset:1024 lds
 v_dot2c_f32_bf16 v250, s31, v218
 v_dot2c_f32_bf16 v252, v218, v218
 v_dot2c_f32_bf16 v251, s31, v219
 v_dot2c_f32_bf16 v253, v219, v219
 s_waitcnt lgkmcnt(4)
 v_dot2c_f32_bf16 v250, s31, v220
 v_dot2c_f32_bf16 v252, v220, v220
 v_dot2c_f32_bf16 v251, s31, v221
 v_dot2c_f32_bf16 v253, v221, v221
 v_dot2c_f32_bf16 v250, s31, v222
 v_dot2c_f32_bf16 v252, v222, v222
 v_dot2c_f32_bf16 v251, s31, v223
 v_dot2c_f32_bf16 v253, v223, v223
 s_waitcnt lgkmcnt(3)
 v_dot2c_f32_bf16 v250, s31, v224
 v_dot2c_f32_bf16 v251, s31, v225
 v_dot2c_f32_bf16 v250, s31, v226
 v_dot2c_f32_bf16 v251, s31, v227
 s_waitcnt lgkmcnt(2)
 v_dot2c_f32_bf16 v250, s31, v228
 v_dot2c_f32_bf16 v251, s31, v229
 v_dot2c_f32_bf16 v250, s31, v230
 v_dot2c_f32_bf16 v251, s31, v231
 s_waitcnt lgkmcnt(1)
 v_dot2c_f32_bf16 v250, s31, v232
 v_dot2c_f32_bf16 v251, s31, v233
 v_dot2c_f32_bf16 v250, s31, v234
 v_dot2c_f32_bf16 v251, s31, v235
 s_waitcnt lgkmcnt(0)
 v_dot2c_f32_bf16 v250, s31, v236
 v_dot2c_f32_bf16 v251, s31, v237
 v_dot2c_f32_bf16 v250, s31, v238
 v_dot2c_f32_bf16 v251, s31, v239
 v_dot2c_f32_bf16 v252, v224, v224
 v_dot2c_f32_bf16 v253, v225, v225
 v_dot2c_f32_bf16 v252, v226, v226
 v_add_f32 v250, v250, v251
 v_dot2c_f32_bf16 v253, v227, v227
 v_dot2c_f32_bf16 v252, v228, v228
 v_mov_b32 v251, v250
 v_dot2c_f32_bf16 v253, v229, v229
 v_dot2c_f32_bf16 v252, v230, v230
 v_permlane32_swap_b32 v250, v251
 v_dot2c_f32_bf16 v253, v231, v231
 v_dot2c_f32_bf16 v252, v232, v232
 v_add_f32 v250, v250, v251
 v_dot2c_f32_bf16 v253, v233, v233
 v_dot2c_f32_bf16 v252, v234, v234
 v_mul_f32 v250, 0xbae38e39, v250
 v_dot2c_f32_bf16 v253, v235, v235
 v_dot2c_f32_bf16 v252, v236, v236
 v_cvt_pk_bf16_f32 v3, 0, v250
 v_dot2c_f32_bf16 v253, v237, v237
 v_dot2c_f32_bf16 v252, v238, v238
 v_dot2c_f32_bf16 v253, v239, v239
 s_set_gpr_idx_on s0, gpr_idx(SRC0)
 v_mov_b32 v48, v96
 v_mov_b32 v49, v97
 v_mov_b32 v50, v98
 v_mov_b32 v51, v99
 v_mov_b32 v52, v100
 v_mov_b32 v53, v101
 v_mov_b32 v54, v102
 v_mov_b32 v55, v103
 s_set_gpr_idx_idx s1
 v_mov_b32 v56, v96
 v_mov_b32 v57, v97
 v_mov_b32 v58, v98
 v_mov_b32 v59, v99
 s_set_gpr_idx_off
 v_add_f32 v252, v252, v253
 v_mov_b32 v253, v252
 s_nop 1
 v_permlane32_swap_b32 v252, v253
 v_add_f32 v252, v252, v253
 v_mul_f32 v252, 0x3ae38e39, v252
 v_fma_f32 v252, -v250, v250, v252
 v_max_f32 v252, 0, v252
 v_cvt_pk_bf16_f32 v252, 0, v252
 v_add_f32 v252, 0x3727c5ac, v252
 v_cvt_pk_bf16_f32 v252, 0, v252
 v_sqrt_f32 v252, v252
 s_nop 0
 v_cvt_pk_bf16_f32 v252, 0, v252
 v_rcp_f32 v2, v252
 s_nop 0
 v_mul_f32 v21, 0x3eeff558, v2
 v_cvt_pk_bf16_f32 v253, v21, 0
 v_cvt_pk_bf16_f32 v21, 0, v21
 v_mul_f32 v252, v21, v3
 v_mul_f32 v3, v3, v2
 v_dot2_f32_bf16 v24, v96, v253, v252
 v_dot2_f32_bf16 v25, v96, v21, v252
 v_dot2_f32_bf16 v26, v97, v253, v252
 v_dot2_f32_bf16 v27, v97, v21, v252
 v_dot2_f32_bf16 v28, v98, v253, v252
 v_dot2_f32_bf16 v29, v98, v21, v252
 v_dot2_f32_bf16 v30, v99, v253, v252
 v_dot2_f32_bf16 v31, v99, v21, v252
 v_cvt_pk_bf16_f32 v96, v24, v25
 v_cvt_pk_bf16_f32 v97, v26, v27
 v_cvt_pk_bf16_f32 v98, v28, v29
 v_cvt_pk_bf16_f32 v99, v30, v31
 v_dot2_f32_bf16 v24, v100, v253, v252
 v_dot2_f32_bf16 v25, v100, v21, v252
 v_dot2_f32_bf16 v26, v101, v253, v252
 v_dot2_f32_bf16 v27, v101, v21, v252
 v_dot2_f32_bf16 v28, v102, v253, v252
 v_dot2_f32_bf16 v29, v102, v21, v252
 v_dot2_f32_bf16 v30, v103, v253, v252
 v_dot2_f32_bf16 v31, v103, v21, v252
 v_cvt_pk_bf16_f32 v100, v24, v25
 v_cvt_pk_bf16_f32 v101, v26, v27
 v_cvt_pk_bf16_f32 v102, v28, v29
 v_cvt_pk_bf16_f32 v103, v30, v31
 s_add_u32 m0, s28, 0x8000
 s_nop 0
 buffer_load_dwordx4 v4, s[8:11], s42 offen offset:0 lds
 v_dot2_f32_bf16 v24, v104, v253, v252
 v_dot2_f32_bf16 v25, v104, v21, v252
 v_dot2_f32_bf16 v26, v105, v253, v252
 v_dot2_f32_bf16 v27, v105, v21, v252
 v_dot2_f32_bf16 v28, v106, v253, v252
 v_dot2_f32_bf16 v29, v106, v21, v252
 v_dot2_f32_bf16 v30, v107, v253, v252
 v_dot2_f32_bf16 v31, v107, v21, v252
 v_cvt_pk_bf16_f32 v104, v24, v25
 v_cvt_pk_bf16_f32 v105, v26, v27
 v_cvt_pk_bf16_f32 v106, v28, v29
 v_cvt_pk_bf16_f32 v107, v30, v31
 v_dot2_f32_bf16 v24, v108, v253, v252
 v_dot2_f32_bf16 v25, v108, v21, v252
 v_dot2_f32_bf16 v26, v109, v253, v252
 v_dot2_f32_bf16 v27, v109, v21, v252
 v_dot2_f32_bf16 v28, v110, v253, v252
 v_dot2_f32_bf16 v29, v110, v21, v252
 v_dot2_f32_bf16 v30, v111, v253, v252
 v_dot2_f32_bf16 v31, v111, v21, v252
 v_cvt_pk_bf16_f32 v108, v24, v25
 v_cvt_pk_bf16_f32 v109, v26, v27
 v_cvt_pk_bf16_f32 v110, v28, v29
 v_cvt_pk_bf16_f32 v111, v30, v31
 v_dot2_f32_bf16 v24, v112, v253, v252
 v_dot2_f32_bf16 v25, v112, v21, v252
 v_dot2_f32_bf16 v26, v113, v253, v252
 v_dot2_f32_bf16 v27, v113, v21, v252
 v_dot2_f32_bf16 v28, v114, v253, v252
 v_dot2_f32_bf16 v29, v114, v21, v252
 v_dot2_f32_bf16 v30, v115, v253, v252
 v_dot2_f32_bf16 v31, v115, v21, v252
 v_cvt_pk_bf16_f32 v112, v24, v25
 v_cvt_pk_bf16_f32 v113, v26, v27
 v_cvt_pk_bf16_f32 v114, v28, v29
 v_cvt_pk_bf16_f32 v115, v30, v31
 v_dot2_f32_bf16 v24, v116, v253, v252
 v_dot2_f32_bf16 v25, v116, v21, v252
 v_dot2_f32_bf16 v26, v117, v253, v252
 v_dot2_f32_bf16 v27, v117, v21, v252
 v_dot2_f32_bf16 v28, v118, v253, v252
 v_dot2_f32_bf16 v29, v118, v21, v252
 s_add_u32 m0, s28, 0x8000
 s_nop 0
 buffer_load_dwordx4 v5, s[8:11], s42 offen offset:1024 lds
 v_dot2_f32_bf16 v30, v119, v253, v252
 v_dot2_f32_bf16 v31, v119, v21, v252
 v_cvt_pk_bf16_f32 v116, v24, v25
 v_cvt_pk_bf16_f32 v117, v26, v27
 v_cvt_pk_bf16_f32 v118, v28, v29
 v_cvt_pk_bf16_f32 v119, v30, v31
 v_dot2_f32_bf16 v24, v120, v253, v252
 v_dot2_f32_bf16 v25, v120, v21, v252
 v_dot2_f32_bf16 v26, v121, v253, v252
 v_dot2_f32_bf16 v27, v121, v21, v252
 v_dot2_f32_bf16 v28, v122, v253, v252
 v_dot2_f32_bf16 v29, v122, v21, v252
 v_dot2_f32_bf16 v30, v123, v253, v252
 v_dot2_f32_bf16 v31, v123, v21, v252
 v_cvt_pk_bf16_f32 v120, v24, v25
 v_cvt_pk_bf16_f32 v121, v26, v27
 v_cvt_pk_bf16_f32 v122, v28, v29
 v_cvt_pk_bf16_f32 v123, v30, v31
 v_dot2_f32_bf16 v24, v124, v253, v252
 v_dot2_f32_bf16 v25, v124, v21, v252
 v_dot2_f32_bf16 v26, v125, v253, v252
 v_dot2_f32_bf16 v27, v125, v21, v252
 v_dot2_f32_bf16 v28, v126, v253, v252
 v_dot2_f32_bf16 v29, v126, v21, v252
 v_dot2_f32_bf16 v30, v127, v253, v252
 v_dot2_f32_bf16 v31, v127, v21, v252
 v_cvt_pk_bf16_f32 v124, v24, v25
 v_cvt_pk_bf16_f32 v125, v26, v27
 v_cvt_pk_bf16_f32 v126, v28, v29
 v_cvt_pk_bf16_f32 v127, v30, v31
 v_dot2_f32_bf16 v24, v128, v253, v252
 v_dot2_f32_bf16 v25, v128, v21, v252
 v_dot2_f32_bf16 v26, v129, v253, v252
 v_dot2_f32_bf16 v27, v129, v21, v252
 v_dot2_f32_bf16 v28, v130, v253, v252
 v_dot2_f32_bf16 v29, v130, v21, v252
 v_dot2_f32_bf16 v30, v131, v253, v252
 v_dot2_f32_bf16 v31, v131, v21, v252
 v_cvt_pk_bf16_f32 v128, v24, v25
 v_cvt_pk_bf16_f32 v129, v26, v27
 v_cvt_pk_bf16_f32 v130, v28, v29
 v_cvt_pk_bf16_f32 v131, v30, v31
 s_add_u32 m0, s28, 0xa000
 s_nop 0
 buffer_load_dwordx4 v4, s[8:11], s43 offen offset:0 lds
 v_dot2_f32_bf16 v24, v132, v253, v252
 v_dot2_f32_bf16 v25, v132, v21, v252
 v_dot2_f32_bf16 v26, v133, v253, v252
 v_dot2_f32_bf16 v27, v133, v21, v252
 v_dot2_f32_bf16 v28, v134, v253, v252
 v_dot2_f32_bf16 v29, v134, v21, v252
 v_dot2_f32_bf16 v30, v135, v253, v252
 v_dot2_f32_bf16 v31, v135, v21, v252
 v_cvt_pk_bf16_f32 v132, v24, v25
 v_cvt_pk_bf16_f32 v133, v26, v27
 v_cvt_pk_bf16_f32 v134, v28, v29
 v_cvt_pk_bf16_f32 v135, v30, v31
 v_dot2_f32_bf16 v24, v136, v253, v252
 v_dot2_f32_bf16 v25, v136, v21, v252
 v_dot2_f32_bf16 v26, v137, v253, v252
 v_dot2_f32_bf16 v27, v137, v21, v252
 v_dot2_f32_bf16 v28, v138, v253, v252
 v_dot2_f32_bf16 v29, v138, v21, v252
 v_dot2_f32_bf16 v30, v139, v253, v252
 v_dot2_f32_bf16 v31, v139, v21, v252
 v_cvt_pk_bf16_f32 v136, v24, v25
 v_cvt_pk_bf16_f32 v137, v26, v27
 v_cvt_pk_bf16_f32 v138, v28, v29
 v_cvt_pk_bf16_f32 v139, v30, v31
 v_dot2_f32_bf16 v24, v140, v253, v252
 v_dot2_f32_bf16 v25, v140, v21, v252
 v_dot2_f32_bf16 v26, v141, v253, v252
 v_dot2_f32_bf16 v27, v141, v21, v252
 v_dot2_f32_bf16 v28, v142, v253, v252
 v_dot2_f32_bf16 v29, v142, v21, v252
 v_dot2_f32_bf16 v30, v143, v253, v252
 v_dot2_f32_bf16 v31, v143, v21, v252
 v_cvt_pk_bf16_f32 v140, v24, v25
 v_cvt_pk_bf16_f32 v141, v26, v27
 v_cvt_pk_bf16_f32 v142, v28, v29
 v_cvt_pk_bf16_f32 v143, v30, v31
 v_dot2_f32_bf16 v24, v144, v253, v252
 v_dot2_f32_bf16 v25, v144, v21, v252
 v_dot2_f32_bf16 v26, v145, v253, v252
 v_dot2_f32_bf16 v27, v145, v21, v252
 v_dot2_f32_bf16 v28, v146, v253, v252
 v_dot2_f32_bf16 v29, v146, v21, v252
 s_add_u32 m0, s28, 0xa000
 s_nop 0
 buffer_load_dwordx4 v5, s[8:11], s43 offen offset:1024 lds
 v_dot2_f32_bf16 v30, v147, v253, v252
 v_dot2_f32_bf16 v31, v147, v21, v252
 v_cvt_pk_bf16_f32 v144, v24, v25
 v_cvt_pk_bf16_f32 v145, v26, v27
 v_cvt_pk_bf16_f32 v146, v28, v29
 v_cvt_pk_bf16_f32 v147, v30, v31
 v_dot2_f32_bf16 v24, v148, v253, v252
 v_dot2_f32_bf16 v25, v148, v21, v252
 v_dot2_f32_bf16 v26, v149, v253, v252
 v_dot2_f32_bf16 v27, v149, v21, v252
 v_dot2_f32_bf16 v28, v150, v253, v252
 v_dot2_f32_bf16 v29, v150, v21, v252
 v_dot2_f32_bf16 v30, v151, v253, v252
 v_dot2_f32_bf16 v31, v151, v21, v252
 v_cvt_pk_bf16_f32 v148, v24, v25
 v_cvt_pk_bf16_f32 v149, v26, v27
 v_cvt_pk_bf16_f32 v150, v28, v29
 v_cvt_pk_bf16_f32 v151, v30, v31
 v_dot2_f32_bf16 v24, v152, v253, v252
 v_dot2_f32_bf16 v25, v152, v21, v252
 v_dot2_f32_bf16 v26, v153, v253, v252
 v_dot2_f32_bf16 v27, v153, v21, v252
 v_dot2_f32_bf16 v28, v154, v253, v252
 v_dot2_f32_bf16 v29, v154, v21, v252
 v_dot2_f32_bf16 v30, v155, v253, v252
 v_dot2_f32_bf16 v31, v155, v21, v252
 v_cvt_pk_bf16_f32 v152, v24, v25
 v_cvt_pk_bf16_f32 v153, v26, v27
 v_cvt_pk_bf16_f32 v154, v28, v29
 v_cvt_pk_bf16_f32 v155, v30, v31
 v_dot2_f32_bf16 v24, v156, v253, v252
 v_dot2_f32_bf16 v25, v156, v21, v252
 v_dot2_f32_bf16 v26, v157, v253, v252
 v_dot2_f32_bf16 v27, v157, v21, v252
 v_dot2_f32_bf16 v28, v158, v253, v252
 v_dot2_f32_bf16 v29, v158, v21, v252
 v_dot2_f32_bf16 v30, v159, v253, v252
 v_dot2_f32_bf16 v31, v159, v21, v252
 v_cvt_pk_bf16_f32 v156, v24, v25
 v_cvt_pk_bf16_f32 v157, v26, v27
 v_cvt_pk_bf16_f32 v158, v28, v29
 v_cvt_pk_bf16_f32 v159, v30, v31
 s_add_u32 m0, s28, 0xc000
 s_nop 0
 buffer_load_dwordx4 v4, s[8:11], s44 offen offset:0 lds
 v_dot2_f32_bf16 v24, v160, v253, v252
 v_dot2_f32_bf16 v25, v160, v21, v252
 v_dot2_f32_bf16 v26, v161, v253, v252
 v_dot2_f32_bf16 v27, v161, v21, v252
 v_dot2_f32_bf16 v28, v162, v253, v252
 v_dot2_f32_bf16 v29, v162, v21, v252
 v_dot2_f32_bf16 v30, v163, v253, v252
 v_dot2_f32_bf16 v31, v163, v21, v252
 v_cvt_pk_bf16_f32 v160, v24, v25
 v_cvt_pk_bf16_f32 v161, v26, v27
 v_cvt_pk_bf16_f32 v162, v28, v29
 v_cvt_pk_bf16_f32 v163, v30, v31
 v_dot2_f32_bf16 v24, v164, v253, v252
 v_dot2_f32_bf16 v25, v164, v21, v252
 v_dot2_f32_bf16 v26, v165, v253, v252
 v_dot2_f32_bf16 v27, v165, v21, v252
 v_dot2_f32_bf16 v28, v166, v253, v252
 v_dot2_f32_bf16 v29, v166, v21, v252
 v_dot2_f32_bf16 v30, v167, v253, v252
 v_dot2_f32_bf16 v31, v167, v21, v252
 v_cvt_pk_bf16_f32 v164, v24, v25
 v_cvt_pk_bf16_f32 v165, v26, v27
 v_cvt_pk_bf16_f32 v166, v28, v29
 v_cvt_pk_bf16_f32 v167, v30, v31
 v_dot2_f32_bf16 v24, v168, v253, v252
 v_dot2_f32_bf16 v25, v168, v21, v252
 v_dot2_f32_bf16 v26, v169, v253, v252
 v_dot2_f32_bf16 v27, v169, v21, v252
 v_dot2_f32_bf16 v28, v170, v253, v252
 v_dot2_f32_bf16 v29, v170, v21, v252
 v_dot2_f32_bf16 v30, v171, v253, v252
 v_dot2_f32_bf16 v31, v171, v21, v252
 v_cvt_pk_bf16_f32 v168, v24, v25
 v_cvt_pk_bf16_f32 v169, v26, v27
 v_cvt_pk_bf16_f32 v170, v28, v29
 v_cvt_pk_bf16_f32 v171, v30, v31
 v_dot2_f32_bf16 v24, v172, v253, v252
 v_dot2_f32_bf16 v25, v172, v21, v252
 v_dot2_f32_bf16 v26, v173, v253, v252
 v_dot2_f32_bf16 v27, v173, v21, v252
 v_dot2_f32_bf16 v28, v174, v253, v252
 v_dot2_f32_bf16 v29, v174, v21, v252
 s_add_u32 m0, s28, 0xc000
 s_nop 0
 buffer_load_dwordx4 v5, s[8:11], s44 offen offset:1024 lds
 v_dot2_f32_bf16 v30, v175, v253, v252
 v_dot2_f32_bf16 v31, v175, v21, v252
 v_cvt_pk_bf16_f32 v172, v24, v25
 v_cvt_pk_bf16_f32 v173, v26, v27
 v_cvt_pk_bf16_f32 v174, v28, v29
 v_cvt_pk_bf16_f32 v175, v30, v31
 v_dot2_f32_bf16 v24, v176, v253, v252
 v_dot2_f32_bf16 v25, v176, v21, v252
 v_dot2_f32_bf16 v26, v177, v253, v252
 v_dot2_f32_bf16 v27, v177, v21, v252
 v_dot2_f32_bf16 v28, v178, v253, v252
 v_dot2_f32_bf16 v29, v178, v21, v252
 v_dot2_f32_bf16 v30, v179, v253, v252
 v_dot2_f32_bf16 v31, v179, v21, v252
 v_cvt_pk_bf16_f32 v176, v24, v25
 v_cvt_pk_bf16_f32 v177, v26, v27
 v_cvt_pk_bf16_f32 v178, v28, v29
 v_cvt_pk_bf16_f32 v179, v30, v31
 v_dot2_f32_bf16 v24, v180, v253, v252
 v_dot2_f32_bf16 v25, v180, v21, v252
 v_dot2_f32_bf16 v26, v181, v253, v252
 v_dot2_f32_bf16 v27, v181, v21, v252
 v_dot2_f32_bf16 v28, v182, v253, v252
 v_dot2_f32_bf16 v29, v182, v21, v252
 v_dot2_f32_bf16 v30, v183, v253, v252
 v_dot2_f32_bf16 v31, v183, v21, v252
 v_cvt_pk_bf16_f32 v180, v24, v25
 v_cvt_pk_bf16_f32 v181, v26, v27
 v_cvt_pk_bf16_f32 v182, v28, v29
 v_cvt_pk_bf16_f32 v183, v30, v31
 v_dot2_f32_bf16 v24, v184, v253, v252
 v_dot2_f32_bf16 v25, v184, v21, v252
 v_dot2_f32_bf16 v26, v185, v253, v252
 v_dot2_f32_bf16 v27, v185, v21, v252
 v_dot2_f32_bf16 v28, v186, v253, v252
 v_dot2_f32_bf16 v29, v186, v21, v252
 v_dot2_f32_bf16 v30, v187, v253, v252
 v_dot2_f32_bf16 v31, v187, v21, v252
 v_cvt_pk_bf16_f32 v184, v24, v25
 v_cvt_pk_bf16_f32 v185, v26, v27
 v_cvt_pk_bf16_f32 v186, v28, v29
 v_cvt_pk_bf16_f32 v187, v30, v31
 s_add_u32 m0, s28, 0xe000
 s_nop 0
 buffer_load_dwordx4 v4, s[8:11], s45 offen offset:0 lds
 v_dot2_f32_bf16 v24, v188, v253, v252
 v_dot2_f32_bf16 v25, v188, v21, v252
 v_dot2_f32_bf16 v26, v189, v253, v252
 v_dot2_f32_bf16 v27, v189, v21, v252
 v_dot2_f32_bf16 v28, v190, v253, v252
 v_dot2_f32_bf16 v29, v190, v21, v252
 v_dot2_f32_bf16 v30, v191, v253, v252
 v_dot2_f32_bf16 v31, v191, v21, v252
 v_cvt_pk_bf16_f32 v188, v24, v25
 v_cvt_pk_bf16_f32 v189, v26, v27
 v_cvt_pk_bf16_f32 v190, v28, v29
 v_cvt_pk_bf16_f32 v191, v30, v31
 v_dot2_f32_bf16 v24, v192, v253, v252
 v_dot2_f32_bf16 v25, v192, v21, v252
 v_dot2_f32_bf16 v26, v193, v253, v252
 v_dot2_f32_bf16 v27, v193, v21, v252
 v_dot2_f32_bf16 v28, v194, v253, v252
 v_dot2_f32_bf16 v29, v194, v21, v252
 v_dot2_f32_bf16 v30, v195, v253, v252
 v_dot2_f32_bf16 v31, v195, v21, v252
 v_cvt_pk_bf16_f32 v192, v24, v25
 v_cvt_pk_bf16_f32 v193, v26, v27
 v_cvt_pk_bf16_f32 v194, v28, v29
 v_cvt_pk_bf16_f32 v195, v30, v31
 v_dot2_f32_bf16 v24, v196, v253, v252
 v_dot2_f32_bf16 v25, v196, v21, v252
 v_dot2_f32_bf16 v26, v197, v253, v252
 v_dot2_f32_bf16 v27, v197, v21, v252
 v_dot2_f32_bf16 v28, v198, v253, v252
 v_dot2_f32_bf16 v29, v198, v21, v252
 v_dot2_f32_bf16 v30, v199, v253, v252
 v_dot2_f32_bf16 v31, v199, v21, v252
 v_cvt_pk_bf16_f32 v196, v24, v25
 v_cvt_pk_bf16_f32 v197, v26, v27
 v_cvt_pk_bf16_f32 v198, v28, v29
 v_cvt_pk_bf16_f32 v199, v30, v31
 v_dot2_f32_bf16 v24, v200, v253, v252
 v_dot2_f32_bf16 v25, v200, v21, v252
 v_dot2_f32_bf16 v26, v201, v253, v252
 v_dot2_f32_bf16 v27, v201, v21, v252
 v_dot2_f32_bf16 v28, v202, v253, v252
 v_dot2_f32_bf16 v29, v202, v21, v252
 s_add_u32 m0, s28, 0xe000
 s_nop 0
 buffer_load_dwordx4 v5, s[8:11], s45 offen offset:1024 lds
 v_dot2_f32_bf16 v30, v203, v253, v252
 v_dot2_f32_bf16 v31, v203, v21, v252
 v_cvt_pk_bf16_f32 v200, v24, v25
 v_cvt_pk_bf16_f32 v201, v26, v27
 v_cvt_pk_bf16_f32 v202, v28, v29
 v_cvt_pk_bf16_f32 v203, v30, v31
 v_dot2_f32_bf16 v24, v204, v253, v252
 v_dot2_f32_bf16 v25, v204, v21, v252
 v_dot2_f32_bf16 v26, v205, v253, v252
 v_dot2_f32_bf16 v27, v205, v21, v252
 v_dot2_f32_bf16 v28, v206, v253, v252
 v_dot2_f32_bf16 v29, v206, v21, v252
 v_dot2_f32_bf16 v30, v207, v253, v252
 v_dot2_f32_bf16 v31, v207, v21, v252
 v_cvt_pk_bf16_f32 v204, v24, v25
 v_cvt_pk_bf16_f32 v205, v26, v27
 v_cvt_pk_bf16_f32 v206, v28, v29
 v_cvt_pk_bf16_f32 v207, v30, v31
 v_dot2_f32_bf16 v24, v208, v253, v252
 v_dot2_f32_bf16 v25, v208, v21, v252
 v_dot2_f32_bf16 v26, v209, v253, v252
 v_dot2_f32_bf16 v27, v209, v21, v252
 v_dot2_f32_bf16 v28, v210, v253, v252
 v_dot2_f32_bf16 v29, v210, v21, v252
 v_dot2_f32_bf16 v30, v211, v253, v252
 v_dot2_f32_bf16 v31, v211, v21, v252
 v_cvt_pk_bf16_f32 v208, v24, v25
 v_cvt_pk_bf16_f32 v209, v26, v27
 v_cvt_pk_bf16_f32 v210, v28, v29
 v_cvt_pk_bf16_f32 v211, v30, v31
 v_dot2_f32_bf16 v24, v212, v253, v252
 v_dot2_f32_bf16 v25, v212, v21, v252
 v_dot2_f32_bf16 v26, v213, v253, v252
 v_dot2_f32_bf16 v27, v213, v21, v252
 v_dot2_f32_bf16 v28, v214, v253, v252
 v_dot2_f32_bf16 v29, v214, v21, v252
 v_dot2_f32_bf16 v30, v215, v253, v252
 v_dot2_f32_bf16 v31, v215, v21, v252
 v_cvt_pk_bf16_f32 v212, v24, v25
 v_cvt_pk_bf16_f32 v213, v26, v27
 v_cvt_pk_bf16_f32 v214, v28, v29
 v_cvt_pk_bf16_f32 v215, v30, v31
 s_waitcnt vmcnt(12)
 s_barrier
 ds_read_b64_tr_b16 a[144:145], v8 offset:0
 ds_read_b64_tr_b16 a[146:147], v8 offset:512
 ds_read_b64_tr_b16 a[148:149], v9 offset:0
 ds_read_b64_tr_b16 a[150:151], v9 offset:512
 ds_read_b64_tr_b16 a[152:153], v8 offset:2048
 ds_read_b64_tr_b16 a[154:155], v8 offset:2560
 ds_read_b64_tr_b16 a[156:157], v9 offset:2048
 ds_read_b64_tr_b16 a[158:159], v9 offset:2560
 ds_read_b64_tr_b16 a[160:161], v8 offset:4096
 ds_read_b64_tr_b16 a[162:163], v8 offset:4608
 ds_read_b64_tr_b16 a[164:165], v9 offset:4096
 ds_read_b64_tr_b16 a[166:167], v9 offset:4608
 ds_read_b64_tr_b16 a[168:169], v8 offset:6144
 ds_read_b64_tr_b16 a[170:171], v8 offset:6656
 ds_read_b64_tr_b16 a[172:173], v9 offset:6144
 ds_read_b64_tr_b16 a[174:175], v9 offset:6656
 s_waitcnt vmcnt(10)
 s_barrier
 ds_read_b64_tr_b16 a[176:177], v8 offset:8192
 ds_read_b64_tr_b16 a[178:179], v8 offset:8704
 s_waitcnt lgkmcnt(15)
 v_mfma_f32_32x32x16_bf16 v[64:79], a[144:147], v[96:99], 0
 s_add_u32 m0, s28, 0x10000
 ds_read_b64_tr_b16 a[144:145], v9 offset:8192
 ds_read_b64_tr_b16 a[146:147], v9 offset:8704
 buffer_load_dwordx4 v4, s[8:11], s46 offen offset:0 lds
 v_lshlrev_b32 v24, 16, v216
 v_and_b32 v25, 0xffff0000, v216
 v_lshlrev_b32 v26, 16, v217
 v_and_b32 v27, 0xffff0000, v217
 s_waitcnt lgkmcnt(15)
 v_mfma_f32_32x32x16_bf16 v[80:95], a[148:151], v[96:99], 0
 ds_read_b64_tr_b16 a[148:149], v8 offset:10240
 ds_read_b64_tr_b16 a[150:151], v8 offset:10752
 v_lshlrev_b32 v28, 16, v218
 v_and_b32 v29, 0xffff0000, v218
 v_lshlrev_b32 v30, 16, v219
 v_and_b32 v31, 0xffff0000, v219
 v_fma_f32 v24, v24, v21, v252
 v_fma_f32 v25, v25, v21, v252
 s_waitcnt lgkmcnt(15)
 v_mfma_f32_32x32x16_bf16 v[64:79], a[152:155], v[100:103], v[64:79]
 ds_read_b64_tr_b16 a[152:153], v9 offset:10240
 ds_read_b64_tr_b16 a[154:155], v9 offset:10752
 buffer_load_dwordx4 v5, s[8:11], s46 offen offset:1024 lds
 v_fma_f32 v26, v26, v21, v252
 v_fma_f32 v27, v27, v21, v252
 v_fma_f32 v28, v28, v21, v252
 v_fma_f32 v29, v29, v21, v252
 s_waitcnt lgkmcnt(15)
 v_mfma_f32_32x32x16_bf16 v[80:95], a[156:159], v[100:103], v[80:95]
 s_waitcnt lgkmcnt(8)
 ds_read_b64_tr_b16 a[156:157], v8 offset:12288
 ds_read_b64_tr_b16 a[158:159], v8 offset:12800
 s_add_u32 m0, s28, 0x12000
 v_fma_f32 v30, v30, v21, v252
 v_fma_f32 v31, v31, v21, v252
 v_cvt_pk_bf16_f32 v216, v24, v25
 v_cvt_pk_bf16_f32 v217, v26, v27
 v_cvt_pk_bf16_f32 v218, v28, v29
 v_mfma_f32_32x32x16_bf16 v[64:79], a[160:163], v[104:107], v[64:79]
 ds_read_b64_tr_b16 a[160:161], v9 offset:12288
 ds_read_b64_tr_b16 a[162:163], v9 offset:12800
 buffer_load_dwordx4 v4, s[8:11], s47 offen offset:0 lds
 v_cvt_pk_bf16_f32 v219, v30, v31
 v_lshlrev_b32 v24, 16, v220
 v_and_b32 v25, 0xffff0000, v220
 v_lshlrev_b32 v26, 16, v221
 v_mfma_f32_32x32x16_bf16 v[80:95], a[164:167], v[104:107], v[80:95]
 ds_read_b64_tr_b16 a[164:165], v8 offset:14336
 ds_read_b64_tr_b16 a[166:167], v8 offset:14848
 v_and_b32 v27, 0xffff0000, v221
 v_lshlrev_b32 v28, 16, v222
 v_and_b32 v29, 0xffff0000, v222
 v_lshlrev_b32 v30, 16, v223
 v_and_b32 v31, 0xffff0000, v223
 v_fma_f32 v24, v24, v21, v252
 v_mfma_f32_32x32x16_bf16 v[64:79], a[168:171], v[108:111], v[64:79]
 ds_read_b64_tr_b16 a[168:169], v9 offset:14336
 ds_read_b64_tr_b16 a[170:171], v9 offset:14848
 buffer_load_dwordx4 v5, s[8:11], s47 offen offset:1024 lds
 v_fma_f32 v25, v25, v21, v252
 v_fma_f32 v26, v26, v21, v252
 v_fma_f32 v27, v27, v21, v252
 v_fma_f32 v28, v28, v21, v252
 v_mfma_f32_32x32x16_bf16 v[80:95], a[172:175], v[108:111], v[80:95]
 s_waitcnt vmcnt(12) lgkmcnt(8)
 s_barrier
 ds_read_b64_tr_b16 a[172:173], v8 offset:16384
 ds_read_b64_tr_b16 a[174:175], v8 offset:16896
 v_fma_f32 v29, v29, v21, v252
 v_fma_f32 v30, v30, v21, v252
 v_fma_f32 v31, v31, v21, v252
 v_cvt_pk_bf16_f32 v220, v24, v25
 v_mfma_f32_32x32x16_bf16 v[64:79], a[176:179], v[112:115], v[64:79]
 ds_read_b64_tr_b16 a[176:177], v9 offset:16384
 ds_read_b64_tr_b16 a[178:179], v9 offset:16896
 v_cvt_pk_bf16_f32 v221, v26, v27
 v_cvt_pk_bf16_f32 v222, v28, v29
 v_cvt_pk_bf16_f32 v223, v30, v31
 v_lshlrev_b32 v24, 16, v224
 v_and_b32 v25, 0xffff0000, v224
 v_lshlrev_b32 v26, 16, v225
 v_mfma_f32_32x32x16_bf16 v[80:95], a[144:147], v[112:115], v[80:95]
 ds_read_b64_tr_b16 a[144:145], v8 offset:18432
 ds_read_b64_tr_b16 a[146:147], v8 offset:18944
 v_and_b32 v27, 0xffff0000, v225
 v_lshlrev_b32 v28, 16, v226
 v_and_b32 v29, 0xffff0000, v226
 v_lshlrev_b32 v30, 16, v227
 v_and_b32 v31, 0xffff0000, v227
 v_fma_f32 v24, v24, v21, v252
 v_mfma_f32_32x32x16_bf16 v[64:79], a[148:151], v[116:119], v[64:79]
 ds_read_b64_tr_b16 a[148:149], v9 offset:18432
 ds_read_b64_tr_b16 a[150:151], v9 offset:18944
 v_fma_f32 v25, v25, v21, v252
 v_fma_f32 v26, v26, v21, v252
 v_fma_f32 v27, v27, v21, v252
 v_fma_f32 v28, v28, v21, v252
 v_fma_f32 v29, v29, v21, v252
 v_fma_f32 v30, v30, v21, v252
 v_mfma_f32_32x32x16_bf16 v[80:95], a[152:155], v[116:119], v[80:95]
 s_waitcnt lgkmcnt(8)
 ds_read_b64_tr_b16 a[152:153], v8 offset:20480
 ds_read_b64_tr_b16 a[154:155], v8 offset:20992
 s_cmp_eq_u32 s73, 0
 s_cselect_b32 s48, 768, 0
 s_sub_u32 s48, 128, s48
 v_add_u32 v4, s48, v4
 v_add_u32 v5, s48, v5
 s_add_u32 m0, s28, 0x2000
 v_mfma_f32_32x32x16_bf16 v[64:79], a[156:159], v[120:123], v[64:79]
 ds_read_b64_tr_b16 a[156:157], v9 offset:20480
 ds_read_b64_tr_b16 a[158:159], v9 offset:20992
 buffer_load_dwordx4 v4, s[8:11], s39 offen offset:0 lds
 v_fma_f32 v31, v31, v21, v252
 v_cvt_pk_bf16_f32 v224, v24, v25
 v_cvt_pk_bf16_f32 v225, v26, v27
 v_cvt_pk_bf16_f32 v226, v28, v29
 v_mfma_f32_32x32x16_bf16 v[80:95], a[160:163], v[120:123], v[80:95]
 ds_read_b64_tr_b16 a[160:161], v8 offset:22528
 ds_read_b64_tr_b16 a[162:163], v8 offset:23040
 v_cvt_pk_bf16_f32 v227, v30, v31
 v_accvgpr_write_b32 a0, v96
 v_accvgpr_write_b32 a1, v97
 v_accvgpr_write_b32 a2, v98
 v_accvgpr_write_b32 a3, v99
 v_accvgpr_write_b32 a4, v100
 v_mfma_f32_32x32x16_bf16 v[64:79], a[164:167], v[124:127], v[64:79]
 ds_read_b64_tr_b16 a[164:165], v9 offset:22528
 ds_read_b64_tr_b16 a[166:167], v9 offset:23040
 v_accvgpr_write_b32 a5, v101
 v_accvgpr_write_b32 a6, v102
 v_accvgpr_write_b32 a7, v103
 v_accvgpr_write_b32 a8, v104
 v_accvgpr_write_b32 a9, v105
 v_accvgpr_write_b32 a10, v106
 v_mfma_f32_32x32x16_bf16 v[80:95], a[168:171], v[124:127], v[80:95]
 s_waitcnt vmcnt(11) lgkmcnt(8)
 s_barrier
 ds_read_b64_tr_b16 a[168:169], v8 offset:24576
 ds_read_b64_tr_b16 a[170:171], v8 offset:25088
 v_accvgpr_write_b32 a11, v107
 v_accvgpr_write_b32 a12, v108
 v_accvgpr_write_b32 a13, v109
 v_accvgpr_write_b32 a14, v110
 v_mfma_f32_32x32x16_bf16 v[64:79], a[172:175], v[128:131], v[64:79]
 ds_read_b64_tr_b16 a[172:173], v9 offset:24576
 ds_read_b64_tr_b16 a[174:175], v9 offset:25088
 v_accvgpr_write_b32 a15, v111
 v_accvgpr_write_b32 a16, v112
 v_accvgpr_write_b32 a17, v113
 v_accvgpr_write_b32 a18, v114
 v_accvgpr_write_b32 a19, v115
 v_accvgpr_write_b32 a20, v116
 v_mfma_f32_32x32x16_bf16 v[80:95], a[176:179], v[128:131], v[80:95]
 ds_read_b64_tr_b16 a[176:177], v8 offset:26624
 ds_read_b64_tr_b16 a[178:179], v8 offset:27136
 v_accvgpr_write_b32 a21, v117
 v_accvgpr_write_b32 a22, v118
 v_accvgpr_write_b32 a23, v119
 v_accvgpr_write_b32 a24, v120
 v_accvgpr_write_b32 a25, v121
 v_accvgpr_write_b32 a26, v122
 v_mfma_f32_32x32x16_bf16 v[64:79], a[144:147], v[132:135], v[64:79]
 ds_read_b64_tr_b16 a[144:145], v9 offset:26624
 ds_read_b64_tr_b16 a[146:147], v9 offset:27136
 buffer_load_dwordx4 v5, s[8:11], s39 offen offset:1024 lds
 v_accvgpr_write_b32 a27, v123
 v_accvgpr_write_b32 a28, v124
 v_accvgpr_write_b32 a29, v125
 v_accvgpr_write_b32 a30, v126
 v_mfma_f32_32x32x16_bf16 v[80:95], a[148:151], v[132:135], v[80:95]
 s_waitcnt lgkmcnt(8)
 ds_read_b64_tr_b16 a[148:149], v8 offset:28672
 ds_read_b64_tr_b16 a[150:151], v8 offset:29184
 v_accvgpr_write_b32 a31, v127
 v_mfma_f32_32x32x16_bf16 v[64:79], a[152:155], v[136:139], v[64:79]
 ds_read_b64_tr_b16 a[152:153], v9 offset:28672
 ds_read_b64_tr_b16 a[154:155], v9 offset:29184
 ds_read_b128 v[96:99], v20 offset:256
 ds_read_b128 v[100:103], v20 offset:288
 ds_read_b128 v[104:107], v20 offset:320
 ds_read_b128 v[108:111], v20 offset:352
 ds_read_b128 v[112:115], v20 offset:384
 ds_read_b128 v[116:119], v20 offset:416
 v_mfma_f32_32x32x16_bf16 v[80:95], a[156:159], v[136:139], v[80:95]
 ds_read_b64_tr_b16 a[156:157], v8 offset:30720
 ds_read_b64_tr_b16 a[158:159], v8 offset:31232
 ds_read_b128 v[120:123], v20 offset:448
 ds_read_b128 v[124:127], v20 offset:480
 v_lshlrev_b32 v24, 16, v228
 v_and_b32 v25, 0xffff0000, v228
 v_lshlrev_b32 v26, 16, v229
 v_and_b32 v27, 0xffff0000, v229
 v_mfma_f32_32x32x16_bf16 v[64:79], a[160:163], v[140:143], v[64:79]
 ds_read_b64_tr_b16 a[160:161], v9 offset:30720
 ds_read_b64_tr_b16 a[162:163], v9 offset:31232
 v_lshlrev_b32 v28, 16, v230
 v_and_b32 v29, 0xffff0000, v230
 v_lshlrev_b32 v30, 16, v231
 v_and_b32 v31, 0xffff0000, v231
 v_fma_f32 v24, v24, v21, v252
 v_fma_f32 v25, v25, v21, v252
 v_mfma_f32_32x32x16_bf16 v[80:95], a[164:167], v[140:143], v[80:95]
 s_waitcnt vmcnt(10) lgkmcnt(15)
 s_barrier
 ds_read_b64_tr_b16 a[164:165], v8 offset:32768
 ds_read_b64_tr_b16 a[166:167], v8 offset:33280
 s_add_u32 m0, s28, 0x4000
 v_fma_f32 v26, v26, v21, v252
 v_fma_f32 v27, v27, v21, v252
 v_fma_f32 v28, v28, v21, v252
 v_mfma_f32_32x32x16_bf16 v[64:79], a[168:171], v[144:147], v[64:79]
 ds_read_b64_tr_b16 a[168:169], v9 offset:32768
 ds_read_b64_tr_b16 a[170:171], v9 offset:33280
 buffer_load_dwordx4 v4, s[8:11], s40 offen offset:0 lds
 v_fma_f32 v29, v29, v21, v252
 v_fma_f32 v30, v30, v21, v252
 v_fma_f32 v31, v31, v21, v252
 v_cvt_pk_bf16_f32 v228, v24, v25
 v_mfma_f32_32x32x16_bf16 v[80:95], a[172:175], v[144:147], v[80:95]
 ds_read_b64_tr_b16 a[172:173], v8 offset:34816
 ds_read_b64_tr_b16 a[174:175], v8 offset:35328
 v_cvt_pk_bf16_f32 v229, v26, v27
 v_cvt_pk_bf16_f32 v230, v28, v29
 v_cvt_pk_bf16_f32 v231, v30, v31
 v_lshlrev_b32 v24, 16, v232
 v_and_b32 v25, 0xffff0000, v232
 v_lshlrev_b32 v26, 16, v233
 v_mfma_f32_32x32x16_bf16 v[64:79], a[176:179], v[148:151], v[64:79]
 ds_read_b64_tr_b16 a[176:177], v9 offset:34816
 ds_read_b64_tr_b16 a[178:179], v9 offset:35328
 v_and_b32 v27, 0xffff0000, v233
 v_lshlrev_b32 v28, 16, v234
 v_and_b32 v29, 0xffff0000, v234
 v_lshlrev_b32 v30, 16, v235
 v_and_b32 v31, 0xffff0000, v235
 v_fma_f32 v24, v24, v21, v252
 v_mfma_f32_32x32x16_bf16 v[80:95], a[144:147], v[148:151], v[80:95]
 s_waitcnt lgkmcnt(8)
 ds_read_b64_tr_b16 a[144:145], v8 offset:36864
 ds_read_b64_tr_b16 a[146:147], v8 offset:37376
 v_fma_f32 v25, v25, v21, v252
 v_fma_f32 v26, v26, v21, v252
 v_fma_f32 v27, v27, v21, v252
 v_fma_f32 v28, v28, v21, v252
 v_fma_f32 v29, v29, v21, v252
 v_fma_f32 v30, v30, v21, v252
 v_mfma_f32_32x32x16_bf16 v[64:79], a[148:151], v[152:155], v[64:79]
 ds_read_b64_tr_b16 a[148:149], v9 offset:36864
 ds_read_b64_tr_b16 a[150:151], v9 offset:37376
 v_fma_f32 v31, v31, v21, v252
 v_cvt_pk_bf16_f32 v232, v24, v25
 v_cvt_pk_bf16_f32 v233, v26, v27
 v_cvt_pk_bf16_f32 v234, v28, v29
 v_cvt_pk_bf16_f32 v235, v30, v31
 v_lshlrev_b32 v24, 16, v236
 v_mfma_f32_32x32x16_bf16 v[80:95], a[152:155], v[152:155], v[80:95]
 ds_read_b64_tr_b16 a[152:153], v8 offset:38912
 ds_read_b64_tr_b16 a[154:155], v8 offset:39424
 v_and_b32 v25, 0xffff0000, v236
 v_lshlrev_b32 v26, 16, v237
 v_and_b32 v27, 0xffff0000, v237
 v_lshlrev_b32 v28, 16, v238
 v_and_b32 v29, 0xffff0000, v238
 v_lshlrev_b32 v30, 16, v239
 v_mfma_f32_32x32x16_bf16 v[64:79], a[156:159], v[156:159], v[64:79]
 ds_read_b64_tr_b16 a[156:157], v9 offset:38912
 ds_read_b64_tr_b16 a[158:159], v9 offset:39424
 buffer_load_dwordx4 v5, s[8:11], s40 offen offset:1024 lds
 v_and_b32 v31, 0xffff0000, v239
 v_fma_f32 v24, v24, v21, v252
 v_fma_f32 v25, v25, v21, v252
 v_fma_f32 v26, v26, v21, v252
 v_mfma_f32_32x32x16_bf16 v[80:95], a[160:163], v[156:159], v[80:95]
 s_waitcnt vmcnt(10) lgkmcnt(8)
 s_barrier
 ds_read_b64_tr_b16 a[160:161], v8 offset:40960
 ds_read_b64_tr_b16 a[162:163], v8 offset:41472
 v_fma_f32 v27, v27, v21, v252
 v_fma_f32 v28, v28, v21, v252
 v_fma_f32 v29, v29, v21, v252
 v_fma_f32 v30, v30, v21, v252
 v_mfma_f32_32x32x16_bf16 v[64:79], a[164:167], v[160:163], v[64:79]
 ds_read_b64_tr_b16 a[164:165], v9 offset:40960
 ds_read_b64_tr_b16 a[166:167], v9 offset:41472
 v_fma_f32 v31, v31, v21, v252
 v_cvt_pk_bf16_f32 v236, v24, v25
 v_cvt_pk_bf16_f32 v237, v26, v27
 v_cvt_pk_bf16_f32 v238, v28, v29
 v_cvt_pk_bf16_f32 v239, v30, v31
 v_mfma_f32_32x32x16_bf16 v[80:95], a[168:171], v[160:163], v[80:95]
 ds_read_b64_tr_b16 a[168:169], v8 offset:43008
 ds_read_b64_tr_b16 a[170:171], v8 offset:43520
 ds_read_b128 v[240:243], v20 offset:0
 ds_read_b128 v[244:247], v20 offset:32
 ds_read_b128 v[248:251], v20 offset:64
 ds_read_b128 v[252:255], v20 offset:96
 v_accvgpr_write_b32 a32, v128
 v_accvgpr_write_b32 a33, v129
 v_mfma_f32_32x32x16_bf16 v[64:79], a[172:175], v[164:167], v[64:79]
 ds_read_b64_tr_b16 a[172:173], v9 offset:43008
 ds_read_b64_tr_b16 a[174:175], v9 offset:43520
 v_accvgpr_write_b32 a34, v130
 v_accvgpr_write_b32 a35, v131
 v_accvgpr_write_b32 a36, v132
 v_accvgpr_write_b32 a37, v133
 v_accvgpr_write_b32 a38, v134
 v_accvgpr_write_b32 a39, v135
 v_mfma_f32_32x32x16_bf16 v[80:95], a[176:179], v[164:167], v[80:95]
 s_waitcnt lgkmcnt(12)
 ds_read_b64_tr_b16 a[176:177], v8 offset:45056
 ds_read_b64_tr_b16 a[178:179], v8 offset:45568
 s_add_u32 m0, s28, 0x6000
 v_accvgpr_write_b32 a40, v136
 v_accvgpr_write_b32 a41, v137
 v_accvgpr_write_b32 a42, v138
 v_accvgpr_write_b32 a43, v139
 v_accvgpr_write_b32 a44, v140
 v_mfma_f32_32x32x16_bf16 v[64:79], a[144:147], v[168:171], v[64:79]
 ds_read_b64_tr_b16 a[144:145], v9 offset:45056
 ds_read_b64_tr_b16 a[146:147], v9 offset:45568
 buffer_load_dwordx4 v4, s[8:11], s41 offen offset:0 lds
 v_accvgpr_write_b32 a45, v141
 v_accvgpr_write_b32 a46, v142
 v_accvgpr_write_b32 a47, v143
 v_accvgpr_write_b32 a48, v144
 v_mfma_f32_32x32x16_bf16 v[80:95], a[148:151], v[168:171], v[80:95]
 ds_read_b64_tr_b16 a[148:149], v8 offset:47104
 ds_read_b64_tr_b16 a[150:151], v8 offset:47616
 v_accvgpr_write_b32 a49, v145
 v_accvgpr_write_b32 a50, v146
 v_accvgpr_write_b32 a51, v147
 v_accvgpr_write_b32 a52, v148
 v_accvgpr_write_b32 a53, v149
 v_accvgpr_write_b32 a54, v150
 v_mfma_f32_32x32x16_bf16 v[64:79], a[152:155], v[172:175], v[64:79]
 ds_read_b64_tr_b16 a[152:153], v9 offset:47104
 ds_read_b64_tr_b16 a[154:155], v9 offset:47616
 buffer_load_dwordx4 v5, s[8:11], s41 offen offset:1024 lds
 v_accvgpr_write_b32 a55, v151
 v_accvgpr_write_b32 a56, v152
 v_accvgpr_write_b32 a57, v153
 v_accvgpr_write_b32 a58, v154
 v_mfma_f32_32x32x16_bf16 v[80:95], a[156:159], v[172:175], v[80:95]
 s_waitcnt vmcnt(10) lgkmcnt(8)
 s_barrier
 ds_read_b64_tr_b16 a[156:157], v8 offset:49152
 ds_read_b64_tr_b16 a[158:159], v8 offset:49664
 s_add_u32 m0, s28, 0x8000
 v_accvgpr_write_b32 a59, v155
 v_accvgpr_write_b32 a60, v156
 v_accvgpr_write_b32 a61, v157
 v_mfma_f32_32x32x16_bf16 v[64:79], a[160:163], v[176:179], v[64:79]
 ds_read_b64_tr_b16 a[160:161], v9 offset:49152
 ds_read_b64_tr_b16 a[162:163], v9 offset:49664
 buffer_load_dwordx4 v4, s[8:11], s42 offen offset:0 lds
 v_accvgpr_write_b32 a62, v158
 v_accvgpr_write_b32 a63, v159
 v_accvgpr_write_b32 a64, v160
 v_accvgpr_write_b32 a65, v161
 v_mfma_f32_32x32x16_bf16 v[80:95], a[164:167], v[176:179], v[80:95]
 ds_read_b64_tr_b16 a[164:165], v8 offset:51200
 ds_read_b64_tr_b16 a[166:167], v8 offset:51712
 v_accvgpr_write_b32 a66, v162
 v_accvgpr_write_b32 a67, v163
 v_accvgpr_write_b32 a68, v164
 v_accvgpr_write_b32 a69, v165
 v_accvgpr_write_b32 a70, v166
 v_accvgpr_write_b32 a71, v167
 v_mfma_f32_32x32x16_bf16 v[64:79], a[168:171], v[180:183], v[64:79]
 ds_read_b64_tr_b16 a[168:169], v9 offset:51200
 ds_read_b64_tr_b16 a[170:171], v9 offset:51712
 buffer_load_dwordx4 v5, s[8:11], s42 offen offset:1024 lds
 v_accvgpr_write_b32 a72, v168
 v_accvgpr_write_b32 a73, v169
 v_accvgpr_write_b32 a74, v170
 v_accvgpr_write_b32 a75, v171
 v_mfma_f32_32x32x16_bf16 v[80:95], a[172:175], v[180:183], v[80:95]
 s_waitcnt lgkmcnt(8)
 ds_read_b64_tr_b16 a[172:173], v8 offset:53248
 ds_read_b64_tr_b16 a[174:175], v8 offset:53760
 s_add_u32 m0, s28, 0xa000
 v_accvgpr_write_b32 a76, v172
 v_accvgpr_write_b32 a77, v173
 v_accvgpr_write_b32 a78, v174
 v_accvgpr_write_b32 a79, v175
 v_accvgpr_write_b32 a80, v176
 v_mfma_f32_32x32x16_bf16 v[64:79], a[176:179], v[184:187], v[64:79]
 ds_read_b64_tr_b16 a[176:177], v9 offset:53248
 ds_read_b64_tr_b16 a[178:179], v9 offset:53760
 buffer_load_dwordx4 v4, s[8:11], s43 offen offset:0 lds
 v_accvgpr_write_b32 a81, v177
 v_accvgpr_write_b32 a82, v178
 v_accvgpr_write_b32 a83, v179
 v_accvgpr_write_b32 a84, v180
 v_mfma_f32_32x32x16_bf16 v[80:95], a[144:147], v[184:187], v[80:95]
 ds_read_b64_tr_b16 a[144:145], v8 offset:55296
 ds_read_b64_tr_b16 a[146:147], v8 offset:55808
 v_accvgpr_write_b32 a85, v181
 v_accvgpr_write_b32 a86, v182
 v_accvgpr_write_b32 a87, v183
 v_accvgpr_write_b32 a88, v184
 v_accvgpr_write_b32 a89, v185
 v_accvgpr_write_b32 a90, v186
 v_mfma_f32_32x32x16_bf16 v[64:79], a[148:151], v[188:191], v[64:79]
 ds_read_b64_tr_b16 a[148:149], v9 offset:55296
 ds_read_b64_tr_b16 a[150:151], v9 offset:55808
 buffer_load_dwordx4 v5, s[8:11], s43 offen offset:1024 lds
 v_accvgpr_write_b32 a91, v187
 v_accvgpr_write_b32 a92, v188
 v_accvgpr_write_b32 a93, v189
 v_accvgpr_write_b32 a94, v190
 v_mfma_f32_32x32x16_bf16 v[80:95], a[152:155], v[188:191], v[80:95]
 s_waitcnt vmcnt(12) lgkmcnt(8)
 s_barrier
 ds_read_b64_tr_b16 a[152:153], v8 offset:57344
 ds_read_b64_tr_b16 a[154:155], v8 offset:57856
 s_add_u32 m0, s28, 0xc000
 v_accvgpr_write_b32 a95, v191
 v_accvgpr_write_b32 a96, v192
 v_accvgpr_write_b32 a97, v193
 v_mfma_f32_32x32x16_bf16 v[64:79], a[156:159], v[192:195], v[64:79]
 ds_read_b64_tr_b16 a[156:157], v9 offset:57344
 ds_read_b64_tr_b16 a[158:159], v9 offset:57856
 buffer_load_dwordx4 v4, s[8:11], s44 offen offset:0 lds
 v_accvgpr_write_b32 a98, v194
 v_accvgpr_write_b32 a99, v195
 v_accvgpr_write_b32 a100, v196
 v_accvgpr_write_b32 a101, v197
 v_mfma_f32_32x32x16_bf16 v[80:95], a[160:163], v[192:195], v[80:95]
 ds_read_b64_tr_b16 a[160:161], v8 offset:59392
 ds_read_b64_tr_b16 a[162:163], v8 offset:59904
 v_accvgpr_write_b32 a102, v198
 v_accvgpr_write_b32 a103, v199
 v_accvgpr_write_b32 a104, v200
 v_accvgpr_write_b32 a105, v201
 v_accvgpr_write_b32 a106, v202
 v_accvgpr_write_b32 a107, v203
 v_mfma_f32_32x32x16_bf16 v[64:79], a[164:167], v[196:199], v[64:79]
 ds_read_b64_tr_b16 a[164:165], v9 offset:59392
 ds_read_b64_tr_b16 a[166:167], v9 offset:59904
 buffer_load_dwordx4 v5, s[8:11], s44 offen offset:1024 lds
 v_accvgpr_write_b32 a108, v204
 v_accvgpr_write_b32 a109, v205
 v_accvgpr_write_b32 a110, v206
 v_accvgpr_write_b32 a111, v207
 v_mfma_f32_32x32x16_bf16 v[80:95], a[168:171], v[196:199], v[80:95]
 s_waitcnt lgkmcnt(8)
 ds_read_b64_tr_b16 a[168:169], v8 offset:61440
 ds_read_b64_tr_b16 a[170:171], v8 offset:61952
 s_add_u32 m0, s28, 0x14000
 v_accvgpr_write_b32 a112, v208
 v_accvgpr_write_b32 a113, v209
 v_accvgpr_write_b32 a114, v210
 v_accvgpr_write_b32 a115, v211
 v_accvgpr_write_b32 a116, v212
 v_mfma_f32_32x32x16_bf16 v[64:79], a[172:175], v[200:203], v[64:79]
 ds_read_b64_tr_b16 a[172:173], v9 offset:61440
 ds_read_b64_tr_b16 a[174:175], v9 offset:61952
 buffer_load_dwordx4 v4, s[8:11], s45 offen offset:0 lds
 v_accvgpr_write_b32 a117, v213
 v_accvgpr_write_b32 a118, v214
 v_accvgpr_write_b32 a119, v215
 v_accvgpr_write_b32 a120, v216
 v_mfma_f32_32x32x16_bf16 v[80:95], a[176:179], v[200:203], v[80:95]
 ds_read_b64_tr_b16 a[176:177], v8 offset:63488
 ds_read_b64_tr_b16 a[178:179], v8 offset:64000
 v_accvgpr_write_b32 a121, v217
 v_accvgpr_write_b32 a122, v218
 v_accvgpr_write_b32 a123, v219
 v_accvgpr_write_b32 a124, v220
 v_accvgpr_write_b32 a125, v221
 v_accvgpr_write_b32 a126, v222
 v_mfma_f32_32x32x16_bf16 v[64:79], a[144:147], v[204:207], v[64:79]
 ds_read_b64_tr_b16 a[144:145], v9 offset:63488
 ds_read_b64_tr_b16 a[146:147], v9 offset:64000
 buffer_load_dwordx4 v5, s[8:11], s45 offen offset:1024 lds
 v_accvgpr_write_b32 a127, v223
 v_accvgpr_write_b32 a128, v224
 v_accvgpr_write_b32 a129, v225
 v_accvgpr_write_b32 a130, v226
 v_mfma_f32_32x32x16_bf16 v[80:95], a[148:151], v[204:207], v[80:95]
 s_waitcnt vmcnt(12) lgkmcnt(8)
 s_barrier
 ds_read_b64_tr_b16 a[148:149], v10 offset:0
 ds_read_b64_tr_b16 a[150:151], v10 offset:512
 s_add_u32 m0, s28, 0xe000
 v_accvgpr_write_b32 a131, v227
 v_accvgpr_write_b32 a132, v228
 v_accvgpr_write_b32 a133, v229
 v_mfma_f32_32x32x16_bf16 v[64:79], a[152:155], v[208:211], v[64:79]
 ds_read_b64_tr_b16 a[152:153], v11 offset:0
 ds_read_b64_tr_b16 a[154:155], v11 offset:512
 buffer_load_dwordx4 v4, s[8:11], s46 offen offset:0 lds
 v_accvgpr_write_b32 a134, v230
 v_accvgpr_write_b32 a135, v231
 v_accvgpr_write_b32 a136, v232
 v_accvgpr_write_b32 a137, v233
 v_mfma_f32_32x32x16_bf16 v[80:95], a[156:159], v[208:211], v[80:95]
 ds_read_b64_tr_b16 a[156:157], v10 offset:2048
 ds_read_b64_tr_b16 a[158:159], v10 offset:2560
 v_accvgpr_write_b32 a138, v234
 v_accvgpr_write_b32 a139, v235
 v_accvgpr_write_b32 a140, v236
 v_accvgpr_write_b32 a141, v237
 v_accvgpr_write_b32 a142, v238
 v_accvgpr_write_b32 a143, v239
 v_mfma_f32_32x32x16_bf16 v[64:79], a[160:163], v[212:215], v[64:79]
 ds_read_b64_tr_b16 a[160:161], v11 offset:2048
 ds_read_b64_tr_b16 a[162:163], v11 offset:2560
 buffer_load_dwordx4 v5, s[8:11], s46 offen offset:1024 lds
 v_mfma_f32_32x32x16_bf16 v[80:95], a[164:167], v[212:215], v[80:95]
 s_waitcnt lgkmcnt(8)
 ds_read_b64_tr_b16 a[164:165], v10 offset:4096
 ds_read_b64_tr_b16 a[166:167], v10 offset:4608
 s_add_u32 m0, s28, 0x16000
 v_mfma_f32_32x32x16_bf16 v[64:79], a[168:171], v[216:219], v[64:79]
 ds_read_b64_tr_b16 a[168:169], v11 offset:4096
 ds_read_b64_tr_b16 a[170:171], v11 offset:4608
 buffer_load_dwordx4 v4, s[8:11], s47 offen offset:0 lds
 v_mfma_f32_32x32x16_bf16 v[80:95], a[172:175], v[216:219], v[80:95]
 ds_read_b64_tr_b16 a[172:173], v10 offset:6144
 ds_read_b64_tr_b16 a[174:175], v10 offset:6656
 v_mfma_f32_32x32x16_bf16 v[64:79], a[176:179], v[220:223], v[64:79]
 ds_read_b64_tr_b16 a[176:177], v11 offset:6144
 ds_read_b64_tr_b16 a[178:179], v11 offset:6656
 buffer_load_dwordx4 v5, s[8:11], s47 offen offset:1024 lds
 v_mfma_f32_32x32x16_bf16 v[80:95], a[144:147], v[220:223], v[80:95]
 s_waitcnt lgkmcnt(8)
 ds_read_b64_tr_b16 a[144:145], v8 offset:0
 ds_read_b64_tr_b16 a[146:147], v8 offset:512
 s_add_u32 s48, s49, s33
 s_add_u32 m0, s28, 0x18000
 v_mfma_f32_32x32x16_bf16 v[64:79], a[148:151], v[224:227], v[64:79]
 ds_read_b64_tr_b16 a[148:149], v9 offset:0
 ds_read_b64_tr_b16 a[150:151], v9 offset:512
 buffer_load_dwordx4 v6, s[12:15], s48 offen offset:0 lds
 v_mfma_f32_32x32x16_bf16 v[80:95], a[152:155], v[224:227], v[80:95]
 ds_read_b64_tr_b16 a[152:153], v8 offset:2048
 ds_read_b64_tr_b16 a[154:155], v8 offset:2560
 v_mfma_f32_32x32x16_bf16 v[64:79], a[156:159], v[228:231], v[64:79]
 ds_read_b64_tr_b16 a[156:157], v9 offset:2048
 ds_read_b64_tr_b16 a[158:159], v9 offset:2560
 buffer_load_dwordx4 v7, s[12:15], s48 offen offset:1024 lds
 v_mfma_f32_32x32x16_bf16 v[80:95], a[160:163], v[228:231], v[80:95]
 s_waitcnt lgkmcnt(8)
 ds_read_b64_tr_b16 a[160:161], v8 offset:4096
 ds_read_b64_tr_b16 a[162:163], v8 offset:4608
 s_add_u32 s48, s50, s33
 s_add_u32 m0, s28, 0x1a000
 v_mfma_f32_32x32x16_bf16 v[64:79], a[164:167], v[232:235], v[64:79]
 ds_read_b64_tr_b16 a[164:165], v9 offset:4096
 ds_read_b64_tr_b16 a[166:167], v9 offset:4608
 buffer_load_dwordx4 v6, s[12:15], s48 offen offset:0 lds
 v_mfma_f32_32x32x16_bf16 v[80:95], a[168:171], v[232:235], v[80:95]
 ds_read_b64_tr_b16 a[168:169], v8 offset:6144
 ds_read_b64_tr_b16 a[170:171], v8 offset:6656
 v_mfma_f32_32x32x16_bf16 v[64:79], a[172:175], v[236:239], v[64:79]
 ds_read_b64_tr_b16 a[172:173], v9 offset:6144
 ds_read_b64_tr_b16 a[174:175], v9 offset:6656
 buffer_load_dwordx4 v7, s[12:15], s48 offen offset:1024 lds
 v_mfma_f32_32x32x16_bf16 v[80:95], a[176:179], v[236:239], v[80:95]
 s_waitcnt vmcnt(16) lgkmcnt(8)
 s_barrier
 ds_read_b64_tr_b16 a[176:177], v8 offset:8192
 ds_read_b64_tr_b16 a[178:179], v8 offset:8704
 s_add_u32 s48, s51, s33
 s_add_u32 m0, s28, 0x10000
 v_mfma_f32_32x32x16_bf16 v[96:111], a[144:147], a[0:3], v[96:111]
 ds_read_b64_tr_b16 a[144:145], v9 offset:8192
 ds_read_b64_tr_b16 a[146:147], v9 offset:8704
 buffer_load_dwordx4 v6, s[12:15], s48 offen offset:0 lds
 v_add_f32 v64, v64, v240
 v_fma_f32 v24, -v64, v64, v22
 v_add_f32 v65, v65, v241
 v_mfma_f32_32x32x16_bf16 v[112:127], a[148:151], a[0:3], v[112:127]
 ds_read_b64_tr_b16 a[148:149], v8 offset:10240
 ds_read_b64_tr_b16 a[150:151], v8 offset:10752
 v_mul_f32 v24, v24, v64
 v_fma_f32 v25, -v65, v65, v22
 v_add_f32 v66, v66, v242
 v_exp_f32 v24, v24
 v_mfma_f32_32x32x16_bf16 v[96:111], a[152:155], a[4:7], v[96:111]
 ds_read_b64_tr_b16 a[152:153], v9 offset:10240
 ds_read_b64_tr_b16 a[154:155], v9 offset:10752
 buffer_load_dwordx4 v7, s[12:15], s48 offen offset:1024 lds
 v_mul_f32 v25, v25, v65
 v_fma_f32 v26, -v66, v66, v22
 v_add_f32 v67, v67, v243
 v_mfma_f32_32x32x16_bf16 v[112:127], a[156:159], a[4:7], v[112:127]
 s_waitcnt lgkmcnt(8)
 ds_read_b64_tr_b16 a[156:157], v8 offset:12288
 ds_read_b64_tr_b16 a[158:159], v8 offset:12800
 s_cmp_eq_u32 s74, 0
 s_cselect_b32 s48, 768, 0
 s_sub_u32 s48, 128, s48
 v_add_u32 v4, s48, v4
 v_add_u32 v5, s48, v5
 s_add_u32 m0, s28, 0x12000
 v_mfma_f32_32x32x16_bf16 v[96:111], a[160:163], a[8:11], v[96:111]
 ds_read_b64_tr_b16 a[160:161], v9 offset:12288
 ds_read_b64_tr_b16 a[162:163], v9 offset:12800
 buffer_load_dwordx4 v4, s[8:11], s39 offen offset:0 lds
 v_add_f32 v24, 1.0, v24
 v_exp_f32 v25, v25
 v_mfma_f32_32x32x16_bf16 v[112:127], a[164:167], a[8:11], v[112:127]
 ds_read_b64_tr_b16 a[164:165], v8 offset:14336
 ds_read_b64_tr_b16 a[166:167], v8 offset:14848
 v_mul_f32 v26, v26, v66
 v_fma_f32 v27, -v67, v67, v22
 v_add_f32 v68, v68, v244
 v_rcp_f32 v24, v24
 v_mfma_f32_32x32x16_bf16 v[96:111], a[168:171], a[12:15], v[96:111]
 ds_read_b64_tr_b16 a[168:169], v9 offset:14336
 ds_read_b64_tr_b16 a[170:171], v9 offset:14848
 buffer_load_dwordx4 v5, s[8:11], s39 offen offset:1024 lds
 v_add_f32 v25, 1.0, v25
 v_exp_f32 v26, v26
 v_mfma_f32_32x32x16_bf16 v[112:127], a[172:175], a[12:15], v[112:127]
 s_waitcnt lgkmcnt(8)
 ds_read_b64_tr_b16 a[172:173], v8 offset:16384
 ds_read_b64_tr_b16 a[174:175], v8 offset:16896
 v_mul_f32 v27, v27, v67
 v_fma_f32 v28, -v68, v68, v22
 v_add_f32 v69, v69, v245
 v_mul_f32 v64, v64, v24
 v_mfma_f32_32x32x16_bf16 v[96:111], a[176:179], a[16:19], v[96:111]
 ds_read_b64_tr_b16 a[176:177], v9 offset:16384
 ds_read_b64_tr_b16 a[178:179], v9 offset:16896
 v_rcp_f32 v25, v25
 v_add_f32 v26, 1.0, v26
 v_exp_f32 v27, v27
 v_mfma_f32_32x32x16_bf16 v[112:127], a[144:147], a[16:19], v[112:127]
 ds_read_b64_tr_b16 a[144:145], v8 offset:18432
 ds_read_b64_tr_b16 a[146:147], v8 offset:18944
 v_mul_f32 v28, v28, v68
 v_fma_f32 v29, -v69, v69, v22
 v_add_f32 v70, v70, v246
 v_mul_f32 v65, v65, v25
 v_mfma_f32_32x32x16_bf16 v[96:111], a[148:151], a[20:23], v[96:111]
 ds_read_b64_tr_b16 a[148:149], v9 offset:18432
 ds_read_b64_tr_b16 a[150:151], v9 offset:18944
 v_rcp_f32 v26, v26
 v_add_f32 v27, 1.0, v27
 v_exp_f32 v28, v28
 v_mfma_f32_32x32x16_bf16 v[112:127], a[152:155], a[20:23], v[112:127]
 s_waitcnt lgkmcnt(8)
 ds_read_b64_tr_b16 a[152:153], v8 offset:20480
 ds_read_b64_tr_b16 a[154:155], v8 offset:20992
 v_mul_f32 v29, v29, v69
 v_fma_f32 v30, -v70, v70, v22
 v_add_f32 v71, v71, v247
 v_cvt_pk_bf16_f32 v64, v64, v65
 v_mul_f32 v66, v66, v26
 v_mfma_f32_32x32x16_bf16 v[96:111], a[156:159], a[24:27], v[96:111]
 ds_read_b64_tr_b16 a[156:157], v9 offset:20480
 ds_read_b64_tr_b16 a[158:159], v9 offset:20992
 v_rcp_f32 v27, v27
 v_add_f32 v28, 1.0, v28
 v_exp_f32 v29, v29
 v_mfma_f32_32x32x16_bf16 v[112:127], a[160:163], a[24:27], v[112:127]
 ds_read_b64_tr_b16 a[160:161], v8 offset:22528
 ds_read_b64_tr_b16 a[162:163], v8 offset:23040
 v_mul_f32 v30, v30, v70
 v_fma_f32 v31, -v71, v71, v22
 v_add_f32 v72, v72, v248
 v_mul_f32 v67, v67, v27
 v_mfma_f32_32x32x16_bf16 v[96:111], a[164:167], a[28:31], v[96:111]
 ds_read_b64_tr_b16 a[164:165], v9 offset:22528
 ds_read_b64_tr_b16 a[166:167], v9 offset:23040
 v_rcp_f32 v28, v28
 v_add_f32 v29, 1.0, v29
 v_exp_f32 v30, v30
 v_mfma_f32_32x32x16_bf16 v[112:127], a[168:171], a[28:31], v[112:127]
 s_waitcnt vmcnt(16) lgkmcnt(8)
 s_barrier
 ds_read_b64_tr_b16 a[168:169], v8 offset:24576
 ds_read_b64_tr_b16 a[170:171], v8 offset:25088
 v_mul_f32 v31, v31, v71
 v_fma_f32 v24, -v72, v72, v22
 v_add_f32 v73, v73, v249
 v_mfma_f32_32x32x16_bf16 v[96:111], a[172:175], a[32:35], v[96:111]
 ds_read_b64_tr_b16 a[172:173], v9 offset:24576
 ds_read_b64_tr_b16 a[174:175], v9 offset:25088
 v_cvt_pk_bf16_f32 v65, v66, v67
 v_mul_f32 v68, v68, v28
 v_rcp_f32 v29, v29
 v_add_f32 v30, 1.0, v30
 v_mfma_f32_32x32x16_bf16 v[112:127], a[176:179], a[32:35], v[112:127]
 ds_read_b64_tr_b16 a[176:177], v8 offset:26624
 ds_read_b64_tr_b16 a[178:179], v8 offset:27136
 v_exp_f32 v31, v31
 v_mul_f32 v24, v24, v72
 v_fma_f32 v25, -v73, v73, v22
 v_add_f32 v74, v74, v250
 v_mfma_f32_32x32x16_bf16 v[96:111], a[144:147], a[36:39], v[96:111]
 ds_read_b64_tr_b16 a[144:145], v9 offset:26624
 ds_read_b64_tr_b16 a[146:147], v9 offset:27136
 v_mul_f32 v69, v69, v29
 v_rcp_f32 v30, v30
 v_add_f32 v31, 1.0, v31
 v_mfma_f32_32x32x16_bf16 v[112:127], a[148:151], a[36:39], v[112:127]
 s_waitcnt lgkmcnt(8)
 ds_read_b64_tr_b16 a[148:149], v8 offset:28672
 ds_read_b64_tr_b16 a[150:151], v8 offset:29184
 v_exp_f32 v24, v24
 v_mul_f32 v25, v25, v73
 v_fma_f32 v26, -v74, v74, v22
 v_add_f32 v75, v75, v251
 v_mfma_f32_32x32x16_bf16 v[96:111], a[152:155], a[40:43], v[96:111]
 ds_read_b64_tr_b16 a[152:153], v9 offset:28672
 ds_read_b64_tr_b16 a[154:155], v9 offset:29184
 v_cvt_pk_bf16_f32 v66, v68, v69
 v_mul_f32 v70, v70, v30
 v_rcp_f32 v31, v31
 v_add_f32 v24, 1.0, v24
 v_mfma_f32_32x32x16_bf16 v[112:127], a[156:159], a[40:43], v[112:127]
 ds_read_b64_tr_b16 a[156:157], v8 offset:30720
 ds_read_b64_tr_b16 a[158:159], v8 offset:31232
 v_exp_f32 v25, v25
 v_mul_f32 v26, v26, v74
 v_fma_f32 v27, -v75, v75, v22
 v_add_f32 v76, v76, v252
 v_mfma_f32_32x32x16_bf16 v[96:111], a[160:163], a[44:47], v[96:111]
 ds_read_b64_tr_b16 a[160:161], v9 offset:30720
 ds_read_b64_tr_b16 a[162:163], v9 offset:31232
 v_mul_f32 v71, v71, v31
 v_rcp_f32 v24, v24
 v_add_f32 v25, 1.0, v25
 v_mfma_f32_32x32x16_bf16 v[112:127], a[164:167], a[44:47], v[112:127]
 s_waitcnt lgkmcnt(8)
 ds_read_b64_tr_b16 a[164:165], v8 offset:32768
 ds_read_b64_tr_b16 a[166:167], v8 offset:33280
 v_exp_f32 v26, v26
 v_mul_f32 v27, v27, v75
 v_fma_f32 v28, -v76, v76, v22
 v_add_f32 v77, v77, v253
 v_mfma_f32_32x32x16_bf16 v[96:111], a[168:171], a[48:51], v[96:111]
 ds_read_b64_tr_b16 a[168:169], v9 offset:32768
 ds_read_b64_tr_b16 a[170:171], v9 offset:33280
 v_cvt_pk_bf16_f32 v67, v70, v71
 v_mul_f32 v72, v72, v24
 v_rcp_f32 v25, v25
 v_add_f32 v26, 1.0, v26
 v_mfma_f32_32x32x16_bf16 v[112:127], a[172:175], a[48:51], v[112:127]
 ds_read_b64_tr_b16 a[172:173], v8 offset:34816
 ds_read_b64_tr_b16 a[174:175], v8 offset:35328
 v_exp_f32 v27, v27
 v_mul_f32 v28, v28, v76
 v_fma_f32 v29, -v77, v77, v22
 v_add_f32 v78, v78, v254
 v_mfma_f32_32x32x16_bf16 v[96:111], a[176:179], a[52:55], v[96:111]
 ds_read_b64_tr_b16 a[176:177], v9 offset:34816
 ds_read_b64_tr_b16 a[178:179], v9 offset:35328
 v_mul_f32 v73, v73, v25
 v_rcp_f32 v26, v26
 v_add_f32 v27, 1.0, v27
 v_mfma_f32_32x32x16_bf16 v[112:127], a[144:147], a[52:55], v[112:127]
 s_waitcnt lgkmcnt(8)
 ds_read_b64_tr_b16 a[144:145], v8 offset:36864
 ds_read_b64_tr_b16 a[146:147], v8 offset:37376
 s_add_u32 m0, s28, 0x2000
 v_exp_f32 v28, v28
 v_mul_f32 v29, v29, v77
 v_fma_f32 v30, -v78, v78, v22
 v_mfma_f32_32x32x16_bf16 v[96:111], a[148:151], a[56:59], v[96:111]
 ds_read_b64_tr_b16 a[148:149], v9 offset:36864
 ds_read_b64_tr_b16 a[150:151], v9 offset:37376
 buffer_load_dwordx4 v4, s[8:11], s40 offen offset:0 lds
 v_add_f32 v79, v79, v255
 v_cvt_pk_bf16_f32 v68, v72, v73
 v_mul_f32 v74, v74, v26
 v_mfma_f32_32x32x16_bf16 v[112:127], a[152:155], a[56:59], v[112:127]
 ds_read_b64_tr_b16 a[152:153], v8 offset:38912
 ds_read_b64_tr_b16 a[154:155], v8 offset:39424
 v_rcp_f32 v27, v27
 v_add_f32 v28, 1.0, v28
 v_exp_f32 v29, v29
 v_mfma_f32_32x32x16_bf16 v[96:111], a[156:159], a[60:63], v[96:111]
 ds_read_b64_tr_b16 a[156:157], v9 offset:38912
 ds_read_b64_tr_b16 a[158:159], v9 offset:39424
 buffer_load_dwordx4 v5, s[8:11], s40 offen offset:1024 lds
 v_mul_f32 v30, v30, v78
 v_fma_f32 v31, -v79, v79, v22
 v_mfma_f32_32x32x16_bf16 v[112:127], a[160:163], a[60:63], v[112:127]
 s_waitcnt vmcnt(14) lgkmcnt(8)
 s_barrier
 ds_read_b64_tr_b16 a[160:161], v8 offset:40960
 ds_read_b64_tr_b16 a[162:163], v8 offset:41472
 s_add_u32 m0, s28, 0x4000
 ds_read_b128 v[240:243], v20 offset:128
 ds_read_b128 v[244:247], v20 offset:160
 v_mfma_f32_32x32x16_bf16 v[96:111], a[164:167], a[64:67], v[96:111]
 ds_read_b64_tr_b16 a[164:165], v9 offset:40960
 ds_read_b64_tr_b16 a[166:167], v9 offset:41472
 buffer_load_dwordx4 v4, s[8:11], s41 offen offset:0 lds
 ds_read_b128 v[248:251], v20 offset:192
 ds_read_b128 v[252:255], v20 offset:224
 v_mul_f32 v75, v75, v27
 v_mfma_f32_32x32x16_bf16 v[112:127], a[168:171], a[64:67], v[112:127]
 ds_read_b64_tr_b16 a[168:169], v8 offset:43008
 ds_read_b64_tr_b16 a[170:171], v8 offset:43520
 v_rcp_f32 v28, v28
 v_add_f32 v29, 1.0, v29
 v_exp_f32 v30, v30
 v_mfma_f32_32x32x16_bf16 v[96:111], a[172:175], a[68:71], v[96:111]
 ds_read_b64_tr_b16 a[172:173], v9 offset:43008
 ds_read_b64_tr_b16 a[174:175], v9 offset:43520
 buffer_load_dwordx4 v5, s[8:11], s41 offen offset:1024 lds
 v_mul_f32 v31, v31, v79
 v_cvt_pk_bf16_f32 v69, v74, v75
 v_mul_f32 v76, v76, v28
 v_mfma_f32_32x32x16_bf16 v[112:127], a[176:179], a[68:71], v[112:127]
 s_waitcnt lgkmcnt(12)
 ds_read_b64_tr_b16 a[176:177], v8 offset:45056
 ds_read_b64_tr_b16 a[178:179], v8 offset:45568
 s_add_u32 m0, s28, 0x6000
 v_rcp_f32 v29, v29
 v_add_f32 v30, 1.0, v30
 v_mfma_f32_32x32x16_bf16 v[96:111], a[144:147], a[72:75], v[96:111]
 ds_read_b64_tr_b16 a[144:145], v9 offset:45056
 ds_read_b64_tr_b16 a[146:147], v9 offset:45568
 buffer_load_dwordx4 v4, s[8:11], s42 offen offset:0 lds
 v_exp_f32 v31, v31
 v_mul_f32 v77, v77, v29
 v_mfma_f32_32x32x16_bf16 v[112:127], a[148:151], a[72:75], v[112:127]
 ds_read_b64_tr_b16 a[148:149], v8 offset:47104
 ds_read_b64_tr_b16 a[150:151], v8 offset:47616
 v_rcp_f32 v30, v30
 v_add_f32 v31, 1.0, v31
 v_cvt_pk_bf16_f32 v70, v76, v77
 v_mul_f32 v78, v78, v30
 v_mfma_f32_32x32x16_bf16 v[96:111], a[152:155], a[76:79], v[96:111]
 ds_read_b64_tr_b16 a[152:153], v9 offset:47104
 ds_read_b64_tr_b16 a[154:155], v9 offset:47616
 buffer_load_dwordx4 v5, s[8:11], s42 offen offset:1024 lds
 v_rcp_f32 v31, v31
 s_nop 0
 v_mul_f32 v79, v79, v31
 v_mfma_f32_32x32x16_bf16 v[112:127], a[156:159], a[76:79], v[112:127]
 s_waitcnt lgkmcnt(8)
 ds_read_b64_tr_b16 a[156:157], v10 offset:8192
 ds_read_b64_tr_b16 a[158:159], v10 offset:8704
 s_add_u32 m0, s28, 0x8000
 v_cvt_pk_bf16_f32 v71, v78, v79
 s_add_u32 s69, s65, 0x0
 v_mfma_f32_32x32x16_bf16 v[96:111], a[160:163], a[80:83], v[96:111]
 ds_read_b64_tr_b16 a[160:161], v11 offset:8192
 ds_read_b64_tr_b16 a[162:163], v11 offset:8704
 buffer_load_dwordx4 v4, s[8:11], s43 offen offset:0 lds
 buffer_store_dwordx4 v[64:67], v33, s[4:7], s69 offen offset:0 sc1
 v_mfma_f32_32x32x16_bf16 v[112:127], a[164:167], a[80:83], v[112:127]
 ds_read_b64_tr_b16 a[164:165], v10 offset:10240
 ds_read_b64_tr_b16 a[166:167], v10 offset:10752
 buffer_store_dwordx4 v[68:71], v33, s[4:7], s69 offen offset:1024 sc1
 v_add_f32 v80, v80, v240
 v_fma_f32 v24, -v80, v80, v22
 v_add_f32 v81, v81, v241
 v_mfma_f32_32x32x16_bf16 v[96:111], a[168:171], a[84:87], v[96:111]
 ds_read_b64_tr_b16 a[168:169], v11 offset:10240
 ds_read_b64_tr_b16 a[170:171], v11 offset:10752
 v_mul_f32 v24, v24, v80
 v_fma_f32 v25, -v81, v81, v22
 v_add_f32 v82, v82, v242
 v_exp_f32 v24, v24
 v_mfma_f32_32x32x16_bf16 v[112:127], a[172:175], a[84:87], v[112:127]
 s_waitcnt lgkmcnt(8)
 ds_read_b64_tr_b16 a[172:173], v10 offset:12288
 ds_read_b64_tr_b16 a[174:175], v10 offset:12800
 v_mul_f32 v25, v25, v81
 v_fma_f32 v26, -v82, v82, v22
 v_add_f32 v83, v83, v243
 v_add_f32 v24, 1.0, v24
 v_mfma_f32_32x32x16_bf16 v[96:111], a[176:179], a[88:91], v[96:111]
 ds_read_b64_tr_b16 a[176:177], v11 offset:12288
 ds_read_b64_tr_b16 a[178:179], v11 offset:12800
 v_exp_f32 v25, v25
 v_mul_f32 v26, v26, v82
 v_fma_f32 v27, -v83, v83, v22
 v_add_f32 v84, v84, v244
 v_mfma_f32_32x32x16_bf16 v[112:127], a[144:147], a[88:91], v[112:127]
 ds_read_b64_tr_b16 a[144:145], v10 offset:14336
 ds_read_b64_tr_b16 a[146:147], v10 offset:14848
 buffer_load_dwordx4 v5, s[8:11], s43 offen offset:1024 lds
 v_rcp_f32 v24, v24
 v_add_f32 v25, 1.0, v25
 v_mfma_f32_32x32x16_bf16 v[96:111], a[148:151], a[92:95], v[96:111]
 s_add_u32 m0, s28, 0xa000
 ds_read_b64_tr_b16 a[148:149], v11 offset:14336
 ds_read_b64_tr_b16 a[150:151], v11 offset:14848
 v_exp_f32 v26, v26
 v_mul_f32 v27, v27, v83
 v_fma_f32 v28, -v84, v84, v22
 v_add_f32 v85, v85, v245
 v_mfma_f32_32x32x16_bf16 v[112:127], a[152:155], a[92:95], v[112:127]
 s_waitcnt vmcnt(18) lgkmcnt(8)
 s_barrier
 ds_read_b64_tr_b16 a[152:153], v8 offset:49152
 ds_read_b64_tr_b16 a[154:155], v8 offset:49664
 buffer_load_dwordx4 v4, s[8:11], s44 offen offset:0 lds
 v_mul_f32 v80, v80, v24
 v_mfma_f32_32x32x16_bf16 v[96:111], a[156:159], a[96:99], v[96:111]
 ds_read_b64_tr_b16 a[156:157], v9 offset:49152
 ds_read_b64_tr_b16 a[158:159], v9 offset:49664
 v_rcp_f32 v25, v25
 v_add_f32 v26, 1.0, v26
 v_exp_f32 v27, v27
 v_mfma_f32_32x32x16_bf16 v[112:127], a[160:163], a[96:99], v[112:127]
 ds_read_b64_tr_b16 a[160:161], v8 offset:51200
 ds_read_b64_tr_b16 a[162:163], v8 offset:51712
 buffer_load_dwordx4 v5, s[8:11], s44 offen offset:1024 lds
 v_mul_f32 v28, v28, v84
 v_fma_f32 v29, -v85, v85, v22
 v_add_f32 v86, v86, v246
 v_mfma_f32_32x32x16_bf16 v[96:111], a[164:167], a[100:103], v[96:111]
 s_add_u32 m0, s28, 0xc000
 ds_read_b64_tr_b16 a[164:165], v9 offset:51200
 ds_read_b64_tr_b16 a[166:167], v9 offset:51712
 v_mul_f32 v81, v81, v25
 v_rcp_f32 v26, v26
 v_add_f32 v27, 1.0, v27
 v_mfma_f32_32x32x16_bf16 v[112:127], a[168:171], a[100:103], v[112:127]
 s_waitcnt lgkmcnt(8)
 ds_read_b64_tr_b16 a[168:169], v8 offset:53248
 ds_read_b64_tr_b16 a[170:171], v8 offset:53760
 buffer_load_dwordx4 v4, s[8:11], s45 offen offset:0 lds
 v_exp_f32 v28, v28
 v_mul_f32 v29, v29, v85
 v_mfma_f32_32x32x16_bf16 v[96:111], a[172:175], a[104:107], v[96:111]
 ds_read_b64_tr_b16 a[172:173], v9 offset:53248
 ds_read_b64_tr_b16 a[174:175], v9 offset:53760
 v_fma_f32 v30, -v86, v86, v22
 v_add_f32 v87, v87, v247
 v_cvt_pk_bf16_f32 v80, v80, v81
 v_mul_f32 v82, v82, v26
 v_mfma_f32_32x32x16_bf16 v[112:127], a[176:179], a[104:107], v[112:127]
 ds_read_b64_tr_b16 a[176:177], v8 offset:55296
 ds_read_b64_tr_b16 a[178:179], v8 offset:55808
 buffer_load_dwordx4 v5, s[8:11], s45 offen offset:1024 lds
 v_rcp_f32 v27, v27
 v_add_f32 v28, 1.0, v28
 v_mfma_f32_32x32x16_bf16 v[96:111], a[144:147], a[108:111], v[96:111]
 s_add_u32 m0, s28, 0x1c000
 ds_read_b64_tr_b16 a[144:145], v9 offset:55296
 ds_read_b64_tr_b16 a[146:147], v9 offset:55808
 v_exp_f32 v29, v29
 v_mul_f32 v30, v30, v86
 v_fma_f32 v31, -v87, v87, v22
 v_add_f32 v88, v88, v248
 v_mfma_f32_32x32x16_bf16 v[112:127], a[148:151], a[108:111], v[112:127]
 s_waitcnt lgkmcnt(8)
 ds_read_b64_tr_b16 a[148:149], v10 offset:16384
 ds_read_b64_tr_b16 a[150:151], v10 offset:16896
 buffer_load_dwordx4 v4, s[8:11], s46 offen offset:0 lds
 v_mul_f32 v83, v83, v27
 v_rcp_f32 v28, v28
 v_mfma_f32_32x32x16_bf16 v[96:111], a[152:155], a[112:115], v[96:111]
 ds_read_b64_tr_b16 a[152:153], v11 offset:16384
 ds_read_b64_tr_b16 a[154:155], v11 offset:16896
 v_add_f32 v29, 1.0, v29
 v_exp_f32 v30, v30
 v_mul_f32 v31, v31, v87
 v_fma_f32 v24, -v88, v88, v22
 v_mfma_f32_32x32x16_bf16 v[112:127], a[156:159], a[112:115], v[112:127]
 ds_read_b64_tr_b16 a[156:157], v10 offset:18432
 ds_read_b64_tr_b16 a[158:159], v10 offset:18944
 v_add_f32 v89, v89, v249
 v_cvt_pk_bf16_f32 v81, v82, v83
 v_mul_f32 v84, v84, v28
 v_rcp_f32 v29, v29
 v_mfma_f32_32x32x16_bf16 v[96:111], a[160:163], a[116:119], v[96:111]
 ds_read_b64_tr_b16 a[160:161], v11 offset:18432
 ds_read_b64_tr_b16 a[162:163], v11 offset:18944
 v_add_f32 v30, 1.0, v30
 v_exp_f32 v31, v31
 v_mul_f32 v24, v24, v88
 v_fma_f32 v25, -v89, v89, v22
 v_mfma_f32_32x32x16_bf16 v[112:127], a[164:167], a[116:119], v[112:127]
 s_waitcnt lgkmcnt(8)
 ds_read_b64_tr_b16 a[164:165], v10 offset:20480
 ds_read_b64_tr_b16 a[166:167], v10 offset:20992
 v_add_f32 v90, v90, v250
 v_mul_f32 v85, v85, v29
 v_rcp_f32 v30, v30
 v_add_f32 v31, 1.0, v31
 v_mfma_f32_32x32x16_bf16 v[96:111], a[168:171], a[120:123], v[96:111]
 ds_read_b64_tr_b16 a[168:169], v11 offset:20480
 ds_read_b64_tr_b16 a[170:171], v11 offset:20992
 v_exp_f32 v24, v24
 v_mul_f32 v25, v25, v89
 v_fma_f32 v26, -v90, v90, v22
 v_add_f32 v91, v91, v251
 v_mfma_f32_32x32x16_bf16 v[112:127], a[172:175], a[120:123], v[112:127]
 ds_read_b64_tr_b16 a[172:173], v10 offset:22528
 ds_read_b64_tr_b16 a[174:175], v10 offset:23040
 buffer_load_dwordx4 v5, s[8:11], s46 offen offset:1024 lds
 v_cvt_pk_bf16_f32 v82, v84, v85
 v_mul_f32 v86, v86, v30
 v_mfma_f32_32x32x16_bf16 v[96:111], a[176:179], a[124:127], v[96:111]
 s_add_u32 m0, s28, 0xe000
 ds_read_b64_tr_b16 a[176:177], v11 offset:22528
 ds_read_b64_tr_b16 a[178:179], v11 offset:23040
 v_rcp_f32 v31, v31
 v_add_f32 v24, 1.0, v24
 v_exp_f32 v25, v25
 v_mfma_f32_32x32x16_bf16 v[112:127], a[144:147], a[124:127], v[112:127]
 s_waitcnt vmcnt(18) lgkmcnt(8)
 s_barrier
 ds_read_b64_tr_b16 a[144:145], v16 offset:24576
 ds_read_b64_tr_b16 a[146:147], v16 offset:25600
 buffer_load_dwordx4 v4, s[8:11], s47 offen offset:0 lds
 v_mul_f32 v26, v26, v90
 v_mfma_f32_32x32x16_bf16 v[96:111], a[148:151], a[128:131], v[96:111]
 ds_read_b64_tr_b16 a[148:149], v17 offset:24576
 ds_read_b64_tr_b16 a[150:151], v17 offset:25600
 v_fma_f32 v27, -v91, v91, v22
 v_add_f32 v92, v92, v252
 v_mul_f32 v87, v87, v31
 v_rcp_f32 v24, v24
 v_mfma_f32_32x32x16_bf16 v[112:127], a[152:155], a[128:131], v[112:127]
 ds_read_b64_tr_b16 a[152:153], v16 offset:26624
 ds_read_b64_tr_b16 a[154:155], v16 offset:27648
 buffer_load_dwordx4 v5, s[8:11], s47 offen offset:1024 lds
 v_add_f32 v25, 1.0, v25
 v_exp_f32 v26, v26
 v_mfma_f32_32x32x16_bf16 v[96:111], a[156:159], a[132:135], v[96:111]
 s_add_u32 s48, s49, s73
 ds_read_b64_tr_b16 a[156:157], v17 offset:26624
 ds_read_b64_tr_b16 a[158:159], v17 offset:27648
 s_add_u32 m0, s28, 0x14000
 v_mul_f32 v27, v27, v91
 v_fma_f32 v28, -v92, v92, v22
 v_add_f32 v93, v93, v253
 v_cvt_pk_bf16_f32 v83, v86, v87
 v_mfma_f32_32x32x16_bf16 v[112:127], a[160:163], a[132:135], v[112:127]
 s_waitcnt lgkmcnt(8)
 ds_read_b64_tr_b16 a[160:161], v16 offset:32768
 ds_read_b64_tr_b16 a[162:163], v16 offset:33792
 buffer_load_dwordx4 v6, s[12:15], s48 offen offset:0 lds
 v_mul_f32 v88, v88, v24
 v_rcp_f32 v25, v25
 v_mfma_f32_32x32x16_bf16 v[96:111], a[164:167], a[136:139], v[96:111]
 ds_read_b64_tr_b16 a[164:165], v17 offset:32768
 ds_read_b64_tr_b16 a[166:167], v17 offset:33792
 v_add_f32 v26, 1.0, v26
 v_exp_f32 v27, v27
 v_mul_f32 v28, v28, v92
 v_fma_f32 v29, -v93, v93, v22
 v_mfma_f32_32x32x16_bf16 v[112:127], a[168:171], a[136:139], v[112:127]
 ds_read_b64_tr_b16 a[168:169], v16 offset:34816
 ds_read_b64_tr_b16 a[170:171], v16 offset:35840
 buffer_load_dwordx4 v7, s[12:15], s48 offen offset:1024 lds
 v_add_f32 v94, v94, v254
 v_mul_f32 v89, v89, v25
 v_mfma_f32_32x32x16_bf16 v[96:111], a[172:175], a[140:143], v[96:111]
 s_add_u32 s48, s50, s73
 ds_read_b64_tr_b16 a[172:173], v17 offset:34816
 ds_read_b64_tr_b16 a[174:175], v17 offset:35840
 s_add_u32 m0, s28, 0x1e000
 v_rcp_f32 v26, v26
 v_add_f32 v27, 1.0, v27
 v_mfma_f32_32x32x16_bf16 v[112:127], a[176:179], a[140:143], v[112:127]
 s_waitcnt lgkmcnt(8)
 ds_read_b64_tr_b16 a[176:177], v14 offset:57344
 ds_read_b64_tr_b16 a[178:179], v14 offset:58368
 buffer_load_dwordx4 v6, s[12:15], s48 offen offset:0 lds
 v_exp_f32 v28, v28
 v_mul_f32 v29, v29, v93
 v_mfma_f32_32x32x16_bf16 v[128:143], a[144:147], v[64:67], 0
 ds_read_b64_tr_b16 a[144:145], v15 offset:57344
 ds_read_b64_tr_b16 a[146:147], v15 offset:58368
 v_fma_f32 v30, -v94, v94, v22
 v_add_f32 v95, v95, v255
 v_cvt_pk_bf16_f32 v84, v88, v89
 v_mul_f32 v90, v90, v26
 v_mfma_f32_32x32x16_bf16 v[144:159], a[148:151], v[64:67], 0
 ds_read_b64_tr_b16 a[148:149], v14 offset:59392
 ds_read_b64_tr_b16 a[150:151], v14 offset:60416
 buffer_load_dwordx4 v7, s[12:15], s48 offen offset:1024 lds
 v_rcp_f32 v27, v27
 v_add_f32 v28, 1.0, v28
 v_mfma_f32_32x32x16_bf16 v[128:143], a[152:155], v[68:71], v[128:143]
 s_add_u32 s48, s51, s73
 ds_read_b64_tr_b16 a[152:153], v15 offset:59392
 ds_read_b64_tr_b16 a[154:155], v15 offset:60416
 s_add_u32 m0, s28, 0x16000
 v_exp_f32 v29, v29
 v_mul_f32 v30, v30, v94
 v_fma_f32 v31, -v95, v95, v22
 v_mfma_f32_32x32x16_bf16 v[144:159], a[156:159], v[68:71], v[144:159]
 s_waitcnt lgkmcnt(8)
 s_barrier
 ds_read_b64_tr_b16 a[156:157], v16 offset:28672
 ds_read_b64_tr_b16 a[158:159], v16 offset:29696
 buffer_load_dwordx4 v6, s[12:15], s48 offen offset:0 lds
 v_mul_f32 v91, v91, v27
 v_mfma_f32_32x32x16_bf16 v[160:175], a[160:163], v[64:67], 0
 ds_read_b64_tr_b16 a[160:161], v17 offset:28672
 ds_read_b64_tr_b16 a[162:163], v17 offset:29696
 v_rcp_f32 v28, v28
 v_add_f32 v29, 1.0, v29
 v_exp_f32 v30, v30
 v_mfma_f32_32x32x16_bf16 v[176:191], a[164:167], v[64:67], 0
 ds_read_b64_tr_b16 a[164:165], v16 offset:30720
 ds_read_b64_tr_b16 a[166:167], v16 offset:31744
 buffer_load_dwordx4 v7, s[12:15], s48 offen offset:1024 lds
 v_mul_f32 v31, v31, v95
 v_cvt_pk_bf16_f32 v85, v90, v91
 v_mul_f32 v92, v92, v28
 v_mfma_f32_32x32x16_bf16 v[160:175], a[168:171], v[68:71], v[160:175]
 ds_read_b64_tr_b16 a[168:169], v17 offset:30720
 ds_read_b64_tr_b16 a[170:171], v17 offset:31744
 s_cmp_eq_u32 s75, 0
 s_cselect_b32 s48, 768, 0
 s_sub_u32 s48, 128, s48
 v_add_u32 v4, s48, v4
 v_add_u32 v5, s48, v5
 s_add_u32 m0, s28, 0x20000
 v_mfma_f32_32x32x16_bf16 v[176:191], a[172:175], v[68:71], v[176:191]
 s_waitcnt lgkmcnt(8)
 ds_read_b64_tr_b16 a[172:173], v16 offset:36864
 ds_read_b64_tr_b16 a[174:175], v16 offset:37888
 buffer_load_dwordx4 v4, s[8:11], s39 offen offset:0 lds
 v_rcp_f32 v29, v29
 v_add_f32 v30, 1.0, v30
 v_mfma_f32_32x32x16_bf16 v[192:207], a[176:179], v[64:67], 0
 ds_read_b64_tr_b16 a[176:177], v17 offset:36864
 ds_read_b64_tr_b16 a[178:179], v17 offset:37888
 v_exp_f32 v31, v31
 v_mul_f32 v93, v93, v29
 v_rcp_f32 v30, v30
 v_mfma_f32_32x32x16_bf16 v[208:223], a[144:147], v[64:67], 0
 ds_read_b64_tr_b16 a[144:145], v16 offset:38912
 ds_read_b64_tr_b16 a[146:147], v16 offset:39936
 buffer_load_dwordx4 v5, s[8:11], s39 offen offset:1024 lds
 v_add_f32 v31, 1.0, v31
 v_cvt_pk_bf16_f32 v86, v92, v93
 v_mul_f32 v94, v94, v30
 v_mfma_f32_32x32x16_bf16 v[192:207], a[148:151], v[68:71], v[192:207]
 s_add_u32 m0, s28, 0x22000
 ds_read_b64_tr_b16 a[148:149], v17 offset:38912
 ds_read_b64_tr_b16 a[150:151], v17 offset:39936
 v_rcp_f32 v31, v31
 s_nop 0
 v_mul_f32 v95, v95, v31
 v_cvt_pk_bf16_f32 v87, v94, v95
 s_add_u32 s69, s65, 0x0
 buffer_store_dwordx4 v[80:83], v33, s[4:7], s69 offen offset:2048 sc1
 buffer_store_dwordx4 v[84:87], v33, s[4:7], s69 offen offset:3072 sc1
 v_mfma_f32_32x32x16_bf16 v[208:223], a[152:155], v[68:71], v[208:223]
 s_waitcnt lgkmcnt(8)
 ds_read_b64_tr_b16 a[152:153], v14 offset:61440
 ds_read_b64_tr_b16 a[154:155], v14 offset:62464
 buffer_load_dwordx4 v4, s[8:11], s40 offen offset:0 lds
 v_fma_f32 v24, -v96, v96, v22
 v_mul_f32 v24, v24, v96
 v_fma_f32 v25, -v97, v97, v22
 v_mfma_f32_32x32x16_bf16 v[128:143], a[156:159], v[80:83], v[128:143]
 ds_read_b64_tr_b16 a[156:157], v15 offset:61440
 ds_read_b64_tr_b16 a[158:159], v15 offset:62464
 ds_read_b128 v[240:243], v20 offset:640
 ds_read_b128 v[244:247], v20 offset:672
 v_exp_f32 v24, v24
 v_mfma_f32_32x32x16_bf16 v[144:159], a[160:163], v[80:83], v[144:159]
 ds_read_b64_tr_b16 a[160:161], v14 offset:63488
 ds_read_b64_tr_b16 a[162:163], v14 offset:64512
 ds_read_b128 v[248:251], v20 offset:704
 ds_read_b128 v[252:255], v20 offset:736
 buffer_load_dwordx4 v5, s[8:11], s40 offen offset:1024 lds
 v_mfma_f32_32x32x16_bf16 v[128:143], a[164:167], v[84:87], v[128:143]
 ds_read_b64_tr_b16 a[164:165], v15 offset:63488
 ds_read_b64_tr_b16 a[166:167], v15 offset:64512
 ds_read_b128 v[64:67], v20 offset:512
 ds_read_b128 v[68:71], v20 offset:544
 s_add_u32 m0, s28, 0x18000
 v_mul_f32 v25, v25, v97
 v_mfma_f32_32x32x16_bf16 v[144:159], a[168:171], v[84:87], v[144:159]
 s_waitcnt vmcnt(28) lgkmcnt(14)
 s_barrier
 ds_read_b64_tr_b16 a[168:169], v10 offset:0
 ds_read_b64_tr_b16 a[170:171], v10 offset:512
 ds_read_b128 v[72:75], v20 offset:576
 ds_read_b128 v[76:79], v20 offset:608
 buffer_load_dwordx4 v4, s[8:11], s41 offen offset:0 lds
 v_mfma_f32_32x32x16_bf16 v[160:175], a[172:175], v[80:83], v[160:175]
 ds_read_b64_tr_b16 a[172:173], v11 offset:0
 ds_read_b64_tr_b16 a[174:175], v11 offset:512
 v_fma_f32 v26, -v98, v98, v22
 v_add_f32 v24, 1.0, v24
 v_exp_f32 v25, v25
 v_mfma_f32_32x32x16_bf16 v[176:191], a[176:179], v[80:83], v[176:191]
 ds_read_b64_tr_b16 a[176:177], v10 offset:2048
 ds_read_b64_tr_b16 a[178:179], v10 offset:2560
 buffer_load_dwordx4 v5, s[8:11], s41 offen offset:1024 lds
 v_mul_f32 v26, v26, v98
 v_fma_f32 v27, -v99, v99, v22
 v_mfma_f32_32x32x16_bf16 v[160:175], a[144:147], v[84:87], v[160:175]
 s_add_u32 m0, s28, 0x24000
 ds_read_b64_tr_b16 a[144:145], v11 offset:2048
 ds_read_b64_tr_b16 a[146:147], v11 offset:2560
 v_rcp_f32 v24, v24
 v_add_f32 v25, 1.0, v25
 v_mfma_f32_32x32x16_bf16 v[176:191], a[148:151], v[84:87], v[176:191]
 s_waitcnt lgkmcnt(12)
 ds_read_b64_tr_b16 a[148:149], v10 offset:4096
 ds_read_b64_tr_b16 a[150:151], v10 offset:4608
 buffer_load_dwordx4 v4, s[8:11], s42 offen offset:0 lds
 v_exp_f32 v26, v26
 v_mfma_f32_32x32x16_bf16 v[192:207], a[152:155], v[80:83], v[192:207]
 ds_read_b64_tr_b16 a[152:153], v11 offset:4096
 ds_read_b64_tr_b16 a[154:155], v11 offset:4608
 v_mul_f32 v27, v27, v99
 v_fma_f32 v28, -v100, v100, v22
 v_mul_f32 v96, v96, v24
 v_mfma_f32_32x32x16_bf16 v[208:223], a[156:159], v[80:83], v[208:223]
 ds_read_b64_tr_b16 a[156:157], v10 offset:6144
 ds_read_b64_tr_b16 a[158:159], v10 offset:6656
 buffer_load_dwordx4 v5, s[8:11], s42 offen offset:1024 lds
 v_rcp_f32 v25, v25
 v_mfma_f32_32x32x16_bf16 v[192:207], a[160:163], v[84:87], v[192:207]
 ds_read_b64_tr_b16 a[160:161], v11 offset:6144
 ds_read_b64_tr_b16 a[162:163], v11 offset:6656
 v_add_f32 v26, 1.0, v26
 v_exp_f32 v27, v27
 v_mul_f32 v28, v28, v100
 v_mfma_f32_32x32x16_bf16 v[208:223], a[164:167], v[84:87], v[208:223]
 s_waitcnt lgkmcnt(8)
 ds_read_b64_tr_b16 a[164:165], v8 offset:0
 ds_read_b64_tr_b16 a[166:167], v8 offset:512
 v_fma_f32 v29, -v101, v101, v22
 v_mul_f32 v97, v97, v25
 v_rcp_f32 v26, v26
 v_mfma_f32_32x32x16_bf16 v[64:79], a[168:171], a[0:3], v[64:79]
 ds_read_b64_tr_b16 a[168:169], v9 offset:0
 ds_read_b64_tr_b16 a[170:171], v9 offset:512
 v_add_f32 v27, 1.0, v27
 v_exp_f32 v28, v28
 v_mul_f32 v29, v29, v101
 v_mfma_f32_32x32x16_bf16 v[80:95], a[172:175], a[0:3], v[240:255]
 ds_read_b64_tr_b16 a[172:173], v8 offset:2048
 ds_read_b64_tr_b16 a[174:175], v8 offset:2560
 v_fma_f32 v30, -v102, v102, v22
 v_cvt_pk_bf16_f32 v96, v96, v97
 v_mul_f32 v98, v98, v26
 v_mfma_f32_32x32x16_bf16 v[64:79], a[176:179], a[4:7], v[64:79]
 ds_read_b64_tr_b16 a[176:177], v9 offset:2048
 ds_read_b64_tr_b16 a[178:179], v9 offset:2560
 v_rcp_f32 v27, v27
 v_add_f32 v28, 1.0, v28
 v_mfma_f32_32x32x16_bf16 v[80:95], a[144:147], a[4:7], v[80:95]
 s_waitcnt lgkmcnt(8)
 ds_read_b64_tr_b16 a[144:145], v8 offset:4096
 ds_read_b64_tr_b16 a[146:147], v8 offset:4608
 v_exp_f32 v29, v29
 v_mul_f32 v30, v30, v102
 v_fma_f32 v31, -v103, v103, v22
 v_mfma_f32_32x32x16_bf16 v[64:79], a[148:151], a[8:11], v[64:79]
 s_add_u32 m0, s28, 0x26000
 ds_read_b64_tr_b16 a[148:149], v9 offset:4096
 ds_read_b64_tr_b16 a[150:151], v9 offset:4608
 v_mul_f32 v99, v99, v27
 v_rcp_f32 v28, v28
 v_add_f32 v29, 1.0, v29
 v_mfma_f32_32x32x16_bf16 v[80:95], a[152:155], a[8:11], v[80:95]
 ds_read_b64_tr_b16 a[152:153], v8 offset:6144
 ds_read_b64_tr_b16 a[154:155], v8 offset:6656
 buffer_load_dwordx4 v4, s[8:11], s43 offen offset:0 lds
 v_exp_f32 v30, v30
 v_mfma_f32_32x32x16_bf16 v[64:79], a[156:159], a[12:15], v[64:79]
 ds_read_b64_tr_b16 a[156:157], v9 offset:6144
 ds_read_b64_tr_b16 a[158:159], v9 offset:6656
 v_mul_f32 v31, v31, v103
 v_fma_f32 v24, -v104, v104, v22
 v_cvt_pk_bf16_f32 v97, v98, v99
 v_mul_f32 v100, v100, v28
 v_mfma_f32_32x32x16_bf16 v[80:95], a[160:163], a[12:15], v[80:95]
 s_waitcnt vmcnt(29) lgkmcnt(8)
 s_barrier
 ds_read_b64_tr_b16 a[160:161], v8 offset:8192
 ds_read_b64_tr_b16 a[162:163], v8 offset:8704
 buffer_load_dwordx4 v5, s[8:11], s43 offen offset:1024 lds
 v_mfma_f32_32x32x16_bf16 v[64:79], a[164:167], a[16:19], v[64:79]
 ds_read_b64_tr_b16 a[164:165], v9 offset:8192
 ds_read_b64_tr_b16 a[166:167], v9 offset:8704
 buffer_store_dwordx4 v[40:43], v60, s[4:7], 0 offen sc1
 v_rcp_f32 v29, v29
 v_mfma_f32_32x32x16_bf16 v[80:95], a[168:171], a[16:19], v[80:95]
 s_add_u32 m0, s28, 0x10000
 ds_read_b64_tr_b16 a[168:169], v8 offset:10240
 ds_read_b64_tr_b16 a[170:171], v8 offset:10752
 v_add_f32 v30, 1.0, v30
 v_exp_f32 v31, v31
 v_mul_f32 v24, v24, v104
 v_mfma_f32_32x32x16_bf16 v[64:79], a[172:175], a[20:23], v[64:79]
 ds_read_b64_tr_b16 a[172:173], v9 offset:10240
 ds_read_b64_tr_b16 a[174:175], v9 offset:10752
 buffer_load_dwordx4 v4, s[8:11], s44 offen offset:0 lds
 v_fma_f32 v25, -v105, v105, v22
 v_mul_f32 v101, v101, v29
 v_mfma_f32_32x32x16_bf16 v[80:95], a[176:179], a[20:23], v[80:95]
 s_waitcnt lgkmcnt(8)
 ds_read_b64_tr_b16 a[176:177], v8 offset:12288
 ds_read_b64_tr_b16 a[178:179], v8 offset:12800
 v_rcp_f32 v30, v30
 v_add_f32 v31, 1.0, v31
 v_mfma_f32_32x32x16_bf16 v[64:79], a[144:147], a[24:27], v[64:79]
 ds_read_b64_tr_b16 a[144:145], v9 offset:12288
 ds_read_b64_tr_b16 a[146:147], v9 offset:12800
 buffer_load_dwordx4 v5, s[8:11], s44 offen offset:1024 lds
 v_exp_f32 v24, v24
 v_mfma_f32_32x32x16_bf16 v[80:95], a[148:151], a[24:27], v[80:95]
 s_add_u32 m0, s28, 0x12000
 ds_read_b64_tr_b16 a[148:149], v8 offset:14336
 ds_read_b64_tr_b16 a[150:151], v8 offset:14848
 v_mul_f32 v25, v25, v105
 v_fma_f32 v26, -v106, v106, v22
 v_cvt_pk_bf16_f32 v98, v100, v101
 v_mul_f32 v102, v102, v30
 v_mfma_f32_32x32x16_bf16 v[64:79], a[152:155], a[28:31], v[64:79]
 ds_read_b64_tr_b16 a[152:153], v9 offset:14336
 ds_read_b64_tr_b16 a[154:155], v9 offset:14848
 buffer_load_dwordx4 v4, s[8:11], s45 offen offset:0 lds
 v_rcp_f32 v31, v31
 v_mfma_f32_32x32x16_bf16 v[80:95], a[156:159], a[28:31], v[80:95]
 s_waitcnt lgkmcnt(8)
 ds_read_b64_tr_b16 a[156:157], v8 offset:16384
 ds_read_b64_tr_b16 a[158:159], v8 offset:16896
 v_add_f32 v24, 1.0, v24
 v_exp_f32 v25, v25
 v_mul_f32 v26, v26, v106
 v_mfma_f32_32x32x16_bf16 v[64:79], a[160:163], a[32:35], v[64:79]
 ds_read_b64_tr_b16 a[160:161], v9 offset:16384
 ds_read_b64_tr_b16 a[162:163], v9 offset:16896
 buffer_store_dwordx4 v[44:47], v32, s[4:7], s62 offen offset:0 sc1
 v_fma_f32 v27, -v107, v107, v22
 v_mul_f32 v103, v103, v31
 v_mfma_f32_32x32x16_bf16 v[80:95], a[164:167], a[32:35], v[80:95]
 ds_read_b64_tr_b16 a[164:165], v8 offset:18432
 ds_read_b64_tr_b16 a[166:167], v8 offset:18944
 v_rcp_f32 v24, v24
 v_add_f32 v25, 1.0, v25
 v_mfma_f32_32x32x16_bf16 v[64:79], a[168:171], a[36:39], v[64:79]
 ds_read_b64_tr_b16 a[168:169], v9 offset:18432
 ds_read_b64_tr_b16 a[170:171], v9 offset:18944
 buffer_load_dwordx4 v5, s[8:11], s45 offen offset:1024 lds
 v_exp_f32 v26, v26
 v_mfma_f32_32x32x16_bf16 v[80:95], a[172:175], a[36:39], v[80:95]
 s_waitcnt lgkmcnt(8)
 ds_read_b64_tr_b16 a[172:173], v8 offset:20480
 ds_read_b64_tr_b16 a[174:175], v8 offset:20992
 s_add_u32 m0, s28, 0x1a000
 v_mul_f32 v27, v27, v107
 v_fma_f32 v28, -v108, v108, v22
 v_cvt_pk_bf16_f32 v99, v102, v103
 v_mfma_f32_32x32x16_bf16 v[64:79], a[176:179], a[40:43], v[64:79]
 ds_read_b64_tr_b16 a[176:177], v9 offset:20480
 ds_read_b64_tr_b16 a[178:179], v9 offset:20992
 buffer_load_dwordx4 v4, s[8:11], s46 offen offset:0 lds
 v_mul_f32 v104, v104, v24
 v_mfma_f32_32x32x16_bf16 v[80:95], a[144:147], a[40:43], v[80:95]
 ds_read_b64_tr_b16 a[144:145], v8 offset:22528
 ds_read_b64_tr_b16 a[146:147], v8 offset:23040
 v_rcp_f32 v25, v25
 v_add_f32 v26, 1.0, v26
 v_mfma_f32_32x32x16_bf16 v[64:79], a[148:151], a[44:47], v[64:79]
 ds_read_b64_tr_b16 a[148:149], v9 offset:22528
 ds_read_b64_tr_b16 a[150:151], v9 offset:23040
 buffer_load_dwordx4 v5, s[8:11], s46 offen offset:1024 lds
 v_exp_f32 v27, v27
 v_mfma_f32_32x32x16_bf16 v[80:95], a[152:155], a[44:47], v[80:95]
 s_waitcnt vmcnt(32) lgkmcnt(8)
 s_barrier
 ds_read_b64_tr_b16 a[152:153], v8 offset:24576
 ds_read_b64_tr_b16 a[154:155], v8 offset:25088
 v_mul_f32 v28, v28, v108
 v_fma_f32 v29, -v109, v109, v22
 v_mfma_f32_32x32x16_bf16 v[64:79], a[156:159], a[48:51], v[64:79]
 ds_read_b64_tr_b16 a[156:157], v9 offset:24576
 ds_read_b64_tr_b16 a[158:159], v9 offset:25088
 buffer_store_dwordx4 v[44:47], v32, s[4:7], s62 offen offset:1024 sc1
 v_mul_f32 v105, v105, v25
 v_mfma_f32_32x32x16_bf16 v[80:95], a[160:163], a[48:51], v[80:95]
 ds_read_b64_tr_b16 a[160:161], v8 offset:26624
 ds_read_b64_tr_b16 a[162:163], v8 offset:27136
 v_rcp_f32 v26, v26
 v_add_f32 v27, 1.0, v27
 v_mfma_f32_32x32x16_bf16 v[64:79], a[164:167], a[52:55], v[64:79]
 ds_read_b64_tr_b16 a[164:165], v9 offset:26624
 ds_read_b64_tr_b16 a[166:167], v9 offset:27136
 v_exp_f32 v28, v28
 v_mul_f32 v29, v29, v109
 v_fma_f32 v30, -v110, v110, v22
 v_mfma_f32_32x32x16_bf16 v[80:95], a[168:171], a[52:55], v[80:95]
 s_waitcnt lgkmcnt(8)
 ds_read_b64_tr_b16 a[168:169], v8 offset:28672
 ds_read_b64_tr_b16 a[170:171], v8 offset:29184
 v_cvt_pk_bf16_f32 v100, v104, v105
 v_mul_f32 v106, v106, v26
 v_rcp_f32 v27, v27
 v_mfma_f32_32x32x16_bf16 v[64:79], a[172:175], a[56:59], v[64:79]
 ds_read_b64_tr_b16 a[172:173], v9 offset:28672
 ds_read_b64_tr_b16 a[174:175], v9 offset:29184
 v_add_f32 v28, 1.0, v28
 v_exp_f32 v29, v29
 v_mul_f32 v30, v30, v110
 v_mfma_f32_32x32x16_bf16 v[80:95], a[176:179], a[56:59], v[80:95]
 ds_read_b64_tr_b16 a[176:177], v8 offset:30720
 ds_read_b64_tr_b16 a[178:179], v8 offset:31232
 v_fma_f32 v31, -v111, v111, v22
 v_mul_f32 v107, v107, v27
 v_rcp_f32 v28, v28
 v_mfma_f32_32x32x16_bf16 v[64:79], a[144:147], a[60:63], v[64:79]
 ds_read_b64_tr_b16 a[144:145], v9 offset:30720
 ds_read_b64_tr_b16 a[146:147], v9 offset:31232
 v_add_f32 v29, 1.0, v29
 v_exp_f32 v30, v30
 v_mul_f32 v31, v31, v111
 v_mfma_f32_32x32x16_bf16 v[80:95], a[148:151], a[60:63], v[80:95]
 s_waitcnt lgkmcnt(8)
 ds_read_b64_tr_b16 a[148:149], v8 offset:32768
 ds_read_b64_tr_b16 a[150:151], v8 offset:33280
 s_cmp_eq_u32 s27, 0
 s_cselect_b32 s67, 384, 0
 v_cvt_pk_bf16_f32 v101, v106, v107
 v_mul_f32 v108, v108, v28
 v_mfma_f32_32x32x16_bf16 v[64:79], a[152:155], a[64:67], v[64:79]
 ds_read_b64_tr_b16 a[152:153], v9 offset:32768
 ds_read_b64_tr_b16 a[154:155], v9 offset:33280
 buffer_load_dword a254, v43, s[12:15], s67 offen offset:0
 v_rcp_f32 v29, v29
 v_mfma_f32_32x32x16_bf16 v[80:95], a[156:159], a[64:67], v[80:95]
 ds_read_b64_tr_b16 a[156:157], v8 offset:34816
 ds_read_b64_tr_b16 a[158:159], v8 offset:35328
 v_add_f32 v30, 1.0, v30
 v_exp_f32 v31, v31
 v_mul_f32 v109, v109, v29
 v_mfma_f32_32x32x16_bf16 v[64:79], a[160:163], a[68:71], v[64:79]
 ds_read_b64_tr_b16 a[160:161], v9 offset:34816
 ds_read_b64_tr_b16 a[162:163], v9 offset:35328
 v_rcp_f32 v30, v30
 v_add_f32 v31, 1.0, v31
 v_cvt_pk_bf16_f32 v102, v108, v109
 v_mfma_f32_32x32x16_bf16 v[80:95], a[164:167], a[68:71], v[80:95]
 s_waitcnt lgkmcnt(8)
 ds_read_b64_tr_b16 a[164:165], v8 offset:36864
 ds_read_b64_tr_b16 a[166:167], v8 offset:37376
 v_mul_f32 v110, v110, v30
 v_rcp_f32 v31, v31
 s_nop 0
 v_mul_f32 v111, v111, v31
 v_mfma_f32_32x32x16_bf16 v[64:79], a[168:171], a[72:75], v[64:79]
 ds_read_b64_tr_b16 a[168:169], v9 offset:36864
 ds_read_b64_tr_b16 a[170:171], v9 offset:37376
 v_cvt_pk_bf16_f32 v103, v110, v111
 s_add_u32 s69, s65, 0x1000
 v_mfma_f32_32x32x16_bf16 v[80:95], a[172:175], a[72:75], v[80:95]
 ds_read_b64_tr_b16 a[172:173], v8 offset:38912
 ds_read_b64_tr_b16 a[174:175], v8 offset:39424
 buffer_store_dwordx4 v[96:99], v33, s[4:7], s69 offen offset:0 sc1
 buffer_store_dwordx4 v[100:103], v33, s[4:7], s69 offen offset:1024 sc1
 v_mfma_f32_32x32x16_bf16 v[64:79], a[176:179], a[76:79], v[64:79]
 ds_read_b64_tr_b16 a[176:177], v9 offset:38912
 ds_read_b64_tr_b16 a[178:179], v9 offset:39424
 v_fma_f32 v24, -v112, v112, v22
 v_mul_f32 v24, v24, v112
 v_fma_f32 v25, -v113, v113, v22
 v_mfma_f32_32x32x16_bf16 v[80:95], a[144:147], a[76:79], v[80:95]
 s_waitcnt vmcnt(32) lgkmcnt(8)
 s_barrier
 ds_read_b64_tr_b16 a[144:145], v8 offset:40960
 ds_read_b64_tr_b16 a[146:147], v8 offset:41472
 v_exp_f32 v24, v24
 v_mfma_f32_32x32x16_bf16 v[64:79], a[148:151], a[80:83], v[64:79]
 ds_read_b64_tr_b16 a[148:149], v9 offset:40960
 ds_read_b64_tr_b16 a[150:151], v9 offset:41472
 v_mul_f32 v25, v25, v113
 v_fma_f32 v26, -v114, v114, v22
 v_add_f32 v24, 1.0, v24
 v_mfma_f32_32x32x16_bf16 v[80:95], a[152:155], a[80:83], v[80:95]
 ds_read_b64_tr_b16 a[152:153], v8 offset:43008
 ds_read_b64_tr_b16 a[154:155], v8 offset:43520
 v_exp_f32 v25, v25
 v_mul_f32 v26, v26, v114
 v_fma_f32 v27, -v115, v115, v22
 v_mfma_f32_32x32x16_bf16 v[64:79], a[156:159], a[84:87], v[64:79]
 ds_read_b64_tr_b16 a[156:157], v9 offset:43008
 ds_read_b64_tr_b16 a[158:159], v9 offset:43520
 v_rcp_f32 v24, v24
 v_add_f32 v25, 1.0, v25
 v_mfma_f32_32x32x16_bf16 v[80:95], a[160:163], a[84:87], v[80:95]
 s_waitcnt lgkmcnt(8)
 ds_read_b64_tr_b16 a[160:161], v8 offset:45056
 ds_read_b64_tr_b16 a[162:163], v8 offset:45568
 v_exp_f32 v26, v26
 v_mul_f32 v27, v27, v115
 v_fma_f32 v28, -v116, v116, v22
 v_mfma_f32_32x32x16_bf16 v[64:79], a[164:167], a[88:91], v[64:79]
 ds_read_b64_tr_b16 a[164:165], v9 offset:45056
 ds_read_b64_tr_b16 a[166:167], v9 offset:45568
 v_mul_f32 v112, v112, v24
 v_rcp_f32 v25, v25
 v_add_f32 v26, 1.0, v26
 v_mfma_f32_32x32x16_bf16 v[80:95], a[168:171], a[88:91], v[80:95]
 ds_read_b64_tr_b16 a[168:169], v8 offset:47104
 ds_read_b64_tr_b16 a[170:171], v8 offset:47616
 v_exp_f32 v27, v27
 v_mul_f32 v28, v28, v116
 v_fma_f32 v29, -v117, v117, v22
 v_mfma_f32_32x32x16_bf16 v[64:79], a[172:175], a[92:95], v[64:79]
 ds_read_b64_tr_b16 a[172:173], v9 offset:47104
 ds_read_b64_tr_b16 a[174:175], v9 offset:47616
 v_mul_f32 v113, v113, v25
 v_rcp_f32 v26, v26
 v_add_f32 v27, 1.0, v27
 v_mfma_f32_32x32x16_bf16 v[80:95], a[176:179], a[92:95], v[80:95]
 s_waitcnt lgkmcnt(8)
 ds_read_b64_tr_b16 a[176:177], v10 offset:40960
 ds_read_b64_tr_b16 a[178:179], v10 offset:41472
 v_exp_f32 v28, v28
 v_mul_f32 v29, v29, v117
 v_fma_f32 v30, -v118, v118, v22
 v_mfma_f32_32x32x16_bf16 v[64:79], a[144:147], a[96:99], v[64:79]
 ds_read_b64_tr_b16 a[144:145], v11 offset:40960
 ds_read_b64_tr_b16 a[146:147], v11 offset:41472
 v_cvt_pk_bf16_f32 v112, v112, v113
 v_mul_f32 v114, v114, v26
 v_rcp_f32 v27, v27
 v_mfma_f32_32x32x16_bf16 v[80:95], a[148:151], a[96:99], v[80:95]
 ds_read_b64_tr_b16 a[148:149], v10 offset:43008
 ds_read_b64_tr_b16 a[150:151], v10 offset:43520
 v_add_f32 v28, 1.0, v28
 v_exp_f32 v29, v29
 v_mul_f32 v30, v30, v118
 v_mfma_f32_32x32x16_bf16 v[64:79], a[152:155], a[100:103], v[64:79]
 ds_read_b64_tr_b16 a[152:153], v11 offset:43008
 ds_read_b64_tr_b16 a[154:155], v11 offset:43520
 v_fma_f32 v31, -v119, v119, v22
 v_mul_f32 v115, v115, v27
 v_rcp_f32 v28, v28
 v_mfma_f32_32x32x16_bf16 v[80:95], a[156:159], a[100:103], v[80:95]
 s_waitcnt lgkmcnt(8)
 ds_read_b64_tr_b16 a[156:157], v10 offset:45056
 ds_read_b64_tr_b16 a[158:159], v10 offset:45568
 v_add_f32 v29, 1.0, v29
 v_exp_f32 v30, v30
 v_mul_f32 v31, v31, v119
 v_mfma_f32_32x32x16_bf16 v[64:79], a[160:163], a[104:107], v[64:79]
 ds_read_b64_tr_b16 a[160:161], v11 offset:45056
 ds_read_b64_tr_b16 a[162:163], v11 offset:45568
 v_fma_f32 v24, -v120, v120, v22
 v_cvt_pk_bf16_f32 v113, v114, v115
 v_mul_f32 v116, v116, v28
 v_mfma_f32_32x32x16_bf16 v[80:95], a[164:167], a[104:107], v[80:95]
 ds_read_b64_tr_b16 a[164:165], v10 offset:47104
 ds_read_b64_tr_b16 a[166:167], v10 offset:47616
 v_rcp_f32 v29, v29
 v_add_f32 v30, 1.0, v30
 v_mfma_f32_32x32x16_bf16 v[64:79], a[168:171], a[108:111], v[64:79]
 ds_read_b64_tr_b16 a[168:169], v11 offset:47104
 ds_read_b64_tr_b16 a[170:171], v11 offset:47616
 v_exp_f32 v31, v31
 v_mul_f32 v24, v24, v120
 v_fma_f32 v25, -v121, v121, v22
 v_mfma_f32_32x32x16_bf16 v[80:95], a[172:175], a[108:111], v[80:95]
 s_waitcnt vmcnt(28) lgkmcnt(8)
 s_barrier
 ds_read_b64_tr_b16 a[172:173], v8 offset:49152
 ds_read_b64_tr_b16 a[174:175], v8 offset:49664
 v_mul_f32 v117, v117, v29
 v_mfma_f32_32x32x16_bf16 v[64:79], a[176:179], a[112:115], v[64:79]
 ds_read_b64_tr_b16 a[176:177], v9 offset:49152
 ds_read_b64_tr_b16 a[178:179], v9 offset:49664
 v_rcp_f32 v30, v30
 v_add_f32 v31, 1.0, v31
 v_mfma_f32_32x32x16_bf16 v[80:95], a[144:147], a[112:115], v[80:95]
 ds_read_b64_tr_b16 a[144:145], v8 offset:51200
 ds_read_b64_tr_b16 a[146:147], v8 offset:51712
 v_exp_f32 v24, v24
 v_mul_f32 v25, v25, v121
 v_fma_f32 v26, -v122, v122, v22
 v_mfma_f32_32x32x16_bf16 v[64:79], a[148:151], a[116:119], v[64:79]
 ds_read_b64_tr_b16 a[148:149], v9 offset:51200
 ds_read_b64_tr_b16 a[150:151], v9 offset:51712
 v_cvt_pk_bf16_f32 v114, v116, v117
 v_mul_f32 v118, v118, v30
 v_rcp_f32 v31, v31
 v_mfma_f32_32x32x16_bf16 v[80:95], a[152:155], a[116:119], v[80:95]
 s_waitcnt lgkmcnt(8)
 ds_read_b64_tr_b16 a[152:153], v8 offset:53248
 ds_read_b64_tr_b16 a[154:155], v8 offset:53760
 v_add_f32 v24, 1.0, v24
 v_exp_f32 v25, v25
 v_mul_f32 v26, v26, v122
 v_mfma_f32_32x32x16_bf16 v[64:79], a[156:159], a[120:123], v[64:79]
 ds_read_b64_tr_b16 a[156:157], v9 offset:53248
 ds_read_b64_tr_b16 a[158:159], v9 offset:53760
 v_fma_f32 v27, -v123, v123, v22
 v_mul_f32 v119, v119, v31
 v_rcp_f32 v24, v24
 v_mfma_f32_32x32x16_bf16 v[80:95], a[160:163], a[120:123], v[80:95]
 ds_read_b64_tr_b16 a[160:161], v8 offset:55296
 ds_read_b64_tr_b16 a[162:163], v8 offset:55808
 v_add_f32 v25, 1.0, v25
 v_exp_f32 v26, v26
 v_mul_f32 v27, v27, v123
 v_mfma_f32_32x32x16_bf16 v[64:79], a[164:167], a[124:127], v[64:79]
 ds_read_b64_tr_b16 a[164:165], v9 offset:55296
 ds_read_b64_tr_b16 a[166:167], v9 offset:55808
 v_fma_f32 v28, -v124, v124, v22
 v_cvt_pk_bf16_f32 v115, v118, v119
 v_mul_f32 v120, v120, v24
 v_mfma_f32_32x32x16_bf16 v[80:95], a[168:171], a[124:127], v[80:95]
 s_waitcnt lgkmcnt(8)
 ds_read_b64_tr_b16 a[168:169], v16 offset:8192
 ds_read_b64_tr_b16 a[170:171], v16 offset:9216
 v_rcp_f32 v25, v25
 v_add_f32 v26, 1.0, v26
 v_mfma_f32_32x32x16_bf16 v[64:79], a[172:175], a[128:131], v[64:79]
 ds_read_b64_tr_b16 a[172:173], v17 offset:8192
 ds_read_b64_tr_b16 a[174:175], v17 offset:9216
 v_exp_f32 v27, v27
 v_mul_f32 v28, v28, v124
 v_fma_f32 v29, -v125, v125, v22
 v_mfma_f32_32x32x16_bf16 v[80:95], a[176:179], a[128:131], v[80:95]
 ds_read_b64_tr_b16 a[176:177], v16 offset:10240
 ds_read_b64_tr_b16 a[178:179], v16 offset:11264
 v_mul_f32 v121, v121, v25
 v_rcp_f32 v26, v26
 v_add_f32 v27, 1.0, v27
 v_mfma_f32_32x32x16_bf16 v[64:79], a[144:147], a[132:135], v[64:79]
 ds_read_b64_tr_b16 a[144:145], v17 offset:10240
 ds_read_b64_tr_b16 a[146:147], v17 offset:11264
 v_exp_f32 v28, v28
 v_mul_f32 v29, v29, v125
 v_fma_f32 v30, -v126, v126, v22
 v_mfma_f32_32x32x16_bf16 v[80:95], a[148:151], a[132:135], v[80:95]
 s_waitcnt vmcnt(24) lgkmcnt(8)
 s_barrier
 ds_read_b64_tr_b16 a[148:149], v16 offset:49152
 ds_read_b64_tr_b16 a[150:151], v16 offset:50176
 v_cvt_pk_bf16_f32 v116, v120, v121
 v_mul_f32 v122, v122, v26
 v_mfma_f32_32x32x16_bf16 v[64:79], a[152:155], a[136:139], v[64:79]
 ds_read_b64_tr_b16 a[152:153], v17 offset:49152
 ds_read_b64_tr_b16 a[154:155], v17 offset:50176
 v_rcp_f32 v27, v27
 v_add_f32 v28, 1.0, v28
 v_mfma_f32_32x32x16_bf16 v[80:95], a[156:159], a[136:139], v[80:95]
 ds_read_b64_tr_b16 a[156:157], v16 offset:51200
 ds_read_b64_tr_b16 a[158:159], v16 offset:52224
 v_exp_f32 v29, v29
 v_mul_f32 v30, v30, v126
 v_fma_f32 v31, -v127, v127, v22
 v_mfma_f32_32x32x16_bf16 v[64:79], a[160:163], a[140:143], v[64:79]
 ds_read_b64_tr_b16 a[160:161], v17 offset:51200
 ds_read_b64_tr_b16 a[162:163], v17 offset:52224
 v_mul_f32 v123, v123, v27
 v_rcp_f32 v28, v28
 v_add_f32 v29, 1.0, v29
 v_mfma_f32_32x32x16_bf16 v[80:95], a[164:167], a[140:143], v[80:95]
 s_waitcnt lgkmcnt(8)
 ds_read_b64_tr_b16 a[164:165], v16 offset:16384
 ds_read_b64_tr_b16 a[166:167], v16 offset:17408
 v_exp_f32 v30, v30
 v_mul_f32 v31, v31, v127
 v_cvt_pk_bf16_f32 v117, v122, v123
 v_mfma_f32_32x32x16_bf16 v[128:143], a[168:171], v[96:99], v[128:143]
 ds_read_b64_tr_b16 a[168:169], v17 offset:16384
 ds_read_b64_tr_b16 a[170:171], v17 offset:17408
 v_mul_f32 v124, v124, v28
 v_rcp_f32 v29, v29
 v_add_f32 v30, 1.0, v30
 v_mfma_f32_32x32x16_bf16 v[144:159], a[172:175], v[96:99], v[144:159]
 ds_read_b64_tr_b16 a[172:173], v16 offset:18432
 ds_read_b64_tr_b16 a[174:175], v16 offset:19456
 v_exp_f32 v31, v31
 v_mul_f32 v125, v125, v29
 v_mfma_f32_32x32x16_bf16 v[128:143], a[176:179], v[100:103], v[128:143]
 ds_read_b64_tr_b16 a[176:177], v17 offset:18432
 ds_read_b64_tr_b16 a[178:179], v17 offset:19456
 v_rcp_f32 v30, v30
 v_add_f32 v31, 1.0, v31
 v_cvt_pk_bf16_f32 v118, v124, v125
 v_mfma_f32_32x32x16_bf16 v[144:159], a[144:147], v[100:103], v[144:159]
 s_waitcnt lgkmcnt(8)
 ds_read_b64_tr_b16 a[144:145], v16 offset:12288
 ds_read_b64_tr_b16 a[146:147], v16 offset:13312
 v_mul_f32 v126, v126, v30
 v_rcp_f32 v31, v31
 s_nop 0
 v_mul_f32 v127, v127, v31
 v_mfma_f32_32x32x16_bf16 v[160:175], a[148:151], v[96:99], v[160:175]
 s_add_u32 m0, s28, 0x2000
 ds_read_b64_tr_b16 a[148:149], v17 offset:12288
 ds_read_b64_tr_b16 a[150:151], v17 offset:13312
 v_cvt_pk_bf16_f32 v119, v126, v127
 s_add_u32 s69, s65, 0x1000
 v_mfma_f32_32x32x16_bf16 v[176:191], a[152:155], v[96:99], v[176:191]
 ds_read_b64_tr_b16 a[152:153], v16 offset:14336
 ds_read_b64_tr_b16 a[154:155], v16 offset:15360
 buffer_load_dwordx4 v4, s[8:11], s47 offen offset:0 lds
 buffer_store_dwordx4 v[112:115], v33, s[4:7], s69 offen offset:2048 sc1
 v_mfma_f32_32x32x16_bf16 v[160:175], a[156:159], v[100:103], v[160:175]
 ds_read_b64_tr_b16 a[156:157], v17 offset:14336
 ds_read_b64_tr_b16 a[158:159], v17 offset:15360
 buffer_store_dwordx4 v[116:119], v33, s[4:7], s69 offen offset:3072 sc1
 v_fma_f32 v24, -v64, v64, v22
 v_mul_f32 v24, v24, v64
 v_mfma_f32_32x32x16_bf16 v[176:191], a[160:163], v[100:103], v[176:191]
 s_waitcnt vmcnt(25) lgkmcnt(8)
 s_barrier
 ds_read_b64_tr_b16 a[160:161], v16 offset:53248
 ds_read_b64_tr_b16 a[162:163], v16 offset:54272
 v_fma_f32 v25, -v65, v65, v22
 v_mfma_f32_32x32x16_bf16 v[192:207], a[164:167], v[96:99], v[192:207]
 ds_read_b64_tr_b16 a[164:165], v17 offset:53248
 ds_read_b64_tr_b16 a[166:167], v17 offset:54272
 v_exp_f32 v24, v24
 v_mul_f32 v25, v25, v65
 v_fma_f32 v26, -v66, v66, v22
 v_mfma_f32_32x32x16_bf16 v[208:223], a[168:171], v[96:99], v[208:223]
 ds_read_b64_tr_b16 a[168:169], v16 offset:55296
 ds_read_b64_tr_b16 a[170:171], v16 offset:56320
 v_add_f32 v24, 1.0, v24
 v_exp_f32 v25, v25
 v_mul_f32 v26, v26, v66
 v_mfma_f32_32x32x16_bf16 v[192:207], a[172:175], v[100:103], v[192:207]
 ds_read_b64_tr_b16 a[172:173], v17 offset:55296
 ds_read_b64_tr_b16 a[174:175], v17 offset:56320
 v_fma_f32 v27, -v67, v67, v22
 v_rcp_f32 v24, v24
 v_add_f32 v25, 1.0, v25
 v_mfma_f32_32x32x16_bf16 v[208:223], a[176:179], v[100:103], v[208:223]
 s_waitcnt lgkmcnt(8)
 ds_read_b64_tr_b16 a[176:177], v16 offset:20480
 ds_read_b64_tr_b16 a[178:179], v16 offset:21504
 v_exp_f32 v26, v26
 v_mul_f32 v27, v27, v67
 v_fma_f32 v28, -v68, v68, v22
 v_mfma_f32_32x32x16_bf16 v[128:143], a[144:147], v[112:115], v[128:143]
 ds_read_b64_tr_b16 a[144:145], v17 offset:20480
 ds_read_b64_tr_b16 a[146:147], v17 offset:21504
 ds_read_b128 v[240:243], v20 offset:896
 ds_read_b128 v[244:247], v20 offset:928
 v_mul_f32 v64, v64, v24
 v_mfma_f32_32x32x16_bf16 v[144:159], a[148:151], v[112:115], v[144:159]
 ds_read_b64_tr_b16 a[148:149], v16 offset:22528
 ds_read_b64_tr_b16 a[150:151], v16 offset:23552
 ds_read_b128 v[248:251], v20 offset:960
 ds_read_b128 v[252:255], v20 offset:992
 v_rcp_f32 v25, v25
 v_mfma_f32_32x32x16_bf16 v[128:143], a[152:155], v[116:119], v[128:143]
 ds_read_b64_tr_b16 a[152:153], v17 offset:22528
 ds_read_b64_tr_b16 a[154:155], v17 offset:23552
 ds_read_b128 v[96:99], v20 offset:768
 ds_read_b128 v[100:103], v20 offset:800
 v_add_f32 v26, 1.0, v26
 v_mfma_f32_32x32x16_bf16 v[144:159], a[156:159], v[116:119], v[144:159]
 s_waitcnt lgkmcnt(14)
 ds_read_b64_tr_b16 a[156:157], v10 offset:57344
 ds_read_b64_tr_b16 a[158:159], v10 offset:57856
 ds_read_b128 v[104:107], v20 offset:832
 ds_read_b128 v[108:111], v20 offset:864
 v_exp_f32 v27, v27
 v_mfma_f32_32x32x16_bf16 v[160:175], a[160:163], v[112:115], v[160:175]
 ds_read_b64_tr_b16 a[160:161], v11 offset:57344
 ds_read_b64_tr_b16 a[162:163], v11 offset:57856
 buffer_load_dwordx4 v5, s[8:11], s47 offen offset:1024 lds
 v_mul_f32 v28, v28, v68
 v_fma_f32 v29, -v69, v69, v22
 v_mfma_f32_32x32x16_bf16 v[176:191], a[164:167], v[112:115], v[176:191]
 s_add_u32 s48, s49, s74
 ds_read_b64_tr_b16 a[164:165], v10 offset:59392
 ds_read_b64_tr_b16 a[166:167], v10 offset:59904
 s_add_u32 m0, s28, 0x4000
 v_mul_f32 v65, v65, v25
 v_rcp_f32 v26, v26
 v_mfma_f32_32x32x16_bf16 v[160:175], a[168:171], v[116:119], v[160:175]
 ds_read_b64_tr_b16 a[168:169], v11 offset:59392
 ds_read_b64_tr_b16 a[170:171], v11 offset:59904
 buffer_load_dwordx4 v6, s[12:15], s48 offen offset:0 lds
 v_add_f32 v27, 1.0, v27
 v_mfma_f32_32x32x16_bf16 v[176:191], a[172:175], v[116:119], v[176:191]
 s_waitcnt lgkmcnt(12)
 ds_read_b64_tr_b16 a[172:173], v10 offset:61440
 ds_read_b64_tr_b16 a[174:175], v10 offset:61952
 v_exp_f32 v28, v28
 v_mul_f32 v29, v29, v69
 v_fma_f32 v30, -v70, v70, v22
 v_mfma_f32_32x32x16_bf16 v[192:207], a[176:179], v[112:115], v[192:207]
 ds_read_b64_tr_b16 a[176:177], v11 offset:61440
 ds_read_b64_tr_b16 a[178:179], v11 offset:61952
 s_waitcnt vmcnt(8)
 buffer_load_dwordx4 v7, s[12:15], s48 offen offset:1024 lds
 v_cvt_pk_bf16_f32 v64, v64, v65
 v_mfma_f32_32x32x16_bf16 v[208:223], a[144:147], v[112:115], v[208:223]
 s_add_u32 s48, s50, s74
 ds_read_b64_tr_b16 a[144:145], v10 offset:63488
 ds_read_b64_tr_b16 a[146:147], v10 offset:64000
 s_add_u32 m0, s28, 0x6000
 v_mul_f32 v66, v66, v26
 v_rcp_f32 v27, v27
 v_mfma_f32_32x32x16_bf16 v[192:207], a[148:151], v[116:119], v[192:207]
 ds_read_b64_tr_b16 a[148:149], v11 offset:63488
 ds_read_b64_tr_b16 a[150:151], v11 offset:64000
 buffer_load_dwordx4 v6, s[12:15], s48 offen offset:0 lds
 v_add_f32 v28, 1.0, v28
 v_mfma_f32_32x32x16_bf16 v[208:223], a[152:155], v[116:119], v[208:223]
 s_waitcnt lgkmcnt(8)
 s_barrier
 ds_read_b64_tr_b16 a[152:153], v12 offset:0
 ds_read_b64_tr_b16 a[154:155], v12 offset:512
 v_exp_f32 v29, v29
 v_mfma_f32_32x32x16_bf16 v[96:111], a[156:159], a[0:3], v[96:111]
 ds_read_b64_tr_b16 a[156:157], v13 offset:0
 ds_read_b64_tr_b16 a[158:159], v13 offset:512
 s_cmp_lg_u32 s24, 0
 s_cbranch_scc1 mrs
 global_store_byte v39, v23, s[34:35] sc1
mrs:
 v_mfma_f32_32x32x16_bf16 v[112:127], a[160:163], a[0:3], v[240:255]
 ds_read_b64_tr_b16 a[160:161], v12 offset:2048
 ds_read_b64_tr_b16 a[162:163], v12 offset:2560
 v_mul_f32 v30, v30, v70
 v_fma_f32 v31, -v71, v71, v22
 v_mul_f32 v67, v67, v27
 v_mfma_f32_32x32x16_bf16 v[96:111], a[164:167], a[4:7], v[96:111]
 ds_read_b64_tr_b16 a[164:165], v13 offset:2048
 ds_read_b64_tr_b16 a[166:167], v13 offset:2560
 buffer_load_dwordx4 v7, s[12:15], s48 offen offset:1024 lds
 v_rcp_f32 v28, v28
 v_mfma_f32_32x32x16_bf16 v[112:127], a[168:171], a[4:7], v[112:127]
 s_waitcnt lgkmcnt(8)
 ds_read_b64_tr_b16 a[168:169], v12 offset:4096
 ds_read_b64_tr_b16 a[170:171], v12 offset:4608
 v_add_f32 v29, 1.0, v29
 v_exp_f32 v30, v30
 v_mul_f32 v31, v31, v71
 v_mfma_f32_32x32x16_bf16 v[96:111], a[172:175], a[8:11], v[96:111]
 ds_read_b64_tr_b16 a[172:173], v13 offset:4096
 ds_read_b64_tr_b16 a[174:175], v13 offset:4608
 v_fma_f32 v24, -v72, v72, v22
 v_cvt_pk_bf16_f32 v65, v66, v67
 v_mul_f32 v68, v68, v28
 v_mfma_f32_32x32x16_bf16 v[112:127], a[176:179], a[8:11], v[112:127]
 ds_read_b64_tr_b16 a[176:177], v12 offset:6144
 ds_read_b64_tr_b16 a[178:179], v12 offset:6656
 v_rcp_f32 v29, v29
 v_add_f32 v30, 1.0, v30
 v_mfma_f32_32x32x16_bf16 v[96:111], a[144:147], a[12:15], v[96:111]
 ds_read_b64_tr_b16 a[144:145], v13 offset:6144
 ds_read_b64_tr_b16 a[146:147], v13 offset:6656
 v_exp_f32 v31, v31
 v_mul_f32 v24, v24, v72
 v_fma_f32 v25, -v73, v73, v22
 v_mfma_f32_32x32x16_bf16 v[112:127], a[148:151], a[12:15], v[112:127]
 s_waitcnt lgkmcnt(8)
 ds_read_b64_tr_b16 a[148:149], v10 offset:24576
 ds_read_b64_tr_b16 a[150:151], v10 offset:25088
 v_mul_f32 v69, v69, v29
 v_rcp_f32 v30, v30
 v_add_f32 v31, 1.0, v31
 v_mfma_f32_32x32x16_bf16 v[96:111], a[152:155], a[16:19], v[96:111]
 ds_read_b64_tr_b16 a[152:153], v11 offset:24576
 ds_read_b64_tr_b16 a[154:155], v11 offset:25088
 v_exp_f32 v24, v24
 v_mul_f32 v25, v25, v73
 v_fma_f32 v26, -v74, v74, v22
 v_mfma_f32_32x32x16_bf16 v[112:127], a[156:159], a[16:19], v[112:127]
 ds_read_b64_tr_b16 a[156:157], v10 offset:26624
 ds_read_b64_tr_b16 a[158:159], v10 offset:27136
 v_cvt_pk_bf16_f32 v66, v68, v69
 v_mul_f32 v70, v70, v30
 v_rcp_f32 v31, v31
 v_mfma_f32_32x32x16_bf16 v[96:111], a[160:163], a[20:23], v[96:111]
 s_add_u32 s48, s51, s74
 ds_read_b64_tr_b16 a[160:161], v11 offset:26624
 ds_read_b64_tr_b16 a[162:163], v11 offset:27136
 s_add_u32 m0, s28, 0x8000
 v_add_f32 v24, 1.0, v24
 v_exp_f32 v25, v25
 v_mfma_f32_32x32x16_bf16 v[112:127], a[164:167], a[20:23], v[112:127]
 s_waitcnt lgkmcnt(8)
 ds_read_b64_tr_b16 a[164:165], v10 offset:28672
 ds_read_b64_tr_b16 a[166:167], v10 offset:29184
 buffer_load_dwordx4 v6, s[12:15], s48 offen offset:0 lds
 v_mul_f32 v26, v26, v74
 v_fma_f32 v27, -v75, v75, v22
 v_mfma_f32_32x32x16_bf16 v[96:111], a[168:171], a[24:27], v[96:111]
 ds_read_b64_tr_b16 a[168:169], v11 offset:28672
 ds_read_b64_tr_b16 a[170:171], v11 offset:29184
 v_mul_f32 v71, v71, v31
 v_rcp_f32 v24, v24
 v_add_f32 v25, 1.0, v25
 v_mfma_f32_32x32x16_bf16 v[112:127], a[172:175], a[24:27], v[112:127]
 ds_read_b64_tr_b16 a[172:173], v10 offset:30720
 ds_read_b64_tr_b16 a[174:175], v10 offset:31232
 buffer_load_dwordx4 v7, s[12:15], s48 offen offset:1024 lds
 v_exp_f32 v26, v26
 v_mfma_f32_32x32x16_bf16 v[96:111], a[176:179], a[28:31], v[96:111]
 ds_read_b64_tr_b16 a[176:177], v11 offset:30720
 ds_read_b64_tr_b16 a[178:179], v11 offset:31232
 s_cmp_eq_u32 s83, 0
 s_cselect_b32 s48, 768, 0
 s_sub_u32 s48, 128, s48
 v_add_u32 v4, s48, v4
 v_add_u32 v5, s48, v5
 s_add_u32 m0, s28, 0xa000
 v_mfma_f32_32x32x16_bf16 v[112:127], a[144:147], a[28:31], v[112:127]
 s_waitcnt lgkmcnt(8)
 s_barrier
 ds_read_b64_tr_b16 a[144:145], v12 offset:8192
 ds_read_b64_tr_b16 a[146:147], v12 offset:8704
 s_cmp_eq_u32 s27, 2
 s_cselect_b32 s67, 0, 384
 buffer_load_dwordx4 v4, s[8:11], s39 offen offset:0 lds
 v_mfma_f32_32x32x16_bf16 v[96:111], a[148:151], a[32:35], v[96:111]
 ds_read_b64_tr_b16 a[148:149], v13 offset:8192
 ds_read_b64_tr_b16 a[150:151], v13 offset:8704
 buffer_load_dword a255, v43, s[12:15], s67 offen offset:384
 v_mul_f32 v27, v27, v75
 v_fma_f32 v28, -v76, v76, v22
 v_mfma_f32_32x32x16_bf16 v[112:127], a[152:155], a[32:35], v[112:127]
 ds_read_b64_tr_b16 a[152:153], v12 offset:10240
 ds_read_b64_tr_b16 a[154:155], v12 offset:10752
 v_cvt_pk_bf16_f32 v67, v70, v71
 v_mul_f32 v72, v72, v24
 v_rcp_f32 v25, v25
 v_mfma_f32_32x32x16_bf16 v[96:111], a[156:159], a[36:39], v[96:111]
 ds_read_b64_tr_b16 a[156:157], v13 offset:10240
 ds_read_b64_tr_b16 a[158:159], v13 offset:10752
 v_add_f32 v26, 1.0, v26
 v_exp_f32 v27, v27
 v_mul_f32 v28, v28, v76
 v_mfma_f32_32x32x16_bf16 v[112:127], a[160:163], a[36:39], v[112:127]
 s_waitcnt lgkmcnt(8)
 ds_read_b64_tr_b16 a[160:161], v12 offset:12288
 ds_read_b64_tr_b16 a[162:163], v12 offset:12800
 v_fma_f32 v29, -v77, v77, v22
 v_mul_f32 v73, v73, v25
 v_rcp_f32 v26, v26
 v_mfma_f32_32x32x16_bf16 v[96:111], a[164:167], a[40:43], v[96:111]
 ds_read_b64_tr_b16 a[164:165], v13 offset:12288
 ds_read_b64_tr_b16 a[166:167], v13 offset:12800
 v_add_f32 v27, 1.0, v27
 v_exp_f32 v28, v28
 v_mul_f32 v29, v29, v77
 v_mfma_f32_32x32x16_bf16 v[112:127], a[168:171], a[40:43], v[112:127]
 ds_read_b64_tr_b16 a[168:169], v12 offset:14336
 ds_read_b64_tr_b16 a[170:171], v12 offset:14848
 v_fma_f32 v30, -v78, v78, v22
 v_cvt_pk_bf16_f32 v68, v72, v73
 v_mul_f32 v74, v74, v26
 v_mfma_f32_32x32x16_bf16 v[96:111], a[172:175], a[44:47], v[96:111]
 ds_read_b64_tr_b16 a[172:173], v13 offset:14336
 ds_read_b64_tr_b16 a[174:175], v13 offset:14848
 v_rcp_f32 v27, v27
 v_add_f32 v28, 1.0, v28
 v_mfma_f32_32x32x16_bf16 v[112:127], a[176:179], a[44:47], v[112:127]
 s_waitcnt lgkmcnt(8)
 ds_read_b64_tr_b16 a[176:177], v12 offset:16384
 ds_read_b64_tr_b16 a[178:179], v12 offset:16896
 buffer_load_dwordx4 v5, s[8:11], s39 offen offset:1024 lds
 v_exp_f32 v29, v29
 v_mfma_f32_32x32x16_bf16 v[96:111], a[144:147], a[48:51], v[96:111]
 s_add_u32 m0, s28, 0xc000
 ds_read_b64_tr_b16 a[144:145], v13 offset:16384
 ds_read_b64_tr_b16 a[146:147], v13 offset:16896
 v_mul_f32 v30, v30, v78
 v_fma_f32 v31, -v79, v79, v22
 v_mul_f32 v75, v75, v27
 v_mfma_f32_32x32x16_bf16 v[112:127], a[148:151], a[48:51], v[112:127]
 ds_read_b64_tr_b16 a[148:149], v12 offset:18432
 ds_read_b64_tr_b16 a[150:151], v12 offset:18944
 buffer_load_dwordx4 v4, s[8:11], s40 offen offset:0 lds
 v_rcp_f32 v28, v28
 v_mfma_f32_32x32x16_bf16 v[96:111], a[152:155], a[52:55], v[96:111]
 s_waitcnt vmcnt(11)
 buffer_store_dword v23, v34, s[4:7], 0 offen offset:0 sc1
 ds_read_b64_tr_b16 a[152:153], v13 offset:18432
 ds_read_b64_tr_b16 a[154:155], v13 offset:18944
 v_add_f32 v29, 1.0, v29
 v_exp_f32 v30, v30
 v_mul_f32 v31, v31, v79
 v_mfma_f32_32x32x16_bf16 v[112:127], a[156:159], a[52:55], v[112:127]
 s_waitcnt lgkmcnt(8)
 ds_read_b64_tr_b16 a[156:157], v12 offset:20480
 ds_read_b64_tr_b16 a[158:159], v12 offset:20992
 buffer_load_dwordx4 v5, s[8:11], s40 offen offset:1024 lds
 v_cvt_pk_bf16_f32 v69, v74, v75
 v_mul_f32 v76, v76, v28
 v_mfma_f32_32x32x16_bf16 v[96:111], a[160:163], a[56:59], v[96:111]
 ds_read_b64_tr_b16 a[160:161], v13 offset:20480
 ds_read_b64_tr_b16 a[162:163], v13 offset:20992
 v_rcp_f32 v29, v29
 v_add_f32 v30, 1.0, v30
 v_mfma_f32_32x32x16_bf16 v[112:127], a[164:167], a[56:59], v[112:127]
 ds_read_b64_tr_b16 a[164:165], v12 offset:22528
 ds_read_b64_tr_b16 a[166:167], v12 offset:23040
 v_exp_f32 v31, v31
 v_mul_f32 v77, v77, v29
 v_mfma_f32_32x32x16_bf16 v[96:111], a[168:171], a[60:63], v[96:111]
 ds_read_b64_tr_b16 a[168:169], v13 offset:22528
 ds_read_b64_tr_b16 a[170:171], v13 offset:23040
 v_rcp_f32 v30, v30
 v_add_f32 v31, 1.0, v31
 v_cvt_pk_bf16_f32 v70, v76, v77
 v_mfma_f32_32x32x16_bf16 v[112:127], a[172:175], a[60:63], v[112:127]
 s_waitcnt lgkmcnt(8)
 s_barrier
 ds_read_b64_tr_b16 a[172:173], v8 offset:57344
 ds_read_b64_tr_b16 a[174:175], v8 offset:57856
 v_mul_f32 v78, v78, v30
 v_mfma_f32_32x32x16_bf16 v[96:111], a[176:179], a[64:67], v[96:111]
 ds_read_b64_tr_b16 a[176:177], v9 offset:57344
 ds_read_b64_tr_b16 a[178:179], v9 offset:57856
 v_rcp_f32 v31, v31
 s_nop 0
 v_mul_f32 v79, v79, v31
 v_cvt_pk_bf16_f32 v71, v78, v79
 v_mfma_f32_32x32x16_bf16 v[112:127], a[144:147], a[64:67], v[112:127]
 s_add_u32 s69, s65, 0x2000
 ds_read_b64_tr_b16 a[144:145], v8 offset:59392
 ds_read_b64_tr_b16 a[146:147], v8 offset:59904
 buffer_store_dwordx4 v[64:67], v33, s[4:7], s69 offen offset:0 sc1
 buffer_store_dwordx4 v[68:71], v33, s[4:7], s69 offen offset:1024 sc1
 v_mfma_f32_32x32x16_bf16 v[96:111], a[148:151], a[68:71], v[96:111]
 ds_read_b64_tr_b16 a[148:149], v9 offset:59392
 ds_read_b64_tr_b16 a[150:151], v9 offset:59904
 v_fma_f32 v24, -v80, v80, v22
 v_mul_f32 v24, v24, v80
 v_fma_f32 v25, -v81, v81, v22
 v_mfma_f32_32x32x16_bf16 v[112:127], a[152:155], a[68:71], v[112:127]
 s_waitcnt lgkmcnt(8)
 ds_read_b64_tr_b16 a[152:153], v8 offset:61440
 ds_read_b64_tr_b16 a[154:155], v8 offset:61952
 v_exp_f32 v24, v24
 v_mul_f32 v25, v25, v81
 v_fma_f32 v26, -v82, v82, v22
 v_mfma_f32_32x32x16_bf16 v[96:111], a[156:159], a[72:75], v[96:111]
 ds_read_b64_tr_b16 a[156:157], v9 offset:61440
 ds_read_b64_tr_b16 a[158:159], v9 offset:61952
 v_add_f32 v24, 1.0, v24
 v_exp_f32 v25, v25
 v_mul_f32 v26, v26, v82
 v_mfma_f32_32x32x16_bf16 v[112:127], a[160:163], a[72:75], v[112:127]
 ds_read_b64_tr_b16 a[160:161], v8 offset:63488
 ds_read_b64_tr_b16 a[162:163], v8 offset:64000
 v_fma_f32 v27, -v83, v83, v22
 v_rcp_f32 v24, v24
 v_add_f32 v25, 1.0, v25
 v_mfma_f32_32x32x16_bf16 v[96:111], a[164:167], a[76:79], v[96:111]
 ds_read_b64_tr_b16 a[164:165], v9 offset:63488
 ds_read_b64_tr_b16 a[166:167], v9 offset:64000
 v_exp_f32 v26, v26
 v_mul_f32 v27, v27, v83
 v_fma_f32 v28, -v84, v84, v22
 v_mfma_f32_32x32x16_bf16 v[112:127], a[168:171], a[76:79], v[112:127]
 s_waitcnt lgkmcnt(8)
 ds_read_b64_tr_b16 a[168:169], v10 offset:0
 ds_read_b64_tr_b16 a[170:171], v10 offset:512
 v_mul_f32 v80, v80, v24
 v_rcp_f32 v25, v25
 v_add_f32 v26, 1.0, v26
 v_mfma_f32_32x32x16_bf16 v[96:111], a[172:175], a[80:83], v[96:111]
 ds_read_b64_tr_b16 a[172:173], v11 offset:0
 ds_read_b64_tr_b16 a[174:175], v11 offset:512
 v_exp_f32 v27, v27
 v_mul_f32 v28, v28, v84
 v_fma_f32 v29, -v85, v85, v22
 v_mfma_f32_32x32x16_bf16 v[112:127], a[176:179], a[80:83], v[112:127]
 ds_read_b64_tr_b16 a[176:177], v10 offset:2048
 ds_read_b64_tr_b16 a[178:179], v10 offset:2560
 v_mul_f32 v81, v81, v25
 v_rcp_f32 v26, v26
 v_add_f32 v27, 1.0, v27
 v_mfma_f32_32x32x16_bf16 v[96:111], a[144:147], a[84:87], v[96:111]
 ds_read_b64_tr_b16 a[144:145], v11 offset:2048
 ds_read_b64_tr_b16 a[146:147], v11 offset:2560
 v_exp_f32 v28, v28
 v_mul_f32 v29, v29, v85
 v_fma_f32 v30, -v86, v86, v22
 v_mfma_f32_32x32x16_bf16 v[112:127], a[148:151], a[84:87], v[112:127]
 s_waitcnt lgkmcnt(8)
 ds_read_b64_tr_b16 a[148:149], v10 offset:4096
 ds_read_b64_tr_b16 a[150:151], v10 offset:4608
 v_cvt_pk_bf16_f32 v80, v80, v81
 v_mul_f32 v82, v82, v26
 v_rcp_f32 v27, v27
 v_mfma_f32_32x32x16_bf16 v[96:111], a[152:155], a[88:91], v[96:111]
 ds_read_b64_tr_b16 a[152:153], v11 offset:4096
 ds_read_b64_tr_b16 a[154:155], v11 offset:4608
 v_add_f32 v28, 1.0, v28
 v_exp_f32 v29, v29
 v_mul_f32 v30, v30, v86
 v_mfma_f32_32x32x16_bf16 v[112:127], a[156:159], a[88:91], v[112:127]
 ds_read_b64_tr_b16 a[156:157], v10 offset:6144
 ds_read_b64_tr_b16 a[158:159], v10 offset:6656
 v_fma_f32 v31, -v87, v87, v22
 v_mul_f32 v83, v83, v27
 v_rcp_f32 v28, v28
 v_mfma_f32_32x32x16_bf16 v[96:111], a[160:163], a[92:95], v[96:111]
 ds_read_b64_tr_b16 a[160:161], v11 offset:6144
 ds_read_b64_tr_b16 a[162:163], v11 offset:6656
 v_add_f32 v29, 1.0, v29
 v_exp_f32 v30, v30
 v_mul_f32 v31, v31, v87
 v_mfma_f32_32x32x16_bf16 v[112:127], a[164:167], a[92:95], v[112:127]
 s_waitcnt vmcnt(14) lgkmcnt(8)
 s_barrier
 ds_read_b64_tr_b16 a[164:165], v10 offset:32768
 ds_read_b64_tr_b16 a[166:167], v10 offset:33280
 v_fma_f32 v24, -v88, v88, v22
 v_cvt_pk_bf16_f32 v81, v82, v83
 v_mfma_f32_32x32x16_bf16 v[96:111], a[168:171], a[96:99], v[96:111]
 ds_read_b64_tr_b16 a[168:169], v11 offset:32768
 ds_read_b64_tr_b16 a[170:171], v11 offset:33280
 v_mul_f32 v84, v84, v28
 v_rcp_f32 v29, v29
 v_add_f32 v30, 1.0, v30
 v_mfma_f32_32x32x16_bf16 v[112:127], a[172:175], a[96:99], v[112:127]
 ds_read_b64_tr_b16 a[172:173], v10 offset:34816
 ds_read_b64_tr_b16 a[174:175], v10 offset:35328
 v_exp_f32 v31, v31
 v_mul_f32 v24, v24, v88
 v_fma_f32 v25, -v89, v89, v22
 v_mfma_f32_32x32x16_bf16 v[96:111], a[176:179], a[100:103], v[96:111]
 ds_read_b64_tr_b16 a[176:177], v11 offset:34816
 ds_read_b64_tr_b16 a[178:179], v11 offset:35328
 v_mul_f32 v85, v85, v29
 v_rcp_f32 v30, v30
 v_add_f32 v31, 1.0, v31
 v_mfma_f32_32x32x16_bf16 v[112:127], a[144:147], a[100:103], v[112:127]
 s_waitcnt lgkmcnt(8)
 ds_read_b64_tr_b16 a[144:145], v10 offset:36864
 ds_read_b64_tr_b16 a[146:147], v10 offset:37376
 v_exp_f32 v24, v24
 v_mul_f32 v25, v25, v89
 v_fma_f32 v26, -v90, v90, v22
 v_mfma_f32_32x32x16_bf16 v[96:111], a[148:151], a[104:107], v[96:111]
 ds_read_b64_tr_b16 a[148:149], v11 offset:36864
 ds_read_b64_tr_b16 a[150:151], v11 offset:37376
 v_cvt_pk_bf16_f32 v82, v84, v85
 v_mul_f32 v86, v86, v30
 v_rcp_f32 v31, v31
 v_mfma_f32_32x32x16_bf16 v[112:127], a[152:155], a[104:107], v[112:127]
 ds_read_b64_tr_b16 a[152:153], v10 offset:38912
 ds_read_b64_tr_b16 a[154:155], v10 offset:39424
 v_add_f32 v24, 1.0, v24
 v_exp_f32 v25, v25
 v_mul_f32 v26, v26, v90
 v_mfma_f32_32x32x16_bf16 v[96:111], a[156:159], a[108:111], v[96:111]
 ds_read_b64_tr_b16 a[156:157], v11 offset:38912
 ds_read_b64_tr_b16 a[158:159], v11 offset:39424
 v_fma_f32 v27, -v91, v91, v22
 v_mul_f32 v87, v87, v31
 v_rcp_f32 v24, v24
 v_mfma_f32_32x32x16_bf16 v[112:127], a[160:163], a[108:111], v[112:127]
 s_waitcnt lgkmcnt(8)
 ds_read_b64_tr_b16 a[160:161], v8 offset:0
 ds_read_b64_tr_b16 a[162:163], v8 offset:512
 v_add_f32 v25, 1.0, v25
 v_exp_f32 v26, v26
 v_mul_f32 v27, v27, v91
 v_mfma_f32_32x32x16_bf16 v[96:111], a[164:167], a[112:115], v[96:111]
 ds_read_b64_tr_b16 a[164:165], v9 offset:0
 ds_read_b64_tr_b16 a[166:167], v9 offset:512
 v_fma_f32 v28, -v92, v92, v22
 v_cvt_pk_bf16_f32 v83, v86, v87
 v_mul_f32 v88, v88, v24
 v_mfma_f32_32x32x16_bf16 v[112:127], a[168:171], a[112:115], v[112:127]
 s_add_u32 m0, s28, 0xe000
 ds_read_b64_tr_b16 a[168:169], v8 offset:2048
 ds_read_b64_tr_b16 a[170:171], v8 offset:2560
 v_rcp_f32 v25, v25
 v_add_f32 v26, 1.0, v26
 v_mfma_f32_32x32x16_bf16 v[96:111], a[172:175], a[116:119], v[96:111]
 ds_read_b64_tr_b16 a[172:173], v9 offset:2048
 ds_read_b64_tr_b16 a[174:175], v9 offset:2560
 buffer_load_dwordx4 v4, s[8:11], s41 offen offset:0 lds
 v_exp_f32 v27, v27
 v_mfma_f32_32x32x16_bf16 v[112:127], a[176:179], a[116:119], v[112:127]
 s_waitcnt lgkmcnt(8)
 ds_read_b64_tr_b16 a[176:177], v8 offset:4096
 ds_read_b64_tr_b16 a[178:179], v8 offset:4608
 v_mul_f32 v28, v28, v92
 v_fma_f32 v29, -v93, v93, v22
 v_mul_f32 v89, v89, v25
 v_mfma_f32_32x32x16_bf16 v[96:111], a[144:147], a[120:123], v[96:111]
 ds_read_b64_tr_b16 a[144:145], v9 offset:4096
 ds_read_b64_tr_b16 a[146:147], v9 offset:4608
 buffer_load_dwordx4 v5, s[8:11], s41 offen offset:1024 lds
 v_rcp_f32 v26, v26
 v_mfma_f32_32x32x16_bf16 v[112:127], a[148:151], a[120:123], v[112:127]
 s_add_u32 m0, s28, 0x10000
 ds_read_b64_tr_b16 a[148:149], v8 offset:6144
 ds_read_b64_tr_b16 a[150:151], v8 offset:6656
 v_add_f32 v27, 1.0, v27
 v_exp_f32 v28, v28
 v_mul_f32 v29, v29, v93
 v_mfma_f32_32x32x16_bf16 v[96:111], a[152:155], a[124:127], v[96:111]
 ds_read_b64_tr_b16 a[152:153], v9 offset:6144
 ds_read_b64_tr_b16 a[154:155], v9 offset:6656
 buffer_load_dwordx4 v4, s[8:11], s42 offen offset:0 lds
 v_fma_f32 v30, -v94, v94, v22
 v_cvt_pk_bf16_f32 v84, v88, v89
 v_mfma_f32_32x32x16_bf16 v[112:127], a[156:159], a[124:127], v[112:127]
 s_waitcnt vmcnt(11) lgkmcnt(8)
 s_barrier
 ds_read_b64_tr_b16 a[156:157], v14 offset:8192
 ds_read_b64_tr_b16 a[158:159], v14 offset:9216
 v_mul_f32 v90, v90, v26
 v_mfma_f32_32x32x16_bf16 v[96:111], a[160:163], a[128:131], v[96:111]
 ds_read_b64_tr_b16 a[160:161], v15 offset:8192
 ds_read_b64_tr_b16 a[162:163], v15 offset:9216
 buffer_load_dwordx4 v5, s[8:11], s42 offen offset:1024 lds
 v_rcp_f32 v27, v27
 v_mfma_f32_32x32x16_bf16 v[112:127], a[164:167], a[128:131], v[112:127]
 ds_read_b64_tr_b16 a[164:165], v14 offset:10240
 ds_read_b64_tr_b16 a[166:167], v14 offset:11264
 v_add_f32 v28, 1.0, v28
 v_exp_f32 v29, v29
 v_mul_f32 v30, v30, v94
 v_mfma_f32_32x32x16_bf16 v[96:111], a[168:171], a[132:135], v[96:111]
 ds_read_b64_tr_b16 a[168:169], v15 offset:10240
 ds_read_b64_tr_b16 a[170:171], v15 offset:11264
 global_load_dword v40, v61, s[34:35] sc1
 v_fma_f32 v31, -v95, v95, v22
 v_mul_f32 v91, v91, v27
 v_mfma_f32_32x32x16_bf16 v[112:127], a[172:175], a[132:135], v[112:127]
 s_waitcnt lgkmcnt(8)
 ds_read_b64_tr_b16 a[172:173], v14 offset:16384
 ds_read_b64_tr_b16 a[174:175], v14 offset:17408
 s_add_u32 m0, s28, 0x12000
 v_rcp_f32 v28, v28
 v_add_f32 v29, 1.0, v29
 v_mfma_f32_32x32x16_bf16 v[96:111], a[176:179], a[136:139], v[96:111]
 ds_read_b64_tr_b16 a[176:177], v15 offset:16384
 ds_read_b64_tr_b16 a[178:179], v15 offset:17408
 buffer_load_dwordx4 v4, s[8:11], s43 offen offset:0 lds
 v_exp_f32 v30, v30
 v_mfma_f32_32x32x16_bf16 v[112:127], a[144:147], a[136:139], v[112:127]
 ds_read_b64_tr_b16 a[144:145], v14 offset:18432
 ds_read_b64_tr_b16 a[146:147], v14 offset:19456
 v_mul_f32 v31, v31, v95
 v_cvt_pk_bf16_f32 v85, v90, v91
 v_mul_f32 v92, v92, v28
 v_mfma_f32_32x32x16_bf16 v[96:111], a[148:151], a[140:143], v[96:111]
 ds_read_b64_tr_b16 a[148:149], v15 offset:18432
 ds_read_b64_tr_b16 a[150:151], v15 offset:19456
 v_rcp_f32 v29, v29
 v_add_f32 v30, 1.0, v30
 v_mfma_f32_32x32x16_bf16 v[112:127], a[152:155], a[140:143], v[112:127]
 s_waitcnt lgkmcnt(8)
 ds_read_b64_tr_b16 a[152:153], v14 offset:24576
 ds_read_b64_tr_b16 a[154:155], v14 offset:25600
 v_exp_f32 v31, v31
 v_mul_f32 v93, v93, v29
 v_mfma_f32_32x32x16_bf16 v[128:143], a[156:159], v[64:67], v[128:143]
 ds_read_b64_tr_b16 a[156:157], v15 offset:24576
 ds_read_b64_tr_b16 a[158:159], v15 offset:25600
 v_rcp_f32 v30, v30
 v_add_f32 v31, 1.0, v31
 v_cvt_pk_bf16_f32 v86, v92, v93
 v_mul_f32 v94, v94, v30
 v_mfma_f32_32x32x16_bf16 v[144:159], a[160:163], v[64:67], v[144:159]
 ds_read_b64_tr_b16 a[160:161], v14 offset:26624
 ds_read_b64_tr_b16 a[162:163], v14 offset:27648
 v_rcp_f32 v31, v31
 s_nop 0
 v_mul_f32 v95, v95, v31
 v_cvt_pk_bf16_f32 v87, v94, v95
 v_mfma_f32_32x32x16_bf16 v[128:143], a[164:167], v[68:71], v[128:143]
 s_add_u32 s69, s65, 0x2000
 ds_read_b64_tr_b16 a[164:165], v15 offset:26624
 ds_read_b64_tr_b16 a[166:167], v15 offset:27648
 buffer_store_dwordx4 v[80:83], v33, s[4:7], s69 offen offset:2048 sc1
 buffer_store_dwordx4 v[84:87], v33, s[4:7], s69 offen offset:3072 sc1
 v_mfma_f32_32x32x16_bf16 v[144:159], a[168:171], v[68:71], v[144:159]
 s_waitcnt lgkmcnt(8)
 s_barrier
 ds_read_b64_tr_b16 a[168:169], v14 offset:12288
 ds_read_b64_tr_b16 a[170:171], v14 offset:13312
 v_fma_f32 v24, -v96, v96, v22
 v_mul_f32 v24, v24, v96
 v_fma_f32 v25, -v97, v97, v22
 v_mfma_f32_32x32x16_bf16 v[160:175], a[172:175], v[64:67], v[160:175]
 ds_read_b64_tr_b16 a[172:173], v15 offset:12288
 ds_read_b64_tr_b16 a[174:175], v15 offset:13312
 v_exp_f32 v24, v24
 v_mul_f32 v25, v25, v97
 v_fma_f32 v26, -v98, v98, v22
 v_add_f32 v24, 1.0, v24
 v_mfma_f32_32x32x16_bf16 v[176:191], a[176:179], v[64:67], v[176:191]
 ds_read_b64_tr_b16 a[176:177], v14 offset:14336
 ds_read_b64_tr_b16 a[178:179], v14 offset:15360
 v_exp_f32 v25, v25
 v_mul_f32 v26, v26, v98
 v_fma_f32 v27, -v99, v99, v22
 v_mfma_f32_32x32x16_bf16 v[160:175], a[144:147], v[68:71], v[160:175]
 ds_read_b64_tr_b16 a[144:145], v15 offset:14336
 ds_read_b64_tr_b16 a[146:147], v15 offset:15360
 v_rcp_f32 v24, v24
 v_add_f32 v25, 1.0, v25
 v_mfma_f32_32x32x16_bf16 v[176:191], a[148:151], v[68:71], v[176:191]
 s_waitcnt lgkmcnt(8)
 ds_read_b64_tr_b16 a[148:149], v14 offset:20480
 ds_read_b64_tr_b16 a[150:151], v14 offset:21504
 v_exp_f32 v26, v26
 v_mul_f32 v27, v27, v99
 v_fma_f32 v28, -v100, v100, v22
 v_mfma_f32_32x32x16_bf16 v[192:207], a[152:155], v[64:67], v[192:207]
 ds_read_b64_tr_b16 a[152:153], v15 offset:20480
 ds_read_b64_tr_b16 a[154:155], v15 offset:21504
 v_mul_f32 v96, v96, v24
 v_rcp_f32 v25, v25
 v_add_f32 v26, 1.0, v26
 v_mfma_f32_32x32x16_bf16 v[208:223], a[156:159], v[64:67], v[208:223]
 ds_read_b64_tr_b16 a[156:157], v14 offset:22528
 ds_read_b64_tr_b16 a[158:159], v14 offset:23552
 buffer_load_dwordx4 v5, s[8:11], s43 offen offset:1024 lds
 v_exp_f32 v27, v27
 v_mfma_f32_32x32x16_bf16 v[192:207], a[160:163], v[68:71], v[192:207]
 s_add_u32 m0, s28, 0x2000
 ds_read_b64_tr_b16 a[160:161], v15 offset:22528
 ds_read_b64_tr_b16 a[162:163], v15 offset:23552
 v_mul_f32 v28, v28, v100
 v_fma_f32 v29, -v101, v101, v22
 v_mul_f32 v97, v97, v25
 v_mfma_f32_32x32x16_bf16 v[208:223], a[164:167], v[68:71], v[208:223]
 s_waitcnt lgkmcnt(8)
 ds_read_b64_tr_b16 a[164:165], v14 offset:28672
 ds_read_b64_tr_b16 a[166:167], v14 offset:29696
 buffer_load_dwordx4 v4, s[8:11], s44 offen offset:0 lds
 v_rcp_f32 v26, v26
 v_mfma_f32_32x32x16_bf16 v[128:143], a[168:171], v[80:83], v[128:143]
 ds_read_b64_tr_b16 a[168:169], v15 offset:28672
 ds_read_b64_tr_b16 a[170:171], v15 offset:29696
 ds_read_b128 v[240:243], v20 offset:1152
 ds_read_b128 v[244:247], v20 offset:1184
 v_add_f32 v27, 1.0, v27
 v_exp_f32 v28, v28
 v_mfma_f32_32x32x16_bf16 v[144:159], a[172:175], v[80:83], v[144:159]
 ds_read_b64_tr_b16 a[172:173], v14 offset:30720
 ds_read_b64_tr_b16 a[174:175], v14 offset:31744
 ds_read_b128 v[248:251], v20 offset:1216
 ds_read_b128 v[252:255], v20 offset:1248
 buffer_load_dwordx4 v5, s[8:11], s44 offen offset:1024 lds
 v_mfma_f32_32x32x16_bf16 v[128:143], a[176:179], v[84:87], v[128:143]
 ds_read_b64_tr_b16 a[176:177], v15 offset:30720
 ds_read_b64_tr_b16 a[178:179], v15 offset:31744
 ds_read_b128 v[64:67], v20 offset:1024
 ds_read_b128 v[68:71], v20 offset:1056
 s_add_u32 m0, s28, 0x4000
 v_mul_f32 v29, v29, v101
 v_mfma_f32_32x32x16_bf16 v[144:159], a[144:147], v[84:87], v[144:159]
 s_waitcnt vmcnt(13) lgkmcnt(14)
 s_barrier
 ds_read_b64_tr_b16 a[144:145], v8 offset:32768
 ds_read_b64_tr_b16 a[146:147], v8 offset:33280
 ds_read_b128 v[72:75], v20 offset:1088
 ds_read_b128 v[76:79], v20 offset:1120
 buffer_load_dwordx4 v4, s[8:11], s45 offen offset:0 lds
 v_mfma_f32_32x32x16_bf16 v[160:175], a[148:151], v[80:83], v[160:175]
 ds_read_b64_tr_b16 a[148:149], v9 offset:32768
 ds_read_b64_tr_b16 a[150:151], v9 offset:33280
 v_fma_f32 v30, -v102, v102, v22
 v_cvt_pk_bf16_f32 v96, v96, v97
 v_mul_f32 v98, v98, v26
 v_rcp_f32 v27, v27
 v_mfma_f32_32x32x16_bf16 v[176:191], a[152:155], v[80:83], v[176:191]
 ds_read_b64_tr_b16 a[152:153], v8 offset:34816
 ds_read_b64_tr_b16 a[154:155], v8 offset:35328
 buffer_load_dwordx4 v5, s[8:11], s45 offen offset:1024 lds
 v_add_f32 v28, 1.0, v28
 v_mfma_f32_32x32x16_bf16 v[160:175], a[156:159], v[84:87], v[160:175]
 s_add_u32 m0, s28, 0x14000
 ds_read_b64_tr_b16 a[156:157], v9 offset:34816
 ds_read_b64_tr_b16 a[158:159], v9 offset:35328
 v_exp_f32 v29, v29
 v_mul_f32 v30, v30, v102
 v_fma_f32 v31, -v103, v103, v22
 v_mfma_f32_32x32x16_bf16 v[176:191], a[160:163], v[84:87], v[176:191]
 s_waitcnt lgkmcnt(12)
 ds_read_b64_tr_b16 a[160:161], v8 offset:36864
 ds_read_b64_tr_b16 a[162:163], v8 offset:37376
 buffer_load_dwordx4 v4, s[8:11], s46 offen offset:0 lds
 v_mul_f32 v99, v99, v27
 v_mfma_f32_32x32x16_bf16 v[192:207], a[164:167], v[80:83], v[192:207]
 ds_read_b64_tr_b16 a[164:165], v9 offset:36864
 ds_read_b64_tr_b16 a[166:167], v9 offset:37376
 v_rcp_f32 v28, v28
 v_add_f32 v29, 1.0, v29
 v_exp_f32 v30, v30
 v_mfma_f32_32x32x16_bf16 v[208:223], a[168:171], v[80:83], v[208:223]
 ds_read_b64_tr_b16 a[168:169], v8 offset:38912
 ds_read_b64_tr_b16 a[170:171], v8 offset:39424
 v_mul_f32 v31, v31, v103
 v_fma_f32 v24, -v104, v104, v22
 v_cvt_pk_bf16_f32 v97, v98, v99
 v_mul_f32 v100, v100, v28
 v_mfma_f32_32x32x16_bf16 v[192:207], a[172:175], v[84:87], v[192:207]
 ds_read_b64_tr_b16 a[172:173], v9 offset:38912
 ds_read_b64_tr_b16 a[174:175], v9 offset:39424
 v_rcp_f32 v29, v29
 v_add_f32 v30, 1.0, v30
 v_mfma_f32_32x32x16_bf16 v[208:223], a[176:179], v[84:87], v[208:223]
 s_waitcnt lgkmcnt(8)
 ds_read_b64_tr_b16 a[176:177], v8 offset:40960
 ds_read_b64_tr_b16 a[178:179], v8 offset:41472
 v_exp_f32 v31, v31
 v_mul_f32 v24, v24, v104
 v_fma_f32 v25, -v105, v105, v22
 v_mfma_f32_32x32x16_bf16 v[64:79], a[144:147], a[0:3], v[64:79]
 ds_read_b64_tr_b16 a[144:145], v9 offset:40960
 ds_read_b64_tr_b16 a[146:147], v9 offset:41472
 v_mul_f32 v101, v101, v29
 v_rcp_f32 v30, v30
 v_add_f32 v31, 1.0, v31
 v_mfma_f32_32x32x16_bf16 v[80:95], a[148:151], a[0:3], v[240:255]
 ds_read_b64_tr_b16 a[148:149], v8 offset:43008
 ds_read_b64_tr_b16 a[150:151], v8 offset:43520
 buffer_load_dwordx4 v5, s[8:11], s46 offen offset:1024 lds
 v_exp_f32 v24, v24
 v_mfma_f32_32x32x16_bf16 v[64:79], a[152:155], a[4:7], v[64:79]
 s_add_u32 m0, s28, 0x16000
 ds_read_b64_tr_b16 a[152:153], v9 offset:43008
 ds_read_b64_tr_b16 a[154:155], v9 offset:43520
 v_mul_f32 v25, v25, v105
 v_fma_f32 v26, -v106, v106, v22
 v_cvt_pk_bf16_f32 v98, v100, v101
 v_mul_f32 v102, v102, v30
 v_mfma_f32_32x32x16_bf16 v[80:95], a[156:159], a[4:7], v[80:95]
 s_waitcnt lgkmcnt(8)
 ds_read_b64_tr_b16 a[156:157], v8 offset:45056
 ds_read_b64_tr_b16 a[158:159], v8 offset:45568
 buffer_load_dwordx4 v4, s[8:11], s47 offen offset:0 lds
 v_rcp_f32 v31, v31
 v_mfma_f32_32x32x16_bf16 v[64:79], a[160:163], a[8:11], v[64:79]
 ds_read_b64_tr_b16 a[160:161], v9 offset:45056
 ds_read_b64_tr_b16 a[162:163], v9 offset:45568
 v_add_f32 v24, 1.0, v24
 v_exp_f32 v25, v25
 v_mul_f32 v26, v26, v106
 v_fma_f32 v27, -v107, v107, v22
 v_mfma_f32_32x32x16_bf16 v[80:95], a[164:167], a[8:11], v[80:95]
 ds_read_b64_tr_b16 a[164:165], v8 offset:47104
 ds_read_b64_tr_b16 a[166:167], v8 offset:47616
 buffer_load_dwordx4 v5, s[8:11], s47 offen offset:1024 lds
 v_mul_f32 v103, v103, v31
 v_mfma_f32_32x32x16_bf16 v[64:79], a[168:171], a[12:15], v[64:79]
 s_add_u32 s48, s49, s75
 ds_read_b64_tr_b16 a[168:169], v9 offset:47104
 ds_read_b64_tr_b16 a[170:171], v9 offset:47616
 s_add_u32 m0, s28, 0x6000
 v_rcp_f32 v24, v24
 v_add_f32 v25, 1.0, v25
 v_mfma_f32_32x32x16_bf16 v[80:95], a[172:175], a[12:15], v[80:95]
 s_waitcnt vmcnt(13) lgkmcnt(8)
 s_barrier
 ds_read_b64_tr_b16 a[172:173], v8 offset:49152
 ds_read_b64_tr_b16 a[174:175], v8 offset:49664
 buffer_load_dwordx4 v6, s[12:15], s48 offen offset:0 lds
 v_mfma_f32_32x32x16_bf16 v[64:79], a[176:179], a[16:19], v[64:79]
 ds_read_b64_tr_b16 a[176:177], v9 offset:49152
 ds_read_b64_tr_b16 a[178:179], v9 offset:49664
 v_exp_f32 v26, v26
 v_mul_f32 v27, v27, v107
 v_fma_f32 v28, -v108, v108, v22
 v_cvt_pk_bf16_f32 v99, v102, v103
 v_mfma_f32_32x32x16_bf16 v[80:95], a[144:147], a[16:19], v[80:95]
 ds_read_b64_tr_b16 a[144:145], v8 offset:51200
 ds_read_b64_tr_b16 a[146:147], v8 offset:51712
 buffer_load_dwordx4 v7, s[12:15], s48 offen offset:1024 lds
 v_mul_f32 v104, v104, v24
 v_mfma_f32_32x32x16_bf16 v[64:79], a[148:151], a[20:23], v[64:79]
 ds_read_b64_tr_b16 a[148:149], v9 offset:51200
 ds_read_b64_tr_b16 a[150:151], v9 offset:51712
 s_waitcnt vmcnt(14)
 v_cmp_ne_u32 vcc, 0x1010101, v40
 s_nop 1
 s_cmp_lg_u64 vcc, 0
 s_cbranch_scc1 mrd_spin
mrd_back:
 s_add_u32 s48, s50, s75
 s_add_u32 m0, s28, 0x8000
 v_mfma_f32_32x32x16_bf16 v[80:95], a[152:155], a[20:23], v[80:95]
 s_waitcnt lgkmcnt(8)
 ds_read_b64_tr_b16 a[152:153], v8 offset:53248
 ds_read_b64_tr_b16 a[154:155], v8 offset:53760
 buffer_load_dwordx4 v6, s[12:15], s48 offen offset:0 lds
 v_rcp_f32 v25, v25
 v_mfma_f32_32x32x16_bf16 v[64:79], a[156:159], a[24:27], v[64:79]
 ds_read_b64_tr_b16 a[156:157], v9 offset:53248
 ds_read_b64_tr_b16 a[158:159], v9 offset:53760
 v_add_f32 v26, 1.0, v26
 v_exp_f32 v27, v27
 v_mul_f32 v28, v28, v108
 v_fma_f32 v29, -v109, v109, v22
 v_mfma_f32_32x32x16_bf16 v[80:95], a[160:163], a[24:27], v[80:95]
 ds_read_b64_tr_b16 a[160:161], v8 offset:55296
 ds_read_b64_tr_b16 a[162:163], v8 offset:55808
 buffer_load_dwordx4 v7, s[12:15], s48 offen offset:1024 lds
 v_mul_f32 v105, v105, v25
 v_mfma_f32_32x32x16_bf16 v[64:79], a[164:167], a[28:31], v[64:79]
 s_add_u32 s48, s51, s75
 ds_read_b64_tr_b16 a[164:165], v9 offset:55296
 ds_read_b64_tr_b16 a[166:167], v9 offset:55808
 s_add_u32 m0, s28, 0xa000
 v_rcp_f32 v26, v26
 v_add_f32 v27, 1.0, v27
 v_mfma_f32_32x32x16_bf16 v[80:95], a[168:171], a[28:31], v[80:95]
 s_waitcnt lgkmcnt(8)
 ds_read_b64_tr_b16 a[168:169], v8 offset:57344
 ds_read_b64_tr_b16 a[170:171], v8 offset:57856
 buffer_load_dwordx4 v6, s[12:15], s48 offen offset:0 lds
 v_exp_f32 v28, v28
 v_mfma_f32_32x32x16_bf16 v[64:79], a[172:175], a[32:35], v[64:79]
 ds_read_b64_tr_b16 a[172:173], v9 offset:57344
 ds_read_b64_tr_b16 a[174:175], v9 offset:57856
 v_mul_f32 v29, v29, v109
 v_fma_f32 v30, -v110, v110, v22
 v_cvt_pk_bf16_f32 v100, v104, v105
 v_mul_f32 v106, v106, v26
 v_mfma_f32_32x32x16_bf16 v[80:95], a[176:179], a[32:35], v[80:95]
 ds_read_b64_tr_b16 a[176:177], v8 offset:59392
 ds_read_b64_tr_b16 a[178:179], v8 offset:59904
 buffer_load_dwordx4 v7, s[12:15], s48 offen offset:1024 lds
 v_rcp_f32 v27, v27
 v_mfma_f32_32x32x16_bf16 v[64:79], a[144:147], a[36:39], v[64:79]
 ds_read_b64_tr_b16 a[144:145], v9 offset:59392
 ds_read_b64_tr_b16 a[146:147], v9 offset:59904
 s_cmp_eq_u32 s85, 0
 s_cselect_b32 s48, 768, 0
 s_sub_u32 s48, 128, s48
 v_add_u32 v4, s48, v4
 v_add_u32 v5, s48, v5
 s_add_u32 m0, s28, 0x18000
 v_mfma_f32_32x32x16_bf16 v[80:95], a[148:151], a[36:39], v[80:95]
 s_waitcnt lgkmcnt(8)
 ds_read_b64_tr_b16 a[148:149], v8 offset:61440
 ds_read_b64_tr_b16 a[150:151], v8 offset:61952
 buffer_load_dwordx4 v4, s[8:11], s39 offen offset:0 lds
 v_add_f32 v28, 1.0, v28
 v_mfma_f32_32x32x16_bf16 v[64:79], a[152:155], a[40:43], v[64:79]
 ds_read_b64_tr_b16 a[152:153], v9 offset:61440
 ds_read_b64_tr_b16 a[154:155], v9 offset:61952
 v_exp_f32 v29, v29
 v_mul_f32 v30, v30, v110
 v_fma_f32 v31, -v111, v111, v22
 v_mul_f32 v107, v107, v27
 v_mfma_f32_32x32x16_bf16 v[80:95], a[156:159], a[40:43], v[80:95]
 ds_read_b64_tr_b16 a[156:157], v8 offset:63488
 ds_read_b64_tr_b16 a[158:159], v8 offset:64000
 buffer_load_dwordx4 v5, s[8:11], s39 offen offset:1024 lds
 v_rcp_f32 v28, v28
 v_mfma_f32_32x32x16_bf16 v[64:79], a[160:163], a[44:47], v[64:79]
 s_add_u32 m0, s28, 0xc000
 ds_read_b64_tr_b16 a[160:161], v9 offset:63488
 ds_read_b64_tr_b16 a[162:163], v9 offset:64000
 v_add_f32 v29, 1.0, v29
 v_exp_f32 v30, v30
 v_mul_f32 v31, v31, v111
 v_mfma_f32_32x32x16_bf16 v[80:95], a[164:167], a[44:47], v[80:95]
 s_waitcnt vmcnt(14) lgkmcnt(8)
 s_barrier
 ds_read_b64_tr_b16 a[164:165], v10 offset:0
 ds_read_b64_tr_b16 a[166:167], v10 offset:512
 buffer_load_dwordx4 v4, s[8:11], s40 offen offset:0 lds
 v_mfma_f32_32x32x16_bf16 v[64:79], a[168:171], a[48:51], v[64:79]
 ds_read_b64_tr_b16 a[168:169], v11 offset:0
 ds_read_b64_tr_b16 a[170:171], v11 offset:512
 v_cvt_pk_bf16_f32 v101, v106, v107
 v_mul_f32 v108, v108, v28
 v_rcp_f32 v29, v29
 v_add_f32 v30, 1.0, v30
 v_mfma_f32_32x32x16_bf16 v[80:95], a[172:175], a[48:51], v[80:95]
 ds_read_b64_tr_b16 a[172:173], v10 offset:2048
 ds_read_b64_tr_b16 a[174:175], v10 offset:2560
 buffer_load_dwordx4 v5, s[8:11], s40 offen offset:1024 lds
 v_exp_f32 v31, v31
 v_mfma_f32_32x32x16_bf16 v[64:79], a[176:179], a[52:55], v[64:79]
 s_add_u32 m0, s28, 0xe000
 ds_read_b64_tr_b16 a[176:177], v11 offset:2048
 ds_read_b64_tr_b16 a[178:179], v11 offset:2560
 v_mul_f32 v109, v109, v29
 v_rcp_f32 v30, v30
 v_add_f32 v31, 1.0, v31
 v_mfma_f32_32x32x16_bf16 v[80:95], a[144:147], a[52:55], v[80:95]
 s_waitcnt lgkmcnt(8)
 ds_read_b64_tr_b16 a[144:145], v10 offset:4096
 ds_read_b64_tr_b16 a[146:147], v10 offset:4608
 buffer_load_dwordx4 v4, s[8:11], s41 offen offset:0 lds
 v_cvt_pk_bf16_f32 v102, v108, v109
 v_mul_f32 v110, v110, v30
 v_mfma_f32_32x32x16_bf16 v[64:79], a[148:151], a[56:59], v[64:79]
 ds_read_b64_tr_b16 a[148:149], v11 offset:4096
 ds_read_b64_tr_b16 a[150:151], v11 offset:4608
 v_rcp_f32 v31, v31
 s_nop 0
 v_mul_f32 v111, v111, v31
 v_cvt_pk_bf16_f32 v103, v110, v111
 s_add_u32 s69, s65, 0x3000
 v_mfma_f32_32x32x16_bf16 v[80:95], a[152:155], a[56:59], v[80:95]
 ds_read_b64_tr_b16 a[152:153], v10 offset:6144
 ds_read_b64_tr_b16 a[154:155], v10 offset:6656
 buffer_load_dwordx4 v5, s[8:11], s41 offen offset:1024 lds
 buffer_store_dwordx4 v[96:99], v33, s[4:7], s69 offen offset:0 sc1
 v_mfma_f32_32x32x16_bf16 v[64:79], a[156:159], a[60:63], v[64:79]
 ds_read_b64_tr_b16 a[156:157], v11 offset:6144
 ds_read_b64_tr_b16 a[158:159], v11 offset:6656
 buffer_load_dword v40, v35, s[4:7], 0 offen offset:0 sc1
 buffer_store_dwordx4 v[100:103], v33, s[4:7], s69 offen offset:1024 sc1
 v_mfma_f32_32x32x16_bf16 v[80:95], a[160:163], a[60:63], v[80:95]
 s_waitcnt lgkmcnt(8)
 ds_read_b64_tr_b16 a[160:161], v8 offset:0
 ds_read_b64_tr_b16 a[162:163], v8 offset:512
 s_add_u32 m0, s28, 0x1a000
 v_fma_f32 v24, -v112, v112, v22
 v_mul_f32 v24, v24, v112
 v_fma_f32 v25, -v113, v113, v22
 v_mfma_f32_32x32x16_bf16 v[64:79], a[164:167], a[64:67], v[64:79]
 ds_read_b64_tr_b16 a[164:165], v9 offset:0
 ds_read_b64_tr_b16 a[166:167], v9 offset:512
 buffer_load_dwordx4 v4, s[8:11], s42 offen offset:0 lds
 v_exp_f32 v24, v24
 v_mul_f32 v25, v25, v113
 v_mfma_f32_32x32x16_bf16 v[80:95], a[168:171], a[64:67], v[80:95]
 ds_read_b64_tr_b16 a[168:169], v8 offset:2048
 ds_read_b64_tr_b16 a[170:171], v8 offset:2560
 v_fma_f32 v26, -v114, v114, v22
 v_add_f32 v24, 1.0, v24
 v_exp_f32 v25, v25
 v_mfma_f32_32x32x16_bf16 v[64:79], a[172:175], a[68:71], v[64:79]
 ds_read_b64_tr_b16 a[172:173], v9 offset:2048
 ds_read_b64_tr_b16 a[174:175], v9 offset:2560
 buffer_load_dwordx4 v5, s[8:11], s42 offen offset:1024 lds
 v_mul_f32 v26, v26, v114
 v_fma_f32 v27, -v115, v115, v22
 v_mfma_f32_32x32x16_bf16 v[80:95], a[176:179], a[68:71], v[80:95]
 s_waitcnt lgkmcnt(8)
 ds_read_b64_tr_b16 a[176:177], v8 offset:4096
 ds_read_b64_tr_b16 a[178:179], v8 offset:4608
 s_add_u32 m0, s28, 0x1c000
 v_rcp_f32 v24, v24
 v_add_f32 v25, 1.0, v25
 v_mfma_f32_32x32x16_bf16 v[64:79], a[144:147], a[72:75], v[64:79]
 ds_read_b64_tr_b16 a[144:145], v9 offset:4096
 ds_read_b64_tr_b16 a[146:147], v9 offset:4608
 buffer_load_dwordx4 v4, s[8:11], s43 offen offset:0 lds
 v_exp_f32 v26, v26
 v_mul_f32 v27, v27, v115
 v_mfma_f32_32x32x16_bf16 v[80:95], a[148:151], a[72:75], v[80:95]
 ds_read_b64_tr_b16 a[148:149], v8 offset:6144
 ds_read_b64_tr_b16 a[150:151], v8 offset:6656
 v_fma_f32 v28, -v116, v116, v22
 v_mul_f32 v112, v112, v24
 v_rcp_f32 v25, v25
 v_mfma_f32_32x32x16_bf16 v[64:79], a[152:155], a[76:79], v[64:79]
 ds_read_b64_tr_b16 a[152:153], v9 offset:6144
 ds_read_b64_tr_b16 a[154:155], v9 offset:6656
 buffer_load_dwordx4 v5, s[8:11], s43 offen offset:1024 lds
 v_add_f32 v26, 1.0, v26
 v_mfma_f32_32x32x16_bf16 v[80:95], a[156:159], a[76:79], v[80:95]
 s_waitcnt vmcnt(21) lgkmcnt(8)
 s_barrier
 ds_read_b64_tr_b16 a[156:157], v8 offset:8192
 ds_read_b64_tr_b16 a[158:159], v8 offset:8704
 s_add_u32 m0, s28, 0x10000
 v_mfma_f32_32x32x16_bf16 v[64:79], a[160:163], a[80:83], v[64:79]
 ds_read_b64_tr_b16 a[160:161], v9 offset:8192
 ds_read_b64_tr_b16 a[162:163], v9 offset:8704
 buffer_load_dwordx4 v4, s[8:11], s44 offen offset:0 lds
 v_exp_f32 v27, v27
 v_mul_f32 v28, v28, v116
 v_mfma_f32_32x32x16_bf16 v[80:95], a[164:167], a[80:83], v[80:95]
 ds_read_b64_tr_b16 a[164:165], v8 offset:10240
 ds_read_b64_tr_b16 a[166:167], v8 offset:10752
 v_fma_f32 v29, -v117, v117, v22
 v_mul_f32 v113, v113, v25
 v_rcp_f32 v26, v26
 v_mfma_f32_32x32x16_bf16 v[64:79], a[168:171], a[84:87], v[64:79]
 ds_read_b64_tr_b16 a[168:169], v9 offset:10240
 ds_read_b64_tr_b16 a[170:171], v9 offset:10752
 v_add_f32 v27, 1.0, v27
 v_exp_f32 v28, v28
 v_mul_f32 v29, v29, v117
 v_mfma_f32_32x32x16_bf16 v[80:95], a[172:175], a[84:87], v[80:95]
 s_waitcnt lgkmcnt(8)
 ds_read_b64_tr_b16 a[172:173], v8 offset:12288
 ds_read_b64_tr_b16 a[174:175], v8 offset:12800
 v_fma_f32 v30, -v118, v118, v22
 v_cvt_pk_bf16_f32 v112, v112, v113
 v_mul_f32 v114, v114, v26
 v_mfma_f32_32x32x16_bf16 v[64:79], a[176:179], a[88:91], v[64:79]
 ds_read_b64_tr_b16 a[176:177], v9 offset:12288
 ds_read_b64_tr_b16 a[178:179], v9 offset:12800
 v_rcp_f32 v27, v27
 v_add_f32 v28, 1.0, v28
 v_exp_f32 v29, v29
 v_mfma_f32_32x32x16_bf16 v[80:95], a[144:147], a[88:91], v[80:95]
 ds_read_b64_tr_b16 a[144:145], v8 offset:14336
 ds_read_b64_tr_b16 a[146:147], v8 offset:14848
 v_mul_f32 v30, v30, v118
 v_fma_f32 v31, -v119, v119, v22
 v_mul_f32 v115, v115, v27
 v_mfma_f32_32x32x16_bf16 v[64:79], a[148:151], a[92:95], v[64:79]
 ds_read_b64_tr_b16 a[148:149], v9 offset:14336
 ds_read_b64_tr_b16 a[150:151], v9 offset:14848
 v_rcp_f32 v28, v28
 v_add_f32 v29, 1.0, v29
 v_mfma_f32_32x32x16_bf16 v[80:95], a[152:155], a[92:95], v[80:95]
 s_waitcnt lgkmcnt(8)
 ds_read_b64_tr_b16 a[152:153], v10 offset:8192
 ds_read_b64_tr_b16 a[154:155], v10 offset:8704
 v_exp_f32 v30, v30
 v_mul_f32 v31, v31, v119
 v_fma_f32 v24, -v120, v120, v22
 v_mfma_f32_32x32x16_bf16 v[64:79], a[156:159], a[96:99], v[64:79]
 ds_read_b64_tr_b16 a[156:157], v11 offset:8192
 ds_read_b64_tr_b16 a[158:159], v11 offset:8704
 buffer_load_dwordx4 v5, s[8:11], s44 offen offset:1024 lds
 v_cvt_pk_bf16_f32 v113, v114, v115
 v_mul_f32 v116, v116, v28
 v_mfma_f32_32x32x16_bf16 v[80:95], a[160:163], a[96:99], v[80:95]
 s_add_u32 m0, s28, 0x12000
 ds_read_b64_tr_b16 a[160:161], v10 offset:10240
 ds_read_b64_tr_b16 a[162:163], v10 offset:10752
 v_rcp_f32 v29, v29
 v_add_f32 v30, 1.0, v30
 v_mfma_f32_32x32x16_bf16 v[64:79], a[164:167], a[100:103], v[64:79]
 ds_read_b64_tr_b16 a[164:165], v11 offset:10240
 ds_read_b64_tr_b16 a[166:167], v11 offset:10752
 buffer_load_dwordx4 v4, s[8:11], s45 offen offset:0 lds
 v_exp_f32 v31, v31
 v_mfma_f32_32x32x16_bf16 v[80:95], a[168:171], a[100:103], v[80:95]
 s_waitcnt lgkmcnt(8)
 ds_read_b64_tr_b16 a[168:169], v10 offset:12288
 ds_read_b64_tr_b16 a[170:171], v10 offset:12800
 v_mul_f32 v24, v24, v120
 v_fma_f32 v25, -v121, v121, v22
 v_mul_f32 v117, v117, v29
 v_mfma_f32_32x32x16_bf16 v[64:79], a[172:175], a[104:107], v[64:79]
 ds_read_b64_tr_b16 a[172:173], v11 offset:12288
 ds_read_b64_tr_b16 a[174:175], v11 offset:12800
 buffer_load_dwordx4 v5, s[8:11], s45 offen offset:1024 lds
 v_rcp_f32 v30, v30
 v_add_f32 v31, 1.0, v31
 v_mfma_f32_32x32x16_bf16 v[80:95], a[176:179], a[104:107], v[80:95]
 s_add_u32 m0, s28, 0x1e000
 ds_read_b64_tr_b16 a[176:177], v10 offset:14336
 ds_read_b64_tr_b16 a[178:179], v10 offset:14848
 v_exp_f32 v24, v24
 v_mul_f32 v25, v25, v121
 v_fma_f32 v26, -v122, v122, v22
 v_mfma_f32_32x32x16_bf16 v[64:79], a[144:147], a[108:111], v[64:79]
 ds_read_b64_tr_b16 a[144:145], v11 offset:14336
 ds_read_b64_tr_b16 a[146:147], v11 offset:14848
 buffer_load_dwordx4 v4, s[8:11], s46 offen offset:0 lds
 v_cvt_pk_bf16_f32 v114, v116, v117
 v_mul_f32 v118, v118, v30
 v_mfma_f32_32x32x16_bf16 v[80:95], a[148:151], a[108:111], v[80:95]
 s_waitcnt vmcnt(22) lgkmcnt(8)
 s_barrier
 ds_read_b64_tr_b16 a[148:149], v10 offset:16384
 ds_read_b64_tr_b16 a[150:151], v10 offset:16896
 v_rcp_f32 v31, v31
 v_mfma_f32_32x32x16_bf16 v[64:79], a[152:155], a[112:115], v[64:79]
 ds_read_b64_tr_b16 a[152:153], v11 offset:16384
 ds_read_b64_tr_b16 a[154:155], v11 offset:16896
 buffer_load_dwordx4 v5, s[8:11], s46 offen offset:1024 lds
 v_add_f32 v24, 1.0, v24
 v_exp_f32 v25, v25
 v_mfma_f32_32x32x16_bf16 v[80:95], a[156:159], a[112:115], v[80:95]
 s_add_u32 m0, s28, 0x2000
 ds_read_b64_tr_b16 a[156:157], v10 offset:18432
 ds_read_b64_tr_b16 a[158:159], v10 offset:18944
 v_mul_f32 v26, v26, v122
 v_fma_f32 v27, -v123, v123, v22
 v_mul_f32 v119, v119, v31
 v_mfma_f32_32x32x16_bf16 v[64:79], a[160:163], a[116:119], v[64:79]
 ds_read_b64_tr_b16 a[160:161], v11 offset:18432
 ds_read_b64_tr_b16 a[162:163], v11 offset:18944
 buffer_load_dwordx4 v4, s[8:11], s47 offen offset:0 lds
 v_rcp_f32 v24, v24
 v_mfma_f32_32x32x16_bf16 v[80:95], a[164:167], a[116:119], v[80:95]
 s_waitcnt lgkmcnt(8)
 ds_read_b64_tr_b16 a[164:165], v10 offset:20480
 ds_read_b64_tr_b16 a[166:167], v10 offset:20992
 v_add_f32 v25, 1.0, v25
 v_exp_f32 v26, v26
 v_mul_f32 v27, v27, v123
 v_mfma_f32_32x32x16_bf16 v[64:79], a[168:171], a[120:123], v[64:79]
 ds_read_b64_tr_b16 a[168:169], v11 offset:20480
 ds_read_b64_tr_b16 a[170:171], v11 offset:20992
 buffer_load_dwordx4 v5, s[8:11], s47 offen offset:1024 lds
 v_fma_f32 v28, -v124, v124, v22
 v_cvt_pk_bf16_f32 v115, v118, v119
 v_mul_f32 v120, v120, v24
 v_mfma_f32_32x32x16_bf16 v[80:95], a[172:175], a[120:123], v[80:95]
 s_add_u32 s48, s52, s33
 ds_read_b64_tr_b16 a[172:173], v10 offset:22528
 ds_read_b64_tr_b16 a[174:175], v10 offset:23040
 s_add_u32 m0, s28, 0x4000
 v_rcp_f32 v25, v25
 v_add_f32 v26, 1.0, v26
 v_mfma_f32_32x32x16_bf16 v[64:79], a[176:179], a[124:127], v[64:79]
 ds_read_b64_tr_b16 a[176:177], v11 offset:22528
 ds_read_b64_tr_b16 a[178:179], v11 offset:23040
 buffer_load_dwordx4 v6, s[12:15], s48 offen offset:0 lds
 v_exp_f32 v27, v27
 v_mfma_f32_32x32x16_bf16 v[80:95], a[144:147], a[124:127], v[80:95]
 s_waitcnt lgkmcnt(8)
 ds_read_b64_tr_b16 a[144:145], v14 offset:16384
 ds_read_b64_tr_b16 a[146:147], v14 offset:17408
 v_mul_f32 v28, v28, v124
 v_fma_f32 v29, -v125, v125, v22
 v_mul_f32 v121, v121, v25
 v_mfma_f32_32x32x16_bf16 v[64:79], a[148:151], a[128:131], v[64:79]
 ds_read_b64_tr_b16 a[148:149], v15 offset:16384
 ds_read_b64_tr_b16 a[150:151], v15 offset:17408
 s_waitcnt vmcnt(14)
 v_cmp_eq_u32 vcc, 0, v40
 s_nop 1
 s_cmp_lg_u64 vcc, 0
 s_cbranch_scc1 mh0_spin
mh0_back:
 v_mfma_f32_32x32x16_bf16 v[80:95], a[152:155], a[128:131], v[80:95]
 ds_read_b64_tr_b16 a[152:153], v14 offset:18432
 ds_read_b64_tr_b16 a[154:155], v14 offset:19456
 buffer_load_dwordx4 v7, s[12:15], s48 offen offset:1024 lds
 v_rcp_f32 v26, v26
 v_mfma_f32_32x32x16_bf16 v[64:79], a[156:159], a[132:135], v[64:79]
 s_add_u32 s48, s53, s33
 ds_read_b64_tr_b16 a[156:157], v15 offset:18432
 ds_read_b64_tr_b16 a[158:159], v15 offset:19456
 s_add_u32 m0, s28, 0x14000
 v_add_f32 v27, 1.0, v27
 v_exp_f32 v28, v28
 v_mfma_f32_32x32x16_bf16 v[80:95], a[160:163], a[132:135], v[80:95]
 s_waitcnt lgkmcnt(8)
 s_barrier
 ds_read_b64_tr_b16 a[160:161], v14 offset:24576
 ds_read_b64_tr_b16 a[162:163], v14 offset:25600
 buffer_load_dwordx4 v6, s[12:15], s48 offen offset:0 lds
 v_mfma_f32_32x32x16_bf16 v[64:79], a[164:167], a[136:139], v[64:79]
 ds_read_b64_tr_b16 a[164:165], v15 offset:24576
 ds_read_b64_tr_b16 a[166:167], v15 offset:25600
 v_mul_f32 v29, v29, v125
 v_fma_f32 v30, -v126, v126, v22
 v_cvt_pk_bf16_f32 v116, v120, v121
 v_mul_f32 v122, v122, v26
 v_mfma_f32_32x32x16_bf16 v[80:95], a[168:171], a[136:139], v[80:95]
 ds_read_b64_tr_b16 a[168:169], v14 offset:26624
 ds_read_b64_tr_b16 a[170:171], v14 offset:27648
 buffer_load_dwordx4 v7, s[12:15], s48 offen offset:1024 lds
 v_rcp_f32 v27, v27
 v_mfma_f32_32x32x16_bf16 v[64:79], a[172:175], a[140:143], v[64:79]
 s_add_u32 s67, s63, 0x0
 ds_read_b64_tr_b16 a[172:173], v15 offset:26624
 ds_read_b64_tr_b16 a[174:175], v15 offset:27648
 v_add_f32 v28, 1.0, v28
 v_exp_f32 v29, v29
 v_mul_f32 v30, v30, v126
 v_mfma_f32_32x32x16_bf16 v[80:95], a[176:179], a[140:143], v[80:95]
 s_waitcnt lgkmcnt(8)
 ds_read_b64_tr_b16 a[176:177], v14 offset:32768
 ds_read_b64_tr_b16 a[178:179], v14 offset:33792
 buffer_load_dwordx4 a[188:191], v33, s[4:7], s67 offen offset:0 sc1
 v_fma_f32 v31, -v127, v127, v22
 v_mul_f32 v123, v123, v27
 v_mfma_f32_32x32x16_bf16 v[128:143], a[144:147], v[96:99], v[128:143]
 s_add_u32 s67, s63, 0x0
 ds_read_b64_tr_b16 a[144:145], v15 offset:32768
 ds_read_b64_tr_b16 a[146:147], v15 offset:33792
 v_rcp_f32 v28, v28
 v_add_f32 v29, 1.0, v29
 v_exp_f32 v30, v30
 v_mfma_f32_32x32x16_bf16 v[144:159], a[148:151], v[96:99], v[144:159]
 ds_read_b64_tr_b16 a[148:149], v14 offset:34816
 ds_read_b64_tr_b16 a[150:151], v14 offset:35840
 buffer_load_dwordx4 a[192:195], v33, s[4:7], s67 offen offset:1024 sc1
 v_mul_f32 v31, v31, v127
 v_cvt_pk_bf16_f32 v117, v122, v123
 v_mfma_f32_32x32x16_bf16 v[128:143], a[152:155], v[100:103], v[128:143]
 s_add_u32 s48, s49, s83
 ds_read_b64_tr_b16 a[152:153], v15 offset:34816
 ds_read_b64_tr_b16 a[154:155], v15 offset:35840
 s_add_u32 m0, s28, 0x20000
 v_mul_f32 v124, v124, v28
 v_rcp_f32 v29, v29
 v_mfma_f32_32x32x16_bf16 v[144:159], a[156:159], v[100:103], v[144:159]
 s_waitcnt lgkmcnt(8)
 ds_read_b64_tr_b16 a[156:157], v14 offset:20480
 ds_read_b64_tr_b16 a[158:159], v14 offset:21504
 buffer_load_dwordx4 v6, s[12:15], s48 offen offset:0 lds
 v_add_f32 v30, 1.0, v30
 v_mfma_f32_32x32x16_bf16 v[160:175], a[160:163], v[96:99], v[160:175]
 s_add_u32 s67, s63, 0x0
 ds_read_b64_tr_b16 a[160:161], v15 offset:20480
 ds_read_b64_tr_b16 a[162:163], v15 offset:21504
 v_exp_f32 v31, v31
 v_mul_f32 v125, v125, v29
 v_rcp_f32 v30, v30
 v_mfma_f32_32x32x16_bf16 v[176:191], a[164:167], v[96:99], v[176:191]
 ds_read_b64_tr_b16 a[164:165], v14 offset:22528
 ds_read_b64_tr_b16 a[166:167], v14 offset:23552
 buffer_load_dwordx4 a[196:199], v33, s[4:7], s67 offen offset:2048 sc1
 v_add_f32 v31, 1.0, v31
 v_cvt_pk_bf16_f32 v118, v124, v125
 v_mfma_f32_32x32x16_bf16 v[160:175], a[168:171], v[100:103], v[160:175]
 ds_read_b64_tr_b16 a[168:169], v15 offset:22528
 ds_read_b64_tr_b16 a[170:171], v15 offset:23552
 v_mul_f32 v126, v126, v30
 v_rcp_f32 v31, v31
 s_nop 0
 v_mul_f32 v127, v127, v31
 v_mfma_f32_32x32x16_bf16 v[176:191], a[172:175], v[100:103], v[176:191]
 s_waitcnt lgkmcnt(8)
 s_barrier
 ds_read_b64_tr_b16 a[172:173], v14 offset:28672
 ds_read_b64_tr_b16 a[174:175], v14 offset:29696
 buffer_load_dwordx4 v7, s[12:15], s48 offen offset:1024 lds
 v_mfma_f32_32x32x16_bf16 v[192:207], a[176:179], v[96:99], v[192:207]
 s_add_u32 s67, s63, 0x0
 ds_read_b64_tr_b16 a[176:177], v15 offset:28672
 ds_read_b64_tr_b16 a[178:179], v15 offset:29696
 v_cvt_pk_bf16_f32 v119, v126, v127
 s_add_u32 s69, s65, 0x3000
 v_mfma_f32_32x32x16_bf16 v[208:223], a[144:147], v[96:99], v[208:223]
 ds_read_b64_tr_b16 a[144:145], v14 offset:30720
 ds_read_b64_tr_b16 a[146:147], v14 offset:31744
 buffer_load_dwordx4 a[200:203], v33, s[4:7], s67 offen offset:3072 sc1
 buffer_store_dwordx4 v[112:115], v33, s[4:7], s69 offen offset:2048 sc1
 v_mfma_f32_32x32x16_bf16 v[192:207], a[148:151], v[100:103], v[192:207]
 ds_read_b64_tr_b16 a[148:149], v15 offset:30720
 ds_read_b64_tr_b16 a[150:151], v15 offset:31744
 buffer_store_dwordx4 v[116:119], v33, s[4:7], s69 offen offset:3072 sc1
 v_fma_f32 v24, -v64, v64, v22
 v_mul_f32 v24, v24, v64
 v_mfma_f32_32x32x16_bf16 v[208:223], a[152:155], v[100:103], v[208:223]
 s_waitcnt lgkmcnt(8)
 ds_read_b64_tr_b16 a[152:153], v14 offset:36864
 ds_read_b64_tr_b16 a[154:155], v14 offset:37888
 v_fma_f32 v25, -v65, v65, v22
 v_exp_f32 v24, v24
 v_mul_f32 v25, v25, v65
 v_mfma_f32_32x32x16_bf16 v[128:143], a[156:159], v[112:115], v[128:143]
 ds_read_b64_tr_b16 a[156:157], v15 offset:36864
 ds_read_b64_tr_b16 a[158:159], v15 offset:37888
 ds_read_b128 v[240:243], v20 offset:1408
 ds_read_b128 v[244:247], v20 offset:1440
 v_fma_f32 v26, -v66, v66, v22
 v_add_f32 v24, 1.0, v24
 v_mfma_f32_32x32x16_bf16 v[144:159], a[160:163], v[112:115], v[144:159]
 ds_read_b64_tr_b16 a[160:161], v14 offset:38912
 ds_read_b64_tr_b16 a[162:163], v14 offset:39936
 ds_read_b128 v[248:251], v20 offset:1472
 ds_read_b128 v[252:255], v20 offset:1504
 v_exp_f32 v25, v25
 v_mfma_f32_32x32x16_bf16 v[128:143], a[164:167], v[116:119], v[128:143]
 ds_read_b64_tr_b16 a[164:165], v15 offset:38912
 ds_read_b64_tr_b16 a[166:167], v15 offset:39936
 ds_read_b128 v[96:99], v20 offset:1280
 ds_read_b128 v[100:103], v20 offset:1312
 v_mul_f32 v26, v26, v66
 v_fma_f32 v27, -v67, v67, v22
 v_mfma_f32_32x32x16_bf16 v[144:159], a[168:171], v[116:119], v[144:159]
 s_waitcnt lgkmcnt(14)
 ds_read_b64_tr_b16 a[168:169], v10 offset:24576
 ds_read_b64_tr_b16 a[170:171], v10 offset:25088
 ds_read_b128 v[104:107], v20 offset:1344
 ds_read_b128 v[108:111], v20 offset:1376
 v_rcp_f32 v24, v24
 v_mfma_f32_32x32x16_bf16 v[160:175], a[172:175], v[112:115], v[160:175]
 ds_read_b64_tr_b16 a[172:173], v11 offset:24576
 ds_read_b64_tr_b16 a[174:175], v11 offset:25088
 v_add_f32 v25, 1.0, v25
 v_exp_f32 v26, v26
 v_mul_f32 v27, v27, v67
 v_fma_f32 v28, -v68, v68, v22
 v_mfma_f32_32x32x16_bf16 v[176:191], a[176:179], v[112:115], v[176:191]
 s_add_u32 s67, s64, 0x0
 ds_read_b64_tr_b16 a[176:177], v10 offset:26624
 ds_read_b64_tr_b16 a[178:179], v10 offset:27136
 v_mul_f32 v64, v64, v24
 v_rcp_f32 v25, v25
 v_add_f32 v26, 1.0, v26
 v_mfma_f32_32x32x16_bf16 v[160:175], a[144:147], v[116:119], v[160:175]
 ds_read_b64_tr_b16 a[144:145], v11 offset:26624
 ds_read_b64_tr_b16 a[146:147], v11 offset:27136
 buffer_load_dwordx4 a[220:223], v33, s[4:7], s67 offen offset:0 sc1
 v_exp_f32 v27, v27
 v_mfma_f32_32x32x16_bf16 v[176:191], a[148:151], v[116:119], v[176:191]
 s_waitcnt lgkmcnt(12)
 ds_read_b64_tr_b16 a[148:149], v10 offset:28672
 ds_read_b64_tr_b16 a[150:151], v10 offset:29184
 s_add_u32 s67, s64, 0x0
 v_mul_f32 v28, v28, v68
 v_fma_f32 v29, -v69, v69, v22
 v_mul_f32 v65, v65, v25
 v_mfma_f32_32x32x16_bf16 v[192:207], a[152:155], v[112:115], v[192:207]
 ds_read_b64_tr_b16 a[152:153], v11 offset:28672
 ds_read_b64_tr_b16 a[154:155], v11 offset:29184
 buffer_load_dwordx4 a[224:227], v33, s[4:7], s67 offen offset:1024 sc1
 v_rcp_f32 v26, v26
 v_add_f32 v27, 1.0, v27
 v_mfma_f32_32x32x16_bf16 v[208:223], a[156:159], v[112:115], v[208:223]
 s_add_u32 s48, s50, s83
 ds_read_b64_tr_b16 a[156:157], v10 offset:30720
 ds_read_b64_tr_b16 a[158:159], v10 offset:31232
 s_add_u32 m0, s28, 0x16000
 v_exp_f32 v28, v28
 v_mul_f32 v29, v29, v69
 v_mfma_f32_32x32x16_bf16 v[192:207], a[160:163], v[116:119], v[192:207]
 ds_read_b64_tr_b16 a[160:161], v11 offset:30720
 ds_read_b64_tr_b16 a[162:163], v11 offset:31232
 buffer_load_dwordx4 v6, s[12:15], s48 offen offset:0 lds
 v_fma_f32 v30, -v70, v70, v22
 v_cvt_pk_bf16_f32 v64, v64, v65
 v_mfma_f32_32x32x16_bf16 v[208:223], a[164:167], v[116:119], v[208:223]
 s_waitcnt lgkmcnt(8)
 s_barrier
 ds_read_b64_tr_b16 a[164:165], v8 offset:40960
 ds_read_b64_tr_b16 a[166:167], v8 offset:41472
 s_add_u32 s67, s64, 0x0
 v_mul_f32 v66, v66, v26
 v_mfma_f32_32x32x16_bf16 v[96:111], a[168:171], a[0:3], v[96:111]
 ds_read_b64_tr_b16 a[168:169], v9 offset:40960
 ds_read_b64_tr_b16 a[170:171], v9 offset:41472
 buffer_load_dwordx4 a[228:231], v33, s[4:7], s67 offen offset:2048 sc1
 v_rcp_f32 v27, v27
 v_add_f32 v28, 1.0, v28
 v_mfma_f32_32x32x16_bf16 v[112:127], a[172:175], a[0:3], v[240:255]
 ds_read_b64_tr_b16 a[172:173], v8 offset:43008
 ds_read_b64_tr_b16 a[174:175], v8 offset:43520
 v_exp_f32 v29, v29
 v_mul_f32 v30, v30, v70
 v_fma_f32 v31, -v71, v71, v22
 v_mfma_f32_32x32x16_bf16 v[96:111], a[176:179], a[4:7], v[96:111]
 ds_read_b64_tr_b16 a[176:177], v9 offset:43008
 ds_read_b64_tr_b16 a[178:179], v9 offset:43520
 buffer_load_dwordx4 v7, s[12:15], s48 offen offset:1024 lds
 v_mul_f32 v67, v67, v27
 v_mfma_f32_32x32x16_bf16 v[112:127], a[144:147], a[4:7], v[112:127]
 s_waitcnt lgkmcnt(8)
 ds_read_b64_tr_b16 a[144:145], v8 offset:45056
 ds_read_b64_tr_b16 a[146:147], v8 offset:45568
 s_add_u32 s48, s51, s83
 s_add_u32 m0, s28, 0x6000
 v_rcp_f32 v28, v28
 v_mfma_f32_32x32x16_bf16 v[96:111], a[148:151], a[8:11], v[96:111]
 ds_read_b64_tr_b16 a[148:149], v9 offset:45056
 ds_read_b64_tr_b16 a[150:151], v9 offset:45568
 buffer_load_dwordx4 v6, s[12:15], s48 offen offset:0 lds
 v_add_f32 v29, 1.0, v29
 v_exp_f32 v30, v30
 v_mfma_f32_32x32x16_bf16 v[112:127], a[152:155], a[8:11], v[112:127]
 s_add_u32 s67, s64, 0x0
 ds_read_b64_tr_b16 a[152:153], v8 offset:47104
 ds_read_b64_tr_b16 a[154:155], v8 offset:47616
 v_mul_f32 v31, v31, v71
 v_fma_f32 v24, -v72, v72, v22
 v_cvt_pk_bf16_f32 v65, v66, v67
 v_mul_f32 v68, v68, v28
 v_mfma_f32_32x32x16_bf16 v[96:111], a[156:159], a[12:15], v[96:111]
 ds_read_b64_tr_b16 a[156:157], v9 offset:47104
 ds_read_b64_tr_b16 a[158:159], v9 offset:47616
 buffer_load_dwordx4 a[232:235], v33, s[4:7], s67 offen offset:3072 sc1
 v_rcp_f32 v29, v29
 v_mfma_f32_32x32x16_bf16 v[112:127], a[160:163], a[12:15], v[112:127]
 s_waitcnt lgkmcnt(8)
 ds_read_b64_tr_b16 a[160:161], v8 offset:49152
 ds_read_b64_tr_b16 a[162:163], v8 offset:49664
 v_add_f32 v30, 1.0, v30
 v_exp_f32 v31, v31
 v_mul_f32 v24, v24, v72
 v_mfma_f32_32x32x16_bf16 v[96:111], a[164:167], a[16:19], v[96:111]
 ds_read_b64_tr_b16 a[164:165], v9 offset:49152
 ds_read_b64_tr_b16 a[166:167], v9 offset:49664
 buffer_load_dwordx4 v7, s[12:15], s48 offen offset:1024 lds
 v_fma_f32 v25, -v73, v73, v22
 v_mul_f32 v69, v69, v29
 v_mfma_f32_32x32x16_bf16 v[112:127], a[168:171], a[16:19], v[112:127]
 ds_read_b64_tr_b16 a[168:169], v8 offset:51200
 ds_read_b64_tr_b16 a[170:171], v8 offset:51712
 v_rcp_f32 v30, v30
 v_add_f32 v31, 1.0, v31
 v_mfma_f32_32x32x16_bf16 v[96:111], a[172:175], a[20:23], v[96:111]
 ds_read_b64_tr_b16 a[172:173], v9 offset:51200
 ds_read_b64_tr_b16 a[174:175], v9 offset:51712
 v_exp_f32 v24, v24
 v_mul_f32 v25, v25, v73
 v_fma_f32 v26, -v74, v74, v22
 v_mfma_f32_32x32x16_bf16 v[112:127], a[176:179], a[20:23], v[112:127]
 s_waitcnt lgkmcnt(8)
 ds_read_b64_tr_b16 a[176:177], v8 offset:53248
 ds_read_b64_tr_b16 a[178:179], v8 offset:53760
 v_cvt_pk_bf16_f32 v66, v68, v69
 v_mul_f32 v70, v70, v30
 v_rcp_f32 v31, v31
 v_mfma_f32_32x32x16_bf16 v[96:111], a[144:147], a[24:27], v[96:111]
 ds_read_b64_tr_b16 a[144:145], v9 offset:53248
 ds_read_b64_tr_b16 a[146:147], v9 offset:53760
 v_add_f32 v24, 1.0, v24
 v_exp_f32 v25, v25
 v_mul_f32 v26, v26, v74
 v_fma_f32 v27, -v75, v75, v22
 v_mfma_f32_32x32x16_bf16 v[112:127], a[148:151], a[24:27], v[112:127]
 s_add_u32 s67, s63, 0x1000
 ds_read_b64_tr_b16 a[148:149], v8 offset:55296
 ds_read_b64_tr_b16 a[150:151], v8 offset:55808
 v_mul_f32 v71, v71, v31
 v_rcp_f32 v24, v24
 v_add_f32 v25, 1.0, v25
 v_mfma_f32_32x32x16_bf16 v[96:111], a[152:155], a[28:31], v[96:111]
 ds_read_b64_tr_b16 a[152:153], v9 offset:55296
 ds_read_b64_tr_b16 a[154:155], v9 offset:55808
 buffer_load_dwordx4 a[204:207], v33, s[4:7], s67 offen offset:0 sc1
 v_exp_f32 v26, v26
 v_mfma_f32_32x32x16_bf16 v[112:127], a[156:159], a[28:31], v[112:127]
 s_waitcnt vmcnt(29) lgkmcnt(8)
 s_barrier
 ds_read_b64_tr_b16 a[156:157], v10 offset:32768
 ds_read_b64_tr_b16 a[158:159], v10 offset:33280
 s_add_u32 s67, s63, 0x1000
 v_mul_f32 v27, v27, v75
 v_mfma_f32_32x32x16_bf16 v[96:111], a[160:163], a[32:35], v[96:111]
 ds_read_b64_tr_b16 a[160:161], v11 offset:32768
 ds_read_b64_tr_b16 a[162:163], v11 offset:33280
 buffer_load_dwordx4 a[208:211], v33, s[4:7], s67 offen offset:1024 sc1
 v_fma_f32 v28, -v76, v76, v22
 v_cvt_pk_bf16_f32 v67, v70, v71
 v_mul_f32 v72, v72, v24
 v_mfma_f32_32x32x16_bf16 v[112:127], a[164:167], a[32:35], v[112:127]
 s_add_u32 s48, s55, s33
 ds_read_b64_tr_b16 a[164:165], v10 offset:34816
 ds_read_b64_tr_b16 a[166:167], v10 offset:35328
 s_add_u32 m0, s28, 0x8000
 v_rcp_f32 v25, v25
 v_add_f32 v26, 1.0, v26
 v_mfma_f32_32x32x16_bf16 v[96:111], a[168:171], a[36:39], v[96:111]
 ds_read_b64_tr_b16 a[168:169], v11 offset:34816
 ds_read_b64_tr_b16 a[170:171], v11 offset:35328
 buffer_load_dwordx4 v6, s[12:15], s48 offen offset:0 lds
 v_exp_f32 v27, v27
 v_mfma_f32_32x32x16_bf16 v[112:127], a[172:175], a[36:39], v[112:127]
 s_waitcnt lgkmcnt(8)
 ds_read_b64_tr_b16 a[172:173], v10 offset:36864
 ds_read_b64_tr_b16 a[174:175], v10 offset:37376
 s_add_u32 s67, s63, 0x1000
 v_mul_f32 v28, v28, v76
 v_fma_f32 v29, -v77, v77, v22
 v_mul_f32 v73, v73, v25
 v_mfma_f32_32x32x16_bf16 v[96:111], a[176:179], a[40:43], v[96:111]
 ds_read_b64_tr_b16 a[176:177], v11 offset:36864
 ds_read_b64_tr_b16 a[178:179], v11 offset:37376
 buffer_load_dwordx4 a[212:215], v33, s[4:7], s67 offen offset:2048 sc1
 v_rcp_f32 v26, v26
 v_add_f32 v27, 1.0, v27
 v_mfma_f32_32x32x16_bf16 v[112:127], a[144:147], a[40:43], v[112:127]
 ds_read_b64_tr_b16 a[144:145], v10 offset:38912
 ds_read_b64_tr_b16 a[146:147], v10 offset:39424
 v_exp_f32 v28, v28
 v_mul_f32 v29, v29, v77
 v_fma_f32 v30, -v78, v78, v22
 v_mfma_f32_32x32x16_bf16 v[96:111], a[148:151], a[44:47], v[96:111]
 ds_read_b64_tr_b16 a[148:149], v11 offset:38912
 ds_read_b64_tr_b16 a[150:151], v11 offset:39424
 buffer_load_dwordx4 v7, s[12:15], s48 offen offset:1024 lds
 v_cvt_pk_bf16_f32 v68, v72, v73
 v_mul_f32 v74, v74, v26
 v_mfma_f32_32x32x16_bf16 v[112:127], a[152:155], a[44:47], v[112:127]
 s_waitcnt lgkmcnt(8)
 ds_read_b64_tr_b16 a[152:153], v10 offset:40960
 ds_read_b64_tr_b16 a[154:155], v10 offset:41472
 s_add_u32 s48, s56, s33
 s_add_u32 m0, s28, 0xa000
 v_rcp_f32 v27, v27
 v_mfma_f32_32x32x16_bf16 v[96:111], a[156:159], a[48:51], v[96:111]
 ds_read_b64_tr_b16 a[156:157], v11 offset:40960
 ds_read_b64_tr_b16 a[158:159], v11 offset:41472
 buffer_load_dwordx4 v6, s[12:15], s48 offen offset:0 lds
 v_add_f32 v28, 1.0, v28
 v_exp_f32 v29, v29
 v_mfma_f32_32x32x16_bf16 v[112:127], a[160:163], a[48:51], v[112:127]
 s_add_u32 s67, s63, 0x1000
 ds_read_b64_tr_b16 a[160:161], v10 offset:43008
 ds_read_b64_tr_b16 a[162:163], v10 offset:43520
 v_mul_f32 v30, v30, v78
 v_fma_f32 v31, -v79, v79, v22
 v_mul_f32 v75, v75, v27
 v_mfma_f32_32x32x16_bf16 v[96:111], a[164:167], a[52:55], v[96:111]
 ds_read_b64_tr_b16 a[164:165], v11 offset:43008
 ds_read_b64_tr_b16 a[166:167], v11 offset:43520
 buffer_load_dwordx4 a[216:219], v33, s[4:7], s67 offen offset:3072 sc1
 v_rcp_f32 v28, v28
 v_mfma_f32_32x32x16_bf16 v[112:127], a[168:171], a[52:55], v[112:127]
 s_waitcnt lgkmcnt(8)
 ds_read_b64_tr_b16 a[168:169], v10 offset:45056
 ds_read_b64_tr_b16 a[170:171], v10 offset:45568
 v_add_f32 v29, 1.0, v29
 v_exp_f32 v30, v30
 v_mul_f32 v31, v31, v79
 v_mfma_f32_32x32x16_bf16 v[96:111], a[172:175], a[56:59], v[96:111]
 ds_read_b64_tr_b16 a[172:173], v11 offset:45056
 ds_read_b64_tr_b16 a[174:175], v11 offset:45568
 buffer_load_dwordx4 v7, s[12:15], s48 offen offset:1024 lds
 v_cvt_pk_bf16_f32 v69, v74, v75
 v_mul_f32 v76, v76, v28
 v_mfma_f32_32x32x16_bf16 v[112:127], a[176:179], a[56:59], v[112:127]
 ds_read_b64_tr_b16 a[176:177], v10 offset:47104
 ds_read_b64_tr_b16 a[178:179], v10 offset:47616
 v_rcp_f32 v29, v29
 v_add_f32 v30, 1.0, v30
 v_mfma_f32_32x32x16_bf16 v[96:111], a[144:147], a[60:63], v[96:111]
 s_waitcnt vmcnt(16)
 buffer_store_dword v23, v34, s[4:7], 0 offen offset:128 sc1
 ds_read_b64_tr_b16 a[144:145], v11 offset:47104
 ds_read_b64_tr_b16 a[146:147], v11 offset:47616
 v_exp_f32 v31, v31
 v_mul_f32 v77, v77, v29
 v_mfma_f32_32x32x16_bf16 v[112:127], a[148:151], a[60:63], v[112:127]
 s_waitcnt lgkmcnt(8)
 s_barrier
 ds_read_b64_tr_b16 a[148:149], v8 offset:57344
 ds_read_b64_tr_b16 a[150:151], v8 offset:57856
 v_rcp_f32 v30, v30
 v_mfma_f32_32x32x16_bf16 v[96:111], a[152:155], a[64:67], v[96:111]
 ds_read_b64_tr_b16 a[152:153], v9 offset:57344
 ds_read_b64_tr_b16 a[154:155], v9 offset:57856
 v_add_f32 v31, 1.0, v31
 v_cvt_pk_bf16_f32 v70, v76, v77
 v_mul_f32 v78, v78, v30
 v_rcp_f32 v31, v31
 v_mfma_f32_32x32x16_bf16 v[112:127], a[156:159], a[64:67], v[112:127]
 ds_read_b64_tr_b16 a[156:157], v8 offset:59392
 ds_read_b64_tr_b16 a[158:159], v8 offset:59904
 v_mul_f32 v79, v79, v31
 v_cvt_pk_bf16_f32 v71, v78, v79
 s_add_u32 s69, s65, 0x4000
 v_mfma_f32_32x32x16_bf16 v[96:111], a[160:163], a[68:71], v[96:111]
 ds_read_b64_tr_b16 a[160:161], v9 offset:59392
 ds_read_b64_tr_b16 a[162:163], v9 offset:59904
 buffer_store_dwordx4 v[64:67], v33, s[4:7], s69 offen offset:0 sc1
 buffer_store_dwordx4 v[68:71], v33, s[4:7], s69 offen offset:1024 sc1
 v_mfma_f32_32x32x16_bf16 v[112:127], a[164:167], a[68:71], v[112:127]
 s_waitcnt lgkmcnt(8)
 ds_read_b64_tr_b16 a[164:165], v8 offset:61440
 ds_read_b64_tr_b16 a[166:167], v8 offset:61952
 v_fma_f32 v24, -v80, v80, v22
 v_mul_f32 v24, v24, v80
 v_fma_f32 v25, -v81, v81, v22
 v_mfma_f32_32x32x16_bf16 v[96:111], a[168:171], a[72:75], v[96:111]
 ds_read_b64_tr_b16 a[168:169], v9 offset:61440
 ds_read_b64_tr_b16 a[170:171], v9 offset:61952
 v_exp_f32 v24, v24
 v_mul_f32 v25, v25, v81
 v_fma_f32 v26, -v82, v82, v22
 v_add_f32 v24, 1.0, v24
 v_mfma_f32_32x32x16_bf16 v[112:127], a[172:175], a[72:75], v[112:127]
 ds_read_b64_tr_b16 a[172:173], v8 offset:63488
 ds_read_b64_tr_b16 a[174:175], v8 offset:64000
 v_exp_f32 v25, v25
 v_mul_f32 v26, v26, v82
 v_fma_f32 v27, -v83, v83, v22
 v_mfma_f32_32x32x16_bf16 v[96:111], a[176:179], a[76:79], v[96:111]
 s_add_u32 s67, s64, 0x1000
 ds_read_b64_tr_b16 a[176:177], v9 offset:63488
 ds_read_b64_tr_b16 a[178:179], v9 offset:64000
 v_rcp_f32 v24, v24
 v_add_f32 v25, 1.0, v25
 v_mfma_f32_32x32x16_bf16 v[112:127], a[144:147], a[76:79], v[112:127]
 s_waitcnt lgkmcnt(8)
 ds_read_b64_tr_b16 a[144:145], v10 offset:0
 ds_read_b64_tr_b16 a[146:147], v10 offset:512
 buffer_load_dwordx4 a[236:239], v33, s[4:7], s67 offen offset:0 sc1
 v_exp_f32 v26, v26
 v_mfma_f32_32x32x16_bf16 v[96:111], a[148:151], a[80:83], v[96:111]
 s_add_u32 s67, s64, 0x1000
 ds_read_b64_tr_b16 a[148:149], v11 offset:0
 ds_read_b64_tr_b16 a[150:151], v11 offset:512
 v_mul_f32 v27, v27, v83
 v_fma_f32 v28, -v84, v84, v22
 v_mul_f32 v80, v80, v24
 v_rcp_f32 v25, v25
 v_mfma_f32_32x32x16_bf16 v[112:127], a[152:155], a[80:83], v[112:127]
 ds_read_b64_tr_b16 a[152:153], v10 offset:2048
 ds_read_b64_tr_b16 a[154:155], v10 offset:2560
 buffer_load_dwordx4 a[240:243], v33, s[4:7], s67 offen offset:1024 sc1
 v_add_f32 v26, 1.0, v26
 v_mfma_f32_32x32x16_bf16 v[96:111], a[156:159], a[84:87], v[96:111]
 s_add_u32 s67, s64, 0x1000
 ds_read_b64_tr_b16 a[156:157], v11 offset:2048
 ds_read_b64_tr_b16 a[158:159], v11 offset:2560
 v_exp_f32 v27, v27
 v_mul_f32 v28, v28, v84
 v_fma_f32 v29, -v85, v85, v22
 v_mfma_f32_32x32x16_bf16 v[112:127], a[160:163], a[84:87], v[112:127]
 s_waitcnt lgkmcnt(8)
 ds_read_b64_tr_b16 a[160:161], v10 offset:4096
 ds_read_b64_tr_b16 a[162:163], v10 offset:4608
 buffer_load_dwordx4 a[244:247], v33, s[4:7], s67 offen offset:2048 sc1
 v_mul_f32 v81, v81, v25
 v_mfma_f32_32x32x16_bf16 v[96:111], a[164:167], a[88:91], v[96:111]
 s_add_u32 s67, s64, 0x1000
 ds_read_b64_tr_b16 a[164:165], v11 offset:4096
 ds_read_b64_tr_b16 a[166:167], v11 offset:4608
 v_rcp_f32 v26, v26
 v_add_f32 v27, 1.0, v27
 v_exp_f32 v28, v28
 v_mfma_f32_32x32x16_bf16 v[112:127], a[168:171], a[88:91], v[112:127]
 ds_read_b64_tr_b16 a[168:169], v10 offset:6144
 ds_read_b64_tr_b16 a[170:171], v10 offset:6656
 buffer_load_dwordx4 a[248:251], v33, s[4:7], s67 offen offset:3072 sc1
 v_mul_f32 v29, v29, v85
 v_fma_f32 v30, -v86, v86, v22
 v_mfma_f32_32x32x16_bf16 v[96:111], a[172:175], a[92:95], v[96:111]
 s_add_u32 s48, s52, s73
 ds_read_b64_tr_b16 a[172:173], v11 offset:6144
 ds_read_b64_tr_b16 a[174:175], v11 offset:6656
 s_add_u32 m0, s28, 0xc000
 v_cvt_pk_bf16_f32 v80, v80, v81
 v_mul_f32 v82, v82, v26
 v_mfma_f32_32x32x16_bf16 v[112:127], a[176:179], a[92:95], v[112:127]
 s_waitcnt lgkmcnt(8)
 s_barrier
 ds_read_b64_tr_b16 a[176:177], v10 offset:49152
 ds_read_b64_tr_b16 a[178:179], v10 offset:49664
 buffer_load_dwordx4 v6, s[12:15], s48 offen offset:0 lds
 v_mfma_f32_32x32x16_bf16 v[96:111], a[144:147], a[96:99], v[96:111]
 ds_read_b64_tr_b16 a[144:145], v11 offset:49152
 ds_read_b64_tr_b16 a[146:147], v11 offset:49664
 v_rcp_f32 v27, v27
 v_add_f32 v28, 1.0, v28
 v_exp_f32 v29, v29
 v_mfma_f32_32x32x16_bf16 v[112:127], a[148:151], a[96:99], v[112:127]
 ds_read_b64_tr_b16 a[148:149], v10 offset:51200
 ds_read_b64_tr_b16 a[150:151], v10 offset:51712
 v_mul_f32 v30, v30, v86
 v_fma_f32 v31, -v87, v87, v22
 v_mul_f32 v83, v83, v27
 v_mfma_f32_32x32x16_bf16 v[96:111], a[152:155], a[100:103], v[96:111]
 ds_read_b64_tr_b16 a[152:153], v11 offset:51200
 ds_read_b64_tr_b16 a[154:155], v11 offset:51712
 v_rcp_f32 v28, v28
 v_add_f32 v29, 1.0, v29
 v_mfma_f32_32x32x16_bf16 v[112:127], a[156:159], a[100:103], v[112:127]
 s_waitcnt lgkmcnt(8)
 ds_read_b64_tr_b16 a[156:157], v10 offset:53248
 ds_read_b64_tr_b16 a[158:159], v10 offset:53760
 v_exp_f32 v30, v30
 v_mul_f32 v31, v31, v87
 v_fma_f32 v24, -v88, v88, v22
 v_mfma_f32_32x32x16_bf16 v[96:111], a[160:163], a[104:107], v[96:111]
 ds_read_b64_tr_b16 a[160:161], v11 offset:53248
 ds_read_b64_tr_b16 a[162:163], v11 offset:53760
 v_cvt_pk_bf16_f32 v81, v82, v83
 v_mul_f32 v84, v84, v28
 v_rcp_f32 v29, v29
 v_add_f32 v30, 1.0, v30
 v_mfma_f32_32x32x16_bf16 v[112:127], a[164:167], a[104:107], v[112:127]
 ds_read_b64_tr_b16 a[164:165], v10 offset:55296
 ds_read_b64_tr_b16 a[166:167], v10 offset:55808
 buffer_load_dwordx4 v7, s[12:15], s48 offen offset:1024 lds
 v_exp_f32 v31, v31
 v_mfma_f32_32x32x16_bf16 v[96:111], a[168:171], a[108:111], v[96:111]
 s_add_u32 s48, s53, s73
 ds_read_b64_tr_b16 a[168:169], v11 offset:55296
 ds_read_b64_tr_b16 a[170:171], v11 offset:55808
 s_add_u32 m0, s28, 0xe000
 v_mul_f32 v24, v24, v88
 v_fma_f32 v25, -v89, v89, v22
 v_mul_f32 v85, v85, v29
 v_mfma_f32_32x32x16_bf16 v[112:127], a[172:175], a[108:111], v[112:127]
 s_waitcnt lgkmcnt(8)
 ds_read_b64_tr_b16 a[172:173], v8 offset:0
 ds_read_b64_tr_b16 a[174:175], v8 offset:512
 buffer_load_dwordx4 v6, s[12:15], s48 offen offset:0 lds
 v_rcp_f32 v30, v30
 v_mfma_f32_32x32x16_bf16 v[96:111], a[176:179], a[112:115], v[96:111]
 ds_read_b64_tr_b16 a[176:177], v9 offset:0
 ds_read_b64_tr_b16 a[178:179], v9 offset:512
 v_add_f32 v31, 1.0, v31
 v_exp_f32 v24, v24
 v_mul_f32 v25, v25, v89
 v_fma_f32 v26, -v90, v90, v22
 v_mfma_f32_32x32x16_bf16 v[112:127], a[144:147], a[112:115], v[112:127]
 ds_read_b64_tr_b16 a[144:145], v8 offset:2048
 ds_read_b64_tr_b16 a[146:147], v8 offset:2560
 buffer_load_dwordx4 v7, s[12:15], s48 offen offset:1024 lds
 v_cvt_pk_bf16_f32 v82, v84, v85
 v_mul_f32 v86, v86, v30
 v_mfma_f32_32x32x16_bf16 v[96:111], a[148:151], a[116:119], v[96:111]
 s_add_u32 s48, s55, s73
 ds_read_b64_tr_b16 a[148:149], v9 offset:2048
 ds_read_b64_tr_b16 a[150:151], v9 offset:2560
 s_add_u32 m0, s28, 0x10000
 v_rcp_f32 v31, v31
 v_add_f32 v24, 1.0, v24
 v_mfma_f32_32x32x16_bf16 v[112:127], a[152:155], a[116:119], v[112:127]
 s_waitcnt lgkmcnt(8)
 ds_read_b64_tr_b16 a[152:153], v8 offset:4096
 ds_read_b64_tr_b16 a[154:155], v8 offset:4608
 buffer_load_dwordx4 v6, s[12:15], s48 offen offset:0 lds
 v_exp_f32 v25, v25
 v_mfma_f32_32x32x16_bf16 v[96:111], a[156:159], a[120:123], v[96:111]
 ds_read_b64_tr_b16 a[156:157], v9 offset:4096
 ds_read_b64_tr_b16 a[158:159], v9 offset:4608
 v_mul_f32 v26, v26, v90
 v_fma_f32 v27, -v91, v91, v22
 v_mul_f32 v87, v87, v31
 v_rcp_f32 v24, v24
 v_mfma_f32_32x32x16_bf16 v[112:127], a[160:163], a[120:123], v[112:127]
 ds_read_b64_tr_b16 a[160:161], v8 offset:6144
 ds_read_b64_tr_b16 a[162:163], v8 offset:6656
 buffer_load_dwordx4 v7, s[12:15], s48 offen offset:1024 lds
 v_add_f32 v25, 1.0, v25
 v_mfma_f32_32x32x16_bf16 v[96:111], a[164:167], a[124:127], v[96:111]
 s_add_u32 s48, s56, s73
 ds_read_b64_tr_b16 a[164:165], v9 offset:6144
 ds_read_b64_tr_b16 a[166:167], v9 offset:6656
 s_add_u32 m0, s28, 0x12000
 v_exp_f32 v26, v26
 v_mul_f32 v27, v27, v91
 v_mfma_f32_32x32x16_bf16 v[112:127], a[168:171], a[124:127], v[112:127]
 s_waitcnt lgkmcnt(8)
 s_barrier
 ds_read_b64_tr_b16 a[168:169], v14 offset:8192
 ds_read_b64_tr_b16 a[170:171], v14 offset:9216
 buffer_load_dwordx4 v6, s[12:15], s48 offen offset:0 lds
 v_mfma_f32_32x32x16_bf16 v[96:111], a[172:175], a[128:131], v[96:111]
 ds_read_b64_tr_b16 a[172:173], v15 offset:8192
 ds_read_b64_tr_b16 a[174:175], v15 offset:9216
 buffer_load_dword v40, v35, s[4:7], 0 offen offset:128 sc1
 v_fma_f32 v28, -v92, v92, v22
 v_cvt_pk_bf16_f32 v83, v86, v87
 v_mul_f32 v88, v88, v24
 v_mfma_f32_32x32x16_bf16 v[112:127], a[176:179], a[128:131], v[112:127]
 ds_read_b64_tr_b16 a[176:177], v14 offset:10240
 ds_read_b64_tr_b16 a[178:179], v14 offset:11264
 v_rcp_f32 v25, v25
 v_add_f32 v26, 1.0, v26
 v_mfma_f32_32x32x16_bf16 v[96:111], a[144:147], a[132:135], v[96:111]
 ds_read_b64_tr_b16 a[144:145], v15 offset:10240
 ds_read_b64_tr_b16 a[146:147], v15 offset:11264
 buffer_load_dwordx4 v7, s[12:15], s48 offen offset:1024 lds
 v_exp_f32 v27, v27
 v_mfma_f32_32x32x16_bf16 v[112:127], a[148:151], a[132:135], v[112:127]
 s_waitcnt lgkmcnt(8)
 ds_read_b64_tr_b16 a[148:149], v14 offset:12288
 ds_read_b64_tr_b16 a[150:151], v14 offset:13312
 s_add_u32 s48, s52, s74
 s_add_u32 m0, s28, 0x18000
 v_mul_f32 v28, v28, v92
 v_fma_f32 v29, -v93, v93, v22
 v_mfma_f32_32x32x16_bf16 v[96:111], a[152:155], a[136:139], v[96:111]
 ds_read_b64_tr_b16 a[152:153], v15 offset:12288
 ds_read_b64_tr_b16 a[154:155], v15 offset:13312
 buffer_load_dwordx4 v6, s[12:15], s48 offen offset:0 lds
 v_mul_f32 v89, v89, v25
 v_rcp_f32 v26, v26
 v_mfma_f32_32x32x16_bf16 v[112:127], a[156:159], a[136:139], v[112:127]
 ds_read_b64_tr_b16 a[156:157], v14 offset:14336
 ds_read_b64_tr_b16 a[158:159], v14 offset:15360
 v_add_f32 v27, 1.0, v27
 v_exp_f32 v28, v28
 v_mul_f32 v29, v29, v93
 v_mfma_f32_32x32x16_bf16 v[96:111], a[160:163], a[140:143], v[96:111]
 ds_read_b64_tr_b16 a[160:161], v15 offset:14336
 ds_read_b64_tr_b16 a[162:163], v15 offset:15360
 buffer_load_dwordx4 v7, s[12:15], s48 offen offset:1024 lds
 v_fma_f32 v30, -v94, v94, v22
 v_cvt_pk_bf16_f32 v84, v88, v89
 v_mfma_f32_32x32x16_bf16 v[112:127], a[164:167], a[140:143], v[112:127]
 s_waitcnt lgkmcnt(8)
 ds_read_b64_tr_b16 a[164:165], v16 offset:8192
 ds_read_b64_tr_b16 a[166:167], v16 offset:9216
 s_add_u32 s48, s53, s74
 s_add_u32 m0, s28, 0x1a000
 v_mul_f32 v90, v90, v26
 v_mfma_f32_32x32x16_bf16 v[128:143], a[168:171], a[188:191], v[128:143]
 ds_read_b64_tr_b16 a[168:169], v17 offset:8192
 ds_read_b64_tr_b16 a[170:171], v17 offset:9216
 buffer_load_dwordx4 v6, s[12:15], s48 offen offset:0 lds
 v_rcp_f32 v27, v27
 v_add_f32 v28, 1.0, v28
 v_mfma_f32_32x32x16_bf16 v[144:159], a[172:175], a[188:191], v[144:159]
 ds_read_b64_tr_b16 a[172:173], v16 offset:10240
 ds_read_b64_tr_b16 a[174:175], v16 offset:11264
 v_exp_f32 v29, v29
 v_mul_f32 v30, v30, v94
 v_fma_f32 v31, -v95, v95, v22
 v_mul_f32 v91, v91, v27
 v_mfma_f32_32x32x16_bf16 v[128:143], a[176:179], a[192:195], v[128:143]
 ds_read_b64_tr_b16 a[176:177], v17 offset:10240
 ds_read_b64_tr_b16 a[178:179], v17 offset:11264
 buffer_load_dwordx4 v7, s[12:15], s48 offen offset:1024 lds
 v_rcp_f32 v28, v28
 v_add_f32 v29, 1.0, v29
 v_mfma_f32_32x32x16_bf16 v[144:159], a[144:147], a[192:195], v[144:159]
 s_waitcnt lgkmcnt(8)
 ds_read_b64_tr_b16 a[144:145], v16 offset:12288
 ds_read_b64_tr_b16 a[146:147], v16 offset:13312
 s_add_u32 s48, s55, s74
 s_add_u32 m0, s28, 0x1c000
 v_exp_f32 v30, v30
 v_mul_f32 v31, v31, v95
 v_mfma_f32_32x32x16_bf16 v[128:143], a[148:151], a[196:199], v[128:143]
 ds_read_b64_tr_b16 a[148:149], v17 offset:12288
 ds_read_b64_tr_b16 a[150:151], v17 offset:13312
 buffer_load_dwordx4 v6, s[12:15], s48 offen offset:0 lds
 v_cvt_pk_bf16_f32 v85, v90, v91
 v_mul_f32 v92, v92, v28
 v_mfma_f32_32x32x16_bf16 v[144:159], a[152:155], a[196:199], v[144:159]
 ds_read_b64_tr_b16 a[152:153], v16 offset:14336
 ds_read_b64_tr_b16 a[154:155], v16 offset:15360
 v_rcp_f32 v29, v29
 v_add_f32 v30, 1.0, v30
 v_exp_f32 v31, v31
 v_mfma_f32_32x32x16_bf16 v[128:143], a[156:159], a[200:203], v[128:143]
 ds_read_b64_tr_b16 a[156:157], v17 offset:14336
 ds_read_b64_tr_b16 a[158:159], v17 offset:15360
 buffer_load_dwordx4 v7, s[12:15], s48 offen offset:1024 lds
 v_mul_f32 v93, v93, v29
 v_rcp_f32 v30, v30
 v_mfma_f32_32x32x16_bf16 v[144:159], a[160:163], a[200:203], v[144:159]
 s_waitcnt vmcnt(33) lgkmcnt(8)
 s_barrier
 ds_read_b64_tr_b16 a[160:161], v16 offset:57344
 ds_read_b64_tr_b16 a[162:163], v16 offset:58368
 v_add_f32 v31, 1.0, v31
 v_cvt_pk_bf16_f32 v86, v92, v93
 v_mul_f32 v94, v94, v30
 v_mfma_f32_32x32x16_bf16 v[160:175], a[164:167], a[188:191], v[160:175]
 ds_read_b64_tr_b16 a[164:165], v17 offset:57344
 ds_read_b64_tr_b16 a[166:167], v17 offset:58368
 v_rcp_f32 v31, v31
 s_nop 0
 v_mul_f32 v95, v95, v31
 v_cvt_pk_bf16_f32 v87, v94, v95
 s_add_u32 s69, s65, 0x4000
 v_mfma_f32_32x32x16_bf16 v[176:191], a[168:171], a[188:191], v[176:191]
 ds_read_b64_tr_b16 a[168:169], v16 offset:59392
 ds_read_b64_tr_b16 a[170:171], v16 offset:60416
 buffer_store_dwordx4 v[80:83], v33, s[4:7], s69 offen offset:2048 sc1
 buffer_store_dwordx4 v[84:87], v33, s[4:7], s69 offen offset:3072 sc1
 v_fma_f32 v24, -v96, v96, v22
 v_mfma_f32_32x32x16_bf16 v[160:175], a[172:175], a[192:195], v[160:175]
 ds_read_b64_tr_b16 a[172:173], v17 offset:59392
 ds_read_b64_tr_b16 a[174:175], v17 offset:60416
 v_mul_f32 v24, v24, v96
 v_fma_f32 v25, -v97, v97, v22
 v_exp_f32 v24, v24
 v_mul_f32 v25, v25, v97
 v_mfma_f32_32x32x16_bf16 v[176:191], a[176:179], a[192:195], v[176:191]
 s_waitcnt lgkmcnt(8)
 ds_read_b64_tr_b16 a[176:177], v16 offset:61440
 ds_read_b64_tr_b16 a[178:179], v16 offset:62464
 v_fma_f32 v26, -v98, v98, v22
 v_add_f32 v24, 1.0, v24
 v_exp_f32 v25, v25
 v_mul_f32 v26, v26, v98
 v_mfma_f32_32x32x16_bf16 v[160:175], a[144:147], a[196:199], v[160:175]
 ds_read_b64_tr_b16 a[144:145], v17 offset:61440
 ds_read_b64_tr_b16 a[146:147], v17 offset:62464
 v_fma_f32 v27, -v99, v99, v22
 v_rcp_f32 v24, v24
 v_add_f32 v25, 1.0, v25
 v_mfma_f32_32x32x16_bf16 v[176:191], a[148:151], a[196:199], v[176:191]
 ds_read_b64_tr_b16 a[148:149], v16 offset:63488
 ds_read_b64_tr_b16 a[150:151], v16 offset:64512
 v_exp_f32 v26, v26
 v_mul_f32 v27, v27, v99
 v_fma_f32 v28, -v100, v100, v22
 v_mul_f32 v96, v96, v24
 v_mfma_f32_32x32x16_bf16 v[160:175], a[152:155], a[200:203], v[160:175]
 s_add_u32 s48, s56, s74
 ds_read_b64_tr_b16 a[152:153], v17 offset:63488
 ds_read_b64_tr_b16 a[154:155], v17 offset:64512
 s_add_u32 m0, s28, 0x2000
 v_rcp_f32 v25, v25
 v_add_f32 v26, 1.0, v26
 v_mfma_f32_32x32x16_bf16 v[176:191], a[156:159], a[200:203], v[176:191]
 s_waitcnt lgkmcnt(8)
 ds_read_b64_tr_b16 a[156:157], v16 offset:16384
 ds_read_b64_tr_b16 a[158:159], v16 offset:17408
 buffer_load_dwordx4 v6, s[12:15], s48 offen offset:0 lds
 v_exp_f32 v27, v27
 v_mul_f32 v28, v28, v100
 v_mfma_f32_32x32x16_bf16 v[128:143], a[160:163], v[64:67], v[128:143]
 ds_read_b64_tr_b16 a[160:161], v17 offset:16384
 ds_read_b64_tr_b16 a[162:163], v17 offset:17408
 v_fma_f32 v29, -v101, v101, v22
 v_mul_f32 v97, v97, v25
 v_rcp_f32 v26, v26
 v_add_f32 v27, 1.0, v27
 v_mfma_f32_32x32x16_bf16 v[144:159], a[164:167], v[64:67], v[144:159]
 ds_read_b64_tr_b16 a[164:165], v16 offset:18432
 ds_read_b64_tr_b16 a[166:167], v16 offset:19456
 buffer_load_dwordx4 v7, s[12:15], s48 offen offset:1024 lds
 v_exp_f32 v28, v28
 v_mul_f32 v29, v29, v101
 v_mfma_f32_32x32x16_bf16 v[128:143], a[168:171], v[68:71], v[128:143]
 s_add_u32 s48, s49, s85
 ds_read_b64_tr_b16 a[168:169], v17 offset:18432
 ds_read_b64_tr_b16 a[170:171], v17 offset:19456
 s_add_u32 m0, s28, 0x4000
 v_fma_f32 v30, -v102, v102, v22
 v_cvt_pk_bf16_f32 v96, v96, v97
 v_mul_f32 v98, v98, v26
 v_mfma_f32_32x32x16_bf16 v[144:159], a[172:175], v[68:71], v[144:159]
 s_waitcnt lgkmcnt(8)
 ds_read_b64_tr_b16 a[172:173], v16 offset:20480
 ds_read_b64_tr_b16 a[174:175], v16 offset:21504
 buffer_load_dwordx4 v6, s[12:15], s48 offen offset:0 lds
 v_rcp_f32 v27, v27
 v_add_f32 v28, 1.0, v28
 v_mfma_f32_32x32x16_bf16 v[128:143], a[176:179], v[80:83], v[128:143]
 ds_read_b64_tr_b16 a[176:177], v17 offset:20480
 ds_read_b64_tr_b16 a[178:179], v17 offset:21504
 v_exp_f32 v29, v29
 v_mul_f32 v30, v30, v102
 v_fma_f32 v31, -v103, v103, v22
 v_mul_f32 v99, v99, v27
 v_mfma_f32_32x32x16_bf16 v[144:159], a[144:147], v[80:83], v[144:159]
 ds_read_b64_tr_b16 a[144:145], v16 offset:22528
 ds_read_b64_tr_b16 a[146:147], v16 offset:23552
 buffer_load_dwordx4 v7, s[12:15], s48 offen offset:1024 lds
 v_rcp_f32 v28, v28
 v_add_f32 v29, 1.0, v29
 v_mfma_f32_32x32x16_bf16 v[128:143], a[148:151], v[84:87], v[128:143]
 s_add_u32 s48, s50, s85
 ds_read_b64_tr_b16 a[148:149], v17 offset:22528
 ds_read_b64_tr_b16 a[150:151], v17 offset:23552
 s_add_u32 m0, s28, 0x14000
 v_exp_f32 v30, v30
 v_mul_f32 v31, v31, v103
 v_fma_f32 v24, -v104, v104, v22
 v_mfma_f32_32x32x16_bf16 v[144:159], a[152:155], v[84:87], v[144:159]
 s_waitcnt vmcnt(31) lgkmcnt(8)
 s_barrier
 ds_read_b64_tr_b16 a[152:153], v14 offset:16384
 ds_read_b64_tr_b16 a[154:155], v14 offset:17408
 buffer_load_dwordx4 v6, s[12:15], s48 offen offset:0 lds
 v_cvt_pk_bf16_f32 v97, v98, v99
 v_mfma_f32_32x32x16_bf16 v[160:175], a[156:159], v[64:67], v[160:175]
 ds_read_b64_tr_b16 a[156:157], v15 offset:16384
 ds_read_b64_tr_b16 a[158:159], v15 offset:17408
 v_mul_f32 v100, v100, v28
 v_rcp_f32 v29, v29
 v_add_f32 v30, 1.0, v30
 v_mfma_f32_32x32x16_bf16 v[176:191], a[160:163], v[64:67], v[176:191]
 ds_read_b64_tr_b16 a[160:161], v14 offset:18432
 ds_read_b64_tr_b16 a[162:163], v14 offset:19456
 buffer_load_dwordx4 v7, s[12:15], s48 offen offset:1024 lds
 v_exp_f32 v31, v31
 v_mul_f32 v24, v24, v104
 v_mfma_f32_32x32x16_bf16 v[160:175], a[164:167], v[68:71], v[160:175]
 ds_read_b64_tr_b16 a[164:165], v15 offset:18432
 ds_read_b64_tr_b16 a[166:167], v15 offset:19456
 s_waitcnt vmcnt(15)
 v_cmp_eq_u32 vcc, 0, v40
 s_nop 1
 s_cmp_lg_u64 vcc, 0
 s_cbranch_scc1 mh1_spin
mh1_back:
 v_fma_f32 v25, -v105, v105, v22
 v_mfma_f32_32x32x16_bf16 v[176:191], a[168:171], v[68:71], v[176:191]
 s_waitcnt lgkmcnt(8)
 ds_read_b64_tr_b16 a[168:169], v14 offset:20480
 ds_read_b64_tr_b16 a[170:171], v14 offset:21504
 v_mul_f32 v101, v101, v29
 v_rcp_f32 v30, v30
 v_add_f32 v31, 1.0, v31
 v_mfma_f32_32x32x16_bf16 v[160:175], a[172:175], v[80:83], v[160:175]
 ds_read_b64_tr_b16 a[172:173], v15 offset:20480
 ds_read_b64_tr_b16 a[174:175], v15 offset:21504
 v_exp_f32 v24, v24
 v_mul_f32 v25, v25, v105
 v_fma_f32 v26, -v106, v106, v22
 v_cvt_pk_bf16_f32 v98, v100, v101
 v_mfma_f32_32x32x16_bf16 v[176:191], a[176:179], v[80:83], v[176:191]
 ds_read_b64_tr_b16 a[176:177], v14 offset:22528
 ds_read_b64_tr_b16 a[178:179], v14 offset:23552
 v_mul_f32 v102, v102, v30
 v_rcp_f32 v31, v31
 v_add_f32 v24, 1.0, v24
 v_mfma_f32_32x32x16_bf16 v[160:175], a[144:147], v[84:87], v[160:175]
 ds_read_b64_tr_b16 a[144:145], v15 offset:22528
 ds_read_b64_tr_b16 a[146:147], v15 offset:23552
 v_exp_f32 v25, v25
 v_mul_f32 v26, v26, v106
 v_fma_f32 v27, -v107, v107, v22
 v_mul_f32 v103, v103, v31
 v_mfma_f32_32x32x16_bf16 v[176:191], a[148:151], v[84:87], v[176:191]
 s_waitcnt lgkmcnt(8)
 ds_read_b64_tr_b16 a[148:149], v14 offset:24576
 ds_read_b64_tr_b16 a[150:151], v14 offset:25600
 s_add_u32 s48, s51, s85
 s_add_u32 m0, s28, 0x1e000
 v_rcp_f32 v24, v24
 v_add_f32 v25, 1.0, v25
 v_mfma_f32_32x32x16_bf16 v[192:207], a[152:155], v[64:67], v[192:207]
 ds_read_b64_tr_b16 a[152:153], v15 offset:24576
 ds_read_b64_tr_b16 a[154:155], v15 offset:25600
 buffer_load_dwordx4 v6, s[12:15], s48 offen offset:0 lds
 v_exp_f32 v26, v26
 v_mul_f32 v27, v27, v107
 v_mfma_f32_32x32x16_bf16 v[208:223], a[156:159], v[64:67], v[208:223]
 ds_read_b64_tr_b16 a[156:157], v14 offset:26624
 ds_read_b64_tr_b16 a[158:159], v14 offset:27648
 v_fma_f32 v28, -v108, v108, v22
 v_cvt_pk_bf16_f32 v99, v102, v103
 v_mul_f32 v104, v104, v24
 v_rcp_f32 v25, v25
 v_mfma_f32_32x32x16_bf16 v[192:207], a[160:163], v[68:71], v[192:207]
 ds_read_b64_tr_b16 a[160:161], v15 offset:26624
 ds_read_b64_tr_b16 a[162:163], v15 offset:27648
 buffer_load_dwordx4 v7, s[12:15], s48 offen offset:1024 lds
 v_add_f32 v26, 1.0, v26
 v_exp_f32 v27, v27
 v_mfma_f32_32x32x16_bf16 v[208:223], a[164:167], v[68:71], v[208:223]
 s_waitcnt lgkmcnt(8)
 ds_read_b64_tr_b16 a[164:165], v14 offset:28672
 ds_read_b64_tr_b16 a[166:167], v14 offset:29696
 s_add_u32 s67, s63, 0x2000
 v_mul_f32 v28, v28, v108
 v_fma_f32 v29, -v109, v109, v22
 v_mul_f32 v105, v105, v25
 v_mfma_f32_32x32x16_bf16 v[192:207], a[168:171], v[80:83], v[192:207]
 ds_read_b64_tr_b16 a[168:169], v15 offset:28672
 ds_read_b64_tr_b16 a[170:171], v15 offset:29696
 buffer_load_dwordx4 a[0:3], v33, s[4:7], s67 offen offset:0 sc1
 v_rcp_f32 v26, v26
 v_add_f32 v27, 1.0, v27
 v_mfma_f32_32x32x16_bf16 v[208:223], a[172:175], v[80:83], v[208:223]
 s_add_u32 s67, s63, 0x2000
 ds_read_b64_tr_b16 a[172:173], v14 offset:30720
 ds_read_b64_tr_b16 a[174:175], v14 offset:31744
 v_exp_f32 v28, v28
 v_mul_f32 v29, v29, v109
 v_fma_f32 v30, -v110, v110, v22
 v_cvt_pk_bf16_f32 v100, v104, v105
 v_mfma_f32_32x32x16_bf16 v[192:207], a[176:179], v[84:87], v[192:207]
 ds_read_b64_tr_b16 a[176:177], v15 offset:30720
 ds_read_b64_tr_b16 a[178:179], v15 offset:31744
 buffer_load_dwordx4 a[4:7], v33, s[4:7], s67 offen offset:1024 sc1
 v_mul_f32 v106, v106, v26
 v_rcp_f32 v27, v27
 v_mfma_f32_32x32x16_bf16 v[208:223], a[144:147], v[84:87], v[208:223]
 s_waitcnt lgkmcnt(8)
 s_barrier
 ds_read_b64_tr_b16 a[144:145], v14 offset:32768
 ds_read_b64_tr_b16 a[146:147], v14 offset:33792
 s_add_u32 s67, s63, 0x2000
 v_add_f32 v28, 1.0, v28
 v_mfma_f32_32x32x16_bf16 v[128:143], a[148:151], a[220:223], v[128:143]
 ds_read_b64_tr_b16 a[148:149], v15 offset:32768
 ds_read_b64_tr_b16 a[150:151], v15 offset:33792
 buffer_load_dwordx4 a[16:19], v33, s[4:7], s67 offen offset:2048 sc1
 v_exp_f32 v29, v29
 v_mul_f32 v30, v30, v110
 v_mfma_f32_32x32x16_bf16 v[144:159], a[152:155], a[220:223], v[144:159]
 s_add_u32 s67, s63, 0x2000
 ds_read_b64_tr_b16 a[152:153], v14 offset:34816
 ds_read_b64_tr_b16 a[154:155], v14 offset:35840
 v_fma_f32 v31, -v111, v111, v22
 v_mul_f32 v107, v107, v27
 v_rcp_f32 v28, v28
 v_add_f32 v29, 1.0, v29
 v_mfma_f32_32x32x16_bf16 v[128:143], a[156:159], a[224:227], v[128:143]
 ds_read_b64_tr_b16 a[156:157], v15 offset:34816
 ds_read_b64_tr_b16 a[158:159], v15 offset:35840
 buffer_load_dwordx4 a[20:23], v33, s[4:7], s67 offen offset:3072 sc1
 v_exp_f32 v30, v30
 v_mul_f32 v31, v31, v111
 v_mfma_f32_32x32x16_bf16 v[144:159], a[160:163], a[224:227], v[144:159]
 s_waitcnt lgkmcnt(8)
 ds_read_b64_tr_b16 a[160:161], v14 offset:36864
 ds_read_b64_tr_b16 a[162:163], v14 offset:37888
 s_add_u32 s67, s64, 0x2000
 v_cvt_pk_bf16_f32 v101, v106, v107
 v_mul_f32 v108, v108, v28
 v_rcp_f32 v29, v29
 v_mfma_f32_32x32x16_bf16 v[128:143], a[164:167], a[228:231], v[128:143]
 ds_read_b64_tr_b16 a[164:165], v15 offset:36864
 ds_read_b64_tr_b16 a[166:167], v15 offset:37888
 buffer_load_dwordx4 a[8:11], v33, s[4:7], s67 offen offset:0 sc1
 v_add_f32 v30, 1.0, v30
 v_exp_f32 v31, v31
 v_mfma_f32_32x32x16_bf16 v[144:159], a[168:171], a[228:231], v[144:159]
 s_add_u32 s67, s64, 0x2000
 ds_read_b64_tr_b16 a[168:169], v14 offset:38912
 ds_read_b64_tr_b16 a[170:171], v14 offset:39936
 v_mul_f32 v109, v109, v29
 v_rcp_f32 v30, v30
 v_add_f32 v31, 1.0, v31
 v_cvt_pk_bf16_f32 v102, v108, v109
 v_mfma_f32_32x32x16_bf16 v[128:143], a[172:175], a[232:235], v[128:143]
 ds_read_b64_tr_b16 a[172:173], v15 offset:38912
 ds_read_b64_tr_b16 a[174:175], v15 offset:39936
 buffer_load_dwordx4 a[12:15], v33, s[4:7], s67 offen offset:1024 sc1
 v_mul_f32 v110, v110, v30
 v_rcp_f32 v31, v31
 v_mfma_f32_32x32x16_bf16 v[144:159], a[176:179], a[232:235], v[144:159]
 s_waitcnt lgkmcnt(8)
 ds_read_b64_tr_b16 a[176:177], v14 offset:40960
 ds_read_b64_tr_b16 a[178:179], v14 offset:41984
 s_add_u32 s48, s52, s75
 s_add_u32 m0, s28, 0x6000
 v_mul_f32 v111, v111, v31
 v_cvt_pk_bf16_f32 v103, v110, v111
 s_add_u32 s69, s65, 0x5000
 v_mfma_f32_32x32x16_bf16 v[160:175], a[144:147], a[220:223], v[160:175]
 ds_read_b64_tr_b16 a[144:145], v15 offset:40960
 ds_read_b64_tr_b16 a[146:147], v15 offset:41984
 buffer_load_dwordx4 v6, s[12:15], s48 offen offset:0 lds
 buffer_store_dwordx4 v[96:99], v33, s[4:7], s69 offen offset:0 sc1
 v_mfma_f32_32x32x16_bf16 v[176:191], a[148:151], a[220:223], v[176:191]
 ds_read_b64_tr_b16 a[148:149], v14 offset:43008
 ds_read_b64_tr_b16 a[150:151], v14 offset:44032
 buffer_store_dwordx4 v[100:103], v33, s[4:7], s69 offen offset:1024 sc1
 v_fma_f32 v24, -v112, v112, v22
 v_mul_f32 v24, v24, v112
 v_fma_f32 v25, -v113, v113, v22
 v_mfma_f32_32x32x16_bf16 v[160:175], a[152:155], a[224:227], v[160:175]
 ds_read_b64_tr_b16 a[152:153], v15 offset:43008
 ds_read_b64_tr_b16 a[154:155], v15 offset:44032
 v_exp_f32 v24, v24
 v_mul_f32 v25, v25, v113
 v_fma_f32 v26, -v114, v114, v22
 v_add_f32 v24, 1.0, v24
 v_mfma_f32_32x32x16_bf16 v[176:191], a[156:159], a[224:227], v[176:191]
 s_waitcnt lgkmcnt(8)
 ds_read_b64_tr_b16 a[156:157], v14 offset:45056
 ds_read_b64_tr_b16 a[158:159], v14 offset:46080
 v_exp_f32 v25, v25
 v_mul_f32 v26, v26, v114
 v_fma_f32 v27, -v115, v115, v22
 v_mfma_f32_32x32x16_bf16 v[160:175], a[160:163], a[228:231], v[160:175]
 ds_read_b64_tr_b16 a[160:161], v15 offset:45056
 ds_read_b64_tr_b16 a[162:163], v15 offset:46080
 v_rcp_f32 v24, v24
 v_add_f32 v25, 1.0, v25
 v_exp_f32 v26, v26
 v_mfma_f32_32x32x16_bf16 v[176:191], a[164:167], a[228:231], v[176:191]
 s_waitcnt vmcnt(17)
 buffer_store_dword v23, v34, s[4:7], 0 offen offset:256 sc1
 ds_read_b64_tr_b16 a[164:165], v14 offset:47104
 ds_read_b64_tr_b16 a[166:167], v14 offset:48128
 v_mul_f32 v27, v27, v115
 v_fma_f32 v28, -v116, v116, v22
 v_mul_f32 v112, v112, v24
 v_rcp_f32 v25, v25
 v_mfma_f32_32x32x16_bf16 v[160:175], a[168:171], a[232:235], v[160:175]
 ds_read_b64_tr_b16 a[168:169], v15 offset:47104
 ds_read_b64_tr_b16 a[170:171], v15 offset:48128
 v_add_f32 v26, 1.0, v26
 v_exp_f32 v27, v27
 v_mul_f32 v28, v28, v116
 v_fma_f32 v29, -v117, v117, v22
 v_mfma_f32_32x32x16_bf16 v[176:191], a[172:175], a[232:235], v[176:191]
 s_waitcnt lgkmcnt(8)
 s_barrier
 ds_read_b64_tr_b16 a[172:173], v14 offset:49152
 ds_read_b64_tr_b16 a[174:175], v14 offset:50176
 v_mul_f32 v113, v113, v25
 v_rcp_f32 v26, v26
 v_mfma_f32_32x32x16_bf16 v[128:143], a[176:179], a[204:207], v[128:143]
 ds_read_b64_tr_b16 a[176:177], v15 offset:49152
 ds_read_b64_tr_b16 a[178:179], v15 offset:50176
 v_add_f32 v27, 1.0, v27
 v_exp_f32 v28, v28
 v_mul_f32 v29, v29, v117
 v_fma_f32 v30, -v118, v118, v22
 v_mfma_f32_32x32x16_bf16 v[144:159], a[144:147], a[204:207], v[144:159]
 ds_read_b64_tr_b16 a[144:145], v14 offset:51200
 ds_read_b64_tr_b16 a[146:147], v14 offset:52224
 v_cvt_pk_bf16_f32 v112, v112, v113
 v_mul_f32 v114, v114, v26
 v_rcp_f32 v27, v27
 v_add_f32 v28, 1.0, v28
 v_mfma_f32_32x32x16_bf16 v[128:143], a[148:151], a[208:211], v[128:143]
 s_add_u32 s67, s64, 0x2000
 ds_read_b64_tr_b16 a[148:149], v15 offset:51200
 ds_read_b64_tr_b16 a[150:151], v15 offset:52224
 v_exp_f32 v29, v29
 v_mul_f32 v30, v30, v118
 v_fma_f32 v31, -v119, v119, v22
 v_mul_f32 v115, v115, v27
 v_mfma_f32_32x32x16_bf16 v[144:159], a[152:155], a[208:211], v[144:159]
 s_waitcnt lgkmcnt(8)
 ds_read_b64_tr_b16 a[152:153], v14 offset:53248
 ds_read_b64_tr_b16 a[154:155], v14 offset:54272
 buffer_load_dwordx4 a[24:27], v33, s[4:7], s67 offen offset:2048 sc1
 v_rcp_f32 v28, v28
 v_add_f32 v29, 1.0, v29
 v_mfma_f32_32x32x16_bf16 v[128:143], a[156:159], a[212:215], v[128:143]
 s_add_u32 s67, s64, 0x2000
 ds_read_b64_tr_b16 a[156:157], v15 offset:53248
 ds_read_b64_tr_b16 a[158:159], v15 offset:54272
 v_exp_f32 v30, v30
 v_mul_f32 v31, v31, v119
 v_fma_f32 v24, -v120, v120, v22
 v_cvt_pk_bf16_f32 v113, v114, v115
 v_mfma_f32_32x32x16_bf16 v[144:159], a[160:163], a[212:215], v[144:159]
 ds_read_b64_tr_b16 a[160:161], v14 offset:55296
 ds_read_b64_tr_b16 a[162:163], v14 offset:56320
 buffer_load_dwordx4 a[28:31], v33, s[4:7], s67 offen offset:3072 sc1
 v_mul_f32 v116, v116, v28
 v_rcp_f32 v29, v29
 v_mfma_f32_32x32x16_bf16 v[128:143], a[164:167], a[216:219], v[128:143]
 s_add_u32 s67, s63, 0x3000
 ds_read_b64_tr_b16 a[164:165], v15 offset:55296
 ds_read_b64_tr_b16 a[166:167], v15 offset:56320
 v_add_f32 v30, 1.0, v30
 v_exp_f32 v31, v31
 v_mul_f32 v24, v24, v120
 v_fma_f32 v25, -v121, v121, v22
 v_mfma_f32_32x32x16_bf16 v[144:159], a[168:171], a[216:219], v[144:159]
 s_waitcnt lgkmcnt(8)
 ds_read_b64_tr_b16 a[168:169], v14 offset:57344
 ds_read_b64_tr_b16 a[170:171], v14 offset:58368
 buffer_load_dwordx4 a[32:35], v33, s[4:7], s67 offen offset:0 sc1
 v_mul_f32 v117, v117, v29
 v_rcp_f32 v30, v30
 v_mfma_f32_32x32x16_bf16 v[160:175], a[172:175], a[204:207], v[160:175]
 s_add_u32 s67, s63, 0x3000
 ds_read_b64_tr_b16 a[172:173], v15 offset:57344
 ds_read_b64_tr_b16 a[174:175], v15 offset:58368
 v_add_f32 v31, 1.0, v31
 v_exp_f32 v24, v24
 v_mul_f32 v25, v25, v121
 v_fma_f32 v26, -v122, v122, v22
 v_mfma_f32_32x32x16_bf16 v[176:191], a[176:179], a[204:207], v[176:191]
 ds_read_b64_tr_b16 a[176:177], v14 offset:59392
 ds_read_b64_tr_b16 a[178:179], v14 offset:60416
 buffer_load_dwordx4 a[36:39], v33, s[4:7], s67 offen offset:1024 sc1
 v_cvt_pk_bf16_f32 v114, v116, v117
 v_mul_f32 v118, v118, v30
 v_mfma_f32_32x32x16_bf16 v[160:175], a[144:147], a[208:211], v[160:175]
 s_add_u32 s67, s63, 0x3000
 ds_read_b64_tr_b16 a[144:145], v15 offset:59392
 ds_read_b64_tr_b16 a[146:147], v15 offset:60416
 v_rcp_f32 v31, v31
 v_add_f32 v24, 1.0, v24
 v_exp_f32 v25, v25
 v_mfma_f32_32x32x16_bf16 v[176:191], a[148:151], a[208:211], v[176:191]
 s_waitcnt lgkmcnt(8)
 ds_read_b64_tr_b16 a[148:149], v14 offset:61440
 ds_read_b64_tr_b16 a[150:151], v14 offset:62464
 buffer_load_dwordx4 a[48:51], v33, s[4:7], s67 offen offset:2048 sc1
 v_mul_f32 v26, v26, v122
 v_fma_f32 v27, -v123, v123, v22
 v_mul_f32 v119, v119, v31
 v_mfma_f32_32x32x16_bf16 v[160:175], a[152:155], a[212:215], v[160:175]
 s_add_u32 s67, s63, 0x3000
 ds_read_b64_tr_b16 a[152:153], v15 offset:61440
 ds_read_b64_tr_b16 a[154:155], v15 offset:62464
 v_rcp_f32 v24, v24
 v_add_f32 v25, 1.0, v25
 v_exp_f32 v26, v26
 v_mfma_f32_32x32x16_bf16 v[176:191], a[156:159], a[212:215], v[176:191]
 ds_read_b64_tr_b16 a[156:157], v14 offset:63488
 ds_read_b64_tr_b16 a[158:159], v14 offset:64512
 buffer_load_dwordx4 a[52:55], v33, s[4:7], s67 offen offset:3072 sc1
 v_mul_f32 v27, v27, v123
 v_fma_f32 v28, -v124, v124, v22
 v_cvt_pk_bf16_f32 v115, v118, v119
 v_mfma_f32_32x32x16_bf16 v[160:175], a[160:163], a[216:219], v[160:175]
 ds_read_b64_tr_b16 a[160:161], v15 offset:63488
 ds_read_b64_tr_b16 a[162:163], v15 offset:64512
 v_mul_f32 v120, v120, v24
 v_rcp_f32 v25, v25
 v_add_f32 v26, 1.0, v26
 v_mfma_f32_32x32x16_bf16 v[176:191], a[164:167], a[216:219], v[176:191]
 s_waitcnt lgkmcnt(8)
 s_barrier
 ds_read_b64_tr_b16 a[164:165], v16 offset:0
 ds_read_b64_tr_b16 a[166:167], v16 offset:1024
 v_exp_f32 v27, v27
 v_mul_f32 v28, v28, v124
 v_fma_f32 v29, -v125, v125, v22
 v_mul_f32 v121, v121, v25
 v_rcp_f32 v26, v26
 v_add_f32 v27, 1.0, v27
 v_exp_f32 v28, v28
 v_mul_f32 v29, v29, v125
 v_fma_f32 v30, -v126, v126, v22
 v_cvt_pk_bf16_f32 v116, v120, v121
 v_mul_f32 v122, v122, v26
 v_rcp_f32 v27, v27
 v_add_f32 v28, 1.0, v28
 v_exp_f32 v29, v29
 v_mul_f32 v30, v30, v126
 v_fma_f32 v31, -v127, v127, v22
 v_mul_f32 v123, v123, v27
 v_rcp_f32 v28, v28
 v_add_f32 v29, 1.0, v29
 v_exp_f32 v30, v30
 v_mul_f32 v31, v31, v127
 v_cvt_pk_bf16_f32 v117, v122, v123
 v_mul_f32 v124, v124, v28
 v_rcp_f32 v29, v29
 v_add_f32 v30, 1.0, v30
 v_exp_f32 v31, v31
 v_mul_f32 v125, v125, v29
 v_rcp_f32 v30, v30
 v_add_f32 v31, 1.0, v31
 v_cvt_pk_bf16_f32 v118, v124, v125
 v_mul_f32 v126, v126, v30
 v_rcp_f32 v31, v31
 s_nop 0
 v_mul_f32 v127, v127, v31
 v_cvt_pk_bf16_f32 v119, v126, v127
 s_add_u32 s69, s65, 0x5000
 buffer_store_dwordx4 v[112:115], v33, s[4:7], s69 offen offset:2048 sc1
 buffer_store_dwordx4 v[116:119], v33, s[4:7], s69 offen offset:3072 sc1
 v_mfma_f32_32x32x16_bf16 v[128:143], a[168:171], a[236:239], v[128:143]
 s_lshl_b32 s69, s26, 7
 ds_read_b64_tr_b16 a[168:169], v17 offset:0
 ds_read_b64_tr_b16 a[170:171], v17 offset:1024
 v_add_u32 v46, s69, v20
 s_lshl_b32 s36, s66, 1
 v_add_u32 v47, s36, v46
 v_mov_b32 v240, 0
 v_mov_b32 v241, 0
 v_mfma_f32_32x32x16_bf16 v[144:159], a[172:175], a[236:239], v[144:159]
 ds_read_b64_tr_b16 a[172:173], v16 offset:2048
 ds_read_b64_tr_b16 a[174:175], v16 offset:3072
 v_mov_b32 v242, 0
 v_mov_b32 v243, 0
 v_mov_b32 v244, 0
 v_mov_b32 v245, 0
 v_mfma_f32_32x32x16_bf16 v[128:143], a[176:179], a[240:243], v[128:143]
 ds_read_b64_tr_b16 a[176:177], v17 offset:2048
 ds_read_b64_tr_b16 a[178:179], v17 offset:3072
 v_mov_b32 v246, 0
 v_mov_b32 v247, 0
 s_mov_b32 s70, 0xbfb8aa3b
 s_mov_b32 s71, s70
 v_mfma_f32_32x32x16_bf16 v[144:159], a[144:147], a[240:243], v[144:159]
 s_waitcnt lgkmcnt(8)
 ds_read_b64_tr_b16 a[144:145], v16 offset:4096
 ds_read_b64_tr_b16 a[146:147], v16 offset:5120
 s_mov_b32 s40, 0x40088e99
 s_mov_b32 s41, s40
 v_readlane_b32 s69, v38, 4
 v_and_b32 v41, 3, v0
 v_mfma_f32_32x32x16_bf16 v[128:143], a[148:151], a[244:247], v[128:143]
 ds_read_b64_tr_b16 a[148:149], v17 offset:4096
 ds_read_b64_tr_b16 a[150:151], v17 offset:5120
 v_mul_u32_u24 v41, 2176, v41
 v_add_u32 v41, s69, v41
 v_readlane_b32 s69, v38, 0
 v_and_b32 v39, 1, v0
 v_mfma_f32_32x32x16_bf16 v[144:159], a[152:155], a[244:247], v[144:159]
 ds_read_b64_tr_b16 a[152:153], v16 offset:6144
 ds_read_b64_tr_b16 a[154:155], v16 offset:7168
 v_mul_u32_u24 v39, 2176, v39
 v_add_u32 v39, s69, v39
 v_mfma_f32_32x32x16_bf16 v[128:143], a[156:159], a[248:251], v[128:143]
 ds_read_b64_tr_b16 a[156:157], v17 offset:6144
 ds_read_b64_tr_b16 a[158:159], v17 offset:7168
 v_mfma_f32_32x32x16_bf16 v[144:159], a[160:163], a[248:251], v[144:159]
 s_waitcnt lgkmcnt(8)
 ds_read_b64_tr_b16 a[160:161], v16 offset:24576
 ds_read_b64_tr_b16 a[162:163], v16 offset:25600
 buffer_load_dwordx4 v7, s[12:15], s48 offen offset:1024 lds
 v_mfma_f32_32x32x16_bf16 v[160:175], a[164:167], a[236:239], v[160:175]
 s_add_u32 s48, s55, s75
 ds_read_b64_tr_b16 a[164:165], v17 offset:24576
 ds_read_b64_tr_b16 a[166:167], v17 offset:25600
 s_add_u32 m0, s28, 0x8000
 v_mfma_f32_32x32x16_bf16 v[176:191], a[168:171], a[236:239], v[176:191]
 ds_read_b64_tr_b16 a[168:169], v16 offset:26624
 ds_read_b64_tr_b16 a[170:171], v16 offset:27648
 buffer_load_dwordx4 v6, s[12:15], s48 offen offset:0 lds
 v_mfma_f32_32x32x16_bf16 v[160:175], a[172:175], a[240:243], v[160:175]
 ds_read_b64_tr_b16 a[172:173], v17 offset:26624
 ds_read_b64_tr_b16 a[174:175], v17 offset:27648
 buffer_load_dword v40, v35, s[4:7], 0 offen offset:256 sc1
 v_mfma_f32_32x32x16_bf16 v[176:191], a[176:179], a[240:243], v[176:191]
 s_waitcnt lgkmcnt(8)
 ds_read_b64_tr_b16 a[176:177], v16 offset:28672
 ds_read_b64_tr_b16 a[178:179], v16 offset:29696
 v_mfma_f32_32x32x16_bf16 v[160:175], a[144:147], a[244:247], v[160:175]
 ds_read_b64_tr_b16 a[144:145], v17 offset:28672
 ds_read_b64_tr_b16 a[146:147], v17 offset:29696
 v_mfma_f32_32x32x16_bf16 v[176:191], a[148:151], a[244:247], v[176:191]
 ds_read_b64_tr_b16 a[148:149], v16 offset:30720
 ds_read_b64_tr_b16 a[150:151], v16 offset:31744
 buffer_load_dwordx4 v7, s[12:15], s48 offen offset:1024 lds
 v_mfma_f32_32x32x16_bf16 v[160:175], a[152:155], a[248:251], v[160:175]
 s_add_u32 s48, s52, s83
 ds_read_b64_tr_b16 a[152:153], v17 offset:30720
 ds_read_b64_tr_b16 a[154:155], v17 offset:31744
 s_add_u32 m0, s28, 0xa000
 v_mfma_f32_32x32x16_bf16 v[176:191], a[156:159], a[248:251], v[176:191]
 s_waitcnt lgkmcnt(8)
 s_barrier
 ds_read_b64_tr_b16 a[156:157], v16 offset:32768
 ds_read_b64_tr_b16 a[158:159], v16 offset:33792
 buffer_load_dwordx4 v6, s[12:15], s48 offen offset:0 lds
 s_waitcnt vmcnt(22)
 v_mfma_f32_32x32x16_bf16 v[128:143], a[160:163], a[0:3], v[128:143]
 ds_read_b64_tr_b16 a[160:161], v17 offset:32768
 ds_read_b64_tr_b16 a[162:163], v17 offset:33792
 v_mfma_f32_32x32x16_bf16 v[144:159], a[164:167], a[0:3], v[144:159]
 ds_read_b64_tr_b16 a[164:165], v16 offset:34816
 ds_read_b64_tr_b16 a[166:167], v16 offset:35840
 buffer_load_dwordx4 v7, s[12:15], s48 offen offset:1024 lds
 s_waitcnt vmcnt(22)
 v_mfma_f32_32x32x16_bf16 v[128:143], a[168:171], a[4:7], v[128:143]
 ds_read_b64_tr_b16 a[168:169], v17 offset:34816
 ds_read_b64_tr_b16 a[170:171], v17 offset:35840
 v_mfma_f32_32x32x16_bf16 v[144:159], a[172:175], a[4:7], v[144:159]
 s_waitcnt lgkmcnt(8)
 ds_read_b64_tr_b16 a[172:173], v16 offset:36864
 ds_read_b64_tr_b16 a[174:175], v16 offset:37888
 s_waitcnt vmcnt(21)
 v_mfma_f32_32x32x16_bf16 v[128:143], a[176:179], a[16:19], v[128:143]
 ds_read_b64_tr_b16 a[176:177], v17 offset:36864
 ds_read_b64_tr_b16 a[178:179], v17 offset:37888
 v_mfma_f32_32x32x16_bf16 v[144:159], a[144:147], a[16:19], v[144:159]
 s_add_u32 s48, s55, s83
 ds_read_b64_tr_b16 a[144:145], v16 offset:38912
 ds_read_b64_tr_b16 a[146:147], v16 offset:39936
 s_add_u32 m0, s28, 0xc000
 s_waitcnt vmcnt(20)
 v_mfma_f32_32x32x16_bf16 v[128:143], a[148:151], a[20:23], v[128:143]
 ds_read_b64_tr_b16 a[148:149], v17 offset:38912
 ds_read_b64_tr_b16 a[150:151], v17 offset:39936
 buffer_load_dwordx4 v6, s[12:15], s48 offen offset:0 lds
 v_mfma_f32_32x32x16_bf16 v[144:159], a[152:155], a[20:23], v[144:159]
 s_waitcnt lgkmcnt(8)
 ds_read_b64_tr_b16 a[152:153], v16 offset:40960
 ds_read_b64_tr_b16 a[154:155], v16 offset:41984
 v_mfma_f32_32x32x16_bf16 v[160:175], a[156:159], a[0:3], v[160:175]
 ds_read_b64_tr_b16 a[156:157], v17 offset:40960
 ds_read_b64_tr_b16 a[158:159], v17 offset:41984
 buffer_load_dwordx4 v7, s[12:15], s48 offen offset:1024 lds
 v_mfma_f32_32x32x16_bf16 v[176:191], a[160:163], a[0:3], v[176:191]
 s_add_u32 s48, s53, s75
 ds_read_b64_tr_b16 a[160:161], v16 offset:43008
 ds_read_b64_tr_b16 a[162:163], v16 offset:44032
 s_add_u32 m0, s28, 0xe000
 v_mfma_f32_32x32x16_bf16 v[160:175], a[164:167], a[4:7], v[160:175]
 ds_read_b64_tr_b16 a[164:165], v17 offset:43008
 ds_read_b64_tr_b16 a[166:167], v17 offset:44032
 buffer_load_dwordx4 v6, s[12:15], s48 offen offset:0 lds
 v_mfma_f32_32x32x16_bf16 v[176:191], a[168:171], a[4:7], v[176:191]
 s_waitcnt lgkmcnt(8)
 ds_read_b64_tr_b16 a[168:169], v16 offset:45056
 ds_read_b64_tr_b16 a[170:171], v16 offset:46080
 v_mfma_f32_32x32x16_bf16 v[160:175], a[172:175], a[16:19], v[160:175]
 ds_read_b64_tr_b16 a[172:173], v17 offset:45056
 ds_read_b64_tr_b16 a[174:175], v17 offset:46080
 buffer_load_dwordx4 v7, s[12:15], s48 offen offset:1024 lds
 v_mfma_f32_32x32x16_bf16 v[176:191], a[176:179], a[16:19], v[176:191]
 s_add_u32 s48, s56, s75
 ds_read_b64_tr_b16 a[176:177], v16 offset:47104
 ds_read_b64_tr_b16 a[178:179], v16 offset:48128
 s_add_u32 m0, s28, 0x10000
 v_mfma_f32_32x32x16_bf16 v[160:175], a[144:147], a[20:23], v[160:175]
 ds_read_b64_tr_b16 a[144:145], v17 offset:47104
 ds_read_b64_tr_b16 a[146:147], v17 offset:48128
 buffer_load_dwordx4 v6, s[12:15], s48 offen offset:0 lds
 v_mfma_f32_32x32x16_bf16 v[176:191], a[148:151], a[20:23], v[176:191]
 s_waitcnt lgkmcnt(8)
 s_barrier
 ds_read_b64_tr_b16 a[148:149], v14 offset:0
 ds_read_b64_tr_b16 a[150:151], v14 offset:1024
 s_waitcnt vmcnt(24)
 v_mfma_f32_32x32x16_bf16 v[128:143], a[152:155], a[8:11], v[128:143]
 ds_read_b64_tr_b16 a[152:153], v15 offset:0
 ds_read_b64_tr_b16 a[154:155], v15 offset:1024
 buffer_load_dwordx4 v7, s[12:15], s48 offen offset:1024 lds
 v_mfma_f32_32x32x16_bf16 v[144:159], a[156:159], a[8:11], v[144:159]
 s_add_u32 s48, s52, s85
 ds_read_b64_tr_b16 a[156:157], v14 offset:2048
 ds_read_b64_tr_b16 a[158:159], v14 offset:3072
 s_add_u32 m0, s28, 0x12000
 s_waitcnt vmcnt(24)
 v_mfma_f32_32x32x16_bf16 v[128:143], a[160:163], a[12:15], v[128:143]
 ds_read_b64_tr_b16 a[160:161], v15 offset:2048
 ds_read_b64_tr_b16 a[162:163], v15 offset:3072
 buffer_load_dwordx4 v6, s[12:15], s48 offen offset:0 lds
 v_mfma_f32_32x32x16_bf16 v[144:159], a[164:167], a[12:15], v[144:159]
 s_waitcnt vmcnt(13)
 buffer_store_dword v23, v34, s[4:7], 0 offen offset:384 sc1
 s_waitcnt lgkmcnt(8)
 ds_read_b64_tr_b16 a[164:165], v14 offset:4096
 ds_read_b64_tr_b16 a[166:167], v14 offset:5120
 v_mfma_f32_32x32x16_bf16 v[128:143], a[168:171], a[24:27], v[128:143]
 ds_read_b64_tr_b16 a[168:169], v15 offset:4096
 ds_read_b64_tr_b16 a[170:171], v15 offset:5120
 v_mfma_f32_32x32x16_bf16 v[144:159], a[172:175], a[24:27], v[144:159]
 ds_read_b64_tr_b16 a[172:173], v14 offset:6144
 ds_read_b64_tr_b16 a[174:175], v14 offset:7168
 buffer_load_dwordx4 v7, s[12:15], s48 offen offset:1024 lds
 v_mfma_f32_32x32x16_bf16 v[128:143], a[176:179], a[28:31], v[128:143]
 s_add_u32 s48, s55, s85
 ds_read_b64_tr_b16 a[176:177], v15 offset:6144
 ds_read_b64_tr_b16 a[178:179], v15 offset:7168
 s_add_u32 m0, s28, 0x16000
 v_mfma_f32_32x32x16_bf16 v[144:159], a[144:147], a[28:31], v[144:159]
 s_waitcnt lgkmcnt(8)
 ds_read_b64_tr_b16 a[144:145], v14 offset:8192
 ds_read_b64_tr_b16 a[146:147], v14 offset:9216
 buffer_load_dwordx4 v6, s[12:15], s48 offen offset:0 lds
 s_add_u32 s67, s64, 0x3000
 v_mfma_f32_32x32x16_bf16 v[160:175], a[148:151], a[8:11], v[160:175]
 ds_read_b64_tr_b16 a[148:149], v15 offset:8192
 ds_read_b64_tr_b16 a[150:151], v15 offset:9216
 buffer_load_dwordx4 a[40:43], v33, s[4:7], s67 offen offset:0 sc1
 s_add_u32 s67, s64, 0x3000
 v_mfma_f32_32x32x16_bf16 v[176:191], a[152:155], a[8:11], v[176:191]
 ds_read_b64_tr_b16 a[152:153], v14 offset:10240
 ds_read_b64_tr_b16 a[154:155], v14 offset:11264
 buffer_load_dwordx4 a[44:47], v33, s[4:7], s67 offen offset:1024 sc1
 s_add_u32 s67, s64, 0x3000
 v_mfma_f32_32x32x16_bf16 v[160:175], a[156:159], a[12:15], v[160:175]
 ds_read_b64_tr_b16 a[156:157], v15 offset:10240
 ds_read_b64_tr_b16 a[158:159], v15 offset:11264
 buffer_load_dwordx4 a[56:59], v33, s[4:7], s67 offen offset:2048 sc1
 s_add_u32 s67, s64, 0x3000
 v_mfma_f32_32x32x16_bf16 v[176:191], a[160:163], a[12:15], v[176:191]
 s_waitcnt lgkmcnt(8)
 ds_read_b64_tr_b16 a[160:161], v14 offset:12288
 ds_read_b64_tr_b16 a[162:163], v14 offset:13312
 buffer_load_dwordx4 a[60:63], v33, s[4:7], s67 offen offset:3072 sc1
 v_mfma_f32_32x32x16_bf16 v[160:175], a[164:167], a[24:27], v[160:175]
 ds_read_b64_tr_b16 a[164:165], v15 offset:12288
 ds_read_b64_tr_b16 a[166:167], v15 offset:13312
 s_waitcnt vmcnt(17)
 v_cmp_eq_u32 vcc, 0, v40
 s_nop 1
 s_cmp_lg_u64 vcc, 0
 s_cbranch_scc1 mh2_spin
mh2_back:
 v_mfma_f32_32x32x16_bf16 v[176:191], a[168:171], a[24:27], v[176:191]
 ds_read_b64_tr_b16 a[168:169], v14 offset:14336
 ds_read_b64_tr_b16 a[170:171], v14 offset:15360
 v_mfma_f32_32x32x16_bf16 v[160:175], a[172:175], a[28:31], v[160:175]
 ds_read_b64_tr_b16 a[172:173], v15 offset:14336
 ds_read_b64_tr_b16 a[174:175], v15 offset:15360
 v_mfma_f32_32x32x16_bf16 v[176:191], a[176:179], a[28:31], v[176:191]
 s_waitcnt lgkmcnt(8)
 s_barrier
 ds_read_b64_tr_b16 a[176:177], v16 offset:8192
 ds_read_b64_tr_b16 a[178:179], v16 offset:9216
 buffer_load_dwordx4 v7, s[12:15], s48 offen offset:1024 lds
 s_add_u32 s67, s63, 0x4000
 v_mfma_f32_32x32x16_bf16 v[128:143], a[144:147], v[96:99], v[128:143]
 ds_read_b64_tr_b16 a[144:145], v17 offset:8192
 ds_read_b64_tr_b16 a[146:147], v17 offset:9216
 buffer_load_dwordx4 a[64:67], v33, s[4:7], s67 offen offset:0 sc1
 s_add_u32 s67, s63, 0x4000
 v_mfma_f32_32x32x16_bf16 v[144:159], a[148:151], v[96:99], v[144:159]
 ds_read_b64_tr_b16 a[148:149], v16 offset:10240
 ds_read_b64_tr_b16 a[150:151], v16 offset:11264
 buffer_load_dwordx4 a[68:71], v33, s[4:7], s67 offen offset:1024 sc1
 v_mfma_f32_32x32x16_bf16 v[128:143], a[152:155], v[100:103], v[128:143]
 ds_read_b64_tr_b16 a[152:153], v17 offset:10240
 ds_read_b64_tr_b16 a[154:155], v17 offset:11264
 v_mfma_f32_32x32x16_bf16 v[144:159], a[156:159], v[100:103], v[144:159]
 s_waitcnt lgkmcnt(8)
 ds_read_b64_tr_b16 a[156:157], v16 offset:12288
 ds_read_b64_tr_b16 a[158:159], v16 offset:13312
 s_add_u32 s67, s63, 0x4000
 v_mfma_f32_32x32x16_bf16 v[128:143], a[160:163], v[112:115], v[128:143]
 ds_read_b64_tr_b16 a[160:161], v17 offset:12288
 ds_read_b64_tr_b16 a[162:163], v17 offset:13312
 buffer_load_dwordx4 a[80:83], v33, s[4:7], s67 offen offset:2048 sc1
 v_mfma_f32_32x32x16_bf16 v[144:159], a[164:167], v[112:115], v[144:159]
 ds_read_b64_tr_b16 a[164:165], v16 offset:14336
 ds_read_b64_tr_b16 a[166:167], v16 offset:15360
 v_mfma_f32_32x32x16_bf16 v[128:143], a[168:171], v[116:119], v[128:143]
 ds_read_b64_tr_b16 a[168:169], v17 offset:14336
 ds_read_b64_tr_b16 a[170:171], v17 offset:15360
 v_mfma_f32_32x32x16_bf16 v[144:159], a[172:175], v[116:119], v[144:159]
 s_waitcnt lgkmcnt(8)
 ds_read_b64_tr_b16 a[172:173], v16 offset:49152
 ds_read_b64_tr_b16 a[174:175], v16 offset:50176
 buffer_load_dword v40, v35, s[4:7], 0 offen offset:384 sc1
 s_add_u32 s67, s63, 0x4000
 v_mfma_f32_32x32x16_bf16 v[160:175], a[176:179], v[96:99], v[160:175]
 ds_read_b64_tr_b16 a[176:177], v17 offset:49152
 ds_read_b64_tr_b16 a[178:179], v17 offset:50176
 buffer_load_dwordx4 a[84:87], v33, s[4:7], s67 offen offset:3072 sc1
 v_mfma_f32_32x32x16_bf16 v[176:191], a[144:147], v[96:99], v[176:191]
 s_add_u32 s67, s64, 0x4000
 ds_read_b64_tr_b16 a[144:145], v16 offset:51200
 ds_read_b64_tr_b16 a[146:147], v16 offset:52224
 v_mfma_f32_32x32x16_bf16 v[160:175], a[148:151], v[100:103], v[160:175]
 ds_read_b64_tr_b16 a[148:149], v17 offset:51200
 ds_read_b64_tr_b16 a[150:151], v17 offset:52224
 buffer_load_dwordx4 a[72:75], v33, s[4:7], s67 offen offset:0 sc1
 v_mfma_f32_32x32x16_bf16 v[176:191], a[152:155], v[100:103], v[176:191]
 s_waitcnt lgkmcnt(8)
 ds_read_b64_tr_b16 a[152:153], v16 offset:53248
 ds_read_b64_tr_b16 a[154:155], v16 offset:54272
 v_mfma_f32_32x32x16_bf16 v[160:175], a[156:159], v[112:115], v[160:175]
 s_add_u32 s67, s64, 0x4000
 ds_read_b64_tr_b16 a[156:157], v17 offset:53248
 ds_read_b64_tr_b16 a[158:159], v17 offset:54272
 v_mfma_f32_32x32x16_bf16 v[176:191], a[160:163], v[112:115], v[176:191]
 ds_read_b64_tr_b16 a[160:161], v16 offset:55296
 ds_read_b64_tr_b16 a[162:163], v16 offset:56320
 buffer_load_dwordx4 a[76:79], v33, s[4:7], s67 offen offset:1024 sc1
 v_mfma_f32_32x32x16_bf16 v[160:175], a[164:167], v[116:119], v[160:175]
 ds_read_b64_tr_b16 a[164:165], v17 offset:55296
 ds_read_b64_tr_b16 a[166:167], v17 offset:56320
 v_mfma_f32_32x32x16_bf16 v[176:191], a[168:171], v[116:119], v[176:191]
 s_waitcnt vmcnt(24) lgkmcnt(8)
 s_barrier
 ds_read_b64_tr_b16 a[168:169], v14 offset:16384
 ds_read_b64_tr_b16 a[170:171], v14 offset:17408
 s_add_u32 s67, s64, 0x4000
 v_mfma_f32_32x32x16_bf16 v[192:207], a[172:175], v[96:99], v[192:207]
 ds_read_b64_tr_b16 a[172:173], v15 offset:16384
 ds_read_b64_tr_b16 a[174:175], v15 offset:17408
 buffer_load_dwordx4 a[88:91], v33, s[4:7], s67 offen offset:2048 sc1
 v_mfma_f32_32x32x16_bf16 v[208:223], a[176:179], v[96:99], v[208:223]
 ds_read_b64_tr_b16 a[176:177], v14 offset:18432
 ds_read_b64_tr_b16 a[178:179], v14 offset:19456
 v_mfma_f32_32x32x16_bf16 v[192:207], a[144:147], v[100:103], v[192:207]
 s_add_u32 s67, s64, 0x4000
 ds_read_b64_tr_b16 a[144:145], v15 offset:18432
 ds_read_b64_tr_b16 a[146:147], v15 offset:19456
 v_mfma_f32_32x32x16_bf16 v[208:223], a[148:151], v[100:103], v[208:223]
 s_waitcnt lgkmcnt(8)
 ds_read_b64_tr_b16 a[148:149], v14 offset:20480
 ds_read_b64_tr_b16 a[150:151], v14 offset:21504
 buffer_load_dwordx4 a[92:95], v33, s[4:7], s67 offen offset:3072 sc1
 v_mfma_f32_32x32x16_bf16 v[192:207], a[152:155], v[112:115], v[192:207]
 ds_read_b64_tr_b16 a[152:153], v15 offset:20480
 ds_read_b64_tr_b16 a[154:155], v15 offset:21504
 v_mfma_f32_32x32x16_bf16 v[208:223], a[156:159], v[112:115], v[208:223]
 ds_read_b64_tr_b16 a[156:157], v14 offset:22528
 ds_read_b64_tr_b16 a[158:159], v14 offset:23552
 v_mfma_f32_32x32x16_bf16 v[192:207], a[160:163], v[116:119], v[192:207]
 ds_read_b64_tr_b16 a[160:161], v15 offset:22528
 ds_read_b64_tr_b16 a[162:163], v15 offset:23552
 v_mfma_f32_32x32x16_bf16 v[208:223], a[164:167], v[116:119], v[208:223]
 s_waitcnt lgkmcnt(8)
 ds_read_b64_tr_b16 a[164:165], v14 offset:24576
 ds_read_b64_tr_b16 a[166:167], v14 offset:25600
 v_mfma_f32_32x32x16_bf16 v[128:143], a[168:171], a[32:35], v[128:143]
 ds_read_b64_tr_b16 a[168:169], v15 offset:24576
 ds_read_b64_tr_b16 a[170:171], v15 offset:25600
 v_mfma_f32_32x32x16_bf16 v[144:159], a[172:175], a[32:35], v[144:159]
 ds_read_b64_tr_b16 a[172:173], v14 offset:26624
 ds_read_b64_tr_b16 a[174:175], v14 offset:27648
 v_mfma_f32_32x32x16_bf16 v[128:143], a[176:179], a[36:39], v[128:143]
 ds_read_b64_tr_b16 a[176:177], v15 offset:26624
 ds_read_b64_tr_b16 a[178:179], v15 offset:27648
 v_mfma_f32_32x32x16_bf16 v[144:159], a[144:147], a[36:39], v[144:159]
 s_waitcnt lgkmcnt(8)
 ds_read_b64_tr_b16 a[144:145], v14 offset:28672
 ds_read_b64_tr_b16 a[146:147], v14 offset:29696
 s_add_u32 s48, s53, s83
 s_add_u32 m0, s28, 0x2000
 v_mfma_f32_32x32x16_bf16 v[128:143], a[148:151], a[48:51], v[128:143]
 ds_read_b64_tr_b16 a[148:149], v15 offset:28672
 ds_read_b64_tr_b16 a[150:151], v15 offset:29696
 buffer_load_dwordx4 v6, s[12:15], s48 offen offset:0 lds
 v_mfma_f32_32x32x16_bf16 v[144:159], a[152:155], a[48:51], v[144:159]
 ds_read_b64_tr_b16 a[152:153], v14 offset:30720
 ds_read_b64_tr_b16 a[154:155], v14 offset:31744
 v_mfma_f32_32x32x16_bf16 v[128:143], a[156:159], a[52:55], v[128:143]
 ds_read_b64_tr_b16 a[156:157], v15 offset:30720
 ds_read_b64_tr_b16 a[158:159], v15 offset:31744
 buffer_load_dwordx4 v7, s[12:15], s48 offen offset:1024 lds
 v_mfma_f32_32x32x16_bf16 v[144:159], a[160:163], a[52:55], v[144:159]
 s_waitcnt vmcnt(24) lgkmcnt(8)
 s_barrier
 ds_read_b64_tr_b16 a[160:161], v14 offset:32768
 ds_read_b64_tr_b16 a[162:163], v14 offset:33792
 s_add_u32 s48, s56, s83
 s_add_u32 m0, s28, 0x4000
 s_waitcnt vmcnt(15)
 v_mfma_f32_32x32x16_bf16 v[128:143], a[164:167], a[40:43], v[128:143]
 ds_read_b64_tr_b16 a[164:165], v15 offset:32768
 ds_read_b64_tr_b16 a[166:167], v15 offset:33792
 buffer_load_dwordx4 v6, s[12:15], s48 offen offset:0 lds
 v_mfma_f32_32x32x16_bf16 v[144:159], a[168:171], a[40:43], v[144:159]
 ds_read_b64_tr_b16 a[168:169], v14 offset:34816
 ds_read_b64_tr_b16 a[170:171], v14 offset:35840
 s_waitcnt vmcnt(15)
 v_mfma_f32_32x32x16_bf16 v[128:143], a[172:175], a[44:47], v[128:143]
 ds_read_b64_tr_b16 a[172:173], v15 offset:34816
 ds_read_b64_tr_b16 a[174:175], v15 offset:35840
 buffer_load_dwordx4 v7, s[12:15], s48 offen offset:1024 lds
 v_mfma_f32_32x32x16_bf16 v[144:159], a[176:179], a[44:47], v[144:159]
 s_waitcnt lgkmcnt(8)
 ds_read_b64_tr_b16 a[176:177], v14 offset:36864
 ds_read_b64_tr_b16 a[178:179], v14 offset:37888
 s_add_u32 s48, s53, s85
 s_add_u32 m0, s28, 0x6000
 s_waitcnt vmcnt(15)
 v_mfma_f32_32x32x16_bf16 v[128:143], a[144:147], a[56:59], v[128:143]
 ds_read_b64_tr_b16 a[144:145], v15 offset:36864
 ds_read_b64_tr_b16 a[146:147], v15 offset:37888
 buffer_load_dwordx4 v6, s[12:15], s48 offen offset:0 lds
 v_mfma_f32_32x32x16_bf16 v[144:159], a[148:151], a[56:59], v[144:159]
 ds_read_b64_tr_b16 a[148:149], v14 offset:38912
 ds_read_b64_tr_b16 a[150:151], v14 offset:39936
 s_waitcnt vmcnt(15)
 v_mfma_f32_32x32x16_bf16 v[128:143], a[152:155], a[60:63], v[128:143]
 ds_read_b64_tr_b16 a[152:153], v15 offset:38912
 ds_read_b64_tr_b16 a[154:155], v15 offset:39936
 buffer_load_dwordx4 v7, s[12:15], s48 offen offset:1024 lds
 v_mfma_f32_32x32x16_bf16 v[144:159], a[156:159], a[60:63], v[144:159]
 s_waitcnt lgkmcnt(8)
 ds_read_b64_tr_b16 a[156:157], v14 offset:40960
 ds_read_b64_tr_b16 a[158:159], v14 offset:41984
 s_add_u32 s48, s56, s85
 s_add_u32 m0, s28, 0x14000
 s_waitcnt vmcnt(14)
 v_mfma_f32_32x32x16_bf16 v[128:143], a[160:163], a[64:67], v[128:143]
 ds_read_b64_tr_b16 a[160:161], v15 offset:40960
 ds_read_b64_tr_b16 a[162:163], v15 offset:41984
 buffer_load_dwordx4 v6, s[12:15], s48 offen offset:0 lds
 v_mfma_f32_32x32x16_bf16 v[144:159], a[164:167], a[64:67], v[144:159]
 ds_read_b64_tr_b16 a[164:165], v14 offset:43008
 ds_read_b64_tr_b16 a[166:167], v14 offset:44032
 s_waitcnt vmcnt(12)
 v_cmp_eq_u32 vcc, 0, v40
 s_nop 1
 s_cmp_lg_u64 vcc, 0
 s_cbranch_scc1 mh3_spin
mh3_back:
 v_mfma_f32_32x32x16_bf16 v[128:143], a[168:171], a[68:71], v[128:143]
 s_add_u32 s67, s63, 0x5000
 ds_read_b64_tr_b16 a[168:169], v15 offset:43008
 ds_read_b64_tr_b16 a[170:171], v15 offset:44032
 v_mfma_f32_32x32x16_bf16 v[144:159], a[172:175], a[68:71], v[144:159]
 s_waitcnt lgkmcnt(8)
 ds_read_b64_tr_b16 a[172:173], v14 offset:45056
 ds_read_b64_tr_b16 a[174:175], v14 offset:46080
 buffer_load_dwordx4 v[64:67], v33, s[4:7], s67 offen offset:0 sc1
 s_add_u32 s67, s63, 0x5000
 v_mfma_f32_32x32x16_bf16 v[128:143], a[176:179], a[80:83], v[128:143]
 ds_read_b64_tr_b16 a[176:177], v15 offset:45056
 ds_read_b64_tr_b16 a[178:179], v15 offset:46080
 buffer_load_dwordx4 v[68:71], v33, s[4:7], s67 offen offset:1024 sc1
 s_add_u32 s67, s63, 0x5000
 v_mfma_f32_32x32x16_bf16 v[144:159], a[144:147], a[80:83], v[144:159]
 ds_read_b64_tr_b16 a[144:145], v14 offset:47104
 ds_read_b64_tr_b16 a[146:147], v14 offset:48128
 buffer_load_dwordx4 v[72:75], v33, s[4:7], s67 offen offset:2048 sc1
 s_add_u32 s67, s63, 0x5000
 s_waitcnt vmcnt(14)
 v_mfma_f32_32x32x16_bf16 v[128:143], a[148:151], a[84:87], v[128:143]
 ds_read_b64_tr_b16 a[148:149], v15 offset:47104
 ds_read_b64_tr_b16 a[150:151], v15 offset:48128
 buffer_load_dwordx4 v[76:79], v33, s[4:7], s67 offen offset:3072 sc1
 s_add_u32 s67, s64, 0x5000
 v_mfma_f32_32x32x16_bf16 v[144:159], a[152:155], a[84:87], v[144:159]
 s_waitcnt lgkmcnt(8)
 s_barrier
 ds_read_b64_tr_b16 a[152:153], v14 offset:49152
 ds_read_b64_tr_b16 a[154:155], v14 offset:50176
 buffer_load_dwordx4 v[80:83], v33, s[4:7], s67 offen offset:0 sc1
 s_add_u32 s67, s64, 0x5000
 s_waitcnt vmcnt(15)
 v_mfma_f32_32x32x16_bf16 v[128:143], a[156:159], a[72:75], v[128:143]
 ds_read_b64_tr_b16 a[156:157], v15 offset:49152
 ds_read_b64_tr_b16 a[158:159], v15 offset:50176
 buffer_load_dwordx4 v[84:87], v33, s[4:7], s67 offen offset:1024 sc1
 s_add_u32 s67, s64, 0x5000
 v_mfma_f32_32x32x16_bf16 v[144:159], a[160:163], a[72:75], v[144:159]
 ds_read_b64_tr_b16 a[160:161], v14 offset:51200
 ds_read_b64_tr_b16 a[162:163], v14 offset:52224
 buffer_load_dwordx4 v[88:91], v33, s[4:7], s67 offen offset:2048 sc1
 s_add_u32 s67, s64, 0x5000
 s_waitcnt vmcnt(16)
 v_mfma_f32_32x32x16_bf16 v[128:143], a[164:167], a[76:79], v[128:143]
 ds_read_b64_tr_b16 a[164:165], v15 offset:51200
 ds_read_b64_tr_b16 a[166:167], v15 offset:52224
 buffer_load_dwordx4 v[92:95], v33, s[4:7], s67 offen offset:3072 sc1
 v_mfma_f32_32x32x16_bf16 v[144:159], a[168:171], a[76:79], v[144:159]
 s_waitcnt lgkmcnt(8)
 ds_read_b64_tr_b16 a[168:169], v14 offset:53248
 ds_read_b64_tr_b16 a[170:171], v14 offset:54272
 s_waitcnt vmcnt(16)
 v_mfma_f32_32x32x16_bf16 v[128:143], a[172:175], a[88:91], v[128:143]
 ds_read_b64_tr_b16 a[172:173], v15 offset:53248
 ds_read_b64_tr_b16 a[174:175], v15 offset:54272
 v_mfma_f32_32x32x16_bf16 v[144:159], a[176:179], a[88:91], v[144:159]
 ds_read_b64_tr_b16 a[176:177], v14 offset:55296
 ds_read_b64_tr_b16 a[178:179], v14 offset:56320
 s_waitcnt vmcnt(15)
 v_mfma_f32_32x32x16_bf16 v[128:143], a[144:147], a[92:95], v[128:143]
 ds_read_b64_tr_b16 a[144:145], v15 offset:55296
 ds_read_b64_tr_b16 a[146:147], v15 offset:56320
 v_mfma_f32_32x32x16_bf16 v[144:159], a[148:151], a[92:95], v[144:159]
 s_waitcnt lgkmcnt(8)
 ds_read_b64_tr_b16 a[148:149], v14 offset:57344
 ds_read_b64_tr_b16 a[150:151], v14 offset:58368
 v_mfma_f32_32x32x16_bf16 v[160:175], a[152:155], a[32:35], v[160:175]
 ds_read_b64_tr_b16 a[152:153], v15 offset:57344
 ds_read_b64_tr_b16 a[154:155], v15 offset:58368
 v_mfma_f32_32x32x16_bf16 v[176:191], a[156:159], a[32:35], v[176:191]
 ds_read_b64_tr_b16 a[156:157], v14 offset:59392
 ds_read_b64_tr_b16 a[158:159], v14 offset:60416
 v_mfma_f32_32x32x16_bf16 v[160:175], a[160:163], a[36:39], v[160:175]
 ds_read_b64_tr_b16 a[160:161], v15 offset:59392
 ds_read_b64_tr_b16 a[162:163], v15 offset:60416
 v_mfma_f32_32x32x16_bf16 v[176:191], a[164:167], a[36:39], v[176:191]
 s_waitcnt lgkmcnt(8)
 ds_read_b64_tr_b16 a[164:165], v14 offset:61440
 ds_read_b64_tr_b16 a[166:167], v14 offset:62464
 v_mfma_f32_32x32x16_bf16 v[160:175], a[168:171], a[48:51], v[160:175]
 ds_read_b64_tr_b16 a[168:169], v15 offset:61440
 ds_read_b64_tr_b16 a[170:171], v15 offset:62464
 v_mfma_f32_32x32x16_bf16 v[176:191], a[172:175], a[48:51], v[176:191]
 ds_read_b64_tr_b16 a[172:173], v14 offset:63488
 ds_read_b64_tr_b16 a[174:175], v14 offset:64512
 v_mfma_f32_32x32x16_bf16 v[160:175], a[176:179], a[52:55], v[160:175]
 ds_read_b64_tr_b16 a[176:177], v15 offset:63488
 ds_read_b64_tr_b16 a[178:179], v15 offset:64512
 v_mfma_f32_32x32x16_bf16 v[176:191], a[144:147], a[52:55], v[176:191]
 s_waitcnt lgkmcnt(8)
 s_barrier
 ds_read_b64_tr_b16 a[144:145], v16 offset:0
 ds_read_b64_tr_b16 a[146:147], v16 offset:1024
 buffer_load_dwordx4 v7, s[12:15], s48 offen offset:1024 lds
 v_mfma_f32_32x32x16_bf16 v[160:175], a[148:151], a[40:43], v[160:175]
 s_add_u32 s48, s54, s33
 ds_read_b64_tr_b16 a[148:149], v16 offset:2048
 ds_read_b64_tr_b16 a[150:151], v16 offset:3072
 s_add_u32 m0, s28, 0x8000
 v_mfma_f32_32x32x16_bf16 v[176:191], a[152:155], a[40:43], v[176:191]
 ds_read_b64_tr_b16 a[152:153], v16 offset:4096
 ds_read_b64_tr_b16 a[154:155], v16 offset:5120
 buffer_load_dwordx4 v6, s[12:15], s48 offen offset:0 lds
 v_mfma_f32_32x32x16_bf16 v[160:175], a[156:159], a[44:47], v[160:175]
 ds_read_b64_tr_b16 a[156:157], v16 offset:6144
 ds_read_b64_tr_b16 a[158:159], v16 offset:7168
 v_mfma_f32_32x32x16_bf16 v[176:191], a[160:163], a[44:47], v[176:191]
 s_waitcnt lgkmcnt(8)
 ds_read_b64_tr_b16 a[160:161], v16 offset:16384
 ds_read_b64_tr_b16 a[162:163], v16 offset:17408
 buffer_load_dwordx4 v7, s[12:15], s48 offen offset:1024 lds
 v_mfma_f32_32x32x16_bf16 v[160:175], a[164:167], a[56:59], v[160:175]
 s_add_u32 s48, s57, s33
 ds_read_b64_tr_b16 a[164:165], v16 offset:18432
 ds_read_b64_tr_b16 a[166:167], v16 offset:19456
 s_add_u32 m0, s28, 0xa000
 v_mfma_f32_32x32x16_bf16 v[176:191], a[168:171], a[56:59], v[176:191]
 ds_read_b64_tr_b16 a[168:169], v16 offset:20480
 ds_read_b64_tr_b16 a[170:171], v16 offset:21504
 buffer_load_dwordx4 v6, s[12:15], s48 offen offset:0 lds
 v_mfma_f32_32x32x16_bf16 v[160:175], a[172:175], a[60:63], v[160:175]
 ds_read_b64_tr_b16 a[172:173], v16 offset:22528
 ds_read_b64_tr_b16 a[174:175], v16 offset:23552
 v_mfma_f32_32x32x16_bf16 v[176:191], a[176:179], a[60:63], v[176:191]
 s_waitcnt lgkmcnt(8)
 ds_read_b64_tr_b16 a[176:177], v17 offset:0
 ds_read_b64_tr_b16 a[178:179], v17 offset:1024
 buffer_load_dwordx4 v7, s[12:15], s48 offen offset:1024 lds
 s_waitcnt vmcnt(12)
 v_mfma_f32_32x32x16_bf16 v[128:143], a[144:147], v[64:67], v[128:143]
 s_add_u32 s48, s54, s73
 ds_read_b64_tr_b16 a[144:145], v17 offset:2048
 ds_read_b64_tr_b16 a[146:147], v17 offset:3072
 s_add_u32 m0, s28, 0xc000
 s_waitcnt vmcnt(11)
 v_mfma_f32_32x32x16_bf16 v[128:143], a[148:151], v[68:71], v[128:143]
 ds_read_b64_tr_b16 a[148:149], v17 offset:4096
 ds_read_b64_tr_b16 a[150:151], v17 offset:5120
 buffer_load_dwordx4 v6, s[12:15], s48 offen offset:0 lds
 s_waitcnt vmcnt(11)
 v_mfma_f32_32x32x16_bf16 v[128:143], a[152:155], v[72:75], v[128:143]
 ds_read_b64_tr_b16 a[152:153], v17 offset:6144
 ds_read_b64_tr_b16 a[154:155], v17 offset:7168
 s_waitcnt vmcnt(10)
 v_mfma_f32_32x32x16_bf16 v[128:143], a[156:159], v[76:79], v[128:143]
 s_waitcnt lgkmcnt(8)
 s_barrier
 ds_read_b64_tr_b16 a[156:157], v17 offset:16384
 ds_read_b64_tr_b16 a[158:159], v17 offset:17408
 buffer_load_dwordx4 v7, s[12:15], s48 offen offset:1024 lds
 s_waitcnt vmcnt(10)
 v_mfma_f32_32x32x16_bf16 v[128:143], a[160:163], v[80:83], v[128:143]
 s_add_u32 s48, s57, s73
 ds_read_b64_tr_b16 a[160:161], v17 offset:18432
 ds_read_b64_tr_b16 a[162:163], v17 offset:19456
 s_add_u32 m0, s28, 0xe000
 s_waitcnt vmcnt(9)
 v_mfma_f32_32x32x16_bf16 v[128:143], a[164:167], v[84:87], v[128:143]
 ds_read_b64_tr_b16 a[164:165], v17 offset:20480
 ds_read_b64_tr_b16 a[166:167], v17 offset:21504
 buffer_load_dwordx4 v6, s[12:15], s48 offen offset:0 lds
 s_waitcnt vmcnt(9)
 v_mfma_f32_32x32x16_bf16 v[128:143], a[168:171], v[88:91], v[128:143]
 ds_read_b64_tr_b16 a[168:169], v17 offset:22528
 ds_read_b64_tr_b16 a[170:171], v17 offset:23552
 s_waitcnt vmcnt(8)
 v_mfma_f32_32x32x16_bf16 v[128:143], a[172:175], v[92:95], v[128:143]
 s_waitcnt lgkmcnt(8)
 ds_read_b64_tr_b16 a[172:173], v14 offset:0
 ds_read_b64_tr_b16 a[174:175], v14 offset:1024
 buffer_load_dwordx4 v7, s[12:15], s48 offen offset:1024 lds
 v_mfma_f32_32x32x16_bf16 v[144:159], a[176:179], v[64:67], v[144:159]
 s_add_u32 s48, s54, s74
 ds_read_b64_tr_b16 a[176:177], v15 offset:0
 ds_read_b64_tr_b16 a[178:179], v15 offset:1024
 s_add_u32 m0, s28, 0x10000
 v_mfma_f32_32x32x16_bf16 v[144:159], a[144:147], v[68:71], v[144:159]
 ds_read_b64_tr_b16 a[144:145], v14 offset:2048
 ds_read_b64_tr_b16 a[146:147], v14 offset:3072
 buffer_load_dwordx4 v6, s[12:15], s48 offen offset:0 lds
 v_cvt_pk_bf16_f32 v128, v128, v129
 v_cvt_pk_bf16_f32 v129, v130, v131
 v_mfma_f32_32x32x16_bf16 v[144:159], a[148:151], v[72:75], v[144:159]
 ds_read_b64_tr_b16 a[148:149], v15 offset:2048
 ds_read_b64_tr_b16 a[150:151], v15 offset:3072
 v_cvt_pk_bf16_f32 v130, v132, v133
 v_cvt_pk_bf16_f32 v131, v134, v135
 v_mfma_f32_32x32x16_bf16 v[144:159], a[152:155], v[76:79], v[144:159]
 s_waitcnt lgkmcnt(8)
 ds_read_b64_tr_b16 a[152:153], v14 offset:4096
 ds_read_b64_tr_b16 a[154:155], v14 offset:5120
 buffer_load_dwordx4 v7, s[12:15], s48 offen offset:1024 lds
 buffer_store_dwordx4 v[128:131], v32, s[4:7], s58 offen offset:0 sc1
 v_mfma_f32_32x32x16_bf16 v[144:159], a[156:159], v[80:83], v[144:159]
 s_add_u32 s48, s57, s74
 ds_read_b64_tr_b16 a[156:157], v15 offset:4096
 ds_read_b64_tr_b16 a[158:159], v15 offset:5120
 s_add_u32 m0, s28, 0x18000
 v_cvt_pk_bf16_f32 v132, v136, v137
 v_cvt_pk_bf16_f32 v133, v138, v139
 v_cvt_pk_bf16_f32 v134, v140, v141
 v_mfma_f32_32x32x16_bf16 v[144:159], a[160:163], v[84:87], v[144:159]
 ds_read_b64_tr_b16 a[160:161], v14 offset:6144
 ds_read_b64_tr_b16 a[162:163], v14 offset:7168
 buffer_load_dwordx4 v6, s[12:15], s48 offen offset:0 lds
 v_cvt_pk_bf16_f32 v135, v142, v143
 v_mfma_f32_32x32x16_bf16 v[144:159], a[164:167], v[88:91], v[144:159]
 ds_read_b64_tr_b16 a[164:165], v15 offset:6144
 ds_read_b64_tr_b16 a[166:167], v15 offset:7168
 buffer_store_dwordx4 v[132:135], v32, s[4:7], s58 offen offset:1024 sc1
 v_mfma_f32_32x32x16_bf16 v[144:159], a[168:171], v[92:95], v[144:159]
 s_waitcnt lgkmcnt(8)
 s_barrier
 ds_read_b64_tr_b16 a[168:169], v14 offset:8192
 ds_read_b64_tr_b16 a[170:171], v14 offset:9216
 buffer_load_dwordx4 v7, s[12:15], s48 offen offset:1024 lds
 v_mfma_f32_32x32x16_bf16 v[160:175], a[172:175], a[64:67], v[160:175]
 s_add_u32 s48, s54, s75
 ds_read_b64_tr_b16 a[172:173], v15 offset:8192
 ds_read_b64_tr_b16 a[174:175], v15 offset:9216
 s_add_u32 m0, s28, 0x12000
 v_mfma_f32_32x32x16_bf16 v[176:191], a[176:179], a[64:67], v[176:191]
 ds_read_b64_tr_b16 a[176:177], v14 offset:10240
 ds_read_b64_tr_b16 a[178:179], v14 offset:11264
 buffer_load_dwordx4 v6, s[12:15], s48 offen offset:0 lds
 v_cvt_pk_bf16_f32 v144, v144, v145
 v_cvt_pk_bf16_f32 v145, v146, v147
 v_mfma_f32_32x32x16_bf16 v[160:175], a[144:147], a[68:71], v[160:175]
 ds_read_b64_tr_b16 a[144:145], v15 offset:10240
 ds_read_b64_tr_b16 a[146:147], v15 offset:11264
 v_cvt_pk_bf16_f32 v146, v148, v149
 v_cvt_pk_bf16_f32 v147, v150, v151
 v_mfma_f32_32x32x16_bf16 v[176:191], a[148:151], a[68:71], v[176:191]
 s_waitcnt lgkmcnt(8)
 ds_read_b64_tr_b16 a[148:149], v14 offset:12288
 ds_read_b64_tr_b16 a[150:151], v14 offset:13312
 buffer_load_dwordx4 v7, s[12:15], s48 offen offset:1024 lds
 buffer_store_dwordx4 v[144:147], v32, s[4:7], s59 offen offset:0 sc1
 v_mfma_f32_32x32x16_bf16 v[160:175], a[152:155], a[80:83], v[160:175]
 s_add_u32 s48, s57, s75
 ds_read_b64_tr_b16 a[152:153], v15 offset:12288
 ds_read_b64_tr_b16 a[154:155], v15 offset:13312
 s_add_u32 m0, s28, 0x16000
 v_cvt_pk_bf16_f32 v148, v152, v153
 v_cvt_pk_bf16_f32 v149, v154, v155
 v_cvt_pk_bf16_f32 v150, v156, v157
 v_mfma_f32_32x32x16_bf16 v[176:191], a[156:159], a[80:83], v[176:191]
 ds_read_b64_tr_b16 a[156:157], v14 offset:14336
 ds_read_b64_tr_b16 a[158:159], v14 offset:15360
 buffer_load_dwordx4 v6, s[12:15], s48 offen offset:0 lds
 v_cvt_pk_bf16_f32 v151, v158, v159
 v_mfma_f32_32x32x16_bf16 v[160:175], a[160:163], a[84:87], v[160:175]
 ds_read_b64_tr_b16 a[160:161], v15 offset:14336
 ds_read_b64_tr_b16 a[162:163], v15 offset:15360
 buffer_store_dwordx4 v[148:151], v32, s[4:7], s59 offen offset:1024 sc1
 v_mfma_f32_32x32x16_bf16 v[176:191], a[164:167], a[84:87], v[176:191]
 s_waitcnt lgkmcnt(8)
 ds_read_b64_tr_b16 a[164:165], v14 offset:16384
 ds_read_b64_tr_b16 a[166:167], v14 offset:17408
 v_mfma_f32_32x32x16_bf16 v[160:175], a[168:171], a[72:75], v[160:175]
 ds_read_b64_tr_b16 a[168:169], v14 offset:18432
 ds_read_b64_tr_b16 a[170:171], v14 offset:19456
 v_mfma_f32_32x32x16_bf16 v[176:191], a[172:175], a[72:75], v[176:191]
 ds_read_b64_tr_b16 a[172:173], v14 offset:20480
 ds_read_b64_tr_b16 a[174:175], v14 offset:21504
 v_mfma_f32_32x32x16_bf16 v[160:175], a[176:179], a[76:79], v[160:175]
 ds_read_b64_tr_b16 a[176:177], v14 offset:22528
 ds_read_b64_tr_b16 a[178:179], v14 offset:23552
 v_mfma_f32_32x32x16_bf16 v[176:191], a[144:147], a[76:79], v[176:191]
 s_waitcnt vmcnt(19) lgkmcnt(8)
 s_barrier
 ds_read_b64_tr_b16 a[144:145], v16 offset:8192
 ds_read_b64_tr_b16 a[146:147], v16 offset:9216
 v_mfma_f32_32x32x16_bf16 v[160:175], a[148:151], a[88:91], v[160:175]
 ds_read_b64_tr_b16 a[148:149], v16 offset:10240
 ds_read_b64_tr_b16 a[150:151], v16 offset:11264
 v_mfma_f32_32x32x16_bf16 v[176:191], a[152:155], a[88:91], v[176:191]
 ds_read_b64_tr_b16 a[152:153], v16 offset:12288
 ds_read_b64_tr_b16 a[154:155], v16 offset:13312
 v_mfma_f32_32x32x16_bf16 v[160:175], a[156:159], a[92:95], v[160:175]
 ds_read_b64_tr_b16 a[156:157], v16 offset:14336
 ds_read_b64_tr_b16 a[158:159], v16 offset:15360
 v_mfma_f32_32x32x16_bf16 v[176:191], a[160:163], a[92:95], v[176:191]
 s_waitcnt lgkmcnt(8)
 ds_read_b64_tr_b16 a[160:161], v15 offset:16384
 ds_read_b64_tr_b16 a[162:163], v15 offset:17408
 v_mfma_f32_32x32x16_bf16 v[160:175], a[164:167], v[64:67], v[160:175]
 ds_read_b64_tr_b16 a[164:165], v15 offset:18432
 ds_read_b64_tr_b16 a[166:167], v15 offset:19456
 buffer_load_dwordx4 v7, s[12:15], s48 offen offset:1024 lds
 v_mfma_f32_32x32x16_bf16 v[160:175], a[168:171], v[68:71], v[160:175]
 s_add_u32 s48, s54, s83
 ds_read_b64_tr_b16 a[168:169], v15 offset:20480
 ds_read_b64_tr_b16 a[170:171], v15 offset:21504
 s_add_u32 m0, s28, 0x2000
 v_mfma_f32_32x32x16_bf16 v[160:175], a[172:175], v[72:75], v[160:175]
 ds_read_b64_tr_b16 a[172:173], v15 offset:22528
 ds_read_b64_tr_b16 a[174:175], v15 offset:23552
 buffer_load_dwordx4 v6, s[12:15], s48 offen offset:0 lds
 v_mfma_f32_32x32x16_bf16 v[160:175], a[176:179], v[76:79], v[160:175]
 s_waitcnt lgkmcnt(8)
 ds_read_b64_tr_b16 a[176:177], v17 offset:8192
 ds_read_b64_tr_b16 a[178:179], v17 offset:9216
 v_mfma_f32_32x32x16_bf16 v[160:175], a[144:147], v[80:83], v[160:175]
 ds_read_b64_tr_b16 a[144:145], v17 offset:10240
 ds_read_b64_tr_b16 a[146:147], v17 offset:11264
 buffer_load_dwordx4 v7, s[12:15], s48 offen offset:1024 lds
 v_mfma_f32_32x32x16_bf16 v[160:175], a[148:151], v[84:87], v[160:175]
 s_add_u32 s48, s57, s83
 ds_read_b64_tr_b16 a[148:149], v17 offset:12288
 ds_read_b64_tr_b16 a[150:151], v17 offset:13312
 s_add_u32 m0, s28, 0x1a000
 v_mfma_f32_32x32x16_bf16 v[160:175], a[152:155], v[88:91], v[160:175]
 ds_read_b64_tr_b16 a[152:153], v17 offset:14336
 ds_read_b64_tr_b16 a[154:155], v17 offset:15360
 buffer_load_dwordx4 v6, s[12:15], s48 offen offset:0 lds
 v_mfma_f32_32x32x16_bf16 v[160:175], a[156:159], v[92:95], v[160:175]
 s_waitcnt vmcnt(17) lgkmcnt(8)
 s_barrier
 ds_read_b64_tr_b16 a[156:157], v14 offset:24576
 ds_read_b64_tr_b16 a[158:159], v14 offset:25600
 v_mfma_f32_32x32x16_bf16 v[176:191], a[160:163], v[64:67], v[176:191]
 ds_read_b64_tr_b16 a[160:161], v14 offset:26624
 ds_read_b64_tr_b16 a[162:163], v14 offset:27648
 buffer_load_dwordx4 v7, s[12:15], s48 offen offset:1024 lds
 v_mfma_f32_32x32x16_bf16 v[176:191], a[164:167], v[68:71], v[176:191]
 s_add_u32 s48, s54, s85
 ds_read_b64_tr_b16 a[164:165], v14 offset:28672
 ds_read_b64_tr_b16 a[166:167], v14 offset:29696
 s_add_u32 m0, s28, 0x4000
 v_cvt_pk_bf16_f32 v160, v160, v161
 v_cvt_pk_bf16_f32 v161, v162, v163
 v_cvt_pk_bf16_f32 v162, v164, v165
 v_mfma_f32_32x32x16_bf16 v[176:191], a[168:171], v[72:75], v[176:191]
 ds_read_b64_tr_b16 a[168:169], v14 offset:30720
 ds_read_b64_tr_b16 a[170:171], v14 offset:31744
 buffer_load_dwordx4 v6, s[12:15], s48 offen offset:0 lds
 v_cvt_pk_bf16_f32 v163, v166, v167
 v_mfma_f32_32x32x16_bf16 v[176:191], a[172:175], v[76:79], v[176:191]
 s_waitcnt lgkmcnt(8)
 ds_read_b64_tr_b16 a[172:173], v14 offset:32768
 ds_read_b64_tr_b16 a[174:175], v14 offset:33792
 buffer_store_dwordx4 v[160:163], v32, s[4:7], s60 offen offset:0 sc1
 v_cvt_pk_bf16_f32 v164, v168, v169
 v_cvt_pk_bf16_f32 v165, v170, v171
 v_mfma_f32_32x32x16_bf16 v[176:191], a[176:179], v[80:83], v[176:191]
 ds_read_b64_tr_b16 a[176:177], v14 offset:34816
 ds_read_b64_tr_b16 a[178:179], v14 offset:35840
 buffer_load_dwordx4 v7, s[12:15], s48 offen offset:1024 lds
 s_add_u32 s48, s57, s85
 s_add_u32 m0, s28, 0x1c000
 v_mfma_f32_32x32x16_bf16 v[176:191], a[144:147], v[84:87], v[176:191]
 ds_read_b64_tr_b16 a[144:145], v14 offset:36864
 ds_read_b64_tr_b16 a[146:147], v14 offset:37888
 buffer_load_dwordx4 v6, s[12:15], s48 offen offset:0 lds
 v_cvt_pk_bf16_f32 v166, v172, v173
 v_cvt_pk_bf16_f32 v167, v174, v175
 v_mfma_f32_32x32x16_bf16 v[176:191], a[148:151], v[88:91], v[176:191]
 ds_read_b64_tr_b16 a[148:149], v14 offset:38912
 ds_read_b64_tr_b16 a[150:151], v14 offset:39936
 buffer_load_dwordx4 v7, s[12:15], s48 offen offset:1024 lds
 buffer_store_dwordx4 v[164:167], v32, s[4:7], s60 offen offset:1024 sc1
 v_mfma_f32_32x32x16_bf16 v[176:191], a[152:155], v[92:95], v[176:191]
 s_waitcnt lgkmcnt(8)
 ds_read_b64_tr_b16 a[152:153], v14 offset:40960
 ds_read_b64_tr_b16 a[154:155], v14 offset:41984
 v_mfma_f32_32x32x16_bf16 v[192:207], a[156:159], a[188:191], v[192:207]
 s_waitcnt vmcnt(11)
 buffer_store_dword v23, v62, s[4:7], s58 offen offset:2048 sc1
 ds_read_b64_tr_b16 a[156:157], v14 offset:43008
 ds_read_b64_tr_b16 a[158:159], v14 offset:44032
 v_mfma_f32_32x32x16_bf16 v[192:207], a[160:163], a[192:195], v[192:207]
 s_mov_b32 s72, 0x2200
 ds_read_b64_tr_b16 a[160:161], v14 offset:45056
 ds_read_b64_tr_b16 a[162:163], v14 offset:46080
 v_cvt_pk_bf16_f32 v176, v176, v177
 v_cvt_pk_bf16_f32 v177, v178, v179
 v_cvt_pk_bf16_f32 v178, v180, v181
 v_cvt_pk_bf16_f32 v179, v182, v183
 v_mfma_f32_32x32x16_bf16 v[192:207], a[164:167], a[196:199], v[192:207]
 ds_read_b64_tr_b16 a[164:165], v14 offset:47104
 ds_read_b64_tr_b16 a[166:167], v14 offset:48128
 buffer_load_dword v40, v38, s[4:7], s72 offen offset:2048 sc1
 buffer_store_dwordx4 v[176:179], v32, s[4:7], s61 offen offset:0 sc1
 v_mfma_f32_32x32x16_bf16 v[192:207], a[168:171], a[200:203], v[192:207]
 s_waitcnt lgkmcnt(8)
 s_barrier
 ds_read_b64_tr_b16 a[168:169], v14 offset:49152
 ds_read_b64_tr_b16 a[170:171], v14 offset:50176
 v_cvt_pk_bf16_f32 v180, v184, v185
 v_cvt_pk_bf16_f32 v181, v186, v187
 v_mfma_f32_32x32x16_bf16 v[192:207], a[172:175], a[220:223], v[192:207]
 ds_read_b64_tr_b16 a[172:173], v14 offset:51200
 ds_read_b64_tr_b16 a[174:175], v14 offset:52224
 v_cvt_pk_bf16_f32 v182, v188, v189
 v_cvt_pk_bf16_f32 v183, v190, v191
 v_mfma_f32_32x32x16_bf16 v[192:207], a[176:179], a[224:227], v[192:207]
 ds_read_b64_tr_b16 a[176:177], v14 offset:53248
 ds_read_b64_tr_b16 a[178:179], v14 offset:54272
 buffer_store_dwordx4 v[180:183], v32, s[4:7], s61 offen offset:1024 sc1
 ds_read_b128 v[248:251], v47 offset:3072
 ds_read_b128 v[252:255], v47 offset:3104
 v_mfma_f32_32x32x16_bf16 v[192:207], a[144:147], a[228:231], v[192:207]
 ds_read_b64_tr_b16 a[144:145], v14 offset:55296
 ds_read_b64_tr_b16 a[146:147], v14 offset:56320
 v_permlane32_swap_b32 v56, v58
 v_permlane32_swap_b32 v57, v59
 v_lshlrev_b32 v128, 16, v56
 v_and_b32 v129, 0xffff0000, v56
 v_mfma_f32_32x32x16_bf16 v[192:207], a[148:151], a[232:235], v[192:207]
 s_waitcnt lgkmcnt(10)
 ds_read_b64_tr_b16 a[148:149], v14 offset:57344
 ds_read_b64_tr_b16 a[150:151], v14 offset:58368
 v_lshlrev_b32 v130, 16, v57
 v_and_b32 v131, 0xffff0000, v57
 v_lshlrev_b32 v132, 16, v58
 v_and_b32 v133, 0xffff0000, v58
 v_mfma_f32_32x32x16_bf16 v[192:207], a[152:155], a[204:207], v[192:207]
 ds_read_b64_tr_b16 a[152:153], v14 offset:59392
 ds_read_b64_tr_b16 a[154:155], v14 offset:60416
 v_lshlrev_b32 v134, 16, v59
 v_and_b32 v135, 0xffff0000, v59
 v_fma_f32 v24, v128, v2, v3
 v_fma_f32 v25, v129, v2, v3
 v_mfma_f32_32x32x16_bf16 v[192:207], a[156:159], a[208:211], v[192:207]
 ds_read_b64_tr_b16 a[156:157], v14 offset:61440
 ds_read_b64_tr_b16 a[158:159], v14 offset:62464
 v_fma_f32 v26, v130, v2, v3
 v_fma_f32 v27, v131, v2, v3
 v_fma_f32 v28, v132, v2, v3
 v_fma_f32 v29, v133, v2, v3
 v_mfma_f32_32x32x16_bf16 v[192:207], a[160:163], a[212:215], v[192:207]
 ds_read_b64_tr_b16 a[160:161], v14 offset:63488
 ds_read_b64_tr_b16 a[162:163], v14 offset:64512
 v_fma_f32 v30, v134, v2, v3
 v_fma_f32 v31, v135, v2, v3
 v_cvt_pk_bf16_f32 v24, 0, v24
 v_cvt_pk_bf16_f32 v25, 0, v25
 v_mfma_f32_32x32x16_bf16 v[192:207], a[164:167], a[216:219], v[192:207]
 s_waitcnt lgkmcnt(8)
 ds_read_b64_tr_b16 a[164:165], v16 offset:24576
 ds_read_b64_tr_b16 a[166:167], v16 offset:25600
 v_cvt_pk_bf16_f32 v26, 0, v26
 v_cvt_pk_bf16_f32 v27, 0, v27
 v_cvt_pk_bf16_f32 v28, 0, v28
 v_cvt_pk_bf16_f32 v29, 0, v29
 v_mfma_f32_32x32x16_bf16 v[192:207], a[168:171], a[236:239], v[192:207]
 ds_read_b64_tr_b16 a[168:169], v16 offset:26624
 ds_read_b64_tr_b16 a[170:171], v16 offset:27648
 v_cvt_pk_bf16_f32 v30, 0, v30
 v_cvt_pk_bf16_f32 v31, 0, v31
 v_mul_f32 v248, v248, v24
 v_mul_f32 v249, v249, v25
 v_mfma_f32_32x32x16_bf16 v[192:207], a[172:175], a[240:243], v[192:207]
 ds_read_b64_tr_b16 a[172:173], v16 offset:28672
 ds_read_b64_tr_b16 a[174:175], v16 offset:29696
 v_mul_f32 v250, v250, v26
 v_mul_f32 v251, v251, v27
 v_mul_f32 v252, v252, v28
 v_mul_f32 v253, v253, v29
 v_mfma_f32_32x32x16_bf16 v[192:207], a[176:179], a[244:247], v[192:207]
 ds_read_b64_tr_b16 a[176:177], v16 offset:30720
 ds_read_b64_tr_b16 a[178:179], v16 offset:31744
 v_mul_f32 v254, v254, v30
 v_mul_f32 v255, v255, v31
 v_cvt_pk_bf16_f32 v248, 0, v248
 v_cvt_pk_bf16_f32 v249, 0, v249
 v_mfma_f32_32x32x16_bf16 v[192:207], a[144:147], a[248:251], v[192:207]
 s_waitcnt vmcnt(12) lgkmcnt(8)
 s_barrier
 ds_read_b64_tr_b16 a[144:145], v16 offset:0
 ds_read_b64_tr_b16 a[146:147], v16 offset:1024
 v_cvt_pk_bf16_f32 v250, 0, v250
 v_cvt_pk_bf16_f32 v251, 0, v251
 v_mfma_f32_32x32x16_bf16 v[192:207], a[148:151], a[0:3], v[192:207]
 ds_read_b64_tr_b16 a[148:149], v16 offset:2048
 ds_read_b64_tr_b16 a[150:151], v16 offset:3072
 v_cvt_pk_bf16_f32 v252, 0, v252
 v_cvt_pk_bf16_f32 v253, 0, v253
 v_cvt_pk_bf16_f32 v254, 0, v254
 v_cvt_pk_bf16_f32 v255, 0, v255
 v_mfma_f32_32x32x16_bf16 v[192:207], a[152:155], a[4:7], v[192:207]
 ds_read_b64_tr_b16 a[152:153], v16 offset:4096
 ds_read_b64_tr_b16 a[154:155], v16 offset:5120
 ds_read_b128 v[136:139], v47 offset:2048
 ds_read_b128 v[140:143], v47 offset:2080
 ds_read_b128 v[160:163], v46 offset:3072
 ds_read_b128 v[164:167], v46 offset:3104
 v_mfma_f32_32x32x16_bf16 v[192:207], a[156:159], a[16:19], v[192:207]
 ds_read_b64_tr_b16 a[156:157], v16 offset:6144
 ds_read_b64_tr_b16 a[158:159], v16 offset:7168
 ds_read_b128 v[168:171], v46 offset:3136
 ds_read_b128 v[172:175], v46 offset:3168
 v_permlane32_swap_b32 v48, v50
 v_permlane32_swap_b32 v49, v51
 v_mfma_f32_32x32x16_bf16 v[192:207], a[160:163], a[20:23], v[192:207]
 s_waitcnt lgkmcnt(14)
 ds_read_b64_tr_b16 a[160:161], v16 offset:16384
 ds_read_b64_tr_b16 a[162:163], v16 offset:17408
 v_permlane32_swap_b32 v52, v54
 v_permlane32_swap_b32 v53, v55
 v_lshlrev_b32 v144, 16, v48
 v_and_b32 v145, 0xffff0000, v48
 v_mfma_f32_32x32x16_bf16 v[192:207], a[164:167], a[8:11], v[192:207]
 ds_read_b64_tr_b16 a[164:165], v16 offset:18432
 ds_read_b64_tr_b16 a[166:167], v16 offset:19456
 v_lshlrev_b32 v146, 16, v49
 v_and_b32 v147, 0xffff0000, v49
 v_lshlrev_b32 v148, 16, v50
 v_and_b32 v149, 0xffff0000, v50
 v_mfma_f32_32x32x16_bf16 v[192:207], a[168:171], a[12:15], v[192:207]
 ds_read_b64_tr_b16 a[168:169], v16 offset:20480
 ds_read_b64_tr_b16 a[170:171], v16 offset:21504
 v_lshlrev_b32 v150, 16, v51
 v_and_b32 v151, 0xffff0000, v51
 v_fma_f32 v24, v144, v2, v3
 v_fma_f32 v25, v145, v2, v3
 v_mfma_f32_32x32x16_bf16 v[192:207], a[172:175], a[24:27], v[192:207]
 ds_read_b64_tr_b16 a[172:173], v16 offset:22528
 ds_read_b64_tr_b16 a[174:175], v16 offset:23552
 v_fma_f32 v26, v146, v2, v3
 v_fma_f32 v27, v147, v2, v3
 v_fma_f32 v28, v148, v2, v3
 v_fma_f32 v29, v149, v2, v3
 v_mfma_f32_32x32x16_bf16 v[192:207], a[176:179], a[28:31], v[192:207]
 s_waitcnt lgkmcnt(10)
 ds_read_b64_tr_b16 a[176:177], v14 offset:0
 ds_read_b64_tr_b16 a[178:179], v14 offset:1024
 v_fma_f32 v30, v150, v2, v3
 v_fma_f32 v31, v151, v2, v3
 v_cvt_pk_bf16_f32 v24, 0, v24
 v_cvt_pk_bf16_f32 v25, 0, v25
 v_mfma_f32_32x32x16_bf16 v[192:207], a[144:147], a[32:35], v[192:207]
 ds_read_b64_tr_b16 a[144:145], v14 offset:2048
 ds_read_b64_tr_b16 a[146:147], v14 offset:3072
 v_cvt_pk_bf16_f32 v26, 0, v26
 v_cvt_pk_bf16_f32 v27, 0, v27
 v_cvt_pk_bf16_f32 v28, 0, v28
 v_cvt_pk_bf16_f32 v29, 0, v29
 v_mfma_f32_32x32x16_bf16 v[192:207], a[148:151], a[36:39], v[192:207]
 ds_read_b64_tr_b16 a[148:149], v14 offset:4096
 ds_read_b64_tr_b16 a[150:151], v14 offset:5120
 v_cvt_pk_bf16_f32 v30, 0, v30
 v_cvt_pk_bf16_f32 v31, 0, v31
 v_mul_f32 v160, v160, v24
 v_mul_f32 v161, v161, v25
 v_mfma_f32_32x32x16_bf16 v[192:207], a[152:155], a[48:51], v[192:207]
 ds_read_b64_tr_b16 a[152:153], v14 offset:6144
 ds_read_b64_tr_b16 a[154:155], v14 offset:7168
 v_mul_f32 v162, v162, v26
 v_mul_f32 v163, v163, v27
 v_mul_f32 v164, v164, v28
 v_mul_f32 v165, v165, v29
 v_mfma_f32_32x32x16_bf16 v[192:207], a[156:159], a[52:55], v[192:207]
 s_waitcnt vmcnt(5) lgkmcnt(8)
 s_barrier
 ds_read_b64_tr_b16 a[156:157], v16 offset:32768
 ds_read_b64_tr_b16 a[158:159], v16 offset:33792
 v_mul_f32 v166, v166, v30
 v_mul_f32 v167, v167, v31
 v_mfma_f32_32x32x16_bf16 v[192:207], a[160:163], a[40:43], v[192:207]
 ds_read_b64_tr_b16 a[160:161], v16 offset:34816
 ds_read_b64_tr_b16 a[162:163], v16 offset:35840
 v_cvt_pk_bf16_f32 v160, 0, v160
 v_cvt_pk_bf16_f32 v161, 0, v161
 v_cvt_pk_bf16_f32 v162, 0, v162
 v_cvt_pk_bf16_f32 v163, 0, v163
 v_mfma_f32_32x32x16_bf16 v[192:207], a[164:167], a[44:47], v[192:207]
 ds_read_b64_tr_b16 a[164:165], v16 offset:36864
 ds_read_b64_tr_b16 a[166:167], v16 offset:37888
 v_cvt_pk_bf16_f32 v164, 0, v164
 v_cvt_pk_bf16_f32 v165, 0, v165
 v_cvt_pk_bf16_f32 v166, 0, v166
 v_cvt_pk_bf16_f32 v167, 0, v167
 v_mfma_f32_32x32x16_bf16 v[192:207], a[168:171], a[56:59], v[192:207]
 ds_read_b64_tr_b16 a[168:169], v16 offset:38912
 ds_read_b64_tr_b16 a[170:171], v16 offset:39936
 v_lshlrev_b32 v152, 16, v52
 v_and_b32 v153, 0xffff0000, v52
 v_lshlrev_b32 v154, 16, v53
 v_and_b32 v155, 0xffff0000, v53
 v_mfma_f32_32x32x16_bf16 v[192:207], a[172:175], a[60:63], v[192:207]
 s_waitcnt vmcnt(0)
 buffer_store_dword v23, v63, s[4:7], s60 offen offset:2048 sc1
 s_waitcnt lgkmcnt(8)
 ds_read_b64_tr_b16 a[172:173], v14 offset:8192
 ds_read_b64_tr_b16 a[174:175], v14 offset:9216
 v_lshlrev_b32 v156, 16, v54
 v_and_b32 v157, 0xffff0000, v54
 v_lshlrev_b32 v158, 16, v55
 v_and_b32 v159, 0xffff0000, v55
 v_mfma_f32_32x32x16_bf16 v[192:207], a[176:179], a[64:67], v[192:207]
 ds_read_b64_tr_b16 a[176:177], v14 offset:10240
 ds_read_b64_tr_b16 a[178:179], v14 offset:11264
 buffer_load_dword v43, v41, s[4:7], 0 offen offset:2048 sc1
 v_fma_f32 v24, v152, v2, v3
 v_fma_f32 v25, v153, v2, v3
 v_mfma_f32_32x32x16_bf16 v[192:207], a[144:147], a[68:71], v[192:207]
 ds_read_b64_tr_b16 a[144:145], v14 offset:12288
 ds_read_b64_tr_b16 a[146:147], v14 offset:13312
 v_fma_f32 v26, v154, v2, v3
 v_fma_f32 v27, v155, v2, v3
 v_fma_f32 v28, v156, v2, v3
 v_fma_f32 v29, v157, v2, v3
 v_mfma_f32_32x32x16_bf16 v[192:207], a[148:151], a[80:83], v[192:207]
 ds_read_b64_tr_b16 a[148:149], v14 offset:14336
 ds_read_b64_tr_b16 a[150:151], v14 offset:15360
 v_fma_f32 v30, v158, v2, v3
 v_fma_f32 v31, v159, v2, v3
 v_cvt_pk_bf16_f32 v24, 0, v24
 v_cvt_pk_bf16_f32 v25, 0, v25
 v_mfma_f32_32x32x16_bf16 v[192:207], a[152:155], a[84:87], v[192:207]
 s_waitcnt lgkmcnt(8)
 ds_read_b64_tr_b16 a[152:153], v16 offset:40960
 ds_read_b64_tr_b16 a[154:155], v16 offset:41984
 v_cvt_pk_bf16_f32 v26, 0, v26
 v_cvt_pk_bf16_f32 v27, 0, v27
 v_cvt_pk_bf16_f32 v28, 0, v28
 v_cvt_pk_bf16_f32 v29, 0, v29
 v_mfma_f32_32x32x16_bf16 v[192:207], a[156:159], a[72:75], v[192:207]
 ds_read_b64_tr_b16 a[156:157], v16 offset:43008
 ds_read_b64_tr_b16 a[158:159], v16 offset:44032
 v_cmp_eq_u32 s[30:31], 0, v40
 v_cvt_pk_bf16_f32 v30, 0, v30
 v_cvt_pk_bf16_f32 v31, 0, v31
 v_mul_f32 v168, v168, v24
 v_mfma_f32_32x32x16_bf16 v[192:207], a[160:163], a[76:79], v[192:207]
 ds_read_b64_tr_b16 a[160:161], v16 offset:45056
 ds_read_b64_tr_b16 a[162:163], v16 offset:46080
 v_mul_f32 v169, v169, v25
 v_mul_f32 v170, v170, v26
 v_mul_f32 v171, v171, v27
 v_mul_f32 v172, v172, v28
 v_mfma_f32_32x32x16_bf16 v[192:207], a[164:167], a[88:91], v[192:207]
 ds_read_b64_tr_b16 a[164:165], v16 offset:47104
 ds_read_b64_tr_b16 a[166:167], v16 offset:48128
 s_cmp_eq_u32 s30, 0
 s_cselect_b32 s78, s6, 0
 s_mov_b32 s67, 0x2200
 v_mul_f32 v173, v173, v29
 v_mfma_f32_32x32x16_bf16 v[192:207], a[168:171], a[92:95], v[192:207]
 s_waitcnt lgkmcnt(8)
 ds_read_b64_tr_b16 a[168:169], v15 offset:24576
 ds_read_b64_tr_b16 a[170:171], v15 offset:25600
 buffer_load_dwordx4 a[128:131], v37, s[76:79], s67 offen sc1
 v_mul_f32 v174, v174, v30
 v_mul_f32 v175, v175, v31
 v_mfma_f32_32x32x16_bf16 v[192:207], a[172:175], v[64:67], v[192:207]
 s_mov_b32 s67, 0x2a80
 ds_read_b64_tr_b16 a[172:173], v15 offset:26624
 ds_read_b64_tr_b16 a[174:175], v15 offset:27648
 v_cvt_pk_bf16_f32 v168, 0, v168
 v_cvt_pk_bf16_f32 v169, 0, v169
 v_cvt_pk_bf16_f32 v170, 0, v170
 v_cvt_pk_bf16_f32 v171, 0, v171
 v_mfma_f32_32x32x16_bf16 v[192:207], a[176:179], v[68:71], v[192:207]
 ds_read_b64_tr_b16 a[176:177], v15 offset:28672
 ds_read_b64_tr_b16 a[178:179], v15 offset:29696
 buffer_load_dwordx4 a[132:135], v37, s[76:79], s67 offen sc1
 v_cvt_pk_bf16_f32 v172, 0, v172
 v_cvt_pk_bf16_f32 v173, 0, v173
 v_mfma_f32_32x32x16_bf16 v[192:207], a[144:147], v[72:75], v[192:207]
 s_mov_b32 s67, 0x3300
 ds_read_b64_tr_b16 a[144:145], v15 offset:30720
 ds_read_b64_tr_b16 a[146:147], v15 offset:31744
 v_cvt_pk_bf16_f32 v174, 0, v174
 v_cvt_pk_bf16_f32 v175, 0, v175
 v_mfma_f32_32x32x16_bf16 v[192:207], a[148:151], v[76:79], v[192:207]
 s_waitcnt lgkmcnt(8)
 ds_read_b64_tr_b16 a[148:149], v15 offset:32768
 ds_read_b64_tr_b16 a[150:151], v15 offset:33792
 buffer_load_dwordx4 a[136:139], v37, s[76:79], s67 offen sc1
 ds_read_b128 v[176:179], v46 offset:2048
 ds_read_b128 v[180:183], v46 offset:2080
 v_mfma_f32_32x32x16_bf16 v[192:207], a[152:155], v[80:83], v[192:207]
 ds_read_b64_tr_b16 a[152:153], v15 offset:34816
 ds_read_b64_tr_b16 a[154:155], v15 offset:35840
 ds_read_b128 v[184:187], v46 offset:2112
 ds_read_b128 v[188:191], v46 offset:2144
 v_mfma_f32_32x32x16_bf16 v[192:207], a[156:159], v[84:87], v[192:207]
 s_mov_b32 s67, 0x3b80
 ds_read_b64_tr_b16 a[156:157], v15 offset:36864
 ds_read_b64_tr_b16 a[158:159], v15 offset:37888
 v_mfma_f32_32x32x16_bf16 v[192:207], a[160:163], v[88:91], v[192:207]
 ds_read_b64_tr_b16 a[160:161], v15 offset:38912
 ds_read_b64_tr_b16 a[162:163], v15 offset:39936
 buffer_load_dwordx4 a[140:143], v37, s[76:79], s67 offen sc1
 v_mfma_f32_32x32x16_bf16 v[192:207], a[164:167], v[92:95], v[192:207]
 s_waitcnt lgkmcnt(12)
 ds_read_b64_tr_b16 a[164:165], v15 offset:40960
 ds_read_b64_tr_b16 a[166:167], v15 offset:41984
 s_mov_b32 s67, 0x2200
 v_mfma_f32_32x32x16_bf16 v[208:223], a[168:171], a[188:191], v[208:223]
 ds_read_b64_tr_b16 a[168:169], v15 offset:43008
 ds_read_b64_tr_b16 a[170:171], v15 offset:44032
 buffer_load_dwordx4 a[96:99], v36, s[76:79], s67 offen offset:0 sc1
 v_mfma_f32_32x32x16_bf16 v[208:223], a[172:175], a[192:195], v[208:223]
 s_mov_b32 s67, 0x2200
 ds_read_b64_tr_b16 a[172:173], v15 offset:45056
 ds_read_b64_tr_b16 a[174:175], v15 offset:46080
 v_cvt_pk_bf16_f32 v192, v192, v193
 v_cvt_pk_bf16_f32 v193, v194, v195
 v_cvt_pk_bf16_f32 v194, v196, v197
 v_cvt_pk_bf16_f32 v195, v198, v199
 v_mfma_f32_32x32x16_bf16 v[208:223], a[176:179], a[196:199], v[208:223]
 ds_read_b64_tr_b16 a[176:177], v15 offset:47104
 ds_read_b64_tr_b16 a[178:179], v15 offset:48128
 buffer_load_dwordx4 a[100:103], v36, s[76:79], s67 offen offset:1024 sc1
 buffer_store_dwordx4 v[192:195], v32, s[4:7], s62 offen offset:0 sc1
 v_mfma_f32_32x32x16_bf16 v[208:223], a[144:147], a[200:203], v[208:223]
 s_waitcnt lgkmcnt(8)
 ds_read_b64_tr_b16 a[144:145], v15 offset:49152
 ds_read_b64_tr_b16 a[146:147], v15 offset:50176
 v_cvt_pk_bf16_f32 v196, v200, v201
 v_cvt_pk_bf16_f32 v197, v202, v203
 v_cvt_pk_bf16_f32 v198, v204, v205
 v_cvt_pk_bf16_f32 v199, v206, v207
 v_mfma_f32_32x32x16_bf16 v[208:223], a[148:151], a[220:223], v[208:223]
 s_mov_b32 s67, 0x2a80
 ds_read_b64_tr_b16 a[148:149], v15 offset:51200
 ds_read_b64_tr_b16 a[150:151], v15 offset:52224
 buffer_store_dwordx4 v[196:199], v32, s[4:7], s62 offen offset:1024 sc1
 v_mfma_f32_32x32x16_bf16 v[208:223], a[152:155], a[224:227], v[208:223]
 ds_read_b64_tr_b16 a[152:153], v15 offset:53248
 ds_read_b64_tr_b16 a[154:155], v15 offset:54272
 buffer_load_dwordx4 a[104:107], v36, s[76:79], s67 offen offset:0 sc1
 v_mfma_f32_32x32x16_bf16 v[208:223], a[156:159], a[228:231], v[208:223]
 s_mov_b32 s67, 0x2a80
 ds_read_b64_tr_b16 a[156:157], v15 offset:55296
 ds_read_b64_tr_b16 a[158:159], v15 offset:56320
 v_mfma_f32_32x32x16_bf16 v[208:223], a[160:163], a[232:235], v[208:223]
 s_waitcnt lgkmcnt(8)
 ds_read_b64_tr_b16 a[160:161], v15 offset:57344
 ds_read_b64_tr_b16 a[162:163], v15 offset:58368
 buffer_load_dwordx4 a[108:111], v36, s[76:79], s67 offen offset:1024 sc1
 v_mfma_f32_32x32x16_bf16 v[208:223], a[164:167], a[204:207], v[208:223]
 ds_read_b64_tr_b16 a[164:165], v15 offset:59392
 ds_read_b64_tr_b16 a[166:167], v15 offset:60416
 buffer_load_dword v40, v38, s[4:7], s72 offen offset:2048 sc1
 s_mov_b32 s67, 0x3300
 v_mfma_f32_32x32x16_bf16 v[208:223], a[168:171], a[208:211], v[208:223]
 ds_read_b64_tr_b16 a[168:169], v15 offset:61440
 ds_read_b64_tr_b16 a[170:171], v15 offset:62464
 buffer_load_dwordx4 a[112:115], v36, s[76:79], s67 offen offset:0 sc1
 v_mfma_f32_32x32x16_bf16 v[208:223], a[172:175], a[212:215], v[208:223]
 ds_read_b64_tr_b16 a[172:173], v15 offset:63488
 ds_read_b64_tr_b16 a[174:175], v15 offset:64512
 v_mfma_f32_32x32x16_bf16 v[208:223], a[176:179], a[216:219], v[208:223]
 s_waitcnt lgkmcnt(8)
 ds_read_b64_tr_b16 a[176:177], v17 offset:24576
 ds_read_b64_tr_b16 a[178:179], v17 offset:25600
 s_mov_b32 s67, 0x3300
 v_mfma_f32_32x32x16_bf16 v[208:223], a[144:147], a[236:239], v[208:223]
 ds_read_b64_tr_b16 a[144:145], v17 offset:26624
 ds_read_b64_tr_b16 a[146:147], v17 offset:27648
 buffer_load_dwordx4 a[116:119], v36, s[76:79], s67 offen offset:1024 sc1
 v_mfma_f32_32x32x16_bf16 v[208:223], a[148:151], a[240:243], v[208:223]
 ds_read_b64_tr_b16 a[148:149], v17 offset:28672
 ds_read_b64_tr_b16 a[150:151], v17 offset:29696
 v_mfma_f32_32x32x16_bf16 v[208:223], a[152:155], a[244:247], v[208:223]
 ds_read_b64_tr_b16 a[152:153], v17 offset:30720
 ds_read_b64_tr_b16 a[154:155], v17 offset:31744
 s_waitcnt vmcnt(13)
 v_cmp_eq_u32 vcc, 0, v43
 s_nop 1
 s_and_b32 s69, vcc_lo, 0xf0
 s_cbranch_scc1 mm_spin
mm_back:
 s_mov_b32 s67, 0x3b80
 v_mfma_f32_32x32x16_bf16 v[208:223], a[156:159], a[248:251], v[208:223]
 s_waitcnt lgkmcnt(8)
 ds_read_b64_tr_b16 a[156:157], v17 offset:0
 ds_read_b64_tr_b16 a[158:159], v17 offset:1024
 buffer_load_dwordx4 a[120:123], v36, s[76:79], s67 offen offset:0 sc1
 s_mov_b32 s67, 0x0
 v_mfma_f32_32x32x16_bf16 v[208:223], a[160:163], a[0:3], v[208:223]
 ds_read_b64_tr_b16 a[160:161], v17 offset:2048
 ds_read_b64_tr_b16 a[162:163], v17 offset:3072
 buffer_load_dwordx4 v[224:227], v37, s[4:7], s67 offen sc1
 v_mfma_f32_32x32x16_bf16 v[208:223], a[164:167], a[4:7], v[208:223]
 ds_read_b64_tr_b16 a[164:165], v17 offset:4096
 ds_read_b64_tr_b16 a[166:167], v17 offset:5120
 v_mfma_f32_32x32x16_bf16 v[208:223], a[168:171], a[16:19], v[208:223]
 ds_read_b64_tr_b16 a[168:169], v17 offset:6144
 ds_read_b64_tr_b16 a[170:171], v17 offset:7168
 buffer_load_dword v61, v39, s[4:7], 0 offen offset:2048 sc1
 v_mfma_f32_32x32x16_bf16 v[208:223], a[172:175], a[20:23], v[208:223]
 s_waitcnt lgkmcnt(8)
 ds_read_b64_tr_b16 a[172:173], v17 offset:16384
 ds_read_b64_tr_b16 a[174:175], v17 offset:17408
 s_mov_b32 s67, 0x880
 v_mfma_f32_32x32x16_bf16 v[208:223], a[176:179], a[8:11], v[208:223]
 ds_read_b64_tr_b16 a[176:177], v17 offset:18432
 ds_read_b64_tr_b16 a[178:179], v17 offset:19456
 buffer_load_dwordx4 v[228:231], v37, s[4:7], s67 offen sc1
 v_mfma_f32_32x32x16_bf16 v[208:223], a[144:147], a[12:15], v[208:223]
 s_mov_b32 s67, 0x1100
 ds_read_b64_tr_b16 a[144:145], v17 offset:20480
 ds_read_b64_tr_b16 a[146:147], v17 offset:21504
 v_mfma_f32_32x32x16_bf16 v[208:223], a[148:151], a[24:27], v[208:223]
 ds_read_b64_tr_b16 a[148:149], v17 offset:22528
 ds_read_b64_tr_b16 a[150:151], v17 offset:23552
 buffer_load_dwordx4 v[232:235], v37, s[4:7], s67 offen sc1
 v_mfma_f32_32x32x16_bf16 v[208:223], a[152:155], a[28:31], v[208:223]
 s_waitcnt lgkmcnt(8)
 ds_read_b64_tr_b16 a[152:153], v15 offset:0
 ds_read_b64_tr_b16 a[154:155], v15 offset:1024
 s_mov_b32 s67, 0x1980
 v_mfma_f32_32x32x16_bf16 v[208:223], a[156:159], a[32:35], v[208:223]
 ds_read_b64_tr_b16 a[156:157], v15 offset:2048
 ds_read_b64_tr_b16 a[158:159], v15 offset:3072
 buffer_load_dwordx4 v[236:239], v37, s[4:7], s67 offen sc1
 s_mov_b32 s67, 0x3b80
 v_mfma_f32_32x32x16_bf16 v[208:223], a[160:163], a[36:39], v[208:223]
 ds_read_b64_tr_b16 a[160:161], v15 offset:4096
 ds_read_b64_tr_b16 a[162:163], v15 offset:5120
 buffer_load_dwordx4 a[124:127], v36, s[76:79], s67 offen offset:1024 sc1
 v_mfma_f32_32x32x16_bf16 v[208:223], a[164:167], a[48:51], v[208:223]
 ds_read_b64_tr_b16 a[164:165], v15 offset:6144
 ds_read_b64_tr_b16 a[166:167], v15 offset:7168
 v_mfma_f32_32x32x16_bf16 v[208:223], a[168:171], a[52:55], v[208:223]
 s_waitcnt lgkmcnt(8)
 ds_read_b64_tr_b16 a[168:169], v17 offset:32768
 ds_read_b64_tr_b16 a[170:171], v17 offset:33792
 v_mfma_f32_32x32x16_bf16 v[208:223], a[172:175], a[40:43], v[208:223]
 ds_read_b64_tr_b16 a[172:173], v17 offset:34816
 ds_read_b64_tr_b16 a[174:175], v17 offset:35840
 v_mfma_f32_32x32x16_bf16 v[208:223], a[176:179], a[44:47], v[208:223]
 ds_read_b64_tr_b16 a[176:177], v17 offset:36864
 ds_read_b64_tr_b16 a[178:179], v17 offset:37888
 v_mfma_f32_32x32x16_bf16 v[208:223], a[144:147], a[56:59], v[208:223]
 ds_read_b64_tr_b16 a[144:145], v17 offset:38912
 ds_read_b64_tr_b16 a[146:147], v17 offset:39936
 s_cmp_lg_u32 s30, 0
 s_cbranch_scc1 mr_spin
mr_back:
 v_mfma_f32_32x32x16_bf16 v[208:223], a[148:151], a[60:63], v[208:223]
 s_waitcnt lgkmcnt(8)
 v_mfma_f32_32x32x16_bf16 v[208:223], a[152:155], a[64:67], v[208:223]
 v_mfma_f32_32x32x16_bf16 v[208:223], a[156:159], a[68:71], v[208:223]
 v_mfma_f32_32x32x16_bf16 v[208:223], a[160:163], a[80:83], v[208:223]
 v_mfma_f32_32x32x16_bf16 v[208:223], a[164:167], a[84:87], v[208:223]
 s_waitcnt lgkmcnt(0)
 ds_read_b64_tr_b16 a[148:149], v15 offset:8192
 ds_read_b64_tr_b16 a[150:151], v15 offset:9216
 v_mfma_f32_32x32x16_bf16 v[208:223], a[168:171], a[72:75], v[208:223]
 ds_read_b64_tr_b16 a[152:153], v15 offset:10240
 ds_read_b64_tr_b16 a[154:155], v15 offset:11264
 v_mfma_f32_32x32x16_bf16 v[208:223], a[172:175], a[76:79], v[208:223]
 ds_read_b64_tr_b16 a[156:157], v15 offset:12288
 ds_read_b64_tr_b16 a[158:159], v15 offset:13312
 v_mfma_f32_32x32x16_bf16 v[208:223], a[176:179], a[88:91], v[208:223]
 ds_read_b64_tr_b16 a[160:161], v15 offset:14336
 ds_read_b64_tr_b16 a[162:163], v15 offset:15360
 v_mfma_f32_32x32x16_bf16 v[208:223], a[144:147], a[92:95], v[208:223]
 s_mov_b32 s67, 0x1100
 ds_read_b64_tr_b16 a[164:165], v17 offset:40960
 ds_read_b64_tr_b16 a[166:167], v17 offset:41984
 s_waitcnt vmcnt(5)
 v_mfma_f32_32x32x16_bf16 v[240:255], a[180:183], v[224:227], v[240:255]
 ds_read_b64_tr_b16 a[168:169], v17 offset:43008
 ds_read_b64_tr_b16 a[170:171], v17 offset:44032
 buffer_load_dwordx4 v[112:115], v36, s[4:7], s67 offen offset:0 sc1
 s_mov_b32 s67, 0x1100
 s_waitcnt vmcnt(4)
 v_mfma_f32_32x32x16_bf16 v[240:255], a[180:183], v[228:231], v[240:255]
 ds_read_b64_tr_b16 a[172:173], v17 offset:45056
 ds_read_b64_tr_b16 a[174:175], v17 offset:46080
 buffer_load_dwordx4 v[116:119], v36, s[4:7], s67 offen offset:1024 sc1
 s_waitcnt vmcnt(4)
 v_mfma_f32_32x32x16_bf16 v[240:255], a[180:183], v[232:235], v[240:255]
 ds_read_b64_tr_b16 a[176:177], v17 offset:47104
 ds_read_b64_tr_b16 a[178:179], v17 offset:48128
 s_waitcnt vmcnt(3)
 v_mfma_f32_32x32x16_bf16 v[240:255], a[180:183], v[236:239], v[240:255]
 s_waitcnt lgkmcnt(8)
 v_mfma_f32_32x32x16_bf16 v[208:223], a[148:151], v[64:67], v[208:223]
 v_mfma_f32_32x32x16_bf16 v[208:223], a[152:155], v[68:71], v[208:223]
 s_nop 7
 s_nop 0
 v_mul_f32 v120, s40, v240
 v_mul_f32 v121, s40, v241
 v_mul_f32 v122, s40, v242
 v_mul_f32 v123, s40, v243
 v_mul_f32 v124, s40, v244
 v_mul_f32 v125, s40, v245
 v_mfma_f32_32x32x16_bf16 v[208:223], a[156:159], v[72:75], v[208:223]
 v_mul_f32 v126, s40, v246
 v_mul_f32 v127, s40, v247
 v_cvt_pk_bf16_f32 v120, 0, v120
 v_cvt_pk_bf16_f32 v121, 0, v121
 v_cvt_pk_bf16_f32 v122, 0, v122
 v_cvt_pk_bf16_f32 v123, 0, v123
 v_mfma_f32_32x32x16_bf16 v[208:223], a[160:163], v[76:79], v[208:223]
 s_waitcnt lgkmcnt(0)
 v_cvt_pk_bf16_f32 v124, 0, v124
 v_cvt_pk_bf16_f32 v125, 0, v125
 v_cvt_pk_bf16_f32 v126, 0, v126
 v_cvt_pk_bf16_f32 v127, 0, v127
 v_add_f32 v120, v120, v136
 v_add_f32 v121, v121, v137
 v_mfma_f32_32x32x16_bf16 v[208:223], a[164:167], v[80:83], v[208:223]
 v_cmp_eq_u32 vcc, 0, v61
 s_nop 1
 s_and_b32 s69, vcc_lo, 0x3
 s_cbranch_scc1 ms_spin
ms_back:
 s_mov_b32 s67, 0x0
 v_add_f32 v122, v122, v138
 v_mfma_f32_32x32x16_bf16 v[208:223], a[168:171], v[84:87], v[208:223]
 buffer_load_dwordx4 v[96:99], v36, s[4:7], s67 offen offset:0 sc1
 s_mov_b32 s67, 0x0
 v_add_f32 v123, v123, v139
 v_add_f32 v124, v124, v140
 v_add_f32 v125, v125, v141
 v_mfma_f32_32x32x16_bf16 v[208:223], a[172:175], v[88:91], v[208:223]
 buffer_load_dwordx4 v[100:103], v36, s[4:7], s67 offen offset:1024 sc1
 s_mov_b32 s67, 0x880
 v_add_f32 v126, v126, v142
 v_add_f32 v127, v127, v143
 v_cvt_pk_bf16_f32 v120, 0, v120
 v_mfma_f32_32x32x16_bf16 v[208:223], a[176:179], v[92:95], v[208:223]
 s_waitcnt vmcnt(4)
 buffer_load_dwordx4 v[104:107], v36, s[4:7], s67 offen offset:0 sc1
 s_mov_b32 s67, 0x880
 v_cvt_pk_bf16_f32 v121, 0, v121
 v_cvt_pk_bf16_f32 v122, 0, v122
 v_cvt_pk_bf16_f32 v123, 0, v123
 v_mfma_f32_32x32x16_bf16 v[240:255], a[184:187], a[128:131], v[240:255]
 buffer_load_dwordx4 v[108:111], v36, s[4:7], s67 offen offset:1024 sc1
 v_cvt_pk_bf16_f32 v124, 0, v124
 v_cvt_pk_bf16_f32 v125, 0, v125
 v_cvt_pk_bf16_f32 v126, 0, v126
 v_cvt_pk_bf16_f32 v127, 0, v127
 v_mfma_f32_32x32x16_bf16 v[240:255], a[184:187], a[132:135], v[240:255]
 v_mul_f32 v24, s70, v120
 v_mul_f32 v25, s70, v121
 v_mul_f32 v26, s70, v122
 v_mul_f32 v27, s70, v123
 v_mul_f32 v28, s70, v124
 v_mul_f32 v29, s70, v125
 v_mfma_f32_32x32x16_bf16 v[240:255], a[184:187], a[136:139], v[240:255]
 v_mul_f32 v30, s70, v126
 v_mul_f32 v31, s70, v127
 v_exp_f32 v24, v24
 v_exp_f32 v25, v25
 v_mfma_f32_32x32x16_bf16 v[240:255], a[184:187], a[140:143], v[240:255]
 v_exp_f32 v26, v26
 v_exp_f32 v27, v27
 v_exp_f32 v28, v28
 v_mfma_f32_32x32x16_bf16 v[160:175], a[180:183], a[96:99], v[160:175]
 v_exp_f32 v29, v29
 v_exp_f32 v30, v30
 v_exp_f32 v31, v31
 v_mfma_f32_32x32x16_bf16 v[160:175], a[184:187], a[100:103], v[160:175]
 v_add_f32 v24, 1.0, v24
 v_add_f32 v25, 1.0, v25
 v_add_f32 v26, 1.0, v26
 v_add_f32 v27, 1.0, v27
 v_add_f32 v28, 1.0, v28
 v_add_f32 v29, 1.0, v29
 v_mfma_f32_32x32x16_bf16 v[160:175], a[180:183], a[104:107], v[160:175]
 v_add_f32 v30, 1.0, v30
 v_add_f32 v31, 1.0, v31
 v_rcp_f32 v24, v24
 v_rcp_f32 v25, v25
 v_mfma_f32_32x32x16_bf16 v[160:175], a[184:187], a[108:111], v[160:175]
 v_rcp_f32 v26, v26
 v_rcp_f32 v27, v27
 v_rcp_f32 v28, v28
 v_mfma_f32_32x32x16_bf16 v[160:175], a[180:183], a[112:115], v[160:175]
 v_rcp_f32 v29, v29
 v_rcp_f32 v30, v30
 v_rcp_f32 v31, v31
 v_mfma_f32_32x32x16_bf16 v[160:175], a[184:187], a[116:119], v[160:175]
 v_mul_f32 v120, v120, v24
 v_mul_f32 v121, v121, v25
 v_mul_f32 v122, v122, v26
 v_mul_f32 v123, v123, v27
 v_mul_f32 v124, v124, v28
 v_mul_f32 v125, v125, v29
 v_mfma_f32_32x32x16_bf16 v[160:175], a[180:183], a[120:123], v[160:175]
 v_mul_f32 v126, v126, v30
 v_mul_f32 v127, v127, v31
 v_cvt_pk_bf16_f32 v120, 0, v120
 v_cvt_pk_bf16_f32 v121, 0, v121
 v_cvt_pk_bf16_f32 v122, 0, v122
 v_cvt_pk_bf16_f32 v123, 0, v123
 v_mfma_f32_32x32x16_bf16 v[160:175], a[184:187], a[124:127], v[160:175]
 v_cvt_pk_bf16_f32 v124, 0, v124
 v_cvt_pk_bf16_f32 v125, 0, v125
 v_cvt_pk_bf16_f32 v126, 0, v126
 v_cvt_pk_bf16_f32 v127, 0, v127
 v_fma_f32 v120, v120, v248, v128
 v_fma_f32 v121, v121, v249, v129
 s_waitcnt vmcnt(3)
 v_mfma_f32_32x32x16_bf16 v[208:223], a[180:183], v[96:99], v[208:223]
 v_fma_f32 v122, v122, v250, v130
 v_fma_f32 v123, v123, v251, v131
 v_fma_f32 v124, v124, v252, v132
 v_fma_f32 v125, v125, v253, v133
 v_fma_f32 v126, v126, v254, v134
 v_fma_f32 v127, v127, v255, v135
 s_waitcnt vmcnt(2)
 v_mfma_f32_32x32x16_bf16 v[208:223], a[184:187], v[100:103], v[208:223]
 buffer_store_dwordx4 v[120:123], v42, s[20:23], s36 offen offset:0
 buffer_store_dwordx4 v[124:127], v42, s[20:23], s36 offen offset:32
 s_waitcnt vmcnt(3)
 v_mfma_f32_32x32x16_bf16 v[208:223], a[180:183], v[104:107], v[208:223]
 s_waitcnt vmcnt(2)
 v_mfma_f32_32x32x16_bf16 v[208:223], a[184:187], v[108:111], v[208:223]
 v_max_u32 v60, v112, v116
 v_cmp_eq_u32 vcc, -1, v60
 s_nop 1
 s_cmp_lg_u64 vcc, 0
 s_cbranch_scc1 ms2_spin
ms2_back:
 v_mfma_f32_32x32x16_bf16 v[208:223], a[180:183], v[112:115], v[208:223]
 v_mfma_f32_32x32x16_bf16 v[208:223], a[184:187], v[116:119], v[208:223]
 s_nop 7
 s_nop 3
 v_pk_mul_f32 v[208:209], v[208:209], s[40:41]
 v_pk_mul_f32 v[210:211], v[210:211], s[40:41]
 v_pk_mul_f32 v[212:213], v[212:213], s[40:41]
 v_pk_mul_f32 v[214:215], v[214:215], s[40:41]
 v_cvt_pk_bf16_f32 v208, 0, v208
 v_cvt_pk_bf16_f32 v209, 0, v209
 v_cvt_pk_bf16_f32 v210, 0, v210
 v_cvt_pk_bf16_f32 v211, 0, v211
 v_cvt_pk_bf16_f32 v212, 0, v212
 v_cvt_pk_bf16_f32 v213, 0, v213
 v_cvt_pk_bf16_f32 v214, 0, v214
 v_cvt_pk_bf16_f32 v215, 0, v215
 v_pk_add_f32 v[208:209], v[208:209], v[176:177]
 v_pk_add_f32 v[210:211], v[210:211], v[178:179]
 v_pk_add_f32 v[212:213], v[212:213], v[180:181]
 v_pk_add_f32 v[214:215], v[214:215], v[182:183]
 v_cvt_pk_bf16_f32 v208, 0, v208
 v_cvt_pk_bf16_f32 v209, 0, v209
 v_cvt_pk_bf16_f32 v210, 0, v210
 v_cvt_pk_bf16_f32 v211, 0, v211
 v_cvt_pk_bf16_f32 v212, 0, v212
 v_cvt_pk_bf16_f32 v213, 0, v213
 v_cvt_pk_bf16_f32 v214, 0, v214
 v_cvt_pk_bf16_f32 v215, 0, v215
 v_pk_mul_f32 v[192:193], v[208:209], s[70:71]
 v_pk_mul_f32 v[194:195], v[210:211], s[70:71]
 v_pk_mul_f32 v[196:197], v[212:213], s[70:71]
 v_pk_mul_f32 v[198:199], v[214:215], s[70:71]
 v_exp_f32 v192, v192
 v_exp_f32 v193, v193
 v_exp_f32 v194, v194
 v_exp_f32 v195, v195
 v_exp_f32 v196, v196
 v_exp_f32 v197, v197
 v_exp_f32 v198, v198
 v_exp_f32 v199, v199
 v_pk_add_f32 v[192:193], v[192:193], 1.0 op_sel_hi:[1,0]
 v_pk_add_f32 v[194:195], v[194:195], 1.0 op_sel_hi:[1,0]
 v_pk_add_f32 v[196:197], v[196:197], 1.0 op_sel_hi:[1,0]
 v_pk_add_f32 v[198:199], v[198:199], 1.0 op_sel_hi:[1,0]
 v_rcp_f32 v192, v192
 v_rcp_f32 v193, v193
 v_rcp_f32 v194, v194
 v_rcp_f32 v195, v195
 v_rcp_f32 v196, v196
 v_rcp_f32 v197, v197
 v_rcp_f32 v198, v198
 v_rcp_f32 v199, v199
 v_pk_mul_f32 v[208:209], v[208:209], v[192:193]
 v_pk_mul_f32 v[210:211], v[210:211], v[194:195]
 v_pk_mul_f32 v[212:213], v[212:213], v[196:197]
 v_pk_mul_f32 v[214:215], v[214:215], v[198:199]
 v_cvt_pk_bf16_f32 v208, 0, v208
 v_cvt_pk_bf16_f32 v209, 0, v209
 v_cvt_pk_bf16_f32 v210, 0, v210
 v_cvt_pk_bf16_f32 v211, 0, v211
 v_cvt_pk_bf16_f32 v212, 0, v212
 v_cvt_pk_bf16_f32 v213, 0, v213
 v_cvt_pk_bf16_f32 v214, 0, v214
 v_cvt_pk_bf16_f32 v215, 0, v215
 v_pk_fma_f32 v[208:209], v[208:209], v[160:161], v[144:145]
 v_pk_fma_f32 v[210:211], v[210:211], v[162:163], v[146:147]
 v_pk_fma_f32 v[212:213], v[212:213], v[164:165], v[148:149]
 v_pk_fma_f32 v[214:215], v[214:215], v[166:167], v[150:151]
 buffer_store_dwordx4 v[208:211], v42, s[20:23], 0 offen offset:0
 buffer_store_dwordx4 v[212:215], v42, s[20:23], 0 offen offset:32
 v_pk_mul_f32 v[216:217], v[216:217], s[40:41]
 v_pk_mul_f32 v[218:219], v[218:219], s[40:41]
 v_pk_mul_f32 v[220:221], v[220:221], s[40:41]
 v_pk_mul_f32 v[222:223], v[222:223], s[40:41]
 v_cvt_pk_bf16_f32 v216, 0, v216
 v_cvt_pk_bf16_f32 v217, 0, v217
 v_cvt_pk_bf16_f32 v218, 0, v218
 v_cvt_pk_bf16_f32 v219, 0, v219
 v_cvt_pk_bf16_f32 v220, 0, v220
 v_cvt_pk_bf16_f32 v221, 0, v221
 v_cvt_pk_bf16_f32 v222, 0, v222
 v_cvt_pk_bf16_f32 v223, 0, v223
 v_pk_add_f32 v[216:217], v[216:217], v[184:185]
 v_pk_add_f32 v[218:219], v[218:219], v[186:187]
 v_pk_add_f32 v[220:221], v[220:221], v[188:189]
 v_pk_add_f32 v[222:223], v[222:223], v[190:191]
 v_cvt_pk_bf16_f32 v216, 0, v216
 v_cvt_pk_bf16_f32 v217, 0, v217
 v_cvt_pk_bf16_f32 v218, 0, v218
 v_cvt_pk_bf16_f32 v219, 0, v219
 v_cvt_pk_bf16_f32 v220, 0, v220
 v_cvt_pk_bf16_f32 v221, 0, v221
 v_cvt_pk_bf16_f32 v222, 0, v222
 v_cvt_pk_bf16_f32 v223, 0, v223
 v_pk_mul_f32 v[200:201], v[216:217], s[70:71]
 v_pk_mul_f32 v[202:203], v[218:219], s[70:71]
 v_pk_mul_f32 v[204:205], v[220:221], s[70:71]
 v_pk_mul_f32 v[206:207], v[222:223], s[70:71]
 v_exp_f32 v200, v200
 v_exp_f32 v201, v201
 v_exp_f32 v202, v202
 v_exp_f32 v203, v203
 v_exp_f32 v204, v204
 v_exp_f32 v205, v205
 v_exp_f32 v206, v206
 v_exp_f32 v207, v207
 v_pk_add_f32 v[200:201], v[200:201], 1.0 op_sel_hi:[1,0]
 v_pk_add_f32 v[202:203], v[202:203], 1.0 op_sel_hi:[1,0]
 v_pk_add_f32 v[204:205], v[204:205], 1.0 op_sel_hi:[1,0]
 v_pk_add_f32 v[206:207], v[206:207], 1.0 op_sel_hi:[1,0]
 v_rcp_f32 v200, v200
 v_rcp_f32 v201, v201
 v_rcp_f32 v202, v202
 v_rcp_f32 v203, v203
 v_rcp_f32 v204, v204
 v_rcp_f32 v205, v205
 v_rcp_f32 v206, v206
 v_rcp_f32 v207, v207
 v_pk_mul_f32 v[216:217], v[216:217], v[200:201]
 v_pk_mul_f32 v[218:219], v[218:219], v[202:203]
 v_pk_mul_f32 v[220:221], v[220:221], v[204:205]
 v_pk_mul_f32 v[222:223], v[222:223], v[206:207]
 v_cvt_pk_bf16_f32 v216, 0, v216
 v_cvt_pk_bf16_f32 v217, 0, v217
 v_cvt_pk_bf16_f32 v218, 0, v218
 v_cvt_pk_bf16_f32 v219, 0, v219
 v_cvt_pk_bf16_f32 v220, 0, v220
 v_cvt_pk_bf16_f32 v221, 0, v221
 v_cvt_pk_bf16_f32 v222, 0, v222
 v_cvt_pk_bf16_f32 v223, 0, v223
 v_pk_fma_f32 v[216:217], v[216:217], v[168:169], v[152:153]
 v_pk_fma_f32 v[218:219], v[218:219], v[170:171], v[154:155]
 v_pk_fma_f32 v[220:221], v[220:221], v[172:173], v[156:157]
 v_pk_fma_f32 v[222:223], v[222:223], v[174:175], v[158:159]
 buffer_store_dwordx4 v[216:219], v42, s[20:23], 0 offen offset:64
 buffer_store_dwordx4 v[220:223], v42, s[20:23], 0 offen offset:96
 s_endpgm
kab_s:
 s_cmp_lt_u32 s24, 2
 s_cselect_b64 s[8:9], s[56:57], s[58:59]
 s_cselect_b64 s[12:13], s[60:61], s[62:63]
 s_mov_b32 s10, 0xa2000
 s_mul_i32 s81, s26, 5
 s_lshl_b32 s74, s26, 2
 s_mul_i32 s39, s74, 36864
 s_and_b32 s84, s24, 1
 s_lshl_b32 s84, s84, 4
 v_add_u32 v28, s84, v24
 v_mul_u32_u24 v28, 1152, v28
 v_xor_b32 v27, v26, v25
 v_lshl_add_u32 v4, v27, 4, v28
 v_xor_b32 v27, 4, v27
 v_lshl_add_u32 v5, v27, 4, v28
 v_add_u32 v5, 0x2000, v5
 s_lshr_b32 s82, s26, 1
 s_add_u32 s82, s82, 16
 s_lshl_b32 s69, s24, 1
 s_add_u32 s69, s69, s74
 s_cmp_lt_u32 s24, 2
 s_cselect_b32 s69, s69, s82
 s_cselect_b32 s70, 63, 15
 s_cselect_b32 s71, 0, s26
 s_lshl_b32 s69, s69, 1
 s_and_b32 s71, s71, 1
 s_add_u32 s69, s69, s71
 s_lshl_b32 s69, s69, 5
 v_and_b32 v48, s70, v0
 v_lshl_add_u32 v27, v48, 1, s69
 global_load_ushort v44, v27, s[52:53]
 global_load_ushort v45, v27, s[54:55]
 global_load_ushort v46, v27, s[64:65]
 s_mov_b32 s14, 0xa2000
 v_lshlrev_b32 v27, 5, v26
 v_add_u32 v27, s84, v27
 s_and_b32 s69, s25, 7
 v_and_b32 v28, 8, v0
 v_add3_u32 v28, v27, v28, s69
 v_mul_u32_u24 v93, 1152, v28
 v_and_b32 v28, 15, v0
 v_add_u32 v28, v27, v28
 v_mul_u32_u24 v92, 1152, v28
 v_add_u32 v92, s49, v92
 s_add_u32 s50, s49, 128
 s_cmp_eq_u32 s50, 1152
 s_cselect_b32 s50, 0, s50
 s_add_u32 s51, s50, 128
 s_cmp_eq_u32 s51, 1152
 s_cselect_b32 s51, 0, s51
 s_add_u32 s52, s51, 128
 s_cmp_eq_u32 s52, 1152
 s_cselect_b32 s52, 0, s52
 s_add_u32 s53, s52, 128
 s_cmp_eq_u32 s53, 1152
 s_cselect_b32 s53, 0, s53
 s_add_u32 s54, s53, 128
 s_cmp_eq_u32 s54, 1152
 s_cselect_b32 s54, 0, s54
 s_add_u32 s55, s54, 128
 s_cmp_eq_u32 s55, 1152
 s_cselect_b32 s55, 0, s55
 s_add_u32 s56, s55, 128
 s_cmp_eq_u32 s56, 1152
 s_cselect_b32 s56, 0, s56
 s_add_u32 s57, s56, 128
 s_cmp_eq_u32 s57, 1152
 s_cselect_b32 s57, 0, s57
 v_and_b32 v247, 31, v0
 s_add_u32 s69, s32, 0x10000
 v_lshl_add_u32 v247, v247, 7, s69
 v_bfe_u32 v246, v0, 1, 3
 v_lshrrev_b32 v248, 5, v0
 v_xor_b32 v246, v246, v248
 v_lshl_add_u32 v246, v246, 4, v247
 v_xor_b32 v247, 32, v246
 v_xor_b32 v248, 64, v246
 v_xor_b32 v249, 96, v246
 s_mov_b32 s31, 0x3f803f80
 s_add_u32 s40, s39, 0x9000
 s_add_u32 s41, s39, 0x12000
 s_add_u32 s42, s39, 0x1b000
 s_mul_i32 s43, s82, 36864
 s_and_b32 s69, s26, 1
 s_mul_i32 s69, s69, 18432
 s_add_u32 s43, s43, s69
 s_lshl_b32 s0, s24, 10
 v_subrev_u32 v68, 17408, v5
 s_cmp_eq_u32 s84, 0
 s_cselect_b64 vcc, -1, 0
 v_cndmask_b32 v68, v68, v4, vcc
 v_lshrrev_b32 v36, 5, v0
 v_and_b32 v37, 31, v0
 v_bfe_u32 v38, v0, 1, 3
 v_xor_b32 v38, v38, v36
 v_lshlrev_b32 v39, 7, v37
 v_add_u32 v39, 0x3000, v39
 v_xor_b32 v40, 0, v38
 v_lshl_add_u32 v8, v40, 4, v39
 v_add_u32 v12, 0x10000, v8
 v_xor_b32 v40, 2, v38
 v_lshl_add_u32 v9, v40, 4, v39
 v_add_u32 v13, 0x10000, v9
 v_xor_b32 v40, 4, v38
 v_lshl_add_u32 v10, v40, 4, v39
 v_add_u32 v14, 0x10000, v10
 v_xor_b32 v40, 6, v38
 v_lshl_add_u32 v11, v40, 4, v39
 v_add_u32 v15, 0x10000, v11
 v_lshlrev_b32 v34, 4, v37
 v_lshrrev_b32 v48, 5, v48
 s_lshl1_add_u32 s69, s24, 1
 s_cmp_lt_u32 s24, 2
 s_cselect_b32 s69, s69, 0
 v_add_u32 v48, s69, v48
 v_mov_b32 v47, 2.0
 v_lshl_add_u32 v48, v48, 11, v34
 s_lshr_b32 s70, s24, 1
 s_lshl_b32 s70, s70, 10
 s_lshr_b32 s71, s84, 1
 s_add_u32 s70, s70, s71
 s_add_u32 s70, s70, 512
 v_add_u32 v35, s70, v34
 v_mov_b32 v38, 12032
 s_cmp_eq_u32 s24, 0
 s_cselect_b32 s75, 0, 2048
 s_cselect_b64 vcc, -1, 0
 v_cndmask_b32 v35, v35, v38, vcc
 v_mov_b32 v40, 1.0
 v_mov_b32 v41, 0
 ds_write_b64 v38, v[40:41]
 v_mov_b32 v28, 1
 s_lshl_b32 s69, s24, 8
 s_add_u32 s69, s69, 0x2800
 v_lshlrev_b32 v38, 3, v37
 v_add_u32 v22, s69, v38
 v_mov_b32 v40, 0
 ds_write_b64 v38, v[40:41] offset:10240
 ds_write_b64 v38, v[40:41] offset:10496
 ds_write_b64 v38, v[40:41] offset:10752
 s_lshl_b32 s73, s81, 12
 s_add_u32 s73, s73, 0x280000
 s_sub_u32 s69, 15, s25
 s_lshl_b32 s69, s69, 8
 s_add_u32 s69, s69, s73
 v_add_u32 v20, s69, v38
 v_lshl_add_u32 v21, v36, 8, v20
 s_lshl_b32 s69, s24, 10
 v_add_u32 v21, s69, v21
 s_mov_b64 s[76:77], s[4:5]
 s_mov_b32 s79, 0x20000
 s_sub_u32 s69, 4, s24
 v_mul_u32_u24 v58, s69, v36
 v_add_u32 v58, s24, v58
 v_lshl_add_u32 v58, v58, 12, v20
 v_mov_b32 v59, 0
 v_mov_b32 v60, -1
 v_mov_b32 v61, -1
 s_mul_i32 s69, s24, 5120
 s_add_u32 s69, s69, 143360
 v_mul_u32_u24 v38, 80, v37
 s_mul_i32 s1, s24, 5120
 v_lshl_add_u32 v72, v36, 3, v38
 v_add_u32 v72, 0x23040, v72
 v_lshl_add_u32 v38, v36, 5, v38
 v_add_u32 v23, s69, v38
 v_bfe_u32 v38, v0, 2, 2
 v_lshl_add_u32 v39, v36, 3, v38
 v_mul_u32_u24 v39, 80, v39
 v_and_b32 v40, 1, v0
 v_lshl_add_u32 v39, v40, 5, v39
 v_bfe_u32 v40, v0, 4, 1
 v_lshl_add_u32 v39, v40, 4, v39
 v_bfe_u32 v40, v0, 1, 1
 v_lshl_add_u32 v39, v40, 3, v39
 v_add_u32 v3, s69, v39
 v_xor_b32 v38, v38, v36
 v_lshlrev_b32 v39, 6, v37
 v_add_u32 v39, 0x3000, v39
 v_lshl_add_u32 v16, v38, 4, v39
 s_and_b32 s69, s26, 1
 s_lshl_b32 s69, s69, 5
 v_xor_b32 v16, s69, v16
 v_xor_b32 v17, 32, v16
 v_add_u32 v18, 0x10000, v16
 v_add_u32 v19, 0x10000, v17
 v_lshrrev_b32 v38, 2, v0
 v_mul_u32_u24 v38, 1152, v38
 v_lshrrev_b32 v39, 4, v0
 v_and_b32 v40, 3, v0
 v_xor_b32 v39, v39, v40
 v_lshl_add_u32 v39, v39, 4, v38
 s_mul_i32 s69, s84, 2304
 s_lshl_b32 s70, s82, 6
 s_add_u32 s69, s69, s70
 s_lshl_b32 s74, s74, 6
 v_add_u32 v6, s69, v39
 v_add_u32 v7, 0x4400, v6
 s_mul_i32 s58, s49, 272
 s_mul_i32 s44, s49, 576
 s_mul_i32 s59, s50, 272
 s_mul_i32 s45, s50, 576
 s_mul_i32 s60, s51, 272
 s_mul_i32 s46, s51, 576
 s_mul_i32 s61, s52, 272
 s_mul_i32 s47, s52, 576
 s_mul_i32 s62, s53, 272
 s_mul_i32 s33, s53, 576
 s_mul_i32 s63, s54, 272
 s_mul_i32 s36, s54, 576
 s_mul_i32 s64, s55, 272
 s_mul_i32 s37, s55, 576
 s_mul_i32 s65, s56, 272
 s_mul_i32 s83, s56, 576
 s_mul_i32 s66, s57, 272
 s_mul_i32 s81, s57, 576
 s_mul_i32 s69, s80, 313344
 s_add_u32 s69, s69, 0x802200
 s_mul_i32 s70, s26, 2176
 s_add_u32 s70, s70, s69
 v_mul_u32_u24 v29, 17408, v36
 v_lshl_add_u32 v29, v37, 2, v29
 v_add_u32 v29, s70, v29
 v_add_u32 v30, s70, v1
 v_add_u32 v31, 17408, v30
 s_add_u32 s80, s74, 36864
 v_lshrrev_b32 v66, 3, v0
 v_mul_u32_u24 v66, 17280, v66
 v_add_u32 v66, v66, v30
 v_mov_b32 v62, 0
 v_mov_b32 v63, 0
 v_mov_b32 v64, 0
 v_mov_b32 v65, 0
 s_add_u32 s71, s26, 12
 s_lshl_b32 s69, s25, 4
 s_add_u32 s69, s69, s71
 v_mov_b32 v32, s69
 v_and_b32 v38, 15, v0
 v_lshl_add_u32 v33, v38, 4, s71
 s_mov_b32 s84, 0
 s_mov_b32 s85, -1
 s_add_u32 s29, s29, 128
 s_cmp_eq_u32 s29, s30
 s_cselect_b32 s29, s38, s29
 s_add_u32 m0, s32, 0x12000
 s_nop 0
 buffer_load_dwordx4 v242, s[16:19], s29 offen offset:0 lds
 buffer_load_dwordx4 v243, s[16:19], s29 offen offset:1024 lds
 buffer_load_dwordx4 v244, s[16:19], s29 offen offset:2048 lds
 buffer_load_dwordx4 v245, s[16:19], s29 offen offset:3072 lds
 s_add_u32 s29, s29, 128
 s_cmp_eq_u32 s29, s30
 s_cselect_b32 s29, s38, s29
 s_add_u32 m0, s32, 0x13000
 s_nop 0
 buffer_load_dwordx4 v242, s[16:19], s29 offen offset:0 lds
 buffer_load_dwordx4 v243, s[16:19], s29 offen offset:1024 lds
 buffer_load_dwordx4 v244, s[16:19], s29 offen offset:2048 lds
 buffer_load_dwordx4 v245, s[16:19], s29 offen offset:3072 lds
 s_waitcnt vmcnt(15)
 ds_read_b128 v[98:101], v246 offset:0
 ds_read_b128 v[102:105], v247 offset:0
 ds_read_b128 v[106:109], v248 offset:0
 ds_read_b128 v[110:113], v249 offset:0
 s_add_u32 s29, s29, 128
 s_cmp_eq_u32 s29, s30
 s_cselect_b32 s29, s38, s29
 s_add_u32 m0, s32, 0x14000
 s_nop 0
 buffer_load_dwordx4 v242, s[16:19], s29 offen offset:0 lds
 buffer_load_dwordx4 v243, s[16:19], s29 offen offset:1024 lds
 buffer_load_dwordx4 v244, s[16:19], s29 offen offset:2048 lds
 buffer_load_dwordx4 v245, s[16:19], s29 offen offset:3072 lds
 s_waitcnt vmcnt(15)
 ds_read_b128 v[114:117], v246 offset:4096
 ds_read_b128 v[118:121], v247 offset:4096
 ds_read_b128 v[122:125], v248 offset:4096
 ds_read_b128 v[126:129], v249 offset:4096
 s_waitcnt lgkmcnt(7)
 v_dot2_f32_bf16 v250, s31, v98, 0
 v_dot2_f32_bf16 v252, v98, v98, 0
 v_dot2_f32_bf16 v251, s31, v99, 0
 v_dot2_f32_bf16 v253, v99, v99, 0
 v_dot2c_f32_bf16 v250, s31, v100
 v_dot2c_f32_bf16 v252, v100, v100
 s_add_u32 s29, s29, 128
 s_cmp_eq_u32 s29, s30
 s_cselect_b32 s29, s38, s29
 s_add_u32 m0, s32, 0x15000
 s_nop 0
 buffer_load_dwordx4 v242, s[16:19], s29 offen offset:0 lds
 v_dot2c_f32_bf16 v251, s31, v101
 v_dot2c_f32_bf16 v253, v101, v101
 s_waitcnt lgkmcnt(6)
 v_dot2c_f32_bf16 v250, s31, v102
 v_dot2c_f32_bf16 v252, v102, v102
 v_dot2c_f32_bf16 v251, s31, v103
 v_dot2c_f32_bf16 v253, v103, v103
 buffer_load_dwordx4 v243, s[16:19], s29 offen offset:1024 lds
 v_dot2c_f32_bf16 v250, s31, v104
 v_dot2c_f32_bf16 v252, v104, v104
 v_dot2c_f32_bf16 v251, s31, v105
 v_dot2c_f32_bf16 v253, v105, v105
 s_waitcnt lgkmcnt(5)
 v_dot2c_f32_bf16 v250, s31, v106
 v_dot2c_f32_bf16 v252, v106, v106
 buffer_load_dwordx4 v244, s[16:19], s29 offen offset:2048 lds
 v_dot2c_f32_bf16 v251, s31, v107
 v_dot2c_f32_bf16 v253, v107, v107
 v_dot2c_f32_bf16 v250, s31, v108
 v_dot2c_f32_bf16 v252, v108, v108
 v_dot2c_f32_bf16 v251, s31, v109
 v_dot2c_f32_bf16 v253, v109, v109
 buffer_load_dwordx4 v245, s[16:19], s29 offen offset:3072 lds
 s_waitcnt lgkmcnt(4)
 v_dot2c_f32_bf16 v250, s31, v110
 v_dot2c_f32_bf16 v252, v110, v110
 v_dot2c_f32_bf16 v251, s31, v111
 v_dot2c_f32_bf16 v253, v111, v111
 v_dot2c_f32_bf16 v250, s31, v112
 v_dot2c_f32_bf16 v252, v112, v112
 v_dot2c_f32_bf16 v251, s31, v113
 v_dot2c_f32_bf16 v253, v113, v113
 s_waitcnt vmcnt(12)
 ds_read_b128 v[130:133], v246 offset:8192
 ds_read_b128 v[134:137], v247 offset:8192
 ds_read_b128 v[138:141], v248 offset:8192
 ds_read_b128 v[142:145], v249 offset:8192
 s_waitcnt lgkmcnt(7)
 v_dot2c_f32_bf16 v250, s31, v114
 v_dot2c_f32_bf16 v252, v114, v114
 v_dot2c_f32_bf16 v251, s31, v115
 v_dot2c_f32_bf16 v253, v115, v115
 v_dot2c_f32_bf16 v250, s31, v116
 v_dot2c_f32_bf16 v252, v116, v116
 s_add_u32 s29, s29, 128
 s_cmp_eq_u32 s29, s30
 s_cselect_b32 s29, s38, s29
 s_add_u32 m0, s32, 0x10000
 s_nop 0
 buffer_load_dwordx4 v242, s[16:19], s29 offen offset:0 lds
 v_dot2c_f32_bf16 v251, s31, v117
 v_dot2c_f32_bf16 v253, v117, v117
 s_waitcnt lgkmcnt(6)
 v_dot2c_f32_bf16 v250, s31, v118
 v_dot2c_f32_bf16 v252, v118, v118
 v_dot2c_f32_bf16 v251, s31, v119
 v_dot2c_f32_bf16 v253, v119, v119
 buffer_load_dwordx4 v243, s[16:19], s29 offen offset:1024 lds
 v_dot2c_f32_bf16 v250, s31, v120
 v_dot2c_f32_bf16 v252, v120, v120
 v_dot2c_f32_bf16 v251, s31, v121
 v_dot2c_f32_bf16 v253, v121, v121
 s_waitcnt lgkmcnt(5)
 v_dot2c_f32_bf16 v250, s31, v122
 v_dot2c_f32_bf16 v252, v122, v122
 buffer_load_dwordx4 v244, s[16:19], s29 offen offset:2048 lds
 v_dot2c_f32_bf16 v251, s31, v123
 v_dot2c_f32_bf16 v253, v123, v123
 v_dot2c_f32_bf16 v250, s31, v124
 v_dot2c_f32_bf16 v252, v124, v124
 v_dot2c_f32_bf16 v251, s31, v125
 v_dot2c_f32_bf16 v253, v125, v125
 buffer_load_dwordx4 v245, s[16:19], s29 offen offset:3072 lds
 s_waitcnt lgkmcnt(4)
 v_dot2c_f32_bf16 v250, s31, v126
 v_dot2c_f32_bf16 v252, v126, v126
 v_dot2c_f32_bf16 v251, s31, v127
 v_dot2c_f32_bf16 v253, v127, v127
 v_dot2c_f32_bf16 v250, s31, v128
 v_dot2c_f32_bf16 v252, v128, v128
 v_dot2c_f32_bf16 v251, s31, v129
 v_dot2c_f32_bf16 v253, v129, v129
 s_waitcnt vmcnt(12)
 ds_read_b128 v[146:149], v246 offset:12288
 ds_read_b128 v[150:153], v247 offset:12288
 ds_read_b128 v[154:157], v248 offset:12288
 ds_read_b128 v[158:161], v249 offset:12288
 s_waitcnt lgkmcnt(7)
 v_dot2c_f32_bf16 v250, s31, v130
 v_dot2c_f32_bf16 v252, v130, v130
 v_dot2c_f32_bf16 v251, s31, v131
 v_dot2c_f32_bf16 v253, v131, v131
 v_dot2c_f32_bf16 v250, s31, v132
 v_dot2c_f32_bf16 v252, v132, v132
 s_add_u32 s29, s29, 128
 s_cmp_eq_u32 s29, s30
 s_cselect_b32 s29, s38, s29
 s_add_u32 m0, s32, 0x11000
 s_nop 0
 buffer_load_dwordx4 v242, s[16:19], s29 offen offset:0 lds
 v_dot2c_f32_bf16 v251, s31, v133
 v_dot2c_f32_bf16 v253, v133, v133
 s_waitcnt lgkmcnt(6)
 v_dot2c_f32_bf16 v250, s31, v134
 v_dot2c_f32_bf16 v252, v134, v134
 v_dot2c_f32_bf16 v251, s31, v135
 v_dot2c_f32_bf16 v253, v135, v135
 buffer_load_dwordx4 v243, s[16:19], s29 offen offset:1024 lds
 v_dot2c_f32_bf16 v250, s31, v136
 v_dot2c_f32_bf16 v252, v136, v136
 v_dot2c_f32_bf16 v251, s31, v137
 v_dot2c_f32_bf16 v253, v137, v137
 s_waitcnt lgkmcnt(5)
 v_dot2c_f32_bf16 v250, s31, v138
 v_dot2c_f32_bf16 v252, v138, v138
 buffer_load_dwordx4 v244, s[16:19], s29 offen offset:2048 lds
 v_dot2c_f32_bf16 v251, s31, v139
 v_dot2c_f32_bf16 v253, v139, v139
 v_dot2c_f32_bf16 v250, s31, v140
 v_dot2c_f32_bf16 v252, v140, v140
 v_dot2c_f32_bf16 v251, s31, v141
 v_dot2c_f32_bf16 v253, v141, v141
 buffer_load_dwordx4 v245, s[16:19], s29 offen offset:3072 lds
 s_waitcnt lgkmcnt(4)
 v_dot2c_f32_bf16 v250, s31, v142
 v_dot2c_f32_bf16 v252, v142, v142
 v_dot2c_f32_bf16 v251, s31, v143
 v_dot2c_f32_bf16 v253, v143, v143
 v_dot2c_f32_bf16 v250, s31, v144
 v_dot2c_f32_bf16 v252, v144, v144
 v_dot2c_f32_bf16 v251, s31, v145
 v_dot2c_f32_bf16 v253, v145, v145
 s_waitcnt vmcnt(12)
 ds_read_b128 v[162:165], v246 offset:16384
 ds_read_b128 v[166:169], v247 offset:16384
 ds_read_b128 v[170:173], v248 offset:16384
 ds_read_b128 v[174:177], v249 offset:16384
 s_waitcnt lgkmcnt(7)
 v_dot2c_f32_bf16 v250, s31, v146
 v_dot2c_f32_bf16 v252, v146, v146
 v_dot2c_f32_bf16 v251, s31, v147
 v_dot2c_f32_bf16 v253, v147, v147
 v_dot2c_f32_bf16 v250, s31, v148
 v_dot2c_f32_bf16 v252, v148, v148
 s_add_u32 s29, s29, 128
 s_cmp_eq_u32 s29, s30
 s_cselect_b32 s29, s38, s29
 s_add_u32 m0, s32, 0x12000
 s_nop 0
 buffer_load_dwordx4 v242, s[16:19], s29 offen offset:0 lds
 v_dot2c_f32_bf16 v251, s31, v149
 v_dot2c_f32_bf16 v253, v149, v149
 s_waitcnt lgkmcnt(6)
 v_dot2c_f32_bf16 v250, s31, v150
 v_dot2c_f32_bf16 v252, v150, v150
 v_dot2c_f32_bf16 v251, s31, v151
 v_dot2c_f32_bf16 v253, v151, v151
 buffer_load_dwordx4 v243, s[16:19], s29 offen offset:1024 lds
 v_dot2c_f32_bf16 v250, s31, v152
 v_dot2c_f32_bf16 v252, v152, v152
 v_dot2c_f32_bf16 v251, s31, v153
 v_dot2c_f32_bf16 v253, v153, v153
 s_waitcnt lgkmcnt(5)
 v_dot2c_f32_bf16 v250, s31, v154
 v_dot2c_f32_bf16 v252, v154, v154
 buffer_load_dwordx4 v244, s[16:19], s29 offen offset:2048 lds
 v_dot2c_f32_bf16 v251, s31, v155
 v_dot2c_f32_bf16 v253, v155, v155
 v_dot2c_f32_bf16 v250, s31, v156
 v_dot2c_f32_bf16 v252, v156, v156
 v_dot2c_f32_bf16 v251, s31, v157
 v_dot2c_f32_bf16 v253, v157, v157
 buffer_load_dwordx4 v245, s[16:19], s29 offen offset:3072 lds
 s_waitcnt lgkmcnt(4)
 v_dot2c_f32_bf16 v250, s31, v158
 v_dot2c_f32_bf16 v252, v158, v158
 v_dot2c_f32_bf16 v251, s31, v159
 v_dot2c_f32_bf16 v253, v159, v159
 v_dot2c_f32_bf16 v250, s31, v160
 v_dot2c_f32_bf16 v252, v160, v160
 v_dot2c_f32_bf16 v251, s31, v161
 v_dot2c_f32_bf16 v253, v161, v161
 v_lshlrev_b32 v36, 16, v44
 v_lshlrev_b32 v37, 16, v45
 v_lshlrev_b32 v38, 16, v46
 v_xor_b32 v37, 0x80000000, v37
 v_mul_f32 v38, 0x3fb8aa3b, v38
 v_exp_f32 v38, v38
 v_mul_f32 v43, v36, v36
 v_cvt_pk_bf16_f32 v38, 0, v38
 v_mul_f32 v39, v38, v36
 v_mul_f32 v40, v38, v37
 v_mul_f32 v39, 0x3fb8aa3b, v39
 v_mul_f32 v40, 0x3e22f983, v40
 v_fract_f32 v40, v40
 v_exp_f32 v39, v39
 v_cos_f32 v41, v40
 v_sin_f32 v42, v40
 v_fma_f32 v43, v37, v37, v43
 v_mul_f32 v74, v39, v41
 v_mul_f32 v75, v39, v42
 v_rcp_f32 v43, v43
 v_add_f32 v38, -1.0, v74
 v_mul_f32 v43, v47, v43
 v_mul_f32 v39, v38, v36
 v_mul_f32 v40, v75, v36
 v_fma_f32 v39, v75, v37, v39
 v_fma_f32 v40, -v38, v37, v40
 v_mul_f32 v76, v39, v43
 v_mul_f32 v77, v40, v43
 v_mul_f32 v36, v74, v74
 v_mul_f32 v37, v74, v75
 v_fma_f32 v36, -v75, v75, v36
 v_fma_f32 v37, v75, v74, v37
 v_mul_f32 v38, v36, v36
 v_mul_f32 v39, v36, v37
 v_fma_f32 v38, -v37, v37, v38
 v_fma_f32 v39, v37, v36, v39
 v_mul_f32 v36, v38, v38
 v_mul_f32 v37, v38, v39
 v_fma_f32 v36, -v39, v39, v36
 v_fma_f32 v37, v39, v38, v37
 v_mul_f32 v78, v36, v36
 v_mul_f32 v79, v36, v37
 v_fma_f32 v78, -v37, v37, v78
 v_fma_f32 v79, v37, v36, v79
 v_mul_f32 v80, v78, v78
 v_mul_f32 v81, v78, v79
 v_fma_f32 v80, -v79, v79, v80
 v_fma_f32 v81, v79, v78, v81
 v_mul_f32 v86, v80, v80
 v_mul_f32 v87, v80, v81
 v_fma_f32 v86, -v81, v81, v86
 v_fma_f32 v87, v81, v80, v87
 v_mul_f32 v82, v86, v86
 v_mul_f32 v83, v86, v87
 v_fma_f32 v82, -v87, v87, v82
 v_fma_f32 v83, v87, v86, v83
 v_mul_f32 v84, v82, v82
 v_mul_f32 v85, v82, v83
 v_fma_f32 v84, -v83, v83, v84
 v_fma_f32 v85, v83, v82, v85
 v_mul_f32 v88, v86, v80
 v_mul_f32 v89, v86, v81
 v_fma_f32 v88, -v87, v81, v88
 v_fma_f32 v89, v87, v80, v89
 ds_write_b128 v48, v[74:77] offset:0
 ds_write_b128 v48, v[78:81] offset:512
 ds_write_b128 v48, v[82:85] offset:1024
 ds_write_b128 v48, v[86:89] offset:1536
 s_waitcnt vmcnt(12)
 ds_read_b128 v[178:181], v246 offset:20480
 ds_read_b128 v[182:185], v247 offset:20480
 ds_read_b128 v[186:189], v248 offset:20480
 ds_read_b128 v[190:193], v249 offset:20480
 s_waitcnt lgkmcnt(11)
 v_dot2c_f32_bf16 v250, s31, v162
 v_dot2c_f32_bf16 v252, v162, v162
 v_dot2c_f32_bf16 v251, s31, v163
 v_dot2c_f32_bf16 v253, v163, v163
 v_dot2c_f32_bf16 v250, s31, v164
 v_dot2c_f32_bf16 v252, v164, v164
 v_dot2c_f32_bf16 v251, s31, v165
 v_dot2c_f32_bf16 v253, v165, v165
 s_waitcnt lgkmcnt(10)
 v_dot2c_f32_bf16 v250, s31, v166
 v_dot2c_f32_bf16 v252, v166, v166
 v_dot2c_f32_bf16 v251, s31, v167
 v_dot2c_f32_bf16 v253, v167, v167
 v_dot2c_f32_bf16 v250, s31, v168
 v_dot2c_f32_bf16 v252, v168, v168
 v_dot2c_f32_bf16 v251, s31, v169
 v_dot2c_f32_bf16 v253, v169, v169
 buffer_store_dwordx2 v[60:61], v58, s[4:7], 0 offen sc1
 s_waitcnt lgkmcnt(9)
 v_dot2c_f32_bf16 v250, s31, v170
 v_dot2c_f32_bf16 v252, v170, v170
 v_dot2c_f32_bf16 v251, s31, v171
 v_dot2c_f32_bf16 v253, v171, v171
 v_dot2c_f32_bf16 v250, s31, v172
 v_dot2c_f32_bf16 v252, v172, v172
 v_dot2c_f32_bf16 v251, s31, v173
 v_dot2c_f32_bf16 v253, v173, v173
 s_waitcnt lgkmcnt(8)
 v_dot2c_f32_bf16 v250, s31, v174
 v_dot2c_f32_bf16 v252, v174, v174
 v_dot2c_f32_bf16 v251, s31, v175
 v_dot2c_f32_bf16 v253, v175, v175
 v_dot2c_f32_bf16 v250, s31, v176
 v_dot2c_f32_bf16 v252, v176, v176
 v_dot2c_f32_bf16 v251, s31, v177
 v_dot2c_f32_bf16 v253, v177, v177
 s_waitcnt vmcnt(9)
 ds_read_b128 v[194:197], v246 offset:0
 ds_read_b128 v[198:201], v247 offset:0
 ds_read_b128 v[202:205], v248 offset:0
 ds_read_b128 v[206:209], v249 offset:0
 s_waitcnt lgkmcnt(7)
 v_dot2c_f32_bf16 v250, s31, v178
 v_dot2c_f32_bf16 v252, v178, v178
 v_dot2c_f32_bf16 v251, s31, v179
 v_dot2c_f32_bf16 v253, v179, v179
 v_dot2c_f32_bf16 v250, s31, v180
 v_dot2c_f32_bf16 v252, v180, v180
 v_dot2c_f32_bf16 v251, s31, v181
 v_dot2c_f32_bf16 v253, v181, v181
 s_waitcnt lgkmcnt(6)
 v_dot2c_f32_bf16 v250, s31, v182
 v_dot2c_f32_bf16 v252, v182, v182
 s_add_u32 s48, s43, s49
 s_add_u32 m0, s0, 0x3000
 s_nop 0
 buffer_load_dwordx4 v68, s[8:11], s48 offen lds
 v_dot2c_f32_bf16 v251, s31, v183
 v_dot2c_f32_bf16 v253, v183, v183
 v_dot2c_f32_bf16 v250, s31, v184
 v_dot2c_f32_bf16 v252, v184, v184
 v_dot2c_f32_bf16 v251, s31, v185
 v_dot2c_f32_bf16 v253, v185, v185
 s_waitcnt lgkmcnt(5)
 v_dot2c_f32_bf16 v250, s31, v186
 v_dot2c_f32_bf16 v252, v186, v186
 v_dot2c_f32_bf16 v251, s31, v187
 v_dot2c_f32_bf16 v253, v187, v187
 s_add_u32 s48, s43, s50
 s_add_u32 m0, s0, 0x4000
 s_nop 0
 buffer_load_dwordx4 v68, s[8:11], s48 offen lds
 v_dot2c_f32_bf16 v250, s31, v188
 v_dot2c_f32_bf16 v252, v188, v188
 v_dot2c_f32_bf16 v251, s31, v189
 v_dot2c_f32_bf16 v253, v189, v189
 s_waitcnt lgkmcnt(4)
 v_dot2c_f32_bf16 v250, s31, v190
 v_dot2c_f32_bf16 v252, v190, v190
 v_dot2c_f32_bf16 v251, s31, v191
 v_dot2c_f32_bf16 v253, v191, v191
 v_dot2c_f32_bf16 v250, s31, v192
 v_dot2c_f32_bf16 v252, v192, v192
 v_dot2c_f32_bf16 v251, s31, v193
 v_dot2c_f32_bf16 v253, v193, v193
 s_waitcnt vmcnt(7)
 ds_read_b128 v[210:213], v246 offset:4096
 ds_read_b128 v[214:217], v247 offset:4096
 ds_read_b128 v[218:221], v248 offset:4096
 ds_read_b128 v[222:225], v249 offset:4096
 s_waitcnt lgkmcnt(7)
 v_dot2c_f32_bf16 v250, s31, v194
 v_dot2c_f32_bf16 v252, v194, v194
 v_dot2c_f32_bf16 v251, s31, v195
 v_dot2c_f32_bf16 v253, v195, v195
 v_dot2c_f32_bf16 v250, s31, v196
 v_dot2c_f32_bf16 v252, v196, v196
 v_dot2c_f32_bf16 v251, s31, v197
 v_dot2c_f32_bf16 v253, v197, v197
 s_waitcnt lgkmcnt(6)
 v_dot2c_f32_bf16 v250, s31, v198
 v_dot2c_f32_bf16 v252, v198, v198
 s_add_u32 s48, s43, s51
 s_add_u32 m0, s0, 0x5000
 s_nop 0
 buffer_load_dwordx4 v68, s[8:11], s48 offen lds
 v_dot2c_f32_bf16 v251, s31, v199
 v_dot2c_f32_bf16 v253, v199, v199
 v_dot2c_f32_bf16 v250, s31, v200
 v_dot2c_f32_bf16 v252, v200, v200
 v_dot2c_f32_bf16 v251, s31, v201
 v_dot2c_f32_bf16 v253, v201, v201
 s_waitcnt lgkmcnt(5)
 v_dot2c_f32_bf16 v250, s31, v202
 v_dot2c_f32_bf16 v252, v202, v202
 v_dot2c_f32_bf16 v251, s31, v203
 v_dot2c_f32_bf16 v253, v203, v203
 s_add_u32 s48, s43, s52
 s_add_u32 m0, s0, 0x6000
 s_nop 0
 buffer_load_dwordx4 v68, s[8:11], s48 offen lds
 v_dot2c_f32_bf16 v250, s31, v204
 v_dot2c_f32_bf16 v252, v204, v204
 v_dot2c_f32_bf16 v251, s31, v205
 v_dot2c_f32_bf16 v253, v205, v205
 s_waitcnt lgkmcnt(4)
 v_dot2c_f32_bf16 v250, s31, v206
 v_dot2c_f32_bf16 v252, v206, v206
 v_dot2c_f32_bf16 v251, s31, v207
 v_dot2c_f32_bf16 v253, v207, v207
 v_dot2c_f32_bf16 v250, s31, v208
 v_dot2c_f32_bf16 v252, v208, v208
 v_dot2c_f32_bf16 v251, s31, v209
 v_dot2c_f32_bf16 v253, v209, v209
 s_waitcnt vmcnt(5)
 ds_read_b128 v[226:229], v246 offset:8192
 ds_read_b128 v[230:233], v247 offset:8192
 ds_read_b128 v[234:237], v248 offset:8192
 ds_read_b128 v[238:241], v249 offset:8192
 s_waitcnt lgkmcnt(7)
 v_dot2c_f32_bf16 v250, s31, v210
 v_dot2c_f32_bf16 v252, v210, v210
 v_dot2c_f32_bf16 v251, s31, v211
 v_dot2c_f32_bf16 v253, v211, v211
 v_dot2c_f32_bf16 v250, s31, v212
 v_dot2c_f32_bf16 v252, v212, v212
 v_dot2c_f32_bf16 v251, s31, v213
 v_dot2c_f32_bf16 v253, v213, v213
 s_waitcnt lgkmcnt(6)
 v_dot2c_f32_bf16 v250, s31, v214
 v_dot2c_f32_bf16 v252, v214, v214
 s_add_u32 s48, s43, s53
 s_add_u32 m0, s0, 0x7000
 s_nop 0
 buffer_load_dwordx4 v68, s[8:11], s48 offen lds
 v_dot2c_f32_bf16 v251, s31, v215
 v_dot2c_f32_bf16 v253, v215, v215
 v_dot2c_f32_bf16 v250, s31, v216
 v_dot2c_f32_bf16 v252, v216, v216
 v_dot2c_f32_bf16 v251, s31, v217
 v_dot2c_f32_bf16 v253, v217, v217
 s_waitcnt lgkmcnt(5)
 v_dot2c_f32_bf16 v250, s31, v218
 v_dot2c_f32_bf16 v252, v218, v218
 v_dot2c_f32_bf16 v251, s31, v219
 v_dot2c_f32_bf16 v253, v219, v219
 s_add_u32 s48, s43, s54
 s_add_u32 m0, s0, 0x8000
 s_nop 0
 buffer_load_dwordx4 v68, s[8:11], s48 offen lds
 v_dot2c_f32_bf16 v250, s31, v220
 v_dot2c_f32_bf16 v252, v220, v220
 v_dot2c_f32_bf16 v251, s31, v221
 v_dot2c_f32_bf16 v253, v221, v221
 s_waitcnt lgkmcnt(4)
 v_dot2c_f32_bf16 v250, s31, v222
 v_dot2c_f32_bf16 v252, v222, v222
 v_dot2c_f32_bf16 v251, s31, v223
 v_dot2c_f32_bf16 v253, v223, v223
 v_dot2c_f32_bf16 v250, s31, v224
 v_dot2c_f32_bf16 v252, v224, v224
 v_dot2c_f32_bf16 v251, s31, v225
 v_dot2c_f32_bf16 v253, v225, v225
 s_waitcnt lgkmcnt(3)
 v_dot2c_f32_bf16 v250, s31, v226
 v_dot2c_f32_bf16 v251, s31, v227
 v_dot2c_f32_bf16 v250, s31, v228
 v_dot2c_f32_bf16 v251, s31, v229
 s_waitcnt lgkmcnt(2)
 v_dot2c_f32_bf16 v250, s31, v230
 v_dot2c_f32_bf16 v251, s31, v231
 v_dot2c_f32_bf16 v250, s31, v232
 v_dot2c_f32_bf16 v251, s31, v233
 s_waitcnt lgkmcnt(1)
 v_dot2c_f32_bf16 v250, s31, v234
 v_dot2c_f32_bf16 v251, s31, v235
 v_dot2c_f32_bf16 v250, s31, v236
 v_dot2c_f32_bf16 v251, s31, v237
 s_waitcnt lgkmcnt(0)
 v_dot2c_f32_bf16 v250, s31, v238
 v_dot2c_f32_bf16 v251, s31, v239
 v_dot2c_f32_bf16 v250, s31, v240
 v_dot2c_f32_bf16 v251, s31, v241
 v_dot2c_f32_bf16 v252, v226, v226
 v_dot2c_f32_bf16 v253, v227, v227
 v_dot2c_f32_bf16 v252, v228, v228
 v_add_f32 v250, v250, v251
 v_dot2c_f32_bf16 v253, v229, v229
 v_dot2c_f32_bf16 v252, v230, v230
 v_mov_b32 v251, v250
 v_dot2c_f32_bf16 v253, v231, v231
 v_dot2c_f32_bf16 v252, v232, v232
 v_permlane32_swap_b32 v250, v251
 v_dot2c_f32_bf16 v253, v233, v233
 v_dot2c_f32_bf16 v252, v234, v234
 v_add_f32 v250, v250, v251
 v_dot2c_f32_bf16 v253, v235, v235
 v_dot2c_f32_bf16 v252, v236, v236
 v_mul_f32 v250, 0xbae38e39, v250
 v_dot2c_f32_bf16 v253, v237, v237
 v_dot2c_f32_bf16 v252, v238, v238
 v_cvt_pk_bf16_f32 v255, 0, v250
 v_dot2c_f32_bf16 v253, v239, v239
 v_dot2c_f32_bf16 v252, v240, v240
 v_dot2c_f32_bf16 v253, v241, v241
 s_nop 2
 v_add_f32 v252, v252, v253
 v_mov_b32 v253, v252
 s_nop 1
 v_permlane32_swap_b32 v252, v253
 v_add_f32 v252, v252, v253
 v_mul_f32 v252, 0x3ae38e39, v252
 v_fma_f32 v252, -v250, v250, v252
 v_max_f32 v252, 0, v252
 v_cvt_pk_bf16_f32 v252, 0, v252
 v_add_f32 v252, 0x3727c5ac, v252
 v_cvt_pk_bf16_f32 v252, 0, v252
 v_sqrt_f32 v252, v252
 s_nop 0
 v_cvt_pk_bf16_f32 v252, 0, v252
 v_rcp_f32 v254, v252
 s_nop 0
 v_cvt_pk_bf16_f32 v254, 0, v254
 v_lshrrev_b32 v253, 16, v254
 v_mul_f32 v255, v255, v254
 v_dot2_f32_bf16 v36, v98, v253, v255
 v_dot2_f32_bf16 v37, v98, v254, v255
 v_dot2_f32_bf16 v38, v99, v253, v255
 v_dot2_f32_bf16 v39, v99, v254, v255
 v_dot2_f32_bf16 v40, v100, v253, v255
 v_dot2_f32_bf16 v41, v100, v254, v255
 v_dot2_f32_bf16 v42, v101, v253, v255
 v_dot2_f32_bf16 v43, v101, v254, v255
 v_cvt_pk_bf16_f32 v98, v36, v37
 v_cvt_pk_bf16_f32 v99, v38, v39
 v_cvt_pk_bf16_f32 v100, v40, v41
 v_cvt_pk_bf16_f32 v101, v42, v43
 v_dot2_f32_bf16 v36, v102, v253, v255
 v_dot2_f32_bf16 v37, v102, v254, v255
 v_dot2_f32_bf16 v38, v103, v253, v255
 v_dot2_f32_bf16 v39, v103, v254, v255
 v_dot2_f32_bf16 v40, v104, v253, v255
 v_dot2_f32_bf16 v41, v104, v254, v255
 v_dot2_f32_bf16 v42, v105, v253, v255
 v_dot2_f32_bf16 v43, v105, v254, v255
 v_cvt_pk_bf16_f32 v102, v36, v37
 v_cvt_pk_bf16_f32 v103, v38, v39
 v_cvt_pk_bf16_f32 v104, v40, v41
 v_cvt_pk_bf16_f32 v105, v42, v43
 v_accvgpr_write_b32 a0, v98
 v_accvgpr_write_b32 a1, v99
 v_accvgpr_write_b32 a2, v100
 v_accvgpr_write_b32 a3, v101
 v_dot2_f32_bf16 v36, v106, v253, v255
 v_dot2_f32_bf16 v37, v106, v254, v255
 v_dot2_f32_bf16 v38, v107, v253, v255
 v_dot2_f32_bf16 v39, v107, v254, v255
 v_dot2_f32_bf16 v40, v108, v253, v255
 v_dot2_f32_bf16 v41, v108, v254, v255
 v_dot2_f32_bf16 v42, v109, v253, v255
 v_dot2_f32_bf16 v43, v109, v254, v255
 v_cvt_pk_bf16_f32 v106, v36, v37
 v_cvt_pk_bf16_f32 v107, v38, v39
 v_cvt_pk_bf16_f32 v108, v40, v41
 v_cvt_pk_bf16_f32 v109, v42, v43
 v_accvgpr_write_b32 a4, v102
 v_accvgpr_write_b32 a5, v103
 v_accvgpr_write_b32 a6, v104
 v_accvgpr_write_b32 a7, v105
 v_dot2_f32_bf16 v36, v110, v253, v255
 v_dot2_f32_bf16 v37, v110, v254, v255
 v_dot2_f32_bf16 v38, v111, v253, v255
 v_dot2_f32_bf16 v39, v111, v254, v255
 v_dot2_f32_bf16 v40, v112, v253, v255
 v_dot2_f32_bf16 v41, v112, v254, v255
 v_dot2_f32_bf16 v42, v113, v253, v255
 v_dot2_f32_bf16 v43, v113, v254, v255
 s_add_u32 s48, s43, s55
 s_add_u32 m0, s0, 0x9000
 s_nop 0
 buffer_load_dwordx4 v68, s[8:11], s48 offen lds
 v_cvt_pk_bf16_f32 v110, v36, v37
 v_cvt_pk_bf16_f32 v111, v38, v39
 v_cvt_pk_bf16_f32 v112, v40, v41
 v_cvt_pk_bf16_f32 v113, v42, v43
 v_accvgpr_write_b32 a8, v106
 v_accvgpr_write_b32 a9, v107
 v_accvgpr_write_b32 a10, v108
 v_accvgpr_write_b32 a11, v109
 v_dot2_f32_bf16 v36, v114, v253, v255
 v_dot2_f32_bf16 v37, v114, v254, v255
 v_dot2_f32_bf16 v38, v115, v253, v255
 v_dot2_f32_bf16 v39, v115, v254, v255
 v_dot2_f32_bf16 v40, v116, v253, v255
 v_dot2_f32_bf16 v41, v116, v254, v255
 v_dot2_f32_bf16 v42, v117, v253, v255
 v_dot2_f32_bf16 v43, v117, v254, v255
 v_cvt_pk_bf16_f32 v114, v36, v37
 v_cvt_pk_bf16_f32 v115, v38, v39
 v_cvt_pk_bf16_f32 v116, v40, v41
 v_cvt_pk_bf16_f32 v117, v42, v43
 v_accvgpr_write_b32 a12, v110
 v_accvgpr_write_b32 a13, v111
 v_accvgpr_write_b32 a14, v112
 v_accvgpr_write_b32 a15, v113
 v_dot2_f32_bf16 v36, v118, v253, v255
 v_dot2_f32_bf16 v37, v118, v254, v255
 v_dot2_f32_bf16 v38, v119, v253, v255
 v_dot2_f32_bf16 v39, v119, v254, v255
 v_dot2_f32_bf16 v40, v120, v253, v255
 v_dot2_f32_bf16 v41, v120, v254, v255
 v_dot2_f32_bf16 v42, v121, v253, v255
 v_dot2_f32_bf16 v43, v121, v254, v255
 v_cvt_pk_bf16_f32 v118, v36, v37
 v_cvt_pk_bf16_f32 v119, v38, v39
 v_cvt_pk_bf16_f32 v120, v40, v41
 v_cvt_pk_bf16_f32 v121, v42, v43
 v_accvgpr_write_b32 a16, v114
 v_accvgpr_write_b32 a17, v115
 v_accvgpr_write_b32 a18, v116
 v_accvgpr_write_b32 a19, v117
 v_dot2_f32_bf16 v36, v122, v253, v255
 v_dot2_f32_bf16 v37, v122, v254, v255
 v_dot2_f32_bf16 v38, v123, v253, v255
 v_dot2_f32_bf16 v39, v123, v254, v255
 v_dot2_f32_bf16 v40, v124, v253, v255
 v_dot2_f32_bf16 v41, v124, v254, v255
 v_dot2_f32_bf16 v42, v125, v253, v255
 v_dot2_f32_bf16 v43, v125, v254, v255
 v_cvt_pk_bf16_f32 v122, v36, v37
 v_cvt_pk_bf16_f32 v123, v38, v39
 v_cvt_pk_bf16_f32 v124, v40, v41
 v_cvt_pk_bf16_f32 v125, v42, v43
 v_accvgpr_write_b32 a20, v118
 v_accvgpr_write_b32 a21, v119
 v_accvgpr_write_b32 a22, v120
 v_accvgpr_write_b32 a23, v121
 v_dot2_f32_bf16 v36, v126, v253, v255
 v_dot2_f32_bf16 v37, v126, v254, v255
 v_dot2_f32_bf16 v38, v127, v253, v255
 v_dot2_f32_bf16 v39, v127, v254, v255
 v_dot2_f32_bf16 v40, v128, v253, v255
 v_dot2_f32_bf16 v41, v128, v254, v255
 v_dot2_f32_bf16 v42, v129, v253, v255
 v_dot2_f32_bf16 v43, v129, v254, v255
 v_cvt_pk_bf16_f32 v126, v36, v37
 v_cvt_pk_bf16_f32 v127, v38, v39
 v_cvt_pk_bf16_f32 v128, v40, v41
 v_cvt_pk_bf16_f32 v129, v42, v43
 s_add_u32 s48, s43, s56
 s_add_u32 m0, s0, 0xa000
 s_nop 0
 buffer_load_dwordx4 v68, s[8:11], s48 offen lds
 v_accvgpr_write_b32 a24, v122
 v_accvgpr_write_b32 a25, v123
 v_accvgpr_write_b32 a26, v124
 v_accvgpr_write_b32 a27, v125
 v_dot2_f32_bf16 v36, v130, v253, v255
 v_dot2_f32_bf16 v37, v130, v254, v255
 v_dot2_f32_bf16 v38, v131, v253, v255
 v_dot2_f32_bf16 v39, v131, v254, v255
 v_dot2_f32_bf16 v40, v132, v253, v255
 v_dot2_f32_bf16 v41, v132, v254, v255
 v_dot2_f32_bf16 v42, v133, v253, v255
 v_dot2_f32_bf16 v43, v133, v254, v255
 v_cvt_pk_bf16_f32 v130, v36, v37
 v_cvt_pk_bf16_f32 v131, v38, v39
 v_cvt_pk_bf16_f32 v132, v40, v41
 v_cvt_pk_bf16_f32 v133, v42, v43
 v_accvgpr_write_b32 a28, v126
 v_accvgpr_write_b32 a29, v127
 v_accvgpr_write_b32 a30, v128
 v_accvgpr_write_b32 a31, v129
 v_dot2_f32_bf16 v36, v134, v253, v255
 v_dot2_f32_bf16 v37, v134, v254, v255
 v_dot2_f32_bf16 v38, v135, v253, v255
 v_dot2_f32_bf16 v39, v135, v254, v255
 v_dot2_f32_bf16 v40, v136, v253, v255
 v_dot2_f32_bf16 v41, v136, v254, v255
 v_dot2_f32_bf16 v42, v137, v253, v255
 v_dot2_f32_bf16 v43, v137, v254, v255
 v_cvt_pk_bf16_f32 v134, v36, v37
 v_cvt_pk_bf16_f32 v135, v38, v39
 v_cvt_pk_bf16_f32 v136, v40, v41
 v_cvt_pk_bf16_f32 v137, v42, v43
 v_dot2_f32_bf16 v36, v138, v253, v255
 v_dot2_f32_bf16 v37, v138, v254, v255
 v_dot2_f32_bf16 v38, v139, v253, v255
 v_dot2_f32_bf16 v39, v139, v254, v255
 v_dot2_f32_bf16 v40, v140, v253, v255
 v_dot2_f32_bf16 v41, v140, v254, v255
 v_dot2_f32_bf16 v42, v141, v253, v255
 v_dot2_f32_bf16 v43, v141, v254, v255
 v_cvt_pk_bf16_f32 v138, v36, v37
 v_cvt_pk_bf16_f32 v139, v38, v39
 v_cvt_pk_bf16_f32 v140, v40, v41
 v_cvt_pk_bf16_f32 v141, v42, v43
 v_dot2_f32_bf16 v36, v142, v253, v255
 v_dot2_f32_bf16 v37, v142, v254, v255
 v_dot2_f32_bf16 v38, v143, v253, v255
 v_dot2_f32_bf16 v39, v143, v254, v255
 v_dot2_f32_bf16 v40, v144, v253, v255
 v_dot2_f32_bf16 v41, v144, v254, v255
 v_dot2_f32_bf16 v42, v145, v253, v255
 v_dot2_f32_bf16 v43, v145, v254, v255
 v_cvt_pk_bf16_f32 v142, v36, v37
 v_cvt_pk_bf16_f32 v143, v38, v39
 v_cvt_pk_bf16_f32 v144, v40, v41
 v_cvt_pk_bf16_f32 v145, v42, v43
 v_dot2_f32_bf16 v36, v146, v253, v255
 v_dot2_f32_bf16 v37, v146, v254, v255
 v_dot2_f32_bf16 v38, v147, v253, v255
 v_dot2_f32_bf16 v39, v147, v254, v255
 v_dot2_f32_bf16 v40, v148, v253, v255
 v_dot2_f32_bf16 v41, v148, v254, v255
 v_dot2_f32_bf16 v42, v149, v253, v255
 v_dot2_f32_bf16 v43, v149, v254, v255
 v_cvt_pk_bf16_f32 v146, v36, v37
 v_cvt_pk_bf16_f32 v147, v38, v39
 v_cvt_pk_bf16_f32 v148, v40, v41
 v_cvt_pk_bf16_f32 v149, v42, v43
 s_add_u32 s48, s43, s57
 s_add_u32 m0, s0, 0xb000
 s_nop 0
 buffer_load_dwordx4 v68, s[8:11], s48 offen lds
 v_dot2_f32_bf16 v36, v150, v253, v255
 v_dot2_f32_bf16 v37, v150, v254, v255
 v_dot2_f32_bf16 v38, v151, v253, v255
 v_dot2_f32_bf16 v39, v151, v254, v255
 v_dot2_f32_bf16 v40, v152, v253, v255
 v_dot2_f32_bf16 v41, v152, v254, v255
 v_dot2_f32_bf16 v42, v153, v253, v255
 v_dot2_f32_bf16 v43, v153, v254, v255
 v_cvt_pk_bf16_f32 v150, v36, v37
 v_cvt_pk_bf16_f32 v151, v38, v39
 v_cvt_pk_bf16_f32 v152, v40, v41
 v_cvt_pk_bf16_f32 v153, v42, v43
 v_dot2_f32_bf16 v36, v154, v253, v255
 v_dot2_f32_bf16 v37, v154, v254, v255
 v_dot2_f32_bf16 v38, v155, v253, v255
 v_dot2_f32_bf16 v39, v155, v254, v255
 v_dot2_f32_bf16 v40, v156, v253, v255
 v_dot2_f32_bf16 v41, v156, v254, v255
 v_dot2_f32_bf16 v42, v157, v253, v255
 v_dot2_f32_bf16 v43, v157, v254, v255
 v_cvt_pk_bf16_f32 v154, v36, v37
 v_cvt_pk_bf16_f32 v155, v38, v39
 v_cvt_pk_bf16_f32 v156, v40, v41
 v_cvt_pk_bf16_f32 v157, v42, v43
 v_dot2_f32_bf16 v36, v158, v253, v255
 v_dot2_f32_bf16 v37, v158, v254, v255
 v_dot2_f32_bf16 v38, v159, v253, v255
 v_dot2_f32_bf16 v39, v159, v254, v255
 v_dot2_f32_bf16 v40, v160, v253, v255
 v_dot2_f32_bf16 v41, v160, v254, v255
 v_dot2_f32_bf16 v42, v161, v253, v255
 v_dot2_f32_bf16 v43, v161, v254, v255
 v_cvt_pk_bf16_f32 v158, v36, v37
 v_cvt_pk_bf16_f32 v159, v38, v39
 v_cvt_pk_bf16_f32 v160, v40, v41
 v_cvt_pk_bf16_f32 v161, v42, v43
 v_dot2_f32_bf16 v36, v162, v253, v255
 v_dot2_f32_bf16 v37, v162, v254, v255
 v_dot2_f32_bf16 v38, v163, v253, v255
 v_dot2_f32_bf16 v39, v163, v254, v255
 v_dot2_f32_bf16 v40, v164, v253, v255
 v_dot2_f32_bf16 v41, v164, v254, v255
 v_dot2_f32_bf16 v42, v165, v253, v255
 v_dot2_f32_bf16 v43, v165, v254, v255
 v_cvt_pk_bf16_f32 v162, v36, v37
 v_cvt_pk_bf16_f32 v163, v38, v39
 v_cvt_pk_bf16_f32 v164, v40, v41
 v_cvt_pk_bf16_f32 v165, v42, v43
 v_dot2_f32_bf16 v36, v166, v253, v255
 v_dot2_f32_bf16 v37, v166, v254, v255
 v_dot2_f32_bf16 v38, v167, v253, v255
 v_dot2_f32_bf16 v39, v167, v254, v255
 v_dot2_f32_bf16 v40, v168, v253, v255
 v_dot2_f32_bf16 v41, v168, v254, v255
 v_dot2_f32_bf16 v42, v169, v253, v255
 v_dot2_f32_bf16 v43, v169, v254, v255
 v_cvt_pk_bf16_f32 v166, v36, v37
 v_cvt_pk_bf16_f32 v167, v38, v39
 v_cvt_pk_bf16_f32 v168, v40, v41
 v_cvt_pk_bf16_f32 v169, v42, v43
 v_dot2_f32_bf16 v36, v170, v253, v255
 v_dot2_f32_bf16 v37, v170, v254, v255
 v_dot2_f32_bf16 v38, v171, v253, v255
 v_dot2_f32_bf16 v39, v171, v254, v255
 v_dot2_f32_bf16 v40, v172, v253, v255
 v_dot2_f32_bf16 v41, v172, v254, v255
 v_dot2_f32_bf16 v42, v173, v253, v255
 v_dot2_f32_bf16 v43, v173, v254, v255
 s_add_u32 s48, s39, s49
 s_add_u32 m0, s28, 0xd000
 s_nop 0
 buffer_load_dwordx4 v4, s[8:11], s48 offen offset:0 lds
 v_cvt_pk_bf16_f32 v170, v36, v37
 v_cvt_pk_bf16_f32 v171, v38, v39
 v_cvt_pk_bf16_f32 v172, v40, v41
 v_cvt_pk_bf16_f32 v173, v42, v43
 v_dot2_f32_bf16 v36, v174, v253, v255
 v_dot2_f32_bf16 v37, v174, v254, v255
 v_dot2_f32_bf16 v38, v175, v253, v255
 v_dot2_f32_bf16 v39, v175, v254, v255
 v_dot2_f32_bf16 v40, v176, v253, v255
 v_dot2_f32_bf16 v41, v176, v254, v255
 v_dot2_f32_bf16 v42, v177, v253, v255
 v_dot2_f32_bf16 v43, v177, v254, v255
 v_cvt_pk_bf16_f32 v174, v36, v37
 v_cvt_pk_bf16_f32 v175, v38, v39
 v_cvt_pk_bf16_f32 v176, v40, v41
 v_cvt_pk_bf16_f32 v177, v42, v43
 v_dot2_f32_bf16 v36, v178, v253, v255
 v_dot2_f32_bf16 v37, v178, v254, v255
 v_dot2_f32_bf16 v38, v179, v253, v255
 v_dot2_f32_bf16 v39, v179, v254, v255
 v_dot2_f32_bf16 v40, v180, v253, v255
 v_dot2_f32_bf16 v41, v180, v254, v255
 v_dot2_f32_bf16 v42, v181, v253, v255
 v_dot2_f32_bf16 v43, v181, v254, v255
 v_cvt_pk_bf16_f32 v178, v36, v37
 v_cvt_pk_bf16_f32 v179, v38, v39
 v_cvt_pk_bf16_f32 v180, v40, v41
 v_cvt_pk_bf16_f32 v181, v42, v43
 v_dot2_f32_bf16 v36, v182, v253, v255
 v_dot2_f32_bf16 v37, v182, v254, v255
 v_dot2_f32_bf16 v38, v183, v253, v255
 v_dot2_f32_bf16 v39, v183, v254, v255
 v_dot2_f32_bf16 v40, v184, v253, v255
 v_dot2_f32_bf16 v41, v184, v254, v255
 v_dot2_f32_bf16 v42, v185, v253, v255
 v_dot2_f32_bf16 v43, v185, v254, v255
 v_cvt_pk_bf16_f32 v182, v36, v37
 v_cvt_pk_bf16_f32 v183, v38, v39
 v_cvt_pk_bf16_f32 v184, v40, v41
 v_cvt_pk_bf16_f32 v185, v42, v43
 v_dot2_f32_bf16 v36, v186, v253, v255
 v_dot2_f32_bf16 v37, v186, v254, v255
 v_dot2_f32_bf16 v38, v187, v253, v255
 v_dot2_f32_bf16 v39, v187, v254, v255
 v_dot2_f32_bf16 v40, v188, v253, v255
 v_dot2_f32_bf16 v41, v188, v254, v255
 v_dot2_f32_bf16 v42, v189, v253, v255
 v_dot2_f32_bf16 v43, v189, v254, v255
 v_cvt_pk_bf16_f32 v186, v36, v37
 v_cvt_pk_bf16_f32 v187, v38, v39
 v_cvt_pk_bf16_f32 v188, v40, v41
 v_cvt_pk_bf16_f32 v189, v42, v43
 v_dot2_f32_bf16 v36, v190, v253, v255
 v_dot2_f32_bf16 v37, v190, v254, v255
 v_dot2_f32_bf16 v38, v191, v253, v255
 v_dot2_f32_bf16 v39, v191, v254, v255
 v_dot2_f32_bf16 v40, v192, v253, v255
 v_dot2_f32_bf16 v41, v192, v254, v255
 v_dot2_f32_bf16 v42, v193, v253, v255
 v_dot2_f32_bf16 v43, v193, v254, v255
 v_cvt_pk_bf16_f32 v190, v36, v37
 v_cvt_pk_bf16_f32 v191, v38, v39
 v_cvt_pk_bf16_f32 v192, v40, v41
 v_cvt_pk_bf16_f32 v193, v42, v43
 v_dot2_f32_bf16 v36, v194, v253, v255
 v_dot2_f32_bf16 v37, v194, v254, v255
 v_dot2_f32_bf16 v38, v195, v253, v255
 v_dot2_f32_bf16 v39, v195, v254, v255
 s_add_u32 m0, s28, 0xd000
 s_nop 0
 buffer_load_dwordx4 v5, s[8:11], s48 offen offset:1024 lds
 v_dot2_f32_bf16 v40, v196, v253, v255
 v_dot2_f32_bf16 v41, v196, v254, v255
 v_dot2_f32_bf16 v42, v197, v253, v255
 v_dot2_f32_bf16 v43, v197, v254, v255
 v_cvt_pk_bf16_f32 v194, v36, v37
 v_cvt_pk_bf16_f32 v195, v38, v39
 v_cvt_pk_bf16_f32 v196, v40, v41
 v_cvt_pk_bf16_f32 v197, v42, v43
 v_dot2_f32_bf16 v36, v198, v253, v255
 v_dot2_f32_bf16 v37, v198, v254, v255
 v_dot2_f32_bf16 v38, v199, v253, v255
 v_dot2_f32_bf16 v39, v199, v254, v255
 v_dot2_f32_bf16 v40, v200, v253, v255
 v_dot2_f32_bf16 v41, v200, v254, v255
 v_dot2_f32_bf16 v42, v201, v253, v255
 v_dot2_f32_bf16 v43, v201, v254, v255
 v_cvt_pk_bf16_f32 v198, v36, v37
 v_cvt_pk_bf16_f32 v199, v38, v39
 v_cvt_pk_bf16_f32 v200, v40, v41
 v_cvt_pk_bf16_f32 v201, v42, v43
 v_dot2_f32_bf16 v36, v202, v253, v255
 v_dot2_f32_bf16 v37, v202, v254, v255
 v_dot2_f32_bf16 v38, v203, v253, v255
 v_dot2_f32_bf16 v39, v203, v254, v255
 v_dot2_f32_bf16 v40, v204, v253, v255
 v_dot2_f32_bf16 v41, v204, v254, v255
 v_dot2_f32_bf16 v42, v205, v253, v255
 v_dot2_f32_bf16 v43, v205, v254, v255
 v_cvt_pk_bf16_f32 v202, v36, v37
 v_cvt_pk_bf16_f32 v203, v38, v39
 v_cvt_pk_bf16_f32 v204, v40, v41
 v_cvt_pk_bf16_f32 v205, v42, v43
 v_dot2_f32_bf16 v36, v206, v253, v255
 v_dot2_f32_bf16 v37, v206, v254, v255
 v_dot2_f32_bf16 v38, v207, v253, v255
 v_dot2_f32_bf16 v39, v207, v254, v255
 v_dot2_f32_bf16 v40, v208, v253, v255
 v_dot2_f32_bf16 v41, v208, v254, v255
 v_dot2_f32_bf16 v42, v209, v253, v255
 v_dot2_f32_bf16 v43, v209, v254, v255
 v_cvt_pk_bf16_f32 v206, v36, v37
 v_cvt_pk_bf16_f32 v207, v38, v39
 v_cvt_pk_bf16_f32 v208, v40, v41
 v_cvt_pk_bf16_f32 v209, v42, v43
 v_dot2_f32_bf16 v36, v210, v253, v255
 v_dot2_f32_bf16 v37, v210, v254, v255
 v_dot2_f32_bf16 v38, v211, v253, v255
 v_dot2_f32_bf16 v39, v211, v254, v255
 v_dot2_f32_bf16 v40, v212, v253, v255
 v_dot2_f32_bf16 v41, v212, v254, v255
 v_dot2_f32_bf16 v42, v213, v253, v255
 v_dot2_f32_bf16 v43, v213, v254, v255
 v_cvt_pk_bf16_f32 v210, v36, v37
 v_cvt_pk_bf16_f32 v211, v38, v39
 v_cvt_pk_bf16_f32 v212, v40, v41
 v_cvt_pk_bf16_f32 v213, v42, v43
 v_dot2_f32_bf16 v36, v214, v253, v255
 v_dot2_f32_bf16 v37, v214, v254, v255
 v_dot2_f32_bf16 v38, v215, v253, v255
 v_dot2_f32_bf16 v39, v215, v254, v255
 v_dot2_f32_bf16 v40, v216, v253, v255
 v_dot2_f32_bf16 v41, v216, v254, v255
 v_dot2_f32_bf16 v42, v217, v253, v255
 v_dot2_f32_bf16 v43, v217, v254, v255
 v_cvt_pk_bf16_f32 v214, v36, v37
 v_cvt_pk_bf16_f32 v215, v38, v39
 v_cvt_pk_bf16_f32 v216, v40, v41
 v_cvt_pk_bf16_f32 v217, v42, v43
 s_waitcnt vmcnt(9)
 s_barrier
 ds_read_b128 a[144:147], v8 offset:0
 ds_read_b128 a[148:151], v9 offset:0
 ds_read_b128 a[152:155], v10 offset:0
 ds_read_b128 a[156:159], v11 offset:0
 ds_read_b128 a[160:163], v8 offset:4096
 ds_read_b128 a[164:167], v9 offset:4096
 ds_read_b128 a[168:171], v10 offset:4096
 s_waitcnt lgkmcnt(6)
 v_mfma_f32_32x32x16_bf16 v[98:113], a[0:3], a[144:147], 0
 ds_read_b128 a[172:175], v11 offset:4096
 s_add_u32 s48, s39, s50
 s_add_u32 m0, s28, 0xf000
 s_nop 0
 buffer_load_dwordx4 v4, s[8:11], s48 offen offset:0 lds
 v_lshlrev_b32 v36, 16, v218
 v_and_b32 v37, 0xffff0000, v218
 s_waitcnt lgkmcnt(6)
 v_mfma_f32_32x32x16_bf16 v[98:113], a[4:7], a[148:151], v[98:113]
 s_waitcnt vmcnt(8)
 s_barrier
 ds_read_b128 a[144:147], v8 offset:8192
 v_lshlrev_b32 v38, 16, v219
 v_and_b32 v39, 0xffff0000, v219
 v_lshlrev_b32 v40, 16, v220
 v_and_b32 v41, 0xffff0000, v220
 v_lshlrev_b32 v42, 16, v221
 v_and_b32 v43, 0xffff0000, v221
 s_waitcnt lgkmcnt(6)
 v_mfma_f32_32x32x16_bf16 v[98:113], a[8:11], a[152:155], v[98:113]
 ds_read_b128 a[148:151], v9 offset:8192
 s_cmp_lg_u32 s24, 0
 s_cbranch_scc1 sre
 global_store_byte v32, v60, s[34:35] sc1
sre:
 v_fma_f32 v36, v36, v254, v255
 v_fma_f32 v37, v37, v254, v255
 v_fma_f32 v38, v38, v254, v255
 s_waitcnt lgkmcnt(6)
 v_mfma_f32_32x32x16_bf16 v[98:113], a[12:15], a[156:159], v[98:113]
 s_waitcnt lgkmcnt(2)
 ds_read_b128 a[152:155], v10 offset:8192
 v_fma_f32 v39, v39, v254, v255
 v_fma_f32 v40, v40, v254, v255
 v_fma_f32 v41, v41, v254, v255
 v_fma_f32 v42, v42, v254, v255
 v_fma_f32 v43, v43, v254, v255
 v_cvt_pk_bf16_f32 v218, v36, v37
 v_cvt_pk_bf16_f32 v219, v38, v39
 v_mfma_f32_32x32x16_bf16 v[98:113], a[16:19], a[160:163], v[98:113]
 ds_read_b128 a[156:159], v11 offset:8192
 buffer_load_dwordx4 v5, s[8:11], s48 offen offset:1024 lds
 v_cvt_pk_bf16_f32 v220, v40, v41
 v_cvt_pk_bf16_f32 v221, v42, v43
 v_lshlrev_b32 v36, 16, v222
 v_and_b32 v37, 0xffff0000, v222
 v_lshlrev_b32 v38, 16, v223
 v_mfma_f32_32x32x16_bf16 v[98:113], a[20:23], a[164:167], v[98:113]
 s_add_u32 s48, s39, s51
 ds_read_b128 a[160:163], v8 offset:12288
 s_add_u32 m0, s28, 0x11000
 v_and_b32 v39, 0xffff0000, v223
 v_lshlrev_b32 v40, 16, v224
 v_and_b32 v41, 0xffff0000, v224
 v_lshlrev_b32 v42, 16, v225
 v_and_b32 v43, 0xffff0000, v225
 v_fma_f32 v36, v36, v254, v255
 v_mfma_f32_32x32x16_bf16 v[98:113], a[24:27], a[168:171], v[98:113]
 ds_read_b128 a[164:167], v9 offset:12288
 buffer_load_dwordx4 v4, s[8:11], s48 offen offset:0 lds
 v_fma_f32 v37, v37, v254, v255
 v_fma_f32 v38, v38, v254, v255
 v_fma_f32 v39, v39, v254, v255
 v_fma_f32 v40, v40, v254, v255
 v_fma_f32 v41, v41, v254, v255
 v_mfma_f32_32x32x16_bf16 v[98:113], a[28:31], a[172:175], v[98:113]
 s_waitcnt lgkmcnt(2)
 ds_read_b128 a[168:171], v10 offset:12288
 v_fma_f32 v42, v42, v254, v255
 v_fma_f32 v43, v43, v254, v255
 v_cvt_pk_bf16_f32 v222, v36, v37
 v_cvt_pk_bf16_f32 v223, v38, v39
 v_cvt_pk_bf16_f32 v224, v40, v41
 v_cvt_pk_bf16_f32 v225, v42, v43
 v_lshlrev_b32 v36, 16, v226
 v_mfma_f32_32x32x16_bf16 v[98:113], v[130:133], a[144:147], v[98:113]
 ds_read_b128 a[172:175], v11 offset:12288
 buffer_load_dwordx4 v5, s[8:11], s48 offen offset:1024 lds
 v_and_b32 v37, 0xffff0000, v226
 v_lshlrev_b32 v38, 16, v227
 v_and_b32 v39, 0xffff0000, v227
 v_lshlrev_b32 v40, 16, v228
 v_and_b32 v41, 0xffff0000, v228
 v_mfma_f32_32x32x16_bf16 v[98:113], v[134:137], a[148:151], v[98:113]
 s_waitcnt vmcnt(9)
 s_barrier
 ds_read_b128 a[144:147], v8 offset:16384
 s_add_u32 s48, s39, s52
 s_add_u32 m0, s28, 0x3000
 v_lshlrev_b32 v42, 16, v229
 v_and_b32 v43, 0xffff0000, v229
 v_fma_f32 v36, v36, v254, v255
 v_fma_f32 v37, v37, v254, v255
 v_mfma_f32_32x32x16_bf16 v[98:113], v[138:141], a[152:155], v[98:113]
 ds_read_b128 a[148:151], v9 offset:16384
 buffer_load_dwordx4 v4, s[8:11], s48 offen offset:0 lds
 v_fma_f32 v38, v38, v254, v255
 v_fma_f32 v39, v39, v254, v255
 v_fma_f32 v40, v40, v254, v255
 v_fma_f32 v41, v41, v254, v255
 v_fma_f32 v42, v42, v254, v255
 v_mfma_f32_32x32x16_bf16 v[98:113], v[142:145], a[156:159], v[98:113]
 s_waitcnt lgkmcnt(2)
 ds_read_b128 a[152:155], v10 offset:16384
 v_fma_f32 v43, v43, v254, v255
 v_cvt_pk_bf16_f32 v226, v36, v37
 v_cvt_pk_bf16_f32 v227, v38, v39
 v_cvt_pk_bf16_f32 v228, v40, v41
 v_cvt_pk_bf16_f32 v229, v42, v43
 v_lshlrev_b32 v36, 16, v230
 v_and_b32 v37, 0xffff0000, v230
 v_mfma_f32_32x32x16_bf16 v[98:113], v[146:149], a[160:163], v[98:113]
 ds_read_b128 a[156:159], v11 offset:16384
 buffer_load_dwordx4 v5, s[8:11], s48 offen offset:1024 lds
 v_lshlrev_b32 v38, 16, v231
 v_and_b32 v39, 0xffff0000, v231
 v_lshlrev_b32 v40, 16, v232
 v_and_b32 v41, 0xffff0000, v232
 v_lshlrev_b32 v42, 16, v233
 v_mfma_f32_32x32x16_bf16 v[98:113], v[150:153], a[164:167], v[98:113]
 s_add_u32 s48, s39, s53
 ds_read_b128 a[160:163], v8 offset:20480
 s_add_u32 m0, s28, 0x13000
 v_and_b32 v43, 0xffff0000, v233
 v_fma_f32 v36, v36, v254, v255
 v_fma_f32 v37, v37, v254, v255
 v_fma_f32 v38, v38, v254, v255
 v_fma_f32 v39, v39, v254, v255
 v_fma_f32 v40, v40, v254, v255
 v_mfma_f32_32x32x16_bf16 v[98:113], v[154:157], a[168:171], v[98:113]
 ds_read_b128 a[164:167], v9 offset:20480
 buffer_load_dwordx4 v4, s[8:11], s48 offen offset:0 lds
 v_fma_f32 v41, v41, v254, v255
 v_fma_f32 v42, v42, v254, v255
 v_fma_f32 v43, v43, v254, v255
 v_cvt_pk_bf16_f32 v230, v36, v37
 v_cvt_pk_bf16_f32 v231, v38, v39
 v_mfma_f32_32x32x16_bf16 v[98:113], v[158:161], a[172:175], v[98:113]
 s_waitcnt lgkmcnt(2)
 ds_read_b128 a[168:171], v10 offset:20480
 v_cvt_pk_bf16_f32 v232, v40, v41
 v_cvt_pk_bf16_f32 v233, v42, v43
 v_lshlrev_b32 v36, 16, v234
 v_and_b32 v37, 0xffff0000, v234
 v_lshlrev_b32 v38, 16, v235
 v_and_b32 v39, 0xffff0000, v235
 v_lshlrev_b32 v40, 16, v236
 v_mfma_f32_32x32x16_bf16 v[98:113], v[162:165], a[144:147], v[98:113]
 ds_read_b128 a[172:175], v11 offset:20480
 buffer_load_dwordx4 v5, s[8:11], s48 offen offset:1024 lds
 v_and_b32 v41, 0xffff0000, v236
 v_lshlrev_b32 v42, 16, v237
 v_and_b32 v43, 0xffff0000, v237
 v_fma_f32 v36, v36, v254, v255
 v_fma_f32 v37, v37, v254, v255
 v_mfma_f32_32x32x16_bf16 v[98:113], v[166:169], a[148:151], v[98:113]
 s_waitcnt vmcnt(11)
 s_barrier
 ds_read_b128 a[144:147], v8 offset:24576
 v_fma_f32 v38, v38, v254, v255
 v_fma_f32 v39, v39, v254, v255
 v_fma_f32 v40, v40, v254, v255
 v_fma_f32 v41, v41, v254, v255
 v_fma_f32 v42, v42, v254, v255
 v_fma_f32 v43, v43, v254, v255
 v_mfma_f32_32x32x16_bf16 v[98:113], v[170:173], a[152:155], v[98:113]
 ds_read_b128 a[148:151], v9 offset:24576
 v_cvt_pk_bf16_f32 v234, v36, v37
 v_cvt_pk_bf16_f32 v235, v38, v39
 v_cvt_pk_bf16_f32 v236, v40, v41
 v_cvt_pk_bf16_f32 v237, v42, v43
 v_lshlrev_b32 v36, 16, v238
 v_and_b32 v37, 0xffff0000, v238
 v_lshlrev_b32 v38, 16, v239
 v_mfma_f32_32x32x16_bf16 v[98:113], v[174:177], a[156:159], v[98:113]
 s_waitcnt lgkmcnt(2)
 ds_read_b128 a[152:155], v10 offset:24576
 v_and_b32 v39, 0xffff0000, v239
 v_lshlrev_b32 v40, 16, v240
 v_and_b32 v41, 0xffff0000, v240
 v_lshlrev_b32 v42, 16, v241
 v_and_b32 v43, 0xffff0000, v241
 v_fma_f32 v36, v36, v254, v255
 v_fma_f32 v37, v37, v254, v255
 v_mfma_f32_32x32x16_bf16 v[98:113], v[178:181], a[160:163], v[98:113]
 s_add_u32 s48, s39, s54
 ds_read_b128 a[156:159], v11 offset:24576
 s_add_u32 m0, s28, 0x5000
 v_fma_f32 v38, v38, v254, v255
 v_fma_f32 v39, v39, v254, v255
 v_fma_f32 v40, v40, v254, v255
 v_fma_f32 v41, v41, v254, v255
 v_fma_f32 v42, v42, v254, v255
 v_fma_f32 v43, v43, v254, v255
 v_mfma_f32_32x32x16_bf16 v[98:113], v[182:185], a[164:167], v[98:113]
 ds_read_b128 a[160:163], v8 offset:28672
 buffer_load_dwordx4 v4, s[8:11], s48 offen offset:0 lds
 v_cvt_pk_bf16_f32 v238, v36, v37
 v_cvt_pk_bf16_f32 v239, v38, v39
 v_cvt_pk_bf16_f32 v240, v40, v41
 v_cvt_pk_bf16_f32 v241, v42, v43
 v_mfma_f32_32x32x16_bf16 v[98:113], v[186:189], a[168:171], v[98:113]
 ds_read_b128 a[164:167], v9 offset:28672
 buffer_load_dword a251, v93, s[8:11], s39 offen offset:640
 ds_read_b128 v[74:77], v34 offset:0
 ds_read_b128 v[78:81], v34 offset:512
 v_accvgpr_write_b32 a32, v130
 v_accvgpr_write_b32 a33, v131
 v_accvgpr_write_b32 a34, v132
 v_mfma_f32_32x32x16_bf16 v[98:113], v[190:193], a[172:175], v[98:113]
 s_waitcnt lgkmcnt(4)
 ds_read_b128 a[168:171], v10 offset:28672
 buffer_load_dwordx4 v5, s[8:11], s48 offen offset:1024 lds
 v_accvgpr_write_b32 a35, v133
 v_accvgpr_write_b32 a36, v134
 v_accvgpr_write_b32 a37, v135
 v_accvgpr_write_b32 a38, v136
 v_accvgpr_write_b32 a39, v137
 v_mfma_f32_32x32x16_bf16 v[98:113], v[194:197], a[144:147], v[98:113]
 ds_read_b128 a[172:175], v11 offset:28672
 buffer_load_dword a252, v92, s[8:11], s39 offen
 s_add_u32 s48, s39, s55
 s_add_u32 m0, s28, 0x7000
 v_accvgpr_write_b32 a40, v138
 v_accvgpr_write_b32 a41, v139
 v_accvgpr_write_b32 a42, v140
 v_mfma_f32_32x32x16_bf16 v[98:113], v[198:201], a[148:151], v[98:113]
 s_waitcnt vmcnt(14)
 s_barrier
 ds_read_b128 a[144:147], v8 offset:32768
 buffer_load_dwordx4 v4, s[8:11], s48 offen offset:0 lds
 v_accvgpr_write_b32 a43, v141
 v_accvgpr_write_b32 a44, v142
 v_accvgpr_write_b32 a45, v143
 v_accvgpr_write_b32 a46, v144
 v_mfma_f32_32x32x16_bf16 v[98:113], v[202:205], a[152:155], v[98:113]
 ds_read_b128 a[148:151], v9 offset:32768
 buffer_load_dwordx4 v5, s[8:11], s48 offen offset:1024 lds
 s_add_u32 s48, s39, s56
 s_add_u32 m0, s28, 0x15000
 v_accvgpr_write_b32 a47, v145
 v_accvgpr_write_b32 a48, v146
 v_accvgpr_write_b32 a49, v147
 v_mfma_f32_32x32x16_bf16 v[98:113], v[206:209], a[156:159], v[98:113]
 s_waitcnt lgkmcnt(2)
 ds_read_b128 a[152:155], v10 offset:32768
 buffer_load_dwordx4 v4, s[8:11], s48 offen offset:0 lds
 v_accvgpr_write_b32 a50, v148
 v_accvgpr_write_b32 a51, v149
 v_accvgpr_write_b32 a52, v150
 v_accvgpr_write_b32 a53, v151
 v_accvgpr_write_b32 a54, v152
 v_mfma_f32_32x32x16_bf16 v[98:113], v[210:213], a[160:163], v[98:113]
 ds_read_b128 a[156:159], v11 offset:32768
 v_accvgpr_write_b32 a55, v153
 v_accvgpr_write_b32 a56, v154
 v_accvgpr_write_b32 a57, v155
 v_accvgpr_write_b32 a58, v156
 v_accvgpr_write_b32 a59, v157
 v_accvgpr_write_b32 a60, v158
 v_accvgpr_write_b32 a61, v159
 v_mfma_f32_32x32x16_bf16 v[98:113], v[214:217], a[164:167], v[98:113]
 s_waitcnt vmcnt(15)
 s_barrier
 ds_read_b128 a[160:163], v8 offset:40960
 v_accvgpr_write_b32 a62, v160
 v_accvgpr_write_b32 a63, v161
 v_mfma_f32_32x32x16_bf16 v[98:113], v[218:221], a[168:171], v[98:113]
 ds_read_b128 a[164:167], v8 offset:45056
 v_mfma_f32_32x32x16_bf16 v[98:113], v[222:225], a[172:175], v[98:113]
 s_waitcnt lgkmcnt(2)
 ds_read_b128 a[168:171], v9 offset:40960
 v_mfma_f32_32x32x16_bf16 v[98:113], v[226:229], a[144:147], v[98:113]
 ds_read_b128 a[172:175], v9 offset:45056
 v_mfma_f32_32x32x16_bf16 v[98:113], v[230:233], a[148:151], v[98:113]
 ds_read_b128 a[144:147], v10 offset:40960
 v_mfma_f32_32x32x16_bf16 v[98:113], v[234:237], a[152:155], v[98:113]
 ds_read_b128 a[148:151], v10 offset:45056
 v_mfma_f32_32x32x16_bf16 v[98:113], v[238:241], a[156:159], v[98:113]
 s_waitcnt lgkmcnt(2)
 ds_read_b128 a[152:155], v11 offset:40960
 v_mfma_f32_32x32x16_bf16 v[130:145], a[0:3], a[160:163], 0
 ds_read_b128 a[156:159], v11 offset:45056
 v_mfma_f32_32x32x16_bf16 v[146:161], a[0:3], a[164:167], 0
 s_waitcnt vmcnt(13)
 s_barrier
 ds_read_b128 a[160:163], v8 offset:49152
 s_nop 3
 v_mov_b32 v114, v98
 v_mov_b32 v115, v99
 v_mov_b32 v116, v100
 v_mov_b32 v117, v101
 v_permlane16_swap_b32 v98, v114
 v_mov_b32 v118, v102
 v_mfma_f32_32x32x16_bf16 v[130:145], a[4:7], a[168:171], v[130:145]
 ds_read_b128 a[164:167], v8 offset:53248
 v_permlane16_swap_b32 v99, v115
 v_mov_b32 v119, v103
 v_permlane16_swap_b32 v100, v116
 v_mov_b32 v120, v104
 v_permlane16_swap_b32 v101, v117
 v_mov_b32 v121, v105
 v_permlane16_swap_b32 v102, v118
 v_mfma_f32_32x32x16_bf16 v[146:161], a[4:7], a[172:175], v[146:161]
 s_waitcnt lgkmcnt(2)
 ds_read_b128 a[168:171], v9 offset:49152
 v_mov_b32 v122, v106
 v_permlane16_swap_b32 v103, v119
 v_mov_b32 v123, v107
 v_permlane16_swap_b32 v104, v120
 v_mov_b32 v124, v108
 v_permlane16_swap_b32 v105, v121
 v_mov_b32 v125, v109
 v_mfma_f32_32x32x16_bf16 v[130:145], a[8:11], a[144:147], v[130:145]
 ds_read_b128 a[172:175], v9 offset:53248
 v_permlane16_swap_b32 v106, v122
 v_mov_b32 v126, v110
 v_permlane16_swap_b32 v107, v123
 v_mov_b32 v127, v111
 v_permlane16_swap_b32 v108, v124
 v_mov_b32 v128, v112
 v_permlane16_swap_b32 v109, v125
 v_mfma_f32_32x32x16_bf16 v[146:161], a[8:11], a[148:151], v[146:161]
 ds_read_b128 a[144:147], v10 offset:49152
 v_mov_b32 v129, v113
 v_permlane16_swap_b32 v110, v126
 v_permlane16_swap_b32 v111, v127
 v_permlane16_swap_b32 v112, v128
 v_permlane16_swap_b32 v113, v129
 v_fma_f32 v38, v74, v98, v99
 v_fma_f32 v39, -v74, v114, -v115
 v_mfma_f32_32x32x16_bf16 v[130:145], a[12:15], a[152:155], v[130:145]
 ds_read_b128 a[148:151], v10 offset:53248
 v_fmac_f32 v38, v75, v114
 v_fmac_f32 v39, v75, v98
 v_fma_f32 v36, v74, v38, v100
 v_fma_f32 v37, v74, v39, -v116
 v_fma_f32 v36, -v75, v39, v36
 v_fmac_f32 v37, v75, v38
 v_fma_f32 v38, v74, v36, v101
 v_mfma_f32_32x32x16_bf16 v[146:161], a[12:15], a[156:159], v[146:161]
 s_waitcnt lgkmcnt(2)
 ds_read_b128 a[152:155], v11 offset:49152
 v_fma_f32 v39, v74, v37, -v117
 v_fma_f32 v38, -v75, v37, v38
 v_fmac_f32 v39, v75, v36
 v_fma_f32 v36, v74, v38, v102
 v_fma_f32 v37, v74, v39, -v118
 v_fma_f32 v36, -v75, v39, v36
 v_fmac_f32 v37, v75, v38
 v_mfma_f32_32x32x16_bf16 v[130:145], a[16:19], a[160:163], v[130:145]
 ds_read_b128 a[156:159], v11 offset:53248
 v_fma_f32 v38, v74, v36, v103
 v_fma_f32 v39, v74, v37, -v119
 v_fma_f32 v38, -v75, v37, v38
 v_fmac_f32 v39, v75, v36
 v_fma_f32 v36, v74, v38, v104
 v_fma_f32 v37, v74, v39, -v120
 v_fma_f32 v36, -v75, v39, v36
 v_mfma_f32_32x32x16_bf16 v[146:161], a[16:19], a[164:167], v[146:161]
 s_waitcnt vmcnt(11)
 s_barrier
 ds_read_b128 a[160:163], v8 offset:57344
 v_fmac_f32 v37, v75, v38
 v_fma_f32 v38, v74, v36, v105
 v_fma_f32 v39, v74, v37, -v121
 v_fma_f32 v38, -v75, v37, v38
 v_fmac_f32 v39, v75, v36
 v_fma_f32 v36, v74, v38, v106
 v_mfma_f32_32x32x16_bf16 v[130:145], a[20:23], a[168:171], v[130:145]
 ds_read_b128 a[164:167], v8 offset:61440
 v_fma_f32 v37, v74, v39, -v122
 v_fma_f32 v36, -v75, v39, v36
 v_fmac_f32 v37, v75, v38
 v_fma_f32 v38, v74, v36, v107
 v_fma_f32 v39, v74, v37, -v123
 v_fma_f32 v38, -v75, v37, v38
 v_fmac_f32 v39, v75, v36
 v_mfma_f32_32x32x16_bf16 v[146:161], a[20:23], a[172:175], v[146:161]
 s_waitcnt lgkmcnt(2)
 ds_read_b128 a[168:171], v9 offset:57344
 v_fma_f32 v36, v74, v38, v108
 v_fma_f32 v37, v74, v39, -v124
 v_fma_f32 v36, -v75, v39, v36
 v_fmac_f32 v37, v75, v38
 v_fma_f32 v38, v74, v36, v109
 v_fma_f32 v39, v74, v37, -v125
 v_fma_f32 v38, -v75, v37, v38
 v_mfma_f32_32x32x16_bf16 v[130:145], a[24:27], a[144:147], v[130:145]
 ds_read_b128 a[172:175], v9 offset:61440
 v_fmac_f32 v39, v75, v36
 v_fma_f32 v36, v74, v38, v110
 v_fma_f32 v37, v74, v39, -v126
 v_fma_f32 v36, -v75, v39, v36
 v_fmac_f32 v37, v75, v38
 v_fma_f32 v38, v74, v36, v111
 v_fma_f32 v39, v74, v37, -v127
 v_mfma_f32_32x32x16_bf16 v[146:161], a[24:27], a[148:151], v[146:161]
 ds_read_b128 a[144:147], v10 offset:57344
 v_fma_f32 v38, -v75, v37, v38
 v_fmac_f32 v39, v75, v36
 v_fma_f32 v36, v74, v38, v112
 v_fma_f32 v37, v74, v39, -v128
 v_fma_f32 v36, -v75, v39, v36
 v_fmac_f32 v37, v75, v38
 v_fma_f32 v44, v74, v36, v113
 v_mfma_f32_32x32x16_bf16 v[130:145], a[28:31], a[152:155], v[130:145]
 ds_read_b128 a[148:151], v10 offset:61440
 v_fma_f32 v45, v74, v37, -v129
 v_fma_f32 v44, -v75, v37, v44
 v_fmac_f32 v45, v75, v36
 v_mov_b32 v42, v44
 v_mov_b32 v43, v45
 s_nop 0
 v_permlane32_swap_b32 v44, v42
 v_permlane32_swap_b32 v45, v43
 v_mfma_f32_32x32x16_bf16 v[146:161], a[28:31], a[156:159], v[146:161]
 s_waitcnt lgkmcnt(2)
 ds_read_b128 a[152:155], v11 offset:57344
 v_fma_f32 v42, v78, v44, v42
 v_fma_f32 v43, v78, v45, v43
 v_fma_f32 v42, -v79, v45, v42
 v_fma_f32 v43, v79, v44, v43
 v_mfma_f32_32x32x16_bf16 v[130:145], a[32:35], a[160:163], v[130:145]
 ds_read_b128 a[156:159], v11 offset:61440
 ds_write_b64 v22, v[42:43] offset:768
 v_mul_f32 v40, v76, v98
 v_mul_f32 v41, v77, v98
 v_fma_f32 v98, v77, v114, v40
 v_fma_f32 v114, -v76, v114, v41
 v_mul_f32 v40, v76, v99
 v_mul_f32 v41, v77, v99
 v_mfma_f32_32x32x16_bf16 v[146:161], a[32:35], a[164:167], v[146:161]
 s_waitcnt vmcnt(9)
 s_barrier
 ds_read_b128 a[160:163], v8 offset:0
 v_fma_f32 v99, v77, v115, v40
 v_fma_f32 v115, -v76, v115, v41
 v_mul_f32 v40, v76, v100
 v_mul_f32 v41, v77, v100
 v_fma_f32 v100, v77, v116, v40
 v_fma_f32 v116, -v76, v116, v41
 v_mfma_f32_32x32x16_bf16 v[130:145], a[36:39], a[168:171], v[130:145]
 ds_read_b128 a[164:167], v8 offset:4096
 s_waitcnt lgkmcnt(2)
 s_barrier
 ds_read_b64 v[36:37], v22 offset:0
 ds_read_b64 v[38:39], v22 offset:256
 ds_read_b64 v[46:47], v22 offset:512
 v_mul_f32 v40, v76, v101
 v_mul_f32 v41, v77, v101
 v_mfma_f32_32x32x16_bf16 v[146:161], a[36:39], a[172:175], v[146:161]
 ds_read_b128 a[168:171], v9 offset:0
 buffer_load_dwordx4 v5, s[8:11], s48 offen offset:1024 lds
 v_fma_f32 v101, v77, v117, v40
 v_fma_f32 v117, -v76, v117, v41
 v_mul_f32 v40, v76, v102
 v_mul_f32 v41, v77, v102
 v_fma_f32 v102, v77, v118, v40
 v_mfma_f32_32x32x16_bf16 v[130:145], a[40:43], a[144:147], v[130:145]
 ds_read_b128 a[172:175], v9 offset:4096
 v_fma_f32 v118, -v76, v118, v41
 v_mul_f32 v40, v76, v103
 v_mul_f32 v41, v77, v103
 v_fma_f32 v103, v77, v119, v40
 v_fma_f32 v119, -v76, v119, v41
 s_waitcnt lgkmcnt(3)
 v_fma_f32 v38, v80, v36, v38
 v_fma_f32 v39, v80, v37, v39
 v_mfma_f32_32x32x16_bf16 v[146:161], a[40:43], a[148:151], v[146:161]
 ds_read_b128 a[144:147], v10 offset:0
 v_fma_f32 v38, -v81, v37, v38
 v_fma_f32 v39, v81, v36, v39
 s_waitcnt lgkmcnt(3)
 v_fma_f32 v46, v80, v38, v46
 v_fma_f32 v47, v80, v39, v47
 v_fma_f32 v46, -v81, v39, v46
 v_fma_f32 v47, v81, v38, v47
 v_fma_f32 v42, v80, v46, v42
 v_mfma_f32_32x32x16_bf16 v[130:145], a[44:47], a[152:155], v[130:145]
 s_add_u32 s48, s39, s57
 ds_read_b128 a[148:151], v10 offset:4096
 s_add_u32 m0, s28, 0x9000
 v_fma_f32 v43, v80, v47, v43
 v_fma_f32 v42, -v81, v47, v42
 v_fma_f32 v43, v81, v46, v43
 s_mov_b32 s69, 0x0
 s_cmp_lg_u32 s24, 3
 s_cbranch_scc1 sg0
 buffer_store_dwordx2 v[42:43], v20, s[4:7], s69 offen sc1
sg0:
 v_mfma_f32_32x32x16_bf16 v[146:161], a[44:47], a[156:159], v[146:161]
 s_waitcnt lgkmcnt(2)
 ds_read_b128 a[152:155], v11 offset:0
 buffer_load_dwordx4 v4, s[8:11], s48 offen offset:0 lds
 v_accvgpr_write_b32 a64, v162
 v_accvgpr_write_b32 a65, v163
 v_accvgpr_write_b32 a66, v164
 v_accvgpr_write_b32 a67, v165
 v_accvgpr_write_b32 a68, v166
 v_mfma_f32_32x32x16_bf16 v[130:145], a[48:51], a[160:163], v[130:145]
 ds_read_b128 a[156:159], v11 offset:4096
 v_accvgpr_write_b32 a69, v167
 v_accvgpr_write_b32 a70, v168
 v_accvgpr_write_b32 a71, v169
 v_accvgpr_write_b32 a72, v170
 v_accvgpr_write_b32 a73, v171
 v_accvgpr_write_b32 a74, v172
 v_accvgpr_write_b32 a75, v173
 v_mfma_f32_32x32x16_bf16 v[146:161], a[48:51], a[164:167], v[146:161]
 s_waitcnt vmcnt(6)
 s_barrier
 ds_read_b128 a[160:163], v12 offset:0
 buffer_load_dwordx4 v5, s[8:11], s48 offen offset:1024 lds
 v_accvgpr_write_b32 a76, v174
 v_accvgpr_write_b32 a77, v175
 v_accvgpr_write_b32 a78, v176
 v_accvgpr_write_b32 a79, v177
 v_mfma_f32_32x32x16_bf16 v[130:145], a[52:55], a[168:171], v[130:145]
 s_add_u32 s48, s40, s49
 ds_read_b128 a[164:167], v12 offset:4096
 s_add_u32 m0, s28, 0xb000
 v_accvgpr_write_b32 a80, v178
 v_accvgpr_write_b32 a81, v179
 v_accvgpr_write_b32 a82, v180
 v_accvgpr_write_b32 a83, v181
 v_accvgpr_write_b32 a84, v182
 v_accvgpr_write_b32 a85, v183
 v_mfma_f32_32x32x16_bf16 v[146:161], a[52:55], a[172:175], v[146:161]
 s_waitcnt lgkmcnt(2)
 ds_read_b128 a[168:171], v13 offset:0
 buffer_load_dwordx4 v4, s[8:11], s48 offen offset:0 lds
 v_accvgpr_write_b32 a86, v184
 v_accvgpr_write_b32 a87, v185
 v_accvgpr_write_b32 a88, v186
 v_accvgpr_write_b32 a89, v187
 v_accvgpr_write_b32 a90, v188
 v_mfma_f32_32x32x16_bf16 v[130:145], a[56:59], a[144:147], v[130:145]
 ds_read_b128 a[172:175], v13 offset:4096
 global_load_ubyte v59, v33, s[34:35] sc1
 v_accvgpr_write_b32 a91, v189
 v_accvgpr_write_b32 a92, v190
 v_accvgpr_write_b32 a93, v191
 v_accvgpr_write_b32 a94, v192
 v_accvgpr_write_b32 a95, v193
 v_mfma_f32_32x32x16_bf16 v[146:161], a[56:59], a[148:151], v[146:161]
 ds_read_b128 a[144:147], v14 offset:0
 v_accvgpr_write_b32 a96, v194
 v_accvgpr_write_b32 a97, v195
 v_accvgpr_write_b32 a98, v196
 v_accvgpr_write_b32 a99, v197
 v_accvgpr_write_b32 a100, v198
 v_accvgpr_write_b32 a101, v199
 v_accvgpr_write_b32 a102, v200
 v_mfma_f32_32x32x16_bf16 v[130:145], a[60:63], a[152:155], v[130:145]
 ds_read_b128 a[148:151], v14 offset:4096
 v_accvgpr_write_b32 a103, v201
 v_accvgpr_write_b32 a104, v202
 v_accvgpr_write_b32 a105, v203
 v_accvgpr_write_b32 a106, v204
 v_accvgpr_write_b32 a107, v205
 v_accvgpr_write_b32 a108, v206
 v_accvgpr_write_b32 a109, v207
 v_mfma_f32_32x32x16_bf16 v[146:161], a[60:63], a[156:159], v[146:161]
 s_waitcnt lgkmcnt(2)
 ds_read_b128 a[152:155], v15 offset:0
 v_accvgpr_write_b32 a110, v208
 v_accvgpr_write_b32 a111, v209
 v_accvgpr_write_b32 a112, v210
 v_accvgpr_write_b32 a113, v211
 v_accvgpr_write_b32 a114, v212
 v_accvgpr_write_b32 a115, v213
 v_accvgpr_write_b32 a116, v214
 v_mfma_f32_32x32x16_bf16 v[130:145], v[162:165], a[160:163], v[130:145]
 ds_read_b128 a[156:159], v15 offset:4096
 buffer_load_dwordx4 v5, s[8:11], s48 offen offset:1024 lds
 v_accvgpr_write_b32 a117, v215
 v_accvgpr_write_b32 a118, v216
 v_accvgpr_write_b32 a119, v217
 v_accvgpr_write_b32 a120, v218
 v_accvgpr_write_b32 a121, v219
 v_mfma_f32_32x32x16_bf16 v[146:161], v[162:165], a[164:167], v[146:161]
 s_add_u32 s48, s40, s50
 ds_read_b128 a[160:163], v8 offset:8192
 s_add_u32 m0, s28, 0xd000
 v_accvgpr_write_b32 a122, v220
 v_accvgpr_write_b32 a123, v221
 v_accvgpr_write_b32 a124, v222
 v_accvgpr_write_b32 a125, v223
 v_accvgpr_write_b32 a126, v224
 v_accvgpr_write_b32 a127, v225
 v_mfma_f32_32x32x16_bf16 v[130:145], v[166:169], a[168:171], v[130:145]
 ds_read_b128 a[164:167], v8 offset:12288
 buffer_load_dwordx4 v4, s[8:11], s48 offen offset:0 lds
 v_accvgpr_write_b32 a128, v226
 v_accvgpr_write_b32 a129, v227
 v_accvgpr_write_b32 a130, v228
 v_mfma_f32_32x32x16_bf16 v[146:161], v[166:169], a[172:175], v[146:161]
 s_waitcnt lgkmcnt(2)
 ds_read_b128 a[168:171], v9 offset:8192
 v_accvgpr_write_b32 a131, v229
 v_accvgpr_write_b32 a132, v230
 v_accvgpr_write_b32 a133, v231
 v_accvgpr_write_b32 a134, v232
 v_accvgpr_write_b32 a135, v233
 v_mfma_f32_32x32x16_bf16 v[130:145], v[170:173], a[144:147], v[130:145]
 ds_read_b128 a[172:175], v9 offset:12288
 buffer_load_dwordx4 v5, s[8:11], s48 offen offset:1024 lds
 v_accvgpr_write_b32 a136, v234
 v_accvgpr_write_b32 a137, v235
 v_accvgpr_write_b32 a138, v236
 v_mfma_f32_32x32x16_bf16 v[146:161], v[170:173], a[148:151], v[146:161]
 s_add_u32 s48, s40, s51
 ds_read_b128 a[144:147], v10 offset:8192
 s_add_u32 m0, s28, 0xf000
 v_accvgpr_write_b32 a139, v237
 v_accvgpr_write_b32 a140, v238
 v_accvgpr_write_b32 a141, v239
 v_accvgpr_write_b32 a142, v240
 v_mfma_f32_32x32x16_bf16 v[130:145], v[174:177], a[152:155], v[130:145]
 ds_read_b128 a[148:151], v10 offset:12288
 buffer_load_dwordx4 v4, s[8:11], s48 offen offset:0 lds
 v_accvgpr_write_b32 a143, v241
 v_mfma_f32_32x32x16_bf16 v[146:161], v[174:177], a[156:159], v[146:161]
 s_waitcnt lgkmcnt(2)
 ds_read_b128 a[152:155], v11 offset:8192
 ds_read_b128 v[82:85], v34 offset:2048
 ds_read_b128 v[86:89], v34 offset:2560
 v_mul_f32 v40, v76, v104
 v_mul_f32 v41, v77, v104
 v_fma_f32 v104, v77, v120, v40
 v_mfma_f32_32x32x16_bf16 v[130:145], v[178:181], a[160:163], v[130:145]
 ds_read_b128 a[156:159], v11 offset:12288
 v_fma_f32 v120, -v76, v120, v41
 v_mul_f32 v40, v76, v105
 v_mul_f32 v41, v77, v105
 v_fma_f32 v105, v77, v121, v40
 v_fma_f32 v121, -v76, v121, v41
 v_mfma_f32_32x32x16_bf16 v[146:161], v[178:181], a[164:167], v[146:161]
 s_waitcnt vmcnt(8)
 s_barrier
 ds_read_b128 a[160:163], v8 offset:16384
 v_mul_f32 v40, v76, v106
 v_mul_f32 v41, v77, v106
 v_fma_f32 v106, v77, v122, v40
 v_fma_f32 v122, -v76, v122, v41
 v_mfma_f32_32x32x16_bf16 v[130:145], v[182:185], a[168:171], v[130:145]
 ds_read_b128 a[164:167], v8 offset:20480
 v_mul_f32 v40, v76, v107
 v_mul_f32 v41, v77, v107
 v_fma_f32 v107, v77, v123, v40
 v_fma_f32 v123, -v76, v123, v41
 v_mul_f32 v40, v76, v108
 v_mfma_f32_32x32x16_bf16 v[146:161], v[182:185], a[172:175], v[146:161]
 s_waitcnt lgkmcnt(2)
 ds_read_b128 a[168:171], v9 offset:16384
 buffer_load_dwordx4 v5, s[8:11], s48 offen offset:1024 lds
 v_mul_f32 v41, v77, v108
 v_fma_f32 v108, v77, v124, v40
 v_fma_f32 v124, -v76, v124, v41
 v_mfma_f32_32x32x16_bf16 v[130:145], v[186:189], a[144:147], v[130:145]
 s_add_u32 s48, s40, s52
 ds_read_b128 a[172:175], v9 offset:20480
 s_add_u32 m0, s28, 0x3000
 v_mul_f32 v40, v76, v109
 v_mul_f32 v41, v77, v109
 v_fma_f32 v109, v77, v125, v40
 v_fma_f32 v125, -v76, v125, v41
 v_mfma_f32_32x32x16_bf16 v[146:161], v[186:189], a[148:151], v[146:161]
 ds_read_b128 a[144:147], v10 offset:16384
 buffer_load_dwordx4 v4, s[8:11], s48 offen offset:0 lds
 v_mul_f32 v40, v76, v110
 v_mul_f32 v41, v77, v110
 v_fma_f32 v110, v77, v126, v40
 v_mfma_f32_32x32x16_bf16 v[130:145], v[190:193], a[152:155], v[130:145]
 ds_read_b128 a[148:151], v10 offset:20480
 v_fma_f32 v126, -v76, v126, v41
 v_mul_f32 v40, v76, v111
 v_mul_f32 v41, v77, v111
 v_fma_f32 v111, v77, v127, v40
 v_fma_f32 v127, -v76, v127, v41
 v_mfma_f32_32x32x16_bf16 v[146:161], v[190:193], a[156:159], v[146:161]
 s_waitcnt lgkmcnt(2)
 ds_read_b128 a[152:155], v11 offset:16384
 buffer_load_dwordx4 v5, s[8:11], s48 offen offset:1024 lds
 v_mul_f32 v40, v76, v112
 v_mul_f32 v41, v77, v112
 v_fma_f32 v112, v77, v128, v40
 v_mfma_f32_32x32x16_bf16 v[130:145], v[194:197], a[160:163], v[130:145]
 s_add_u32 s48, s40, s53
 ds_read_b128 a[156:159], v11 offset:20480
 s_add_u32 m0, s28, 0x11000
 v_fma_f32 v128, -v76, v128, v41
 v_mul_f32 v40, v76, v113
 v_mul_f32 v41, v77, v113
 v_fma_f32 v113, v77, v129, v40
 v_mfma_f32_32x32x16_bf16 v[146:161], v[194:197], a[164:167], v[146:161]
 ds_read_b128 a[160:163], v12 offset:8192
 buffer_load_dwordx4 v4, s[8:11], s48 offen offset:0 lds
 v_fma_f32 v129, -v76, v129, v41
 v_mfma_f32_32x32x16_bf16 v[130:145], v[198:201], a[168:171], v[130:145]
 ds_read_b128 a[164:167], v12 offset:12288
 v_mfma_f32_32x32x16_bf16 v[146:161], v[198:201], a[172:175], v[146:161]
 s_waitcnt lgkmcnt(2)
 ds_read_b128 a[168:171], v13 offset:8192
 buffer_load_dwordx4 v5, s[8:11], s48 offen offset:1024 lds
 v_mfma_f32_32x32x16_bf16 v[130:145], v[202:205], a[144:147], v[130:145]
 s_add_u32 s48, s40, s54
 ds_read_b128 a[172:175], v13 offset:12288
 s_add_u32 m0, s28, 0x13000
 v_mfma_f32_32x32x16_bf16 v[146:161], v[202:205], a[148:151], v[146:161]
 ds_read_b128 a[144:147], v14 offset:8192
 buffer_load_dwordx4 v4, s[8:11], s48 offen offset:0 lds
 v_mfma_f32_32x32x16_bf16 v[130:145], v[206:209], a[152:155], v[130:145]
 ds_read_b128 a[148:151], v14 offset:12288
 v_mfma_f32_32x32x16_bf16 v[146:161], v[206:209], a[156:159], v[146:161]
 s_waitcnt lgkmcnt(2)
 ds_read_b128 a[152:155], v15 offset:8192
 buffer_load_dwordx4 v5, s[8:11], s48 offen offset:1024 lds
 v_mfma_f32_32x32x16_bf16 v[130:145], v[210:213], a[160:163], v[130:145]
 s_add_u32 s48, s40, s55
 ds_read_b128 a[156:159], v15 offset:12288
 s_add_u32 m0, s28, 0x5000
 v_mfma_f32_32x32x16_bf16 v[146:161], v[210:213], a[164:167], v[146:161]
 s_waitcnt vmcnt(10)
 s_barrier
 ds_read_b128 a[160:163], v8 offset:24576
 buffer_load_dwordx4 v4, s[8:11], s48 offen offset:0 lds
 v_mfma_f32_32x32x16_bf16 v[130:145], v[214:217], a[168:171], v[130:145]
 ds_read_b128 a[164:167], v8 offset:28672
 v_mfma_f32_32x32x16_bf16 v[146:161], v[214:217], a[172:175], v[146:161]
 s_waitcnt lgkmcnt(2)
 ds_read_b128 a[168:171], v9 offset:24576
 buffer_load_dwordx4 v5, s[8:11], s48 offen offset:1024 lds
 s_mov_b32 s67, 0x0
 v_mfma_f32_32x32x16_bf16 v[130:145], v[218:221], a[144:147], v[130:145]
 ds_read_b128 a[172:175], v9 offset:28672
 buffer_store_dwordx4 v[62:65], v66, s[4:7], s67 offen offset:2048 sc1
 v_mfma_f32_32x32x16_bf16 v[146:161], v[218:221], a[148:151], v[146:161]
 s_add_u32 s48, s40, s56
 ds_read_b128 a[144:147], v10 offset:24576
 s_add_u32 m0, s28, 0x7000
 v_mfma_f32_32x32x16_bf16 v[130:145], v[222:225], a[152:155], v[130:145]
 ds_read_b128 a[148:151], v10 offset:28672
 buffer_load_dwordx4 v4, s[8:11], s48 offen offset:0 lds
 v_mfma_f32_32x32x16_bf16 v[146:161], v[222:225], a[156:159], v[146:161]
 s_waitcnt lgkmcnt(2)
 ds_read_b128 a[152:155], v11 offset:24576
 s_mov_b32 s67, 0x22000
 v_mfma_f32_32x32x16_bf16 v[130:145], v[226:229], a[160:163], v[130:145]
 ds_read_b128 a[156:159], v11 offset:28672
 buffer_store_dwordx4 v[62:65], v66, s[4:7], s67 offen offset:2048 sc1
 v_mfma_f32_32x32x16_bf16 v[146:161], v[226:229], a[164:167], v[146:161]
 ds_read_b128 a[160:163], v8 offset:32768
 v_mfma_f32_32x32x16_bf16 v[130:145], v[230:233], a[168:171], v[130:145]
 ds_read_b128 a[164:167], v8 offset:36864
 buffer_load_dwordx4 v5, s[8:11], s48 offen offset:1024 lds
 v_mfma_f32_32x32x16_bf16 v[146:161], v[230:233], a[172:175], v[146:161]
 s_waitcnt lgkmcnt(2)
 ds_read_b128 a[168:171], v9 offset:32768
 v_mfma_f32_32x32x16_bf16 v[130:145], v[234:237], a[144:147], v[130:145]
 ds_read_b128 a[172:175], v9 offset:36864
 v_cmp_eq_u32 vcc, 0, v59
 s_nop 1
 s_cmp_lg_u64 vcc, 0
 s_cbranch_scc1 srd_spin
srd_back:
 s_mov_b32 s67, 0x2a800
 v_mfma_f32_32x32x16_bf16 v[146:161], v[234:237], a[148:151], v[146:161]
 ds_read_b128 a[144:147], v10 offset:32768
 buffer_store_dwordx4 v[62:65], v66, s[4:7], s67 offen offset:2048 sc1
 v_mfma_f32_32x32x16_bf16 v[130:145], v[238:241], a[152:155], v[130:145]
 s_add_u32 s48, s40, s57
 ds_read_b128 a[148:151], v10 offset:36864
 s_add_u32 m0, s28, 0x17000
 v_mfma_f32_32x32x16_bf16 v[146:161], v[238:241], a[156:159], v[146:161]
 s_waitcnt lgkmcnt(2)
 ds_read_b128 a[152:155], v11 offset:32768
 buffer_load_dwordx4 v4, s[8:11], s48 offen offset:0 lds
 s_mov_b32 s72, 0x0
 s_add_u32 s78, s73, 0x1000
 v_mfma_f32_32x32x16_bf16 v[162:177], a[0:3], a[160:163], 0
 ds_read_b128 a[156:159], v11 offset:36864
 buffer_load_dwordx2 v[58:59], v21, s[76:79], s72 offen offset:256 sc1
 v_mfma_f32_32x32x16_bf16 v[178:193], a[0:3], a[164:167], 0
 s_waitcnt vmcnt(15)
 s_barrier
 ds_read_b128 a[160:163], v8 offset:40960
 v_fma_f32 v38, v82, v130, v131
 v_fma_f32 v39, -v82, v146, -v147
 v_fmac_f32 v38, v83, v146
 v_fmac_f32 v39, v83, v130
 v_mfma_f32_32x32x16_bf16 v[162:177], a[4:7], a[168:171], v[162:177]
 ds_read_b128 a[164:167], v8 offset:45056
 buffer_load_dwordx2 v[60:61], v21, s[76:79], s72 offen offset:768 sc1
 v_fma_f32 v36, v82, v38, v132
 v_fma_f32 v37, v82, v39, -v148
 v_fma_f32 v36, -v83, v39, v36
 v_mfma_f32_32x32x16_bf16 v[178:193], a[4:7], a[172:175], v[178:193]
 s_waitcnt lgkmcnt(2)
 ds_read_b128 a[168:171], v9 offset:40960
 v_fmac_f32 v37, v83, v38
 v_fma_f32 v38, v82, v36, v133
 v_fma_f32 v39, v82, v37, -v149
 v_fma_f32 v38, -v83, v37, v38
 v_fmac_f32 v39, v83, v36
 v_mfma_f32_32x32x16_bf16 v[162:177], a[8:11], a[144:147], v[162:177]
 ds_read_b128 a[172:175], v9 offset:45056
 buffer_load_dwordx4 v5, s[8:11], s48 offen offset:1024 lds
 v_fma_f32 v36, v82, v38, v134
 v_fma_f32 v37, v82, v39, -v150
 v_fma_f32 v36, -v83, v39, v36
 v_mfma_f32_32x32x16_bf16 v[178:193], a[8:11], a[148:151], v[178:193]
 ds_read_b128 a[144:147], v10 offset:40960
 v_fmac_f32 v37, v83, v38
 v_fma_f32 v38, v82, v36, v135
 v_fma_f32 v39, v82, v37, -v151
 v_fma_f32 v38, -v83, v37, v38
 v_fmac_f32 v39, v83, v36
 v_mfma_f32_32x32x16_bf16 v[162:177], a[12:15], a[152:155], v[162:177]
 ds_read_b128 a[148:151], v10 offset:45056
 v_fma_f32 v36, v82, v38, v136
 v_fma_f32 v37, v82, v39, -v152
 v_fma_f32 v36, -v83, v39, v36
 v_fmac_f32 v37, v83, v38
 v_fma_f32 v38, v82, v36, v137
 v_mfma_f32_32x32x16_bf16 v[178:193], a[12:15], a[156:159], v[178:193]
 s_waitcnt lgkmcnt(2)
 ds_read_b128 a[152:155], v11 offset:40960
 v_fma_f32 v39, v82, v37, -v153
 v_fma_f32 v38, -v83, v37, v38
 v_fmac_f32 v39, v83, v36
 v_fma_f32 v36, v82, v38, v138
 v_fma_f32 v37, v82, v39, -v154
 v_mfma_f32_32x32x16_bf16 v[162:177], a[16:19], a[160:163], v[162:177]
 ds_read_b128 a[156:159], v11 offset:45056
 v_fma_f32 v36, -v83, v39, v36
 v_fmac_f32 v37, v83, v38
 v_fma_f32 v38, v82, v36, v139
 v_fma_f32 v39, v82, v37, -v155
 v_fma_f32 v38, -v83, v37, v38
 v_mfma_f32_32x32x16_bf16 v[178:193], a[16:19], a[164:167], v[178:193]
 ds_read_b128 a[160:163], v8 offset:49152
 v_fmac_f32 v39, v83, v36
 v_fma_f32 v36, v82, v38, v140
 v_fma_f32 v37, v82, v39, -v156
 v_fma_f32 v36, -v83, v39, v36
 v_fmac_f32 v37, v83, v38
 v_mfma_f32_32x32x16_bf16 v[162:177], a[20:23], a[168:171], v[162:177]
 ds_read_b128 a[164:167], v8 offset:53248
 v_fma_f32 v38, v82, v36, v141
 v_fma_f32 v39, v82, v37, -v157
 v_fma_f32 v38, -v83, v37, v38
 v_fmac_f32 v39, v83, v36
 v_fma_f32 v36, v82, v38, v142
 v_mfma_f32_32x32x16_bf16 v[178:193], a[20:23], a[172:175], v[178:193]
 s_waitcnt lgkmcnt(2)
 ds_read_b128 a[168:171], v9 offset:49152
 v_fma_f32 v37, v82, v39, -v158
 v_fma_f32 v36, -v83, v39, v36
 v_fmac_f32 v37, v83, v38
 v_fma_f32 v38, v82, v36, v143
 v_fma_f32 v39, v82, v37, -v159
 v_mfma_f32_32x32x16_bf16 v[162:177], a[24:27], a[144:147], v[162:177]
 ds_read_b128 a[172:175], v9 offset:53248
 v_fma_f32 v38, -v83, v37, v38
 v_fmac_f32 v39, v83, v36
 v_fma_f32 v36, v82, v38, v144
 v_fma_f32 v37, v82, v39, -v160
 v_fma_f32 v36, -v83, v39, v36
 v_mfma_f32_32x32x16_bf16 v[178:193], a[24:27], a[148:151], v[178:193]
 ds_read_b128 a[144:147], v10 offset:49152
 v_fmac_f32 v37, v83, v38
 v_fma_f32 v48, v82, v36, v145
 v_fma_f32 v49, v82, v37, -v161
 v_fma_f32 v48, -v83, v37, v48
 v_fmac_f32 v49, v83, v36
 v_mfma_f32_32x32x16_bf16 v[162:177], a[28:31], a[152:155], v[162:177]
 ds_read_b128 a[148:151], v10 offset:53248
 v_mov_b32 v42, v48
 v_mov_b32 v43, v49
 s_nop 0
 v_permlane32_swap_b32 v48, v42
 v_permlane32_swap_b32 v49, v43
 v_fma_f32 v42, v86, v48, v42
 v_mfma_f32_32x32x16_bf16 v[178:193], a[28:31], a[156:159], v[178:193]
 s_waitcnt lgkmcnt(2)
 ds_read_b128 a[152:155], v11 offset:49152
 v_fma_f32 v43, v86, v49, v43
 v_fma_f32 v42, -v87, v49, v42
 v_fma_f32 v43, v87, v48, v43
 v_mfma_f32_32x32x16_bf16 v[162:177], a[32:35], a[160:163], v[162:177]
 ds_read_b128 a[156:159], v11 offset:53248
 ds_write_b64 v22, v[42:43] offset:768
 v_mul_f32 v40, v84, v130
 v_mul_f32 v41, v85, v130
 v_fma_f32 v130, v85, v146, v40
 v_fma_f32 v146, -v84, v146, v41
 v_mfma_f32_32x32x16_bf16 v[178:193], a[32:35], a[164:167], v[178:193]
 s_waitcnt vmcnt(13)
 s_barrier
 ds_read_b128 a[160:163], v8 offset:0
 v_mul_f32 v40, v84, v131
 v_mul_f32 v41, v85, v131
 v_fma_f32 v131, v85, v147, v40
 v_fma_f32 v147, -v84, v147, v41
 v_mfma_f32_32x32x16_bf16 v[162:177], a[36:39], a[168:171], v[162:177]
 ds_read_b128 a[164:167], v8 offset:4096
 v_mul_f32 v40, v84, v132
 v_mul_f32 v41, v85, v132
 v_fma_f32 v132, v85, v148, v40
 v_fma_f32 v148, -v84, v148, v41
 s_waitcnt lgkmcnt(2)
 s_barrier
 v_mfma_f32_32x32x16_bf16 v[178:193], a[36:39], a[172:175], v[178:193]
 ds_read_b128 a[168:171], v9 offset:0
 ds_read_b64 v[36:37], v22 offset:0
 ds_read_b64 v[38:39], v22 offset:256
 ds_read_b64 v[50:51], v22 offset:512
 v_mul_f32 v40, v84, v133
 v_mul_f32 v41, v85, v133
 v_mfma_f32_32x32x16_bf16 v[162:177], a[40:43], a[144:147], v[162:177]
 ds_read_b128 a[172:175], v9 offset:4096
 v_fma_f32 v133, v85, v149, v40
 v_fma_f32 v149, -v84, v149, v41
 v_mul_f32 v40, v84, v134
 v_mul_f32 v41, v85, v134
 v_fma_f32 v134, v85, v150, v40
 v_mfma_f32_32x32x16_bf16 v[178:193], a[40:43], a[148:151], v[178:193]
 s_add_u32 s48, s41, s49
 ds_read_b128 a[144:147], v10 offset:0
 s_add_u32 m0, s28, 0x9000
 v_fma_f32 v150, -v84, v150, v41
 v_mul_f32 v40, v84, v135
 v_mul_f32 v41, v85, v135
 v_fma_f32 v135, v85, v151, v40
 v_mfma_f32_32x32x16_bf16 v[162:177], a[44:47], a[152:155], v[162:177]
 ds_read_b128 a[148:151], v10 offset:4096
 buffer_load_dwordx4 v4, s[8:11], s48 offen offset:0 lds
 v_fma_f32 v151, -v84, v151, v41
 s_waitcnt lgkmcnt(4)
 v_fma_f32 v38, v88, v36, v38
 v_fma_f32 v39, v88, v37, v39
 v_mfma_f32_32x32x16_bf16 v[178:193], a[44:47], a[156:159], v[178:193]
 s_waitcnt lgkmcnt(2)
 ds_read_b128 a[152:155], v11 offset:0
 v_fma_f32 v38, -v89, v37, v38
 v_fma_f32 v39, v89, v36, v39
 v_fma_f32 v50, v88, v38, v50
 v_fma_f32 v51, v88, v39, v51
 v_fma_f32 v50, -v89, v39, v50
 v_mfma_f32_32x32x16_bf16 v[162:177], a[48:51], a[160:163], v[162:177]
 ds_read_b128 a[156:159], v11 offset:4096
 buffer_load_dwordx4 v5, s[8:11], s48 offen offset:1024 lds
 v_fma_f32 v51, v89, v38, v51
 v_fma_f32 v42, v88, v50, v42
 v_fma_f32 v43, v88, v51, v43
 v_mfma_f32_32x32x16_bf16 v[178:193], a[48:51], a[164:167], v[178:193]
 ds_read_b128 a[160:163], v8 offset:57344
 v_fma_f32 v42, -v89, v51, v42
 v_fma_f32 v43, v89, v50, v43
 s_mov_b32 s69, 0x1000
 s_cmp_lg_u32 s24, 3
 s_cbranch_scc1 sg1
 buffer_store_dwordx2 v[42:43], v20, s[4:7], s69 offen sc1
sg1:
 v_mfma_f32_32x32x16_bf16 v[162:177], a[52:55], a[168:171], v[162:177]
 s_add_u32 s48, s41, s50
 ds_read_b128 a[164:167], v8 offset:61440
 s_add_u32 m0, s28, 0xb000
 ds_read_b128 v[52:55], v34 offset:1024
 ds_read_b64 v[56:57], v35
 v_add_u32 v35, s75, v35
 v_mfma_f32_32x32x16_bf16 v[178:193], a[52:55], a[172:175], v[178:193]
 s_waitcnt lgkmcnt(4)
 ds_read_b128 a[168:171], v9 offset:57344
 buffer_load_dwordx4 v4, s[8:11], s48 offen offset:0 lds
 ds_read_b128 v[90:93], v34 offset:4096
 ds_read_b128 v[94:97], v34 offset:4608
 v_mul_f32 v40, v84, v136
 v_mfma_f32_32x32x16_bf16 v[162:177], a[56:59], a[144:147], v[162:177]
 ds_read_b128 a[172:175], v9 offset:61440
 v_mul_f32 v41, v85, v136
 v_fma_f32 v136, v85, v152, v40
 v_fma_f32 v152, -v84, v152, v41
 v_mul_f32 v40, v84, v137
 v_mul_f32 v41, v85, v137
 v_mfma_f32_32x32x16_bf16 v[178:193], a[56:59], a[148:151], v[178:193]
 ds_read_b128 a[144:147], v10 offset:57344
 v_fma_f32 v137, v85, v153, v40
 v_fma_f32 v153, -v84, v153, v41
 v_mul_f32 v40, v84, v138
 v_mul_f32 v41, v85, v138
 v_fma_f32 v138, v85, v154, v40
 v_mfma_f32_32x32x16_bf16 v[162:177], a[60:63], a[152:155], v[162:177]
 ds_read_b128 a[148:151], v10 offset:61440
 v_fma_f32 v154, -v84, v154, v41
 v_mul_f32 v40, v84, v139
 v_mul_f32 v41, v85, v139
 v_fma_f32 v139, v85, v155, v40
 v_fma_f32 v155, -v84, v155, v41
 v_mfma_f32_32x32x16_bf16 v[178:193], a[60:63], a[156:159], v[178:193]
 s_waitcnt lgkmcnt(2)
 ds_read_b128 a[152:155], v11 offset:57344
 buffer_load_dwordx4 v5, s[8:11], s48 offen offset:1024 lds
 v_mul_f32 v40, v84, v140
 v_mul_f32 v41, v85, v140
 v_fma_f32 v140, v85, v156, v40
 v_mfma_f32_32x32x16_bf16 v[162:177], a[64:67], a[160:163], v[162:177]
 ds_read_b128 a[156:159], v11 offset:61440
 s_waitcnt vmcnt(8)
 s_add_u32 s48, s41, s51
 s_add_u32 m0, s28, 0x3000
 v_fma_f32 v156, -v84, v156, v41
 v_mul_f32 v40, v84, v141
 v_mfma_f32_32x32x16_bf16 v[178:193], a[64:67], a[164:167], v[178:193]
 s_barrier
 ds_read_b128 a[160:163], v12 offset:0
 buffer_load_dwordx4 v4, s[8:11], s48 offen offset:0 lds
 v_mul_f32 v41, v85, v141
 v_fma_f32 v141, v85, v157, v40
 v_mfma_f32_32x32x16_bf16 v[162:177], a[68:71], a[168:171], v[162:177]
 ds_read_b128 a[164:167], v12 offset:4096
 s_cmp_lg_u32 s24, 0
 s_cbranch_scc1 srs
 global_store_byte v32, v28, s[34:35] sc1
srs:
 v_fma_f32 v157, -v84, v157, v41
 v_mfma_f32_32x32x16_bf16 v[178:193], a[68:71], a[172:175], v[178:193]
 s_waitcnt lgkmcnt(2)
 ds_read_b128 a[168:171], v13 offset:0
 v_mfma_f32_32x32x16_bf16 v[162:177], a[72:75], a[144:147], v[162:177]
 ds_read_b128 a[172:175], v13 offset:4096
 buffer_load_dwordx4 v5, s[8:11], s48 offen offset:1024 lds
 v_mfma_f32_32x32x16_bf16 v[178:193], a[72:75], a[148:151], v[178:193]
 s_add_u32 s48, s41, s52
 ds_read_b128 a[144:147], v14 offset:0
 s_add_u32 m0, s28, 0xd000
 v_mfma_f32_32x32x16_bf16 v[162:177], a[76:79], a[152:155], v[162:177]
 ds_read_b128 a[148:151], v14 offset:4096
 buffer_load_dwordx4 v4, s[8:11], s48 offen offset:0 lds
 v_mfma_f32_32x32x16_bf16 v[178:193], a[76:79], a[156:159], v[178:193]
 s_waitcnt lgkmcnt(2)
 ds_read_b128 a[152:155], v15 offset:0
 v_mfma_f32_32x32x16_bf16 v[162:177], a[80:83], a[160:163], v[162:177]
 ds_read_b128 a[156:159], v15 offset:4096
 buffer_load_dwordx4 v5, s[8:11], s48 offen offset:1024 lds
 v_mfma_f32_32x32x16_bf16 v[178:193], a[80:83], a[164:167], v[178:193]
 s_add_u32 s48, s41, s53
 ds_read_b128 a[160:163], v8 offset:8192
 s_add_u32 m0, s28, 0xf000
 v_mfma_f32_32x32x16_bf16 v[162:177], a[84:87], a[168:171], v[162:177]
 ds_read_b128 a[164:167], v8 offset:12288
 buffer_load_dwordx4 v4, s[8:11], s48 offen offset:0 lds
 s_waitcnt vmcnt(10)
 v_max_u32 v36, v58, v60
 v_cmp_eq_u32 vcc, -1, v36
 s_nop 1
 s_cmp_lg_u64 vcc, 0
 s_cbranch_scc1 sa0_spin
sa0_back:
 v_mfma_f32_32x32x16_bf16 v[178:193], a[84:87], a[172:175], v[178:193]
 s_waitcnt lgkmcnt(2)
 ds_read_b128 a[168:171], v9 offset:8192
 v_add_u32 v37, s1, v72
 v_fma_f32 v58, v54, v60, v58
 v_fma_f32 v59, v54, v61, v59
 v_fma_f32 v58, -v55, v61, v58
 v_fma_f32 v59, v55, v60, v59
 v_mfma_f32_32x32x16_bf16 v[162:177], a[88:91], a[144:147], v[162:177]
 ds_read_b128 a[172:175], v9 offset:12288
 ds_write_b64 v37, v[58:59]
 v_mul_f32 v70, v54, v54
 v_mul_f32 v71, v54, v55
 v_fma_f32 v70, -v55, v55, v70
 v_fma_f32 v71, v55, v54, v71
 v_mfma_f32_32x32x16_bf16 v[178:193], a[88:91], a[148:151], v[178:193]
 ds_read_b128 a[144:147], v10 offset:8192
 v_mul_f32 v40, v84, v142
 v_mul_f32 v41, v85, v142
 v_fma_f32 v142, v85, v158, v40
 v_fma_f32 v158, -v84, v158, v41
 v_mul_f32 v40, v84, v143
 v_mfma_f32_32x32x16_bf16 v[162:177], a[92:95], a[152:155], v[162:177]
 ds_read_b128 a[148:151], v10 offset:12288
 v_mul_f32 v41, v85, v143
 v_fma_f32 v143, v85, v159, v40
 v_fma_f32 v159, -v84, v159, v41
 s_waitcnt lgkmcnt(2)
 s_barrier
 v_mfma_f32_32x32x16_bf16 v[178:193], a[92:95], a[156:159], v[178:193]
 ds_read_b128 a[152:155], v11 offset:8192
 buffer_load_dwordx4 v5, s[8:11], s48 offen offset:1024 lds
 ds_read_b64 v[68:69], v72 offset:15360
 ds_read_b64 v[66:67], v72 offset:10240
 ds_read_b64 v[64:65], v72 offset:5120
 v_mfma_f32_32x32x16_bf16 v[162:177], a[96:99], a[160:163], v[162:177]
 s_add_u32 s48, s41, s54
 ds_read_b128 a[156:159], v11 offset:12288
 s_add_u32 m0, s28, 0x11000
 ds_read_b64 v[62:63], v72 offset:0
 v_mul_f32 v40, v84, v144
 v_mul_f32 v41, v85, v144
 v_fma_f32 v144, v85, v160, v40
 v_mfma_f32_32x32x16_bf16 v[178:193], a[96:99], a[164:167], v[178:193]
 s_waitcnt vmcnt(10)
 s_barrier
 ds_read_b128 a[160:163], v8 offset:16384
 buffer_load_dwordx4 v4, s[8:11], s48 offen offset:0 lds
 v_fma_f32 v160, -v84, v160, v41
 v_mul_f32 v40, v84, v145
 v_mfma_f32_32x32x16_bf16 v[162:177], a[100:103], a[168:171], v[162:177]
 ds_read_b128 a[164:167], v8 offset:20480
 v_mul_f32 v41, v85, v145
 v_fma_f32 v145, v85, v161, v40
 v_fma_f32 v161, -v84, v161, v41
 s_waitcnt lgkmcnt(5)
 v_fma_f32 v66, v70, v68, v66
 v_fma_f32 v67, v70, v69, v67
 v_mfma_f32_32x32x16_bf16 v[178:193], a[100:103], a[172:175], v[178:193]
 s_waitcnt lgkmcnt(3)
 ds_read_b128 a[168:171], v9 offset:16384
 buffer_load_dwordx4 v5, s[8:11], s48 offen offset:1024 lds
 v_fma_f32 v66, -v71, v69, v66
 v_fma_f32 v67, v71, v68, v67
 v_fma_f32 v64, v70, v66, v64
 v_mfma_f32_32x32x16_bf16 v[162:177], a[104:107], a[144:147], v[162:177]
 s_add_u32 s48, s41, s55
 ds_read_b128 a[172:175], v9 offset:20480
 s_add_u32 m0, s28, 0x13000
 v_fma_f32 v65, v70, v67, v65
 v_fma_f32 v64, -v71, v67, v64
 v_fma_f32 v65, v71, v66, v65
 s_waitcnt lgkmcnt(4)
 v_fma_f32 v62, v70, v64, v62
 v_mfma_f32_32x32x16_bf16 v[178:193], a[104:107], a[148:151], v[178:193]
 ds_read_b128 a[144:147], v10 offset:16384
 buffer_load_dwordx4 v4, s[8:11], s48 offen offset:0 lds
 v_fma_f32 v63, v70, v65, v63
 v_fma_f32 v62, -v71, v65, v62
 v_fma_f32 v63, v71, v64, v63
 v_mfma_f32_32x32x16_bf16 v[162:177], a[108:111], a[152:155], v[162:177]
 ds_read_b128 a[148:151], v10 offset:20480
 v_mov_b32 v64, v62
 v_mov_b32 v65, v63
 s_nop 0
 v_permlane32_swap_b32 v62, v64
 v_permlane32_swap_b32 v63, v65
 v_fma_f32 v62, v52, v64, v62
 v_mfma_f32_32x32x16_bf16 v[178:193], a[108:111], a[156:159], v[178:193]
 s_waitcnt lgkmcnt(2)
 ds_read_b128 a[152:155], v11 offset:16384
 buffer_load_dwordx4 v5, s[8:11], s48 offen offset:1024 lds
 v_fma_f32 v63, v52, v65, v63
 v_fma_f32 v62, -v53, v65, v62
 v_fma_f32 v63, v53, v64, v63
 v_mfma_f32_32x32x16_bf16 v[162:177], a[112:115], a[160:163], v[162:177]
 s_add_u32 s48, s41, s56
 ds_read_b128 a[156:159], v11 offset:20480
 s_add_u32 m0, s28, 0x15000
 v_fma_f32 v46, v56, v62, v46
 v_fma_f32 v47, v56, v63, v47
 v_fma_f32 v46, -v57, v63, v46
 v_fma_f32 v47, v57, v62, v47
 v_mfma_f32_32x32x16_bf16 v[178:193], a[112:115], a[164:167], v[178:193]
 ds_read_b128 a[160:163], v12 offset:16384
 buffer_load_dwordx4 v4, s[8:11], s48 offen offset:0 lds
 v_fma_f32 v44, v78, v46, v44
 v_fma_f32 v45, v78, v47, v45
 v_fma_f32 v44, -v79, v47, v44
 v_mfma_f32_32x32x16_bf16 v[162:177], a[116:119], a[168:171], v[162:177]
 ds_read_b128 a[164:167], v12 offset:20480
 v_fma_f32 v45, v79, v46, v45
 v_cndmask_b32 v38, v46, v44, s[84:85]
 v_cndmask_b32 v39, v47, v45, s[84:85]
 v_mul_f32 v36, v76, v38
 v_mul_f32 v37, v76, v39
 v_mfma_f32_32x32x16_bf16 v[178:193], a[116:119], a[172:175], v[178:193]
 s_waitcnt lgkmcnt(2)
 ds_read_b128 a[168:171], v13 offset:16384
 buffer_load_dwordx4 v5, s[8:11], s48 offen offset:1024 lds
 v_fma_f32 v36, -v77, v39, v36
 v_fma_f32 v37, v77, v38, v37
 v_fmac_f32 v98, v74, v36
 v_mfma_f32_32x32x16_bf16 v[162:177], a[120:123], a[144:147], v[162:177]
 s_add_u32 s48, s41, s57
 ds_read_b128 a[172:175], v13 offset:20480
 s_add_u32 m0, s28, 0x19000
 v_fmac_f32 v114, v74, v37
 v_fma_f32 v98, -v75, v37, v98
 v_fmac_f32 v114, v75, v36
 v_fmac_f32 v99, v74, v98
 v_mfma_f32_32x32x16_bf16 v[178:193], a[120:123], a[148:151], v[178:193]
 ds_read_b128 a[144:147], v14 offset:16384
 buffer_load_dwordx4 v4, s[8:11], s48 offen offset:0 lds
 v_fmac_f32 v115, v74, v114
 v_fma_f32 v99, -v75, v114, v99
 v_fmac_f32 v115, v75, v98
 v_mfma_f32_32x32x16_bf16 v[162:177], a[124:127], a[152:155], v[162:177]
 ds_read_b128 a[148:151], v14 offset:20480
 v_fmac_f32 v100, v74, v99
 v_fmac_f32 v116, v74, v115
 v_fma_f32 v100, -v75, v115, v100
 v_fmac_f32 v116, v75, v99
 v_fmac_f32 v101, v74, v100
 v_mfma_f32_32x32x16_bf16 v[178:193], a[124:127], a[156:159], v[178:193]
 s_waitcnt lgkmcnt(2)
 ds_read_b128 a[152:155], v15 offset:16384
 buffer_load_dwordx4 v5, s[8:11], s48 offen offset:1024 lds
 v_fmac_f32 v117, v74, v116
 v_cvt_pk_bf16_f32 v98, v98, v99
 v_cvt_pk_bf16_f32 v114, v114, v115
 v_mfma_f32_32x32x16_bf16 v[162:177], a[128:131], a[160:163], v[162:177]
 s_add_u32 s48, s42, s49
 ds_read_b128 a[156:159], v15 offset:20480
 s_add_u32 m0, s28, 0x5000
 v_fma_f32 v101, -v75, v116, v101
 v_fmac_f32 v117, v75, v100
 v_fmac_f32 v102, v74, v101
 v_fmac_f32 v118, v74, v117
 v_mfma_f32_32x32x16_bf16 v[178:193], a[128:131], a[164:167], v[178:193]
 s_waitcnt vmcnt(14)
 s_barrier
 ds_read_b128 a[160:163], v8 offset:24576
 buffer_load_dwordx4 v4, s[8:11], s48 offen offset:0 lds
 v_fma_f32 v102, -v75, v117, v102
 v_fmac_f32 v118, v75, v101
 v_mfma_f32_32x32x16_bf16 v[162:177], a[132:135], a[168:171], v[162:177]
 ds_read_b128 a[164:167], v8 offset:28672
 v_fmac_f32 v103, v74, v102
 v_fmac_f32 v119, v74, v118
 v_cvt_pk_bf16_f32 v99, v100, v101
 v_cvt_pk_bf16_f32 v115, v116, v117
 v_fma_f32 v103, -v75, v118, v103
 v_mfma_f32_32x32x16_bf16 v[178:193], a[132:135], a[172:175], v[178:193]
 s_waitcnt lgkmcnt(2)
 ds_read_b128 a[168:171], v9 offset:24576
 buffer_load_dwordx4 v5, s[8:11], s48 offen offset:1024 lds
 v_fmac_f32 v119, v75, v102
 v_fmac_f32 v104, v74, v103
 v_fmac_f32 v120, v74, v119
 v_mfma_f32_32x32x16_bf16 v[162:177], a[136:139], a[144:147], v[162:177]
 s_add_u32 s48, s42, s50
 ds_read_b128 a[172:175], v9 offset:28672
 s_add_u32 m0, s28, 0x7000
 v_fma_f32 v104, -v75, v119, v104
 v_fmac_f32 v120, v75, v103
 v_fmac_f32 v105, v74, v104
 v_fmac_f32 v121, v74, v120
 v_mfma_f32_32x32x16_bf16 v[178:193], a[136:139], a[148:151], v[178:193]
 ds_read_b128 a[144:147], v10 offset:24576
 buffer_load_dwordx4 v4, s[8:11], s48 offen offset:0 lds
 v_cvt_pk_bf16_f32 v100, v102, v103
 v_cvt_pk_bf16_f32 v116, v118, v119
 v_fma_f32 v105, -v75, v120, v105
 v_mfma_f32_32x32x16_bf16 v[162:177], a[140:143], a[152:155], v[162:177]
 ds_read_b128 a[148:151], v10 offset:28672
 v_fmac_f32 v121, v75, v104
 v_fmac_f32 v106, v74, v105
 v_fmac_f32 v122, v74, v121
 v_fma_f32 v106, -v75, v121, v106
 v_fmac_f32 v122, v75, v105
 v_mfma_f32_32x32x16_bf16 v[178:193], a[140:143], a[156:159], v[178:193]
 s_waitcnt lgkmcnt(2)
 ds_read_b128 a[152:155], v11 offset:24576
 buffer_load_dwordx4 v5, s[8:11], s48 offen offset:1024 lds
 v_fmac_f32 v107, v74, v106
 v_fmac_f32 v123, v74, v122
 v_cvt_pk_bf16_f32 v101, v104, v105
 v_mfma_f32_32x32x16_bf16 v[194:209], a[0:3], a[160:163], 0
 s_add_u32 s48, s42, s51
 ds_read_b128 a[156:159], v11 offset:28672
 s_add_u32 m0, s28, 0x1b000
 v_cvt_pk_bf16_f32 v117, v120, v121
 v_fma_f32 v107, -v75, v122, v107
 v_fmac_f32 v123, v75, v106
 v_fmac_f32 v108, v74, v107
 v_mfma_f32_32x32x16_bf16 v[210:225], a[0:3], a[164:167], 0
 ds_read_b128 a[160:163], v8 offset:32768
 buffer_load_dwordx4 v4, s[8:11], s48 offen offset:0 lds
 v_fmac_f32 v124, v74, v123
 v_fma_f32 v108, -v75, v123, v108
 v_fmac_f32 v124, v75, v107
 v_mfma_f32_32x32x16_bf16 v[194:209], a[4:7], a[168:171], v[194:209]
 ds_read_b128 a[164:167], v8 offset:36864
 v_fmac_f32 v109, v74, v108
 v_fmac_f32 v125, v74, v124
 v_cvt_pk_bf16_f32 v102, v106, v107
 v_cvt_pk_bf16_f32 v118, v122, v123
 v_fma_f32 v109, -v75, v124, v109
 v_mfma_f32_32x32x16_bf16 v[210:225], a[4:7], a[172:175], v[210:225]
 s_waitcnt lgkmcnt(2)
 ds_read_b128 a[168:171], v9 offset:32768
 buffer_load_dwordx4 v5, s[8:11], s48 offen offset:1024 lds
 v_fmac_f32 v125, v75, v108
 v_fmac_f32 v110, v74, v109
 v_fmac_f32 v126, v74, v125
 v_mfma_f32_32x32x16_bf16 v[194:209], a[8:11], a[144:147], v[194:209]
 s_add_u32 s48, s42, s52
 ds_read_b128 a[172:175], v9 offset:36864
 s_add_u32 m0, s28, 0x1d000
 v_fma_f32 v110, -v75, v125, v110
 v_fmac_f32 v126, v75, v109
 v_fmac_f32 v111, v74, v110
 v_fmac_f32 v127, v74, v126
 v_mfma_f32_32x32x16_bf16 v[210:225], a[8:11], a[148:151], v[210:225]
 ds_read_b128 a[144:147], v10 offset:32768
 buffer_load_dwordx4 v4, s[8:11], s48 offen offset:0 lds
 v_cvt_pk_bf16_f32 v103, v108, v109
 v_cvt_pk_bf16_f32 v119, v124, v125
 v_fma_f32 v111, -v75, v126, v111
 v_mfma_f32_32x32x16_bf16 v[194:209], a[12:15], a[152:155], v[194:209]
 ds_read_b128 a[148:151], v10 offset:36864
 v_fmac_f32 v127, v75, v110
 v_fmac_f32 v112, v74, v111
 v_fmac_f32 v128, v74, v127
 v_fma_f32 v112, -v75, v127, v112
 v_fmac_f32 v128, v75, v111
 v_mfma_f32_32x32x16_bf16 v[210:225], a[12:15], a[156:159], v[210:225]
 s_waitcnt lgkmcnt(2)
 ds_read_b128 a[152:155], v11 offset:32768
 buffer_load_dwordx4 v5, s[8:11], s48 offen offset:1024 lds
 v_fmac_f32 v113, v74, v112
 v_fmac_f32 v129, v74, v128
 v_cvt_pk_bf16_f32 v104, v110, v111
 v_mfma_f32_32x32x16_bf16 v[194:209], a[16:19], a[160:163], v[194:209]
 s_add_u32 s48, s42, s53
 ds_read_b128 a[156:159], v11 offset:36864
 s_add_u32 m0, s28, 0x9000
 v_cvt_pk_bf16_f32 v120, v126, v127
 v_fma_f32 v113, -v75, v128, v113
 v_fmac_f32 v129, v75, v112
 v_cvt_pk_bf16_f32 v105, v112, v113
 v_mfma_f32_32x32x16_bf16 v[210:225], a[16:19], a[164:167], v[210:225]
 s_waitcnt vmcnt(18)
 s_barrier
 ds_read_b128 a[160:163], v8 offset:0
 buffer_load_dwordx4 v4, s[8:11], s48 offen offset:0 lds
 s_mov_b32 s72, 0x1000
 s_add_u32 s78, s73, 0x2000
 v_mfma_f32_32x32x16_bf16 v[194:209], a[20:23], a[168:171], v[194:209]
 ds_read_b128 a[164:167], v8 offset:4096
 buffer_load_dwordx2 v[58:59], v21, s[76:79], s72 offen offset:256 sc1
 v_cvt_pk_bf16_f32 v121, v128, v129
 v_mfma_f32_32x32x16_bf16 v[210:225], a[20:23], a[172:175], v[210:225]
 s_waitcnt lgkmcnt(2)
 ds_read_b128 a[168:171], v9 offset:0
 ds_write_b128 v23, v[98:101] offset:0
 ds_write_b128 v23, v[102:105] offset:16
 v_mfma_f32_32x32x16_bf16 v[194:209], a[24:27], a[144:147], v[194:209]
 ds_read_b128 a[172:175], v9 offset:4096
 buffer_load_dwordx2 v[60:61], v21, s[76:79], s72 offen offset:768 sc1
 ds_write_b128 v23, v[114:117] offset:2560
 v_mfma_f32_32x32x16_bf16 v[210:225], a[24:27], a[148:151], v[210:225]
 ds_read_b128 a[144:147], v10 offset:0
 ds_write_b128 v23, v[118:121] offset:2576
 ds_read_b64_tr_b16 a[176:177], v3 offset:0
 ds_read_b64_tr_b16 a[178:179], v3 offset:320
 ds_read_b64_tr_b16 a[184:185], v3 offset:2560
 v_mfma_f32_32x32x16_bf16 v[194:209], a[28:31], a[152:155], v[194:209]
 ds_read_b128 a[148:151], v10 offset:4096
 buffer_load_dwordx4 v5, s[8:11], s48 offen offset:1024 lds
 ds_read_b64_tr_b16 a[186:187], v3 offset:2880
 v_fma_f32 v38, v90, v162, v163
 v_fma_f32 v39, -v90, v178, -v179
 v_mfma_f32_32x32x16_bf16 v[210:225], a[28:31], a[156:159], v[210:225]
 s_waitcnt lgkmcnt(8)
 ds_read_b128 a[152:155], v11 offset:0
 s_add_u32 s48, s42, s54
 s_add_u32 m0, s28, 0x17000
 v_fmac_f32 v38, v91, v178
 v_fmac_f32 v39, v91, v162
 v_fma_f32 v36, v90, v38, v164
 v_mfma_f32_32x32x16_bf16 v[194:209], a[32:35], a[160:163], v[194:209]
 ds_read_b128 a[156:159], v11 offset:4096
 buffer_load_dwordx4 v4, s[8:11], s48 offen offset:0 lds
 v_fma_f32 v37, v90, v39, -v180
 v_fma_f32 v36, -v91, v39, v36
 v_fmac_f32 v37, v91, v38
 v_mfma_f32_32x32x16_bf16 v[210:225], a[32:35], a[164:167], v[210:225]
 ds_read_b128 a[160:163], v8 offset:40960
 v_fma_f32 v38, v90, v36, v165
 v_fma_f32 v39, v90, v37, -v181
 v_fma_f32 v38, -v91, v37, v38
 v_fmac_f32 v39, v91, v36
 v_fma_f32 v36, v90, v38, v166
 v_mfma_f32_32x32x16_bf16 v[194:209], a[36:39], a[168:171], v[194:209]
 ds_read_b128 a[164:167], v8 offset:45056
 buffer_load_dwordx4 v5, s[8:11], s48 offen offset:1024 lds
 v_fma_f32 v37, v90, v39, -v182
 v_fma_f32 v36, -v91, v39, v36
 v_fmac_f32 v37, v91, v38
 v_mfma_f32_32x32x16_bf16 v[210:225], a[36:39], a[172:175], v[210:225]
 s_waitcnt lgkmcnt(2)
 ds_read_b128 a[168:171], v9 offset:40960
 s_add_u32 s48, s42, s55
 s_add_u32 m0, s28, 0x1f000
 v_fma_f32 v38, v90, v36, v167
 v_fma_f32 v39, v90, v37, -v183
 v_fma_f32 v38, -v91, v37, v38
 v_mfma_f32_32x32x16_bf16 v[194:209], a[40:43], a[144:147], v[194:209]
 ds_read_b128 a[172:175], v9 offset:45056
 buffer_load_dwordx4 v4, s[8:11], s48 offen offset:0 lds
 v_fmac_f32 v39, v91, v36
 v_fma_f32 v36, v90, v38, v168
 v_fma_f32 v37, v90, v39, -v184
 v_mfma_f32_32x32x16_bf16 v[210:225], a[40:43], a[148:151], v[210:225]
 ds_read_b128 a[144:147], v10 offset:40960
 v_fma_f32 v36, -v91, v39, v36
 v_fmac_f32 v37, v91, v38
 v_fma_f32 v38, v90, v36, v169
 v_fma_f32 v39, v90, v37, -v185
 v_fma_f32 v38, -v91, v37, v38
 v_mfma_f32_32x32x16_bf16 v[194:209], a[44:47], a[152:155], v[194:209]
 ds_read_b128 a[148:151], v10 offset:45056
 buffer_load_dwordx4 v5, s[8:11], s48 offen offset:1024 lds
 v_fmac_f32 v39, v91, v36
 v_fma_f32 v36, v90, v38, v170
 v_fma_f32 v37, v90, v39, -v186
 v_mfma_f32_32x32x16_bf16 v[210:225], a[44:47], a[156:159], v[210:225]
 s_waitcnt lgkmcnt(2)
 ds_read_b128 a[152:155], v11 offset:40960
 s_add_u32 s48, s42, s56
 s_add_u32 m0, s28, 0x21000
 v_fma_f32 v36, -v91, v39, v36
 v_fmac_f32 v37, v91, v38
 v_fma_f32 v38, v90, v36, v171
 v_mfma_f32_32x32x16_bf16 v[194:209], a[48:51], a[160:163], v[194:209]
 ds_read_b128 a[156:159], v11 offset:45056
 buffer_load_dwordx4 v4, s[8:11], s48 offen offset:0 lds
 v_fma_f32 v39, v90, v37, -v187
 v_fma_f32 v38, -v91, v37, v38
 v_fmac_f32 v39, v91, v36
 v_mfma_f32_32x32x16_bf16 v[210:225], a[48:51], a[164:167], v[210:225]
 s_waitcnt vmcnt(23)
 s_barrier
 ds_read_b128 a[160:163], v8 offset:49152
 v_fma_f32 v36, v90, v38, v172
 v_fma_f32 v37, v90, v39, -v188
 v_fma_f32 v36, -v91, v39, v36
 v_fmac_f32 v37, v91, v38
 v_mfma_f32_32x32x16_bf16 v[194:209], a[52:55], a[168:171], v[194:209]
 ds_read_b128 a[164:167], v8 offset:53248
 buffer_load_dwordx4 v5, s[8:11], s48 offen offset:1024 lds
 v_fma_f32 v38, v90, v36, v173
 v_fma_f32 v39, v90, v37, -v189
 v_fma_f32 v38, -v91, v37, v38
 v_mfma_f32_32x32x16_bf16 v[210:225], a[52:55], a[172:175], v[210:225]
 s_waitcnt lgkmcnt(2)
 ds_read_b128 a[168:171], v9 offset:49152
 v_fmac_f32 v39, v91, v36
 v_fma_f32 v36, v90, v38, v174
 v_fma_f32 v37, v90, v39, -v190
 v_fma_f32 v36, -v91, v39, v36
 v_fmac_f32 v37, v91, v38
 v_mfma_f32_32x32x16_bf16 v[194:209], a[56:59], a[144:147], v[194:209]
 ds_read_b128 a[172:175], v9 offset:53248
 v_fma_f32 v38, v90, v36, v175
 v_fma_f32 v39, v90, v37, -v191
 v_fma_f32 v38, -v91, v37, v38
 v_fmac_f32 v39, v91, v36
 v_fma_f32 v36, v90, v38, v176
 v_mfma_f32_32x32x16_bf16 v[210:225], a[56:59], a[148:151], v[210:225]
 ds_read_b128 a[144:147], v10 offset:49152
 v_fma_f32 v37, v90, v39, -v192
 v_fma_f32 v36, -v91, v39, v36
 v_fmac_f32 v37, v91, v38
 v_fma_f32 v44, v90, v36, v177
 v_fma_f32 v45, v90, v37, -v193
 v_mfma_f32_32x32x16_bf16 v[194:209], a[60:63], a[152:155], v[194:209]
 s_add_u32 s48, s42, s57
 ds_read_b128 a[148:151], v10 offset:53248
 s_add_u32 m0, s28, 0x3000
 v_fma_f32 v44, -v91, v37, v44
 v_fmac_f32 v45, v91, v36
 v_mov_b32 v42, v44
 v_mov_b32 v43, v45
 v_mfma_f32_32x32x16_bf16 v[210:225], a[60:63], a[156:159], v[210:225]
 s_waitcnt lgkmcnt(2)
 ds_read_b128 a[152:155], v11 offset:49152
 buffer_load_dwordx4 v4, s[8:11], s48 offen offset:0 lds
 v_permlane32_swap_b32 v44, v42
 v_permlane32_swap_b32 v45, v43
 v_fma_f32 v42, v94, v44, v42
 v_mfma_f32_32x32x16_bf16 v[194:209], a[64:67], a[160:163], v[194:209]
 ds_read_b128 a[156:159], v11 offset:53248
 v_fma_f32 v43, v94, v45, v43
 v_fma_f32 v42, -v95, v45, v42
 v_fma_f32 v43, v95, v44, v43
 v_mfma_f32_32x32x16_bf16 v[210:225], a[64:67], a[164:167], v[210:225]
 ds_read_b128 a[160:163], v8 offset:57344
 buffer_load_dwordx4 v5, s[8:11], s48 offen offset:1024 lds
 ds_write_b64 v22, v[42:43] offset:768
 v_mul_f32 v40, v92, v162
 v_mul_f32 v41, v93, v162
 v_mfma_f32_32x32x16_bf16 v[194:209], a[68:71], a[168:171], v[194:209]
 s_add_u32 m0, s28, 0xb000
 ds_read_b128 a[164:167], v8 offset:61440
 v_fma_f32 v162, v93, v178, v40
 v_fma_f32 v178, -v92, v178, v41
 v_mul_f32 v40, v92, v163
 v_mul_f32 v41, v93, v163
 v_fma_f32 v163, v93, v179, v40
 v_mfma_f32_32x32x16_bf16 v[210:225], a[68:71], a[172:175], v[210:225]
 s_waitcnt lgkmcnt(3)
 ds_read_b128 a[168:171], v9 offset:57344
 buffer_load_dwordx4 v6, s[12:15], s44 offen offset:0 lds
 v_fma_f32 v179, -v92, v179, v41
 v_mul_f32 v40, v92, v164
 v_mul_f32 v41, v93, v164
 v_mfma_f32_32x32x16_bf16 v[194:209], a[72:75], a[144:147], v[194:209]
 ds_read_b128 a[172:175], v9 offset:61440
 v_fma_f32 v164, v93, v180, v40
 v_fma_f32 v180, -v92, v180, v41
 s_waitcnt lgkmcnt(3)
 s_barrier
 v_mfma_f32_32x32x16_bf16 v[210:225], a[72:75], a[148:151], v[210:225]
 ds_read_b128 a[144:147], v10 offset:57344
 buffer_load_dwordx4 v7, s[12:15], s44 offen offset:1024 lds
 ds_read_b64 v[36:37], v22 offset:0
 ds_read_b64 v[38:39], v22 offset:256
 ds_read_b64 v[46:47], v22 offset:512
 v_mfma_f32_32x32x16_bf16 v[194:209], a[76:79], a[152:155], v[194:209]
 ds_read_b128 a[148:151], v10 offset:61440
 v_mul_f32 v40, v92, v165
 v_mul_f32 v41, v93, v165
 v_fma_f32 v165, v93, v181, v40
 v_fma_f32 v181, -v92, v181, v41
 v_mul_f32 v40, v92, v166
 v_mfma_f32_32x32x16_bf16 v[210:225], a[76:79], a[156:159], v[210:225]
 s_waitcnt lgkmcnt(5)
 ds_read_b128 a[152:155], v11 offset:57344
 v_mul_f32 v41, v93, v166
 v_fma_f32 v166, v93, v182, v40
 v_fma_f32 v182, -v92, v182, v41
 v_mul_f32 v40, v92, v167
 v_mul_f32 v41, v93, v167
 v_fma_f32 v167, v93, v183, v40
 v_fma_f32 v183, -v92, v183, v41
 s_waitcnt lgkmcnt(3)
 v_fma_f32 v38, v96, v36, v38
 v_fma_f32 v39, v96, v37, v39
 v_fma_f32 v38, -v97, v37, v38
 v_fma_f32 v39, v97, v36, v39
 s_waitcnt lgkmcnt(2)
 v_fma_f32 v46, v96, v38, v46
 v_fma_f32 v47, v96, v39, v47
 v_fma_f32 v46, -v97, v39, v46
 v_fma_f32 v47, v97, v38, v47
 v_fma_f32 v42, v96, v46, v42
 v_fma_f32 v43, v96, v47, v43
 v_fma_f32 v42, -v97, v47, v42
 v_fma_f32 v43, v97, v46, v43
 s_mov_b32 s69, 0x2000
 s_cmp_lg_u32 s24, 3
 s_cbranch_scc1 sg2
 buffer_store_dwordx2 v[42:43], v20, s[4:7], s69 offen sc1
sg2:
 v_mfma_f32_32x32x16_bf16 v[194:209], a[80:83], a[160:163], v[194:209]
 s_add_u32 m0, s28, 0xd000
 ds_read_b128 a[156:159], v11 offset:61440
 ds_read_b128 v[52:55], v34 offset:3072
 ds_read_b64 v[56:57], v35
 v_add_u32 v35, s75, v35
 v_mfma_f32_32x32x16_bf16 v[210:225], a[80:83], a[164:167], v[210:225]
 s_waitcnt vmcnt(24)
 s_barrier
 ds_read_b128 a[160:163], v12 offset:0
 buffer_load_dwordx4 v6, s[12:15], s45 offen offset:0 lds
 ds_read_b128 v[74:77], v34 offset:6144
 ds_read_b128 v[78:81], v34 offset:6656
 v_mfma_f32_32x32x16_bf16 v[194:209], a[84:87], a[168:171], v[194:209]
 ds_read_b128 a[164:167], v12 offset:4096
 v_mul_f32 v40, v92, v168
 v_mul_f32 v41, v93, v168
 v_fma_f32 v168, v93, v184, v40
 v_fma_f32 v184, -v92, v184, v41
 v_mul_f32 v40, v92, v169
 v_mfma_f32_32x32x16_bf16 v[210:225], a[84:87], a[172:175], v[210:225]
 s_waitcnt lgkmcnt(6)
 ds_read_b128 a[168:171], v13 offset:0
 buffer_load_dwordx4 v7, s[12:15], s45 offen offset:1024 lds
 v_mul_f32 v41, v93, v169
 v_fma_f32 v169, v93, v185, v40
 v_fma_f32 v185, -v92, v185, v41
 v_mfma_f32_32x32x16_bf16 v[194:209], a[88:91], a[144:147], v[194:209]
 s_add_u32 m0, s28, 0xf000
 ds_read_b128 a[172:175], v13 offset:4096
 v_mul_f32 v40, v92, v170
 v_mul_f32 v41, v93, v170
 v_fma_f32 v170, v93, v186, v40
 v_fma_f32 v186, -v92, v186, v41
 v_mul_f32 v40, v92, v171
 v_mfma_f32_32x32x16_bf16 v[210:225], a[88:91], a[148:151], v[210:225]
 ds_read_b128 a[144:147], v14 offset:0
 buffer_load_dwordx4 v6, s[12:15], s46 offen offset:0 lds
 v_mul_f32 v41, v93, v171
 v_fma_f32 v171, v93, v187, v40
 v_fma_f32 v187, -v92, v187, v41
 v_mfma_f32_32x32x16_bf16 v[194:209], a[92:95], a[152:155], v[194:209]
 ds_read_b128 a[148:151], v14 offset:4096
 v_mul_f32 v40, v92, v172
 v_mul_f32 v41, v93, v172
 v_fma_f32 v172, v93, v188, v40
 v_fma_f32 v188, -v92, v188, v41
 v_mul_f32 v40, v92, v173
 v_mfma_f32_32x32x16_bf16 v[210:225], a[92:95], a[156:159], v[210:225]
 s_waitcnt lgkmcnt(2)
 ds_read_b128 a[152:155], v15 offset:0
 buffer_load_dwordx4 v7, s[12:15], s46 offen offset:1024 lds
 v_mul_f32 v41, v93, v173
 v_fma_f32 v173, v93, v189, v40
 v_fma_f32 v189, -v92, v189, v41
 v_mfma_f32_32x32x16_bf16 v[194:209], a[96:99], a[160:163], v[194:209]
 ds_read_b128 a[156:159], v15 offset:4096
 s_waitcnt vmcnt(15)
 v_max_u32 v36, v58, v60
 v_cmp_eq_u32 vcc, -1, v36
 s_nop 1
 s_cmp_lg_u64 vcc, 0
 s_cbranch_scc1 sa1_spin
sa1_back:
 v_mfma_f32_32x32x16_bf16 v[210:225], a[96:99], a[164:167], v[210:225]
 ds_read_b128 a[160:163], v12 offset:8192
 v_add_u32 v37, s1, v72
 v_fma_f32 v58, v54, v60, v58
 v_fma_f32 v59, v54, v61, v59
 v_fma_f32 v58, -v55, v61, v58
 v_fma_f32 v59, v55, v60, v59
 v_mfma_f32_32x32x16_bf16 v[194:209], a[100:103], a[168:171], v[194:209]
 ds_read_b128 a[164:167], v12 offset:12288
 ds_write_b64 v37, v[58:59]
 v_mul_f32 v70, v54, v54
 v_mul_f32 v71, v54, v55
 v_fma_f32 v70, -v55, v55, v70
 v_fma_f32 v71, v55, v54, v71
 v_mfma_f32_32x32x16_bf16 v[210:225], a[100:103], a[172:175], v[210:225]
 s_waitcnt lgkmcnt(3)
 ds_read_b128 a[168:171], v13 offset:8192
 v_mul_f32 v40, v92, v174
 v_mul_f32 v41, v93, v174
 v_fma_f32 v174, v93, v190, v40
 v_fma_f32 v190, -v92, v190, v41
 v_mul_f32 v40, v92, v175
 v_mfma_f32_32x32x16_bf16 v[194:209], a[104:107], a[144:147], v[194:209]
 ds_read_b128 a[172:175], v13 offset:12288
 v_mul_f32 v41, v93, v175
 v_fma_f32 v175, v93, v191, v40
 v_fma_f32 v191, -v92, v191, v41
 s_waitcnt lgkmcnt(2)
 s_barrier
 v_mfma_f32_32x32x16_bf16 v[210:225], a[104:107], a[148:151], v[210:225]
 ds_read_b128 a[144:147], v14 offset:8192
 ds_read_b64 v[68:69], v72 offset:15360
 ds_read_b64 v[66:67], v72 offset:10240
 ds_read_b64 v[64:65], v72 offset:5120
 ds_read_b64 v[62:63], v72 offset:0
 v_mul_f32 v40, v92, v176
 v_mfma_f32_32x32x16_bf16 v[194:209], a[108:111], a[152:155], v[194:209]
 ds_read_b128 a[148:151], v14 offset:12288
 v_mul_f32 v41, v93, v176
 v_fma_f32 v176, v93, v192, v40
 v_fma_f32 v192, -v92, v192, v41
 v_mul_f32 v40, v92, v177
 v_mul_f32 v41, v93, v177
 v_mfma_f32_32x32x16_bf16 v[210:225], a[108:111], a[156:159], v[210:225]
 s_waitcnt lgkmcnt(6)
 ds_read_b128 a[152:155], v15 offset:8192
 v_fma_f32 v177, v93, v193, v40
 v_fma_f32 v193, -v92, v193, v41
 s_waitcnt lgkmcnt(4)
 v_fma_f32 v66, v70, v68, v66
 v_fma_f32 v67, v70, v69, v67
 v_fma_f32 v66, -v71, v69, v66
 v_mfma_f32_32x32x16_bf16 v[194:209], a[112:115], a[160:163], v[194:209]
 s_add_u32 m0, s28, 0x11000
 ds_read_b128 a[156:159], v15 offset:12288
 v_fma_f32 v67, v71, v68, v67
 s_waitcnt lgkmcnt(4)
 v_fma_f32 v64, v70, v66, v64
 v_fma_f32 v65, v70, v67, v65
 v_fma_f32 v64, -v71, v67, v64
 v_fma_f32 v65, v71, v66, v65
 v_mfma_f32_32x32x16_bf16 v[210:225], a[112:115], a[164:167], v[210:225]
 s_barrier
 ds_read_b128 a[160:163], v12 offset:24576
 buffer_load_dwordx4 v6, s[12:15], s47 offen offset:0 lds
 s_waitcnt lgkmcnt(4)
 v_fma_f32 v62, v70, v64, v62
 v_fma_f32 v63, v70, v65, v63
 v_mfma_f32_32x32x16_bf16 v[194:209], a[116:119], a[168:171], v[194:209]
 ds_read_b128 a[164:167], v12 offset:28672
 v_fma_f32 v62, -v71, v65, v62
 v_fma_f32 v63, v71, v64, v63
 v_mov_b32 v64, v62
 v_mov_b32 v65, v63
 s_nop 0
 v_permlane32_swap_b32 v62, v64
 v_mfma_f32_32x32x16_bf16 v[210:225], a[116:119], a[172:175], v[210:225]
 s_waitcnt lgkmcnt(2)
 ds_read_b128 a[168:171], v13 offset:24576
 v_permlane32_swap_b32 v63, v65
 v_fma_f32 v62, v52, v64, v62
 v_fma_f32 v63, v52, v65, v63
 v_fma_f32 v62, -v53, v65, v62
 v_fma_f32 v63, v53, v64, v63
 v_mfma_f32_32x32x16_bf16 v[194:209], a[120:123], a[144:147], v[194:209]
 ds_read_b128 a[172:175], v13 offset:28672
 v_fma_f32 v50, v56, v62, v50
 v_fma_f32 v51, v56, v63, v51
 v_fma_f32 v50, -v57, v63, v50
 v_fma_f32 v51, v57, v62, v51
 v_fma_f32 v48, v86, v50, v48
 v_mfma_f32_32x32x16_bf16 v[210:225], a[120:123], a[148:151], v[210:225]
 ds_read_b128 a[144:147], v14 offset:24576
 v_fma_f32 v49, v86, v51, v49
 v_fma_f32 v48, -v87, v51, v48
 v_fma_f32 v49, v87, v50, v49
 v_cndmask_b32 v38, v50, v48, s[84:85]
 v_cndmask_b32 v39, v51, v49, s[84:85]
 v_mfma_f32_32x32x16_bf16 v[194:209], a[124:127], a[152:155], v[194:209]
 ds_read_b128 a[148:151], v14 offset:28672
 v_mul_f32 v36, v84, v38
 v_mul_f32 v37, v84, v39
 v_fma_f32 v36, -v85, v39, v36
 v_fma_f32 v37, v85, v38, v37
 v_fmac_f32 v130, v82, v36
 v_mfma_f32_32x32x16_bf16 v[210:225], a[124:127], a[156:159], v[210:225]
 s_waitcnt lgkmcnt(2)
 ds_read_b128 a[152:155], v15 offset:24576
 v_fmac_f32 v146, v82, v37
 v_fma_f32 v130, -v83, v37, v130
 v_fmac_f32 v146, v83, v36
 v_fmac_f32 v131, v82, v130
 v_fmac_f32 v147, v82, v146
 v_mfma_f32_32x32x16_bf16 v[194:209], a[128:131], a[160:163], v[194:209]
 ds_read_b128 a[156:159], v15 offset:28672
 buffer_load_dwordx4 v7, s[12:15], s47 offen offset:1024 lds
 v_fma_f32 v131, -v83, v146, v131
 v_fmac_f32 v147, v83, v130
 v_fmac_f32 v132, v82, v131
 v_mfma_f32_32x32x16_bf16 v[210:225], a[128:131], a[164:167], v[210:225]
 s_add_u32 m0, s28, 0x13000
 ds_read_b128 a[160:163], v8 offset:8192
 v_fmac_f32 v148, v82, v147
 v_fma_f32 v132, -v83, v147, v132
 v_fmac_f32 v148, v83, v131
 v_fmac_f32 v133, v82, v132
 v_fmac_f32 v149, v82, v148
 v_mfma_f32_32x32x16_bf16 v[194:209], a[132:135], a[168:171], v[194:209]
 ds_read_b128 a[164:167], v8 offset:12288
 buffer_load_dwordx4 v6, s[12:15], s33 offen offset:0 lds
 v_cvt_pk_bf16_f32 v130, v130, v131
 v_cvt_pk_bf16_f32 v146, v146, v147
 v_fma_f32 v133, -v83, v148, v133
 v_mfma_f32_32x32x16_bf16 v[210:225], a[132:135], a[172:175], v[210:225]
 s_waitcnt lgkmcnt(2)
 ds_read_b128 a[168:171], v9 offset:8192
 v_fmac_f32 v149, v83, v132
 v_fmac_f32 v134, v82, v133
 v_fmac_f32 v150, v82, v149
 v_fma_f32 v134, -v83, v149, v134
 v_fmac_f32 v150, v83, v133
 v_mfma_f32_32x32x16_bf16 v[194:209], a[136:139], a[144:147], v[194:209]
 ds_read_b128 a[172:175], v9 offset:12288
 buffer_load_dwordx4 v7, s[12:15], s33 offen offset:1024 lds
 v_fmac_f32 v135, v82, v134
 v_fmac_f32 v151, v82, v150
 v_cvt_pk_bf16_f32 v131, v132, v133
 v_mfma_f32_32x32x16_bf16 v[210:225], a[136:139], a[148:151], v[210:225]
 ds_read_b128 a[144:147], v10 offset:8192
 v_cvt_pk_bf16_f32 v147, v148, v149
 v_fma_f32 v135, -v83, v150, v135
 v_fmac_f32 v151, v83, v134
 v_fmac_f32 v136, v82, v135
 v_fmac_f32 v152, v82, v151
 v_mfma_f32_32x32x16_bf16 v[194:209], a[140:143], a[152:155], v[194:209]
 ds_read_b128 a[148:151], v10 offset:12288
 v_fma_f32 v136, -v83, v151, v136
 v_fmac_f32 v152, v83, v135
 v_fmac_f32 v137, v82, v136
 v_fmac_f32 v153, v82, v152
 v_cvt_pk_bf16_f32 v132, v134, v135
 v_mfma_f32_32x32x16_bf16 v[210:225], a[140:143], a[156:159], v[210:225]
 s_waitcnt lgkmcnt(2)
 ds_read_b128 a[152:155], v11 offset:8192
 s_mov_b32 s72, 0x2000
 s_add_u32 s78, s73, 0x3000
 v_cvt_pk_bf16_f32 v148, v150, v151
 v_fma_f32 v137, -v83, v152, v137
 v_fmac_f32 v153, v83, v136
 v_mfma_f32_32x32x16_bf16 v[98:113], a[0:3], a[160:163], 0
 ds_read_b128 a[156:159], v11 offset:12288
 buffer_load_dwordx2 v[58:59], v21, s[76:79], s72 offen offset:256 sc1
 v_fmac_f32 v138, v82, v137
 v_fmac_f32 v154, v82, v153
 v_fma_f32 v138, -v83, v153, v138
 v_mfma_f32_32x32x16_bf16 v[114:129], a[0:3], a[164:167], 0
 s_barrier
 ds_read_b128 a[160:163], v8 offset:16384
 v_fmac_f32 v154, v83, v137
 v_fmac_f32 v139, v82, v138
 v_fmac_f32 v155, v82, v154
 v_cvt_pk_bf16_f32 v133, v136, v137
 v_mfma_f32_32x32x16_bf16 v[98:113], a[4:7], a[168:171], v[98:113]
 ds_read_b128 a[164:167], v8 offset:20480
 buffer_load_dwordx2 v[60:61], v21, s[76:79], s72 offen offset:768 sc1
 v_cvt_pk_bf16_f32 v149, v152, v153
 v_fma_f32 v139, -v83, v154, v139
 v_fmac_f32 v155, v83, v138
 v_mfma_f32_32x32x16_bf16 v[114:129], a[4:7], a[172:175], v[114:129]
 s_waitcnt lgkmcnt(2)
 ds_read_b128 a[168:171], v9 offset:16384
 s_add_u32 s48, s44, s74
 s_add_u32 m0, s28, 0x15000
 v_fmac_f32 v140, v82, v139
 v_fmac_f32 v156, v82, v155
 v_fma_f32 v140, -v83, v155, v140
 v_mfma_f32_32x32x16_bf16 v[98:113], a[8:11], a[144:147], v[98:113]
 ds_read_b128 a[172:175], v9 offset:20480
 buffer_load_dwordx4 v4, s[12:15], s48 offen offset:0 lds
 v_fmac_f32 v156, v83, v139
 v_fmac_f32 v141, v82, v140
 v_fmac_f32 v157, v82, v156
 v_mfma_f32_32x32x16_bf16 v[114:129], a[8:11], a[148:151], v[114:129]
 ds_read_b128 a[144:147], v10 offset:16384
 v_cvt_pk_bf16_f32 v134, v138, v139
 v_cvt_pk_bf16_f32 v150, v154, v155
 v_fma_f32 v141, -v83, v156, v141
 v_fmac_f32 v157, v83, v140
 v_fmac_f32 v142, v82, v141
 v_mfma_f32_32x32x16_bf16 v[98:113], a[12:15], a[152:155], v[98:113]
 ds_read_b128 a[148:151], v10 offset:20480
 buffer_load_dwordx4 v5, s[12:15], s48 offen offset:1024 lds
 v_fmac_f32 v158, v82, v157
 v_fma_f32 v142, -v83, v157, v142
 v_fmac_f32 v158, v83, v141
 v_mfma_f32_32x32x16_bf16 v[114:129], a[12:15], a[156:159], v[114:129]
 s_waitcnt lgkmcnt(2)
 ds_read_b128 a[152:155], v11 offset:16384
 s_add_u32 s48, s44, s80
 s_add_u32 m0, s28, 0x19000
 v_fmac_f32 v143, v82, v142
 v_fmac_f32 v159, v82, v158
 v_cvt_pk_bf16_f32 v135, v140, v141
 v_mfma_f32_32x32x16_bf16 v[98:113], a[16:19], a[160:163], v[98:113]
 ds_read_b128 a[156:159], v11 offset:20480
 buffer_load_dwordx4 v4, s[12:15], s48 offen offset:0 lds
 v_cvt_pk_bf16_f32 v151, v156, v157
 v_fma_f32 v143, -v83, v158, v143
 v_fmac_f32 v159, v83, v142
 v_mfma_f32_32x32x16_bf16 v[114:129], a[16:19], a[164:167], v[114:129]
 ds_read_b128 a[160:163], v12 offset:32768
 v_fmac_f32 v144, v82, v143
 v_fmac_f32 v160, v82, v159
 v_fma_f32 v144, -v83, v159, v144
 v_fmac_f32 v160, v83, v143
 v_fmac_f32 v145, v82, v144
 v_mfma_f32_32x32x16_bf16 v[98:113], a[20:23], a[168:171], v[98:113]
 ds_read_b128 a[164:167], v12 offset:36864
 buffer_load_dwordx4 v5, s[12:15], s48 offen offset:1024 lds
 v_fmac_f32 v161, v82, v160
 v_cvt_pk_bf16_f32 v136, v142, v143
 v_cvt_pk_bf16_f32 v152, v158, v159
 v_mfma_f32_32x32x16_bf16 v[114:129], a[20:23], a[172:175], v[114:129]
 s_waitcnt lgkmcnt(2)
 ds_read_b128 a[168:171], v13 offset:32768
 v_fma_f32 v145, -v83, v160, v145
 v_fmac_f32 v161, v83, v144
 v_cvt_pk_bf16_f32 v137, v144, v145
 v_cvt_pk_bf16_f32 v153, v160, v161
 v_mfma_f32_32x32x16_bf16 v[98:113], a[24:27], a[144:147], v[98:113]
 ds_read_b128 a[172:175], v13 offset:36864
 ds_write_b128 v23, v[130:133] offset:0
 ds_write_b128 v23, v[134:137] offset:16
 v_mfma_f32_32x32x16_bf16 v[114:129], a[24:27], a[148:151], v[114:129]
 ds_read_b128 a[144:147], v14 offset:32768
 ds_write_b128 v23, v[146:149] offset:2560
 ds_write_b128 v23, v[150:153] offset:2576
 ds_read_b64_tr_b16 a[192:193], v3 offset:0
 v_mfma_f32_32x32x16_bf16 v[98:113], a[28:31], a[152:155], v[98:113]
 ds_read_b128 a[148:151], v14 offset:36864
 ds_read_b64_tr_b16 a[194:195], v3 offset:320
 ds_read_b64_tr_b16 a[196:197], v3 offset:1280
 ds_read_b64_tr_b16 a[198:199], v3 offset:1600
 ds_read_b64_tr_b16 a[200:201], v3 offset:2560
 ds_read_b64_tr_b16 a[202:203], v3 offset:2880
 v_mfma_f32_32x32x16_bf16 v[114:129], a[28:31], a[156:159], v[114:129]
 s_waitcnt lgkmcnt(12)
 ds_read_b128 a[152:155], v15 offset:32768
 ds_read_b64_tr_b16 a[204:205], v3 offset:3840
 ds_read_b64_tr_b16 a[206:207], v3 offset:4160
 v_fma_f32 v38, v74, v194, v195
 v_fma_f32 v39, -v74, v210, -v211
 v_fmac_f32 v38, v75, v210
 v_mfma_f32_32x32x16_bf16 v[98:113], a[32:35], a[160:163], v[98:113]
 s_add_u32 s48, s45, s74
 ds_read_b128 a[156:159], v15 offset:36864
 s_add_u32 m0, s28, 0x5000
 v_fmac_f32 v39, v75, v194
 v_fma_f32 v36, v74, v38, v196
 v_fma_f32 v37, v74, v39, -v212
 v_fma_f32 v36, -v75, v39, v36
 v_mfma_f32_32x32x16_bf16 v[114:129], a[32:35], a[164:167], v[114:129]
 s_waitcnt vmcnt(24)
 s_barrier
 ds_read_b128 a[160:163], v12 offset:40960
 buffer_load_dwordx4 v4, s[12:15], s48 offen offset:0 lds
 v_fmac_f32 v37, v75, v38
 v_fma_f32 v38, v74, v36, v197
 v_mfma_f32_32x32x16_bf16 v[98:113], a[36:39], a[168:171], v[98:113]
 ds_read_b128 a[164:167], v12 offset:45056
 v_fma_f32 v39, v74, v37, -v213
 v_fma_f32 v38, -v75, v37, v38
 v_fmac_f32 v39, v75, v36
 v_fma_f32 v36, v74, v38, v198
 v_fma_f32 v37, v74, v39, -v214
 v_mfma_f32_32x32x16_bf16 v[114:129], a[36:39], a[172:175], v[114:129]
 s_waitcnt lgkmcnt(2)
 ds_read_b128 a[168:171], v13 offset:40960
 buffer_load_dwordx4 v5, s[12:15], s48 offen offset:1024 lds
 v_fma_f32 v36, -v75, v39, v36
 v_fmac_f32 v37, v75, v38
 v_fma_f32 v38, v74, v36, v199
 v_mfma_f32_32x32x16_bf16 v[98:113], a[40:43], a[144:147], v[98:113]
 s_add_u32 s48, s45, s80
 ds_read_b128 a[172:175], v13 offset:45056
 s_add_u32 m0, s28, 0x7000
 v_fma_f32 v39, v74, v37, -v215
 v_fma_f32 v38, -v75, v37, v38
 v_fmac_f32 v39, v75, v36
 v_fma_f32 v36, v74, v38, v200
 v_mfma_f32_32x32x16_bf16 v[114:129], a[40:43], a[148:151], v[114:129]
 ds_read_b128 a[144:147], v14 offset:40960
 buffer_load_dwordx4 v4, s[12:15], s48 offen offset:0 lds
 v_fma_f32 v37, v74, v39, -v216
 v_fma_f32 v36, -v75, v39, v36
 v_fmac_f32 v37, v75, v38
 v_mfma_f32_32x32x16_bf16 v[98:113], a[44:47], a[152:155], v[98:113]
 ds_read_b128 a[148:151], v14 offset:45056
 v_fma_f32 v38, v74, v36, v201
 v_fma_f32 v39, v74, v37, -v217
 v_fma_f32 v38, -v75, v37, v38
 v_fmac_f32 v39, v75, v36
 v_fma_f32 v36, v74, v38, v202
 v_mfma_f32_32x32x16_bf16 v[114:129], a[44:47], a[156:159], v[114:129]
 s_waitcnt lgkmcnt(2)
 ds_read_b128 a[152:155], v15 offset:40960
 buffer_load_dwordx4 v5, s[12:15], s48 offen offset:1024 lds
 v_fma_f32 v37, v74, v39, -v218
 v_fma_f32 v36, -v75, v39, v36
 v_fmac_f32 v37, v75, v38
 v_mfma_f32_32x32x16_bf16 v[98:113], a[48:51], a[160:163], v[98:113]
 ds_read_b128 a[156:159], v15 offset:45056
 v_fma_f32 v38, v74, v36, v203
 v_fma_f32 v39, v74, v37, -v219
 v_fma_f32 v38, -v75, v37, v38
 v_fmac_f32 v39, v75, v36
 v_fma_f32 v36, v74, v38, v204
 v_mfma_f32_32x32x16_bf16 v[114:129], a[48:51], a[164:167], v[114:129]
 ds_read_b128 a[160:163], v8 offset:24576
 v_fma_f32 v37, v74, v39, -v220
 v_fma_f32 v36, -v75, v39, v36
 v_fmac_f32 v37, v75, v38
 v_fma_f32 v38, v74, v36, v205
 v_fma_f32 v39, v74, v37, -v221
 v_mfma_f32_32x32x16_bf16 v[98:113], a[52:55], a[168:171], v[98:113]
 ds_read_b128 a[164:167], v8 offset:28672
 v_fma_f32 v38, -v75, v37, v38
 v_fmac_f32 v39, v75, v36
 v_fma_f32 v36, v74, v38, v206
 v_fma_f32 v37, v74, v39, -v222
 v_fma_f32 v36, -v75, v39, v36
 v_mfma_f32_32x32x16_bf16 v[114:129], a[52:55], a[172:175], v[114:129]
 s_waitcnt lgkmcnt(2)
 ds_read_b128 a[168:171], v9 offset:24576
 v_fmac_f32 v37, v75, v38
 v_fma_f32 v38, v74, v36, v207
 v_fma_f32 v39, v74, v37, -v223
 v_fma_f32 v38, -v75, v37, v38
 v_fmac_f32 v39, v75, v36
 v_mfma_f32_32x32x16_bf16 v[98:113], a[56:59], a[144:147], v[98:113]
 ds_read_b128 a[172:175], v9 offset:28672
 v_fma_f32 v36, v74, v38, v208
 v_fma_f32 v37, v74, v39, -v224
 v_fma_f32 v36, -v75, v39, v36
 v_fmac_f32 v37, v75, v38
 v_fma_f32 v48, v74, v36, v209
 v_mfma_f32_32x32x16_bf16 v[114:129], a[56:59], a[148:151], v[114:129]
 ds_read_b128 a[144:147], v10 offset:24576
 v_fma_f32 v49, v74, v37, -v225
 v_fma_f32 v48, -v75, v37, v48
 v_fmac_f32 v49, v75, v36
 v_mov_b32 v42, v48
 v_mov_b32 v43, v49
 v_mfma_f32_32x32x16_bf16 v[98:113], a[60:63], a[152:155], v[98:113]
 ds_read_b128 a[148:151], v10 offset:28672
 v_permlane32_swap_b32 v48, v42
 v_permlane32_swap_b32 v49, v43
 v_fma_f32 v42, v78, v48, v42
 v_fma_f32 v43, v78, v49, v43
 v_fma_f32 v42, -v79, v49, v42
 v_mfma_f32_32x32x16_bf16 v[114:129], a[60:63], a[156:159], v[114:129]
 s_waitcnt lgkmcnt(2)
 ds_read_b128 a[152:155], v11 offset:24576
 v_fma_f32 v43, v79, v48, v43
 v_mfma_f32_32x32x16_bf16 v[98:113], a[64:67], a[160:163], v[98:113]
 s_add_u32 s48, s46, s74
 ds_read_b128 a[156:159], v11 offset:28672
 s_add_u32 m0, s28, 0x1b000
 ds_write_b64 v22, v[42:43] offset:768
 v_mul_f32 v40, v76, v194
 v_mul_f32 v41, v77, v194
 v_fma_f32 v194, v77, v210, v40
 v_mfma_f32_32x32x16_bf16 v[114:129], a[64:67], a[164:167], v[114:129]
 s_waitcnt vmcnt(24)
 s_barrier
 ds_read_b128 a[160:163], v12 offset:16384
 buffer_load_dwordx4 v4, s[12:15], s48 offen offset:0 lds
 v_fma_f32 v210, -v76, v210, v41
 v_mul_f32 v40, v76, v195
 v_mfma_f32_32x32x16_bf16 v[98:113], a[68:71], a[168:171], v[98:113]
 ds_read_b128 a[164:167], v12 offset:20480
 v_mul_f32 v41, v77, v195
 v_fma_f32 v195, v77, v211, v40
 v_fma_f32 v211, -v76, v211, v41
 v_mul_f32 v40, v76, v196
 v_mul_f32 v41, v77, v196
 v_mfma_f32_32x32x16_bf16 v[114:129], a[68:71], a[172:175], v[114:129]
 s_waitcnt lgkmcnt(3)
 ds_read_b128 a[168:171], v13 offset:16384
 buffer_load_dwordx4 v5, s[12:15], s48 offen offset:1024 lds
 v_fma_f32 v196, v77, v212, v40
 v_fma_f32 v212, -v76, v212, v41
 s_waitcnt lgkmcnt(3)
 s_barrier
 v_mfma_f32_32x32x16_bf16 v[98:113], a[72:75], a[144:147], v[98:113]
 s_add_u32 s48, s46, s80
 ds_read_b128 a[172:175], v13 offset:20480
 s_add_u32 m0, s28, 0x1d000
 ds_read_b64 v[36:37], v22 offset:0
 ds_read_b64 v[38:39], v22 offset:256
 ds_read_b64 v[50:51], v22 offset:512
 v_mul_f32 v40, v76, v197
 v_mfma_f32_32x32x16_bf16 v[114:129], a[72:75], a[148:151], v[114:129]
 ds_read_b128 a[144:147], v14 offset:16384
 buffer_load_dwordx4 v4, s[12:15], s48 offen offset:0 lds
 v_mul_f32 v41, v77, v197
 v_fma_f32 v197, v77, v213, v40
 v_fma_f32 v213, -v76, v213, v41
 v_mfma_f32_32x32x16_bf16 v[98:113], a[76:79], a[152:155], v[98:113]
 ds_read_b128 a[148:151], v14 offset:20480
 v_mul_f32 v40, v76, v198
 v_mul_f32 v41, v77, v198
 v_fma_f32 v198, v77, v214, v40
 v_fma_f32 v214, -v76, v214, v41
 v_mul_f32 v40, v76, v199
 v_mfma_f32_32x32x16_bf16 v[114:129], a[76:79], a[156:159], v[114:129]
 s_waitcnt lgkmcnt(5)
 ds_read_b128 a[152:155], v15 offset:16384
 buffer_load_dwordx4 v5, s[12:15], s48 offen offset:1024 lds
 v_mul_f32 v41, v77, v199
 v_fma_f32 v199, v77, v215, v40
 v_fma_f32 v215, -v76, v215, v41
 s_waitcnt lgkmcnt(4)
 v_fma_f32 v38, v80, v36, v38
 v_fma_f32 v39, v80, v37, v39
 v_fma_f32 v38, -v81, v37, v38
 v_fma_f32 v39, v81, v36, v39
 s_waitcnt lgkmcnt(3)
 v_fma_f32 v50, v80, v38, v50
 v_fma_f32 v51, v80, v39, v51
 v_fma_f32 v50, -v81, v39, v50
 v_fma_f32 v51, v81, v38, v51
 v_fma_f32 v42, v80, v50, v42
 v_fma_f32 v43, v80, v51, v43
 v_fma_f32 v42, -v81, v51, v42
 v_fma_f32 v43, v81, v50, v43
 s_mov_b32 s69, 0x3000
 s_cmp_lg_u32 s24, 3
 s_cbranch_scc1 sg3
 buffer_store_dwordx2 v[42:43], v20, s[4:7], s69 offen sc1
sg3:
 v_mfma_f32_32x32x16_bf16 v[98:113], a[80:83], a[160:163], v[98:113]
 ds_read_b128 a[156:159], v15 offset:20480
 ds_read_b128 v[52:55], v34 offset:5120
 ds_read_b64 v[56:57], v35
 v_add_u32 v35, s75, v35
 v_mfma_f32_32x32x16_bf16 v[114:129], a[80:83], a[164:167], v[114:129]
 ds_read_b128 a[160:163], v12 offset:49152
 ds_read_b128 v[82:85], v34 offset:8192
 ds_read_b128 v[86:89], v34 offset:8704
 v_mul_f32 v40, v76, v200
 v_mul_f32 v41, v77, v200
 v_fma_f32 v200, v77, v216, v40
 v_mfma_f32_32x32x16_bf16 v[98:113], a[84:87], a[168:171], v[98:113]
 ds_read_b128 a[164:167], v12 offset:53248
 v_fma_f32 v216, -v76, v216, v41
 v_mul_f32 v40, v76, v201
 v_mul_f32 v41, v77, v201
 v_fma_f32 v201, v77, v217, v40
 v_fma_f32 v217, -v76, v217, v41
 v_mfma_f32_32x32x16_bf16 v[114:129], a[84:87], a[172:175], v[114:129]
 s_waitcnt lgkmcnt(6)
 ds_read_b128 a[168:171], v13 offset:49152
 v_mul_f32 v40, v76, v202
 v_mul_f32 v41, v77, v202
 v_fma_f32 v202, v77, v218, v40
 v_fma_f32 v218, -v76, v218, v41
 v_mul_f32 v40, v76, v203
 v_mfma_f32_32x32x16_bf16 v[98:113], a[88:91], a[144:147], v[98:113]
 ds_read_b128 a[172:175], v13 offset:53248
 v_mul_f32 v41, v77, v203
 v_fma_f32 v203, v77, v219, v40
 v_fma_f32 v219, -v76, v219, v41
 v_mul_f32 v40, v76, v204
 v_mul_f32 v41, v77, v204
 v_mfma_f32_32x32x16_bf16 v[114:129], a[88:91], a[148:151], v[114:129]
 ds_read_b128 a[144:147], v14 offset:49152
 v_fma_f32 v204, v77, v220, v40
 v_fma_f32 v220, -v76, v220, v41
 v_mul_f32 v40, v76, v205
 v_mul_f32 v41, v77, v205
 v_fma_f32 v205, v77, v221, v40
 v_mfma_f32_32x32x16_bf16 v[98:113], a[92:95], a[152:155], v[98:113]
 ds_read_b128 a[148:151], v14 offset:53248
 v_fma_f32 v221, -v76, v221, v41
 s_waitcnt vmcnt(12)
 v_max_u32 v36, v58, v60
 v_cmp_eq_u32 vcc, -1, v36
 s_nop 1
 s_cmp_lg_u64 vcc, 0
 s_cbranch_scc1 sa2_spin
sa2_back:
 v_mfma_f32_32x32x16_bf16 v[114:129], a[92:95], a[156:159], v[114:129]
 s_waitcnt lgkmcnt(2)
 ds_read_b128 a[152:155], v15 offset:49152
 v_add_u32 v37, s1, v72
 v_fma_f32 v58, v54, v60, v58
 v_fma_f32 v59, v54, v61, v59
 v_fma_f32 v58, -v55, v61, v58
 v_fma_f32 v59, v55, v60, v59
 v_mfma_f32_32x32x16_bf16 v[98:113], a[96:99], a[160:163], v[98:113]
 s_add_u32 s48, s47, s74
 ds_read_b128 a[156:159], v15 offset:53248
 s_add_u32 m0, s28, 0x9000
 ds_write_b64 v37, v[58:59]
 v_mul_f32 v70, v54, v54
 v_mul_f32 v71, v54, v55
 v_fma_f32 v70, -v55, v55, v70
 v_mfma_f32_32x32x16_bf16 v[114:129], a[96:99], a[164:167], v[114:129]
 s_barrier
 ds_read_b128 a[160:163], v12 offset:57344
 buffer_load_dwordx4 v4, s[12:15], s48 offen offset:0 lds
 v_fma_f32 v71, v55, v54, v71
 v_mul_f32 v40, v76, v206
 v_mfma_f32_32x32x16_bf16 v[98:113], a[100:103], a[168:171], v[98:113]
 ds_read_b128 a[164:167], v12 offset:61440
 v_mul_f32 v41, v77, v206
 v_fma_f32 v206, v77, v222, v40
 v_fma_f32 v222, -v76, v222, v41
 v_mul_f32 v40, v76, v207
 v_mul_f32 v41, v77, v207
 v_mfma_f32_32x32x16_bf16 v[114:129], a[100:103], a[172:175], v[114:129]
 s_waitcnt lgkmcnt(3)
 ds_read_b128 a[168:171], v13 offset:57344
 buffer_load_dwordx4 v5, s[12:15], s48 offen offset:1024 lds
 v_fma_f32 v207, v77, v223, v40
 v_fma_f32 v223, -v76, v223, v41
 s_waitcnt lgkmcnt(3)
 s_barrier
 v_mfma_f32_32x32x16_bf16 v[98:113], a[104:107], a[144:147], v[98:113]
 s_add_u32 s48, s47, s80
 ds_read_b128 a[172:175], v13 offset:61440
 s_add_u32 m0, s28, 0x17000
 ds_read_b64 v[68:69], v72 offset:15360
 ds_read_b64 v[66:67], v72 offset:10240
 ds_read_b64 v[64:65], v72 offset:5120
 ds_read_b64 v[62:63], v72 offset:0
 v_mfma_f32_32x32x16_bf16 v[114:129], a[104:107], a[148:151], v[114:129]
 ds_read_b128 a[144:147], v14 offset:57344
 buffer_load_dwordx4 v4, s[12:15], s48 offen offset:0 lds
 v_mul_f32 v40, v76, v208
 v_mul_f32 v41, v77, v208
 v_fma_f32 v208, v77, v224, v40
 v_mfma_f32_32x32x16_bf16 v[98:113], a[108:111], a[152:155], v[98:113]
 ds_read_b128 a[148:151], v14 offset:61440
 v_fma_f32 v224, -v76, v224, v41
 v_mul_f32 v40, v76, v209
 v_mul_f32 v41, v77, v209
 v_fma_f32 v209, v77, v225, v40
 v_fma_f32 v225, -v76, v225, v41
 v_mfma_f32_32x32x16_bf16 v[114:129], a[108:111], a[156:159], v[114:129]
 s_waitcnt lgkmcnt(6)
 ds_read_b128 a[152:155], v15 offset:57344
 buffer_load_dwordx4 v5, s[12:15], s48 offen offset:1024 lds
 s_waitcnt lgkmcnt(5)
 v_fma_f32 v66, v70, v68, v66
 v_fma_f32 v67, v70, v69, v67
 v_fma_f32 v66, -v71, v69, v66
 v_mfma_f32_32x32x16_bf16 v[98:113], a[112:115], a[160:163], v[98:113]
 ds_read_b128 a[156:159], v15 offset:61440
 v_fma_f32 v67, v71, v68, v67
 s_waitcnt lgkmcnt(5)
 v_fma_f32 v64, v70, v66, v64
 v_fma_f32 v65, v70, v67, v65
 v_fma_f32 v64, -v71, v67, v64
 v_fma_f32 v65, v71, v66, v65
 v_mfma_f32_32x32x16_bf16 v[114:129], a[112:115], a[164:167], v[114:129]
 ds_read_b128 a[160:163], v8 offset:0
 s_waitcnt lgkmcnt(5)
 v_fma_f32 v62, v70, v64, v62
 v_fma_f32 v63, v70, v65, v63
 v_fma_f32 v62, -v71, v65, v62
 v_fma_f32 v63, v71, v64, v63
 v_mov_b32 v64, v62
 v_mfma_f32_32x32x16_bf16 v[98:113], a[116:119], a[168:171], v[98:113]
 ds_read_b128 a[164:167], v8 offset:4096
 v_mov_b32 v65, v63
 v_permlane32_swap_b32 v62, v64
 s_nop 0
 v_permlane32_swap_b32 v63, v65
 v_fma_f32 v62, v52, v64, v62
 v_fma_f32 v63, v52, v65, v63
 v_mfma_f32_32x32x16_bf16 v[114:129], a[116:119], a[172:175], v[114:129]
 s_waitcnt lgkmcnt(2)
 ds_read_b128 a[168:171], v9 offset:0
 v_fma_f32 v62, -v53, v65, v62
 v_fma_f32 v63, v53, v64, v63
 v_fma_f32 v46, v56, v62, v46
 v_fma_f32 v47, v56, v63, v47
 v_fma_f32 v46, -v57, v63, v46
 v_mfma_f32_32x32x16_bf16 v[98:113], a[120:123], a[144:147], v[98:113]
 ds_read_b128 a[172:175], v9 offset:4096
 v_fma_f32 v47, v57, v62, v47
 v_fma_f32 v44, v94, v46, v44
 v_fma_f32 v45, v94, v47, v45
 v_fma_f32 v44, -v95, v47, v44
 v_fma_f32 v45, v95, v46, v45
 v_mfma_f32_32x32x16_bf16 v[114:129], a[120:123], a[148:151], v[114:129]
 ds_read_b128 a[144:147], v10 offset:0
 v_cndmask_b32 v38, v46, v44, s[84:85]
 v_cndmask_b32 v39, v47, v45, s[84:85]
 v_mul_f32 v36, v92, v38
 v_mul_f32 v37, v92, v39
 v_fma_f32 v36, -v93, v39, v36
 v_mfma_f32_32x32x16_bf16 v[98:113], a[124:127], a[152:155], v[98:113]
 ds_read_b128 a[148:151], v10 offset:4096
 v_fma_f32 v37, v93, v38, v37
 v_fmac_f32 v162, v90, v36
 v_fmac_f32 v178, v90, v37
 v_fma_f32 v162, -v91, v37, v162
 v_fmac_f32 v178, v91, v36
 v_mfma_f32_32x32x16_bf16 v[114:129], a[124:127], a[156:159], v[114:129]
 s_waitcnt lgkmcnt(2)
 ds_read_b128 a[152:155], v11 offset:0
 v_fmac_f32 v163, v90, v162
 v_fmac_f32 v179, v90, v178
 v_fma_f32 v163, -v91, v178, v163
 v_fmac_f32 v179, v91, v162
 v_fmac_f32 v164, v90, v163
 v_mfma_f32_32x32x16_bf16 v[98:113], a[128:131], a[160:163], v[98:113]
 s_add_u32 s48, s33, s74
 ds_read_b128 a[156:159], v11 offset:4096
 s_add_u32 m0, s28, 0x1f000
 v_fmac_f32 v180, v90, v179
 v_fma_f32 v164, -v91, v179, v164
 v_fmac_f32 v180, v91, v163
 v_fmac_f32 v165, v90, v164
 v_mfma_f32_32x32x16_bf16 v[114:129], a[128:131], a[164:167], v[114:129]
 s_barrier
 ds_read_b128 a[160:163], v16 offset:32768
 buffer_load_dwordx4 v4, s[12:15], s48 offen offset:0 lds
 v_fmac_f32 v181, v90, v180
 v_cvt_pk_bf16_f32 v162, v162, v163
 v_mfma_f32_32x32x16_bf16 v[98:113], a[132:135], a[168:171], v[98:113]
 ds_read_b128 a[164:167], v16 offset:34816
 v_cvt_pk_bf16_f32 v178, v178, v179
 v_fma_f32 v165, -v91, v180, v165
 v_fmac_f32 v181, v91, v164
 v_fmac_f32 v166, v90, v165
 v_fmac_f32 v182, v90, v181
 v_mfma_f32_32x32x16_bf16 v[114:129], a[132:135], a[172:175], v[114:129]
 s_waitcnt lgkmcnt(2)
 ds_read_b128 a[168:171], v16 offset:36864
 buffer_load_dwordx4 v5, s[12:15], s48 offen offset:1024 lds
 v_fma_f32 v166, -v91, v181, v166
 v_fmac_f32 v182, v91, v165
 v_fmac_f32 v167, v90, v166
 v_mfma_f32_32x32x16_bf16 v[98:113], a[136:139], a[144:147], v[98:113]
 s_add_u32 s48, s33, s80
 ds_read_b128 a[172:175], v16 offset:38912
 s_add_u32 m0, s28, 0x21000
 v_fmac_f32 v183, v90, v182
 v_cvt_pk_bf16_f32 v163, v164, v165
 v_cvt_pk_bf16_f32 v179, v180, v181
 v_fma_f32 v167, -v91, v182, v167
 v_mfma_f32_32x32x16_bf16 v[114:129], a[136:139], a[148:151], v[114:129]
 ds_read_b128 a[144:147], v16 offset:40960
 buffer_load_dwordx4 v4, s[12:15], s48 offen offset:0 lds
 v_fmac_f32 v183, v91, v166
 v_fmac_f32 v168, v90, v167
 v_fmac_f32 v184, v90, v183
 v_mfma_f32_32x32x16_bf16 v[98:113], a[140:143], a[152:155], v[98:113]
 ds_read_b128 a[148:151], v16 offset:43008
 v_fma_f32 v168, -v91, v183, v168
 v_fmac_f32 v184, v91, v167
 v_fmac_f32 v169, v90, v168
 v_fmac_f32 v185, v90, v184
 v_cvt_pk_bf16_f32 v164, v166, v167
 v_mfma_f32_32x32x16_bf16 v[114:129], a[140:143], a[156:159], v[114:129]
 s_waitcnt lgkmcnt(2)
 ds_read_b128 a[152:155], v16 offset:45056
 buffer_load_dwordx4 v5, s[12:15], s48 offen offset:1024 lds
 v_cvt_pk_bf16_f32 v180, v182, v183
 v_fma_f32 v169, -v91, v184, v169
 v_fmac_f32 v185, v91, v168
 v_mfma_f32_32x32x16_bf16 a[0:15], a[160:163], a[176:179], 0
 s_mov_b32 s72, 0x3000
 ds_read_b128 a[156:159], v16 offset:47104
 s_add_u32 s78, s73, 0x4000
 v_fmac_f32 v170, v90, v169
 v_fmac_f32 v186, v90, v185
 v_fma_f32 v170, -v91, v185, v170
 v_fmac_f32 v186, v91, v169
 v_mfma_f32_32x32x16_bf16 a[16:31], a[164:167], a[176:179], 0
 ds_read_b128 a[160:163], v16 offset:49152
 buffer_load_dwordx2 v[58:59], v21, s[76:79], s72 offen offset:256 sc1
 v_fmac_f32 v171, v90, v170
 v_fmac_f32 v187, v90, v186
 v_cvt_pk_bf16_f32 v165, v168, v169
 v_mfma_f32_32x32x16_bf16 a[0:15], a[168:171], a[184:187], a[0:15]
 ds_read_b128 a[164:167], v16 offset:51200
 v_cvt_pk_bf16_f32 v181, v184, v185
 v_fma_f32 v171, -v91, v186, v171
 v_fmac_f32 v187, v91, v170
 v_fmac_f32 v172, v90, v171
 v_fmac_f32 v188, v90, v187
 v_mfma_f32_32x32x16_bf16 a[16:31], a[172:175], a[184:187], a[16:31]
 s_waitcnt lgkmcnt(2)
 ds_read_b128 a[168:171], v16 offset:53248
 buffer_load_dwordx2 v[60:61], v21, s[76:79], s72 offen offset:768 sc1
 v_fma_f32 v172, -v91, v187, v172
 v_fmac_f32 v188, v91, v171
 v_fmac_f32 v173, v90, v172
 v_mfma_f32_32x32x16_bf16 a[32:47], a[144:147], a[176:179], 0
 ds_read_b128 a[172:175], v16 offset:55296
 v_fmac_f32 v189, v90, v188
 v_cvt_pk_bf16_f32 v166, v170, v171
 v_cvt_pk_bf16_f32 v182, v186, v187
 v_fma_f32 v173, -v91, v188, v173
 v_fmac_f32 v189, v91, v172
 v_mfma_f32_32x32x16_bf16 a[48:63], a[148:151], a[176:179], 0
 ds_read_b128 a[144:147], v16 offset:57344
 v_fmac_f32 v174, v90, v173
 v_fmac_f32 v190, v90, v189
 v_fma_f32 v174, -v91, v189, v174
 v_fmac_f32 v190, v91, v173
 v_fmac_f32 v175, v90, v174
 v_mfma_f32_32x32x16_bf16 a[32:47], a[152:155], a[184:187], a[32:47]
 ds_read_b128 a[148:151], v16 offset:59392
 v_fmac_f32 v191, v90, v190
 v_cvt_pk_bf16_f32 v167, v172, v173
 v_cvt_pk_bf16_f32 v183, v188, v189
 v_fma_f32 v175, -v91, v190, v175
 v_fmac_f32 v191, v91, v174
 v_mfma_f32_32x32x16_bf16 a[48:63], a[156:159], a[184:187], a[48:63]
 s_waitcnt lgkmcnt(2)
 ds_read_b128 a[152:155], v16 offset:61440
 v_fmac_f32 v176, v90, v175
 v_fmac_f32 v192, v90, v191
 v_fma_f32 v176, -v91, v191, v176
 v_fmac_f32 v192, v91, v175
 v_fmac_f32 v177, v90, v176
 v_mfma_f32_32x32x16_bf16 a[64:79], a[160:163], a[176:179], 0
 s_add_u32 s48, s44, s74
 ds_read_b128 a[156:159], v16 offset:63488
 s_add_u32 m0, s28, 0x2f80
 v_fmac_f32 v193, v90, v192
 v_cvt_pk_bf16_f32 v168, v174, v175
 v_cvt_pk_bf16_f32 v184, v190, v191
 v_fma_f32 v177, -v91, v192, v177
 v_mfma_f32_32x32x16_bf16 a[80:95], a[164:167], a[176:179], 0
 s_waitcnt vmcnt(14)
 s_barrier
 ds_read_b128 a[160:163], v18 offset:0
 buffer_load_dwordx4 v4, s[12:15], s48 offen offset:128 lds
 v_fmac_f32 v193, v91, v176
 v_cvt_pk_bf16_f32 v169, v176, v177
 v_mfma_f32_32x32x16_bf16 a[64:79], a[168:171], a[184:187], a[64:79]
 ds_read_b128 a[164:167], v18 offset:2048
 v_cvt_pk_bf16_f32 v185, v192, v193
 v_mfma_f32_32x32x16_bf16 a[80:95], a[172:175], a[184:187], a[80:95]
 s_waitcnt lgkmcnt(2)
 ds_read_b128 a[168:171], v18 offset:4096
 buffer_load_dwordx4 v5, s[12:15], s48 offen offset:1152 lds
 ds_write_b128 v23, v[162:165] offset:0
 v_mfma_f32_32x32x16_bf16 a[96:111], a[144:147], a[176:179], 0
 s_add_u32 s48, s44, s80
 ds_read_b128 a[172:175], v18 offset:6144
 s_add_u32 m0, s28, 0xaf80
 ds_write_b128 v23, v[166:169] offset:16
 ds_write_b128 v23, v[178:181] offset:2560
 v_mfma_f32_32x32x16_bf16 a[112:127], a[148:151], a[176:179], 0
 ds_read_b128 a[144:147], v12 offset:8192
 buffer_load_dwordx4 v4, s[12:15], s48 offen offset:128 lds
 ds_write_b128 v23, v[182:185] offset:2576
 ds_read_b64_tr_b16 a[208:209], v3 offset:0
 v_mfma_f32_32x32x16_bf16 a[96:111], a[152:155], a[184:187], a[96:111]
 ds_read_b128 a[148:151], v12 offset:24576
 ds_read_b64_tr_b16 a[210:211], v3 offset:320
 ds_read_b64_tr_b16 a[212:213], v3 offset:1280
 ds_read_b64_tr_b16 a[214:215], v3 offset:1600
 ds_read_b64_tr_b16 a[216:217], v3 offset:2560
 ds_read_b64_tr_b16 a[218:219], v3 offset:2880
 v_mfma_f32_32x32x16_bf16 a[112:127], a[156:159], a[184:187], a[112:127]
 s_waitcnt lgkmcnt(11)
 ds_read_b128 a[152:155], v13 offset:8192
 buffer_load_dwordx4 v5, s[12:15], s48 offen offset:1152 lds
 ds_read_b64_tr_b16 a[220:221], v3 offset:3840
 ds_read_b64_tr_b16 a[222:223], v3 offset:4160
 v_fma_f32 v38, v82, v98, v99
 v_mfma_f32_32x32x16_bf16 v[130:145], a[160:163], a[176:179], 0
 s_add_u32 s48, s45, s74
 ds_read_b128 a[156:159], v13 offset:24576
 s_add_u32 m0, s28, 0xcf80
 v_fma_f32 v39, -v82, v114, -v115
 v_fmac_f32 v38, v83, v114
 v_fmac_f32 v39, v83, v98
 v_fma_f32 v36, v82, v38, v100
 v_mfma_f32_32x32x16_bf16 v[146:161], a[164:167], a[176:179], 0
 ds_read_b128 a[160:163], v12 offset:12288
 buffer_load_dwordx4 v4, s[12:15], s48 offen offset:128 lds
 v_fma_f32 v37, v82, v39, -v116
 v_fma_f32 v36, -v83, v39, v36
 v_fmac_f32 v37, v83, v38
 v_mfma_f32_32x32x16_bf16 v[130:145], a[168:171], a[184:187], v[130:145]
 ds_read_b128 a[164:167], v12 offset:28672
 v_fma_f32 v38, v82, v36, v101
 v_fma_f32 v39, v82, v37, -v117
 v_fma_f32 v38, -v83, v37, v38
 v_fmac_f32 v39, v83, v36
 v_fma_f32 v36, v82, v38, v102
 v_mfma_f32_32x32x16_bf16 v[146:161], a[172:175], a[184:187], v[146:161]
 s_waitcnt lgkmcnt(2)
 ds_read_b128 a[168:171], v13 offset:12288
 buffer_load_dwordx4 v5, s[12:15], s48 offen offset:1152 lds
 v_fma_f32 v37, v82, v39, -v118
 v_fma_f32 v36, -v83, v39, v36
 v_fmac_f32 v37, v83, v38
 v_mfma_f32_32x32x16_bf16 a[0:15], a[144:147], a[192:195], a[0:15]
 ds_read_b128 a[172:175], v13 offset:28672
 v_fma_f32 v38, v82, v36, v103
 v_fma_f32 v39, v82, v37, -v119
 v_fma_f32 v38, -v83, v37, v38
 v_fmac_f32 v39, v83, v36
 v_fma_f32 v36, v82, v38, v104
 v_mfma_f32_32x32x16_bf16 a[16:31], a[148:151], a[192:195], a[16:31]
 ds_read_b128 a[144:147], v8 offset:8192
 v_fma_f32 v37, v82, v39, -v120
 v_fma_f32 v36, -v83, v39, v36
 v_fmac_f32 v37, v83, v38
 v_fma_f32 v38, v82, v36, v105
 v_fma_f32 v39, v82, v37, -v121
 v_mfma_f32_32x32x16_bf16 a[0:15], a[152:155], a[196:199], a[0:15]
 ds_read_b128 a[148:151], v8 offset:16384
 v_fma_f32 v38, -v83, v37, v38
 v_fmac_f32 v39, v83, v36
 v_fma_f32 v36, v82, v38, v106
 v_fma_f32 v37, v82, v39, -v122
 v_fma_f32 v36, -v83, v39, v36
 v_mfma_f32_32x32x16_bf16 a[16:31], a[156:159], a[196:199], a[16:31]
 s_waitcnt lgkmcnt(2)
 ds_read_b128 a[152:155], v9 offset:8192
 v_fmac_f32 v37, v83, v38
 v_fma_f32 v38, v82, v36, v107
 v_fma_f32 v39, v82, v37, -v123
 v_fma_f32 v38, -v83, v37, v38
 v_fmac_f32 v39, v83, v36
 v_mfma_f32_32x32x16_bf16 a[0:15], a[160:163], a[200:203], a[0:15]
 ds_read_b128 a[156:159], v9 offset:16384
 v_fma_f32 v36, v82, v38, v108
 v_fma_f32 v37, v82, v39, -v124
 v_fma_f32 v36, -v83, v39, v36
 v_fmac_f32 v37, v83, v38
 v_fma_f32 v38, v82, v36, v109
 v_mfma_f32_32x32x16_bf16 a[16:31], a[164:167], a[200:203], a[16:31]
 ds_read_b128 a[160:163], v8 offset:12288
 v_fma_f32 v39, v82, v37, -v125
 v_fma_f32 v38, -v83, v37, v38
 v_fmac_f32 v39, v83, v36
 v_fma_f32 v36, v82, v38, v110
 v_fma_f32 v37, v82, v39, -v126
 v_mfma_f32_32x32x16_bf16 a[0:15], a[168:171], a[204:207], a[0:15]
 ds_read_b128 a[164:167], v8 offset:20480
 v_fma_f32 v36, -v83, v39, v36
 v_fmac_f32 v37, v83, v38
 v_fma_f32 v38, v82, v36, v111
 v_fma_f32 v39, v82, v37, -v127
 v_fma_f32 v38, -v83, v37, v38
 v_mfma_f32_32x32x16_bf16 a[16:31], a[172:175], a[204:207], a[16:31]
 s_waitcnt lgkmcnt(2)
 ds_read_b128 a[168:171], v9 offset:12288
 v_fmac_f32 v39, v83, v36
 v_fma_f32 v36, v82, v38, v112
 v_fma_f32 v37, v82, v39, -v128
 v_fma_f32 v36, -v83, v39, v36
 v_fmac_f32 v37, v83, v38
 v_mfma_f32_32x32x16_bf16 a[32:47], a[144:147], a[192:195], a[32:47]
 s_add_u32 s48, s45, s80
 ds_read_b128 a[172:175], v9 offset:20480
 s_add_u32 m0, s28, 0xef80
 v_fma_f32 v44, v82, v36, v113
 v_fma_f32 v45, v82, v37, -v129
 v_fma_f32 v44, -v83, v37, v44
 v_fmac_f32 v45, v83, v36
 v_mfma_f32_32x32x16_bf16 a[48:63], a[148:151], a[192:195], a[48:63]
 s_waitcnt vmcnt(12)
 s_barrier
 ds_read_b128 a[144:147], v12 offset:32768
 buffer_load_dwordx4 v4, s[12:15], s48 offen offset:128 lds
 v_mov_b32 v42, v44
 v_mov_b32 v43, v45
 v_mfma_f32_32x32x16_bf16 a[32:47], a[152:155], a[196:199], a[32:47]
 ds_read_b128 a[148:151], v12 offset:40960
 v_permlane32_swap_b32 v44, v42
 v_permlane32_swap_b32 v45, v43
 v_fma_f32 v42, v86, v44, v42
 v_fma_f32 v43, v86, v45, v43
 v_fma_f32 v42, -v87, v45, v42
 v_mfma_f32_32x32x16_bf16 a[48:63], a[156:159], a[196:199], a[48:63]
 s_waitcnt lgkmcnt(2)
 ds_read_b128 a[152:155], v13 offset:32768
 buffer_load_dwordx4 v5, s[12:15], s48 offen offset:1152 lds
 v_fma_f32 v43, v87, v44, v43
 v_mfma_f32_32x32x16_bf16 a[32:47], a[160:163], a[200:203], a[32:47]
 ds_read_b128 a[156:159], v13 offset:40960
 ds_write_b64 v22, v[42:43] offset:768
 v_mul_f32 v40, v84, v98
 v_mul_f32 v41, v85, v98
 v_fma_f32 v98, v85, v114, v40
 v_fma_f32 v114, -v84, v114, v41
 v_mfma_f32_32x32x16_bf16 a[48:63], a[164:167], a[200:203], a[48:63]
 ds_read_b128 a[160:163], v12 offset:36864
 v_mul_f32 v40, v84, v99
 v_mul_f32 v41, v85, v99
 v_fma_f32 v99, v85, v115, v40
 v_fma_f32 v115, -v84, v115, v41
 v_mul_f32 v40, v84, v100
 v_mfma_f32_32x32x16_bf16 a[32:47], a[168:171], a[204:207], a[32:47]
 ds_read_b128 a[164:167], v12 offset:45056
 v_mul_f32 v41, v85, v100
 v_fma_f32 v100, v85, v116, v40
 v_fma_f32 v116, -v84, v116, v41
 s_waitcnt lgkmcnt(2)
 s_barrier
 v_mfma_f32_32x32x16_bf16 a[48:63], a[172:175], a[204:207], a[48:63]
 ds_read_b128 a[168:171], v13 offset:36864
 ds_read_b64 v[36:37], v22 offset:0
 ds_read_b64 v[38:39], v22 offset:256
 ds_read_b64 v[46:47], v22 offset:512
 v_mul_f32 v40, v84, v101
 v_mul_f32 v41, v85, v101
 v_mfma_f32_32x32x16_bf16 a[64:79], a[144:147], a[192:195], a[64:79]
 ds_read_b128 a[172:175], v13 offset:45056
 v_fma_f32 v101, v85, v117, v40
 v_fma_f32 v117, -v84, v117, v41
 v_mul_f32 v40, v84, v102
 v_mul_f32 v41, v85, v102
 v_fma_f32 v102, v85, v118, v40
 v_mfma_f32_32x32x16_bf16 a[80:95], a[148:151], a[192:195], a[80:95]
 s_add_u32 s48, s46, s74
 ds_read_b128 a[144:147], v8 offset:24576
 s_add_u32 m0, s28, 0x10f80
 v_fma_f32 v118, -v84, v118, v41
 v_mul_f32 v40, v84, v103
 v_mul_f32 v41, v85, v103
 v_fma_f32 v103, v85, v119, v40
 v_mfma_f32_32x32x16_bf16 a[64:79], a[152:155], a[196:199], a[64:79]
 ds_read_b128 a[148:151], v12 offset:16384
 buffer_load_dwordx4 v4, s[12:15], s48 offen offset:128 lds
 v_fma_f32 v119, -v84, v119, v41
 s_waitcnt lgkmcnt(4)
 v_fma_f32 v38, v88, v36, v38
 v_fma_f32 v39, v88, v37, v39
 v_mfma_f32_32x32x16_bf16 a[80:95], a[156:159], a[196:199], a[80:95]
 s_waitcnt lgkmcnt(2)
 ds_read_b128 a[152:155], v9 offset:24576
 v_fma_f32 v38, -v89, v37, v38
 v_fma_f32 v39, v89, v36, v39
 v_fma_f32 v46, v88, v38, v46
 v_fma_f32 v47, v88, v39, v47
 v_fma_f32 v46, -v89, v39, v46
 v_fma_f32 v47, v89, v38, v47
 v_fma_f32 v42, v88, v46, v42
 v_fma_f32 v43, v88, v47, v43
 v_fma_f32 v42, -v89, v47, v42
 v_fma_f32 v43, v89, v46, v43
 s_mov_b32 s69, 0x4000
 s_cmp_lg_u32 s24, 3
 s_cbranch_scc1 sg4
 buffer_store_dwordx2 v[42:43], v20, s[4:7], s69 offen sc1
sg4:
 v_mfma_f32_32x32x16_bf16 a[64:79], a[160:163], a[200:203], a[64:79]
 ds_read_b128 a[156:159], v13 offset:16384
 ds_read_b128 v[52:55], v34 offset:7168
 ds_read_b64 v[56:57], v35
 v_add_u32 v35, s75, v35
 v_mfma_f32_32x32x16_bf16 a[80:95], a[164:167], a[200:203], a[80:95]
 ds_read_b128 a[160:163], v8 offset:28672
 v_mfma_f32_32x32x16_bf16 a[64:79], a[168:171], a[204:207], a[64:79]
 ds_read_b128 a[164:167], v12 offset:20480
 buffer_load_dwordx4 v5, s[12:15], s48 offen offset:1152 lds
 s_waitcnt vmcnt(10)
 v_max_u32 v36, v58, v60
 v_cmp_eq_u32 vcc, -1, v36
 s_nop 1
 s_cmp_lg_u64 vcc, 0
 s_cbranch_scc1 sa3_spin
sa3_back:
 v_mfma_f32_32x32x16_bf16 a[80:95], a[172:175], a[204:207], a[80:95]
 s_waitcnt lgkmcnt(4)
 ds_read_b128 a[168:171], v9 offset:28672
 s_add_u32 s48, s46, s80
 s_add_u32 m0, s28, 0x12f80
 v_add_u32 v37, s1, v72
 s_waitcnt lgkmcnt(4)
 v_fma_f32 v58, v54, v60, v58
 v_fma_f32 v59, v54, v61, v59
 v_mfma_f32_32x32x16_bf16 a[96:111], a[144:147], a[192:195], a[96:111]
 ds_read_b128 a[172:175], v13 offset:20480
 buffer_load_dwordx4 v4, s[12:15], s48 offen offset:128 lds
 v_fma_f32 v58, -v55, v61, v58
 v_fma_f32 v59, v55, v60, v59
 v_mfma_f32_32x32x16_bf16 a[112:127], a[148:151], a[192:195], a[112:127]
 s_barrier
 ds_read_b128 a[144:147], v12 offset:49152
 ds_write_b64 v37, v[58:59]
 v_mul_f32 v70, v54, v54
 v_mul_f32 v71, v54, v55
 v_fma_f32 v70, -v55, v55, v70
 v_mfma_f32_32x32x16_bf16 a[96:111], a[152:155], a[196:199], a[96:111]
 ds_read_b128 a[148:151], v12 offset:57344
 buffer_load_dwordx4 v5, s[12:15], s48 offen offset:1152 lds
 v_fma_f32 v71, v55, v54, v71
 v_mul_f32 v40, v84, v110
 v_mul_f32 v41, v85, v110
 v_mfma_f32_32x32x16_bf16 a[112:127], a[156:159], a[196:199], a[112:127]
 s_waitcnt lgkmcnt(3)
 ds_read_b128 a[152:155], v13 offset:49152
 v_fma_f32 v110, v85, v126, v40
 v_fma_f32 v126, -v84, v126, v41
 v_mul_f32 v40, v84, v111
 v_mul_f32 v41, v85, v111
 v_fma_f32 v111, v85, v127, v40
 v_mfma_f32_32x32x16_bf16 a[96:111], a[160:163], a[200:203], a[96:111]
 ds_read_b128 a[156:159], v13 offset:57344
 v_fma_f32 v127, -v84, v127, v41
 s_waitcnt lgkmcnt(3)
 s_barrier
 v_mfma_f32_32x32x16_bf16 a[112:127], a[164:167], a[200:203], a[112:127]
 ds_read_b128 a[160:163], v12 offset:53248
 ds_read_b64 v[68:69], v72 offset:15360
 ds_read_b64 v[66:67], v72 offset:10240
 ds_read_b64 v[64:65], v72 offset:5120
 ds_read_b64 v[62:63], v72 offset:0
 v_mul_f32 v40, v84, v112
 v_mfma_f32_32x32x16_bf16 a[96:111], a[168:171], a[204:207], a[96:111]
 ds_read_b128 a[164:167], v12 offset:61440
 v_mul_f32 v41, v85, v112
 v_fma_f32 v112, v85, v128, v40
 v_fma_f32 v128, -v84, v128, v41
 v_mul_f32 v40, v84, v113
 v_mul_f32 v41, v85, v113
 v_mfma_f32_32x32x16_bf16 a[112:127], a[172:175], a[204:207], a[112:127]
 s_waitcnt lgkmcnt(6)
 ds_read_b128 a[168:171], v13 offset:53248
 v_fma_f32 v113, v85, v129, v40
 v_fma_f32 v129, -v84, v129, v41
 s_waitcnt lgkmcnt(4)
 v_fma_f32 v66, v70, v68, v66
 v_fma_f32 v67, v70, v69, v67
 v_fma_f32 v66, -v71, v69, v66
 v_mfma_f32_32x32x16_bf16 v[130:145], a[144:147], a[192:195], v[130:145]
 ds_read_b128 a[172:175], v13 offset:61440
 v_fma_f32 v67, v71, v68, v67
 s_waitcnt lgkmcnt(4)
 v_fma_f32 v64, v70, v66, v64
 v_fma_f32 v65, v70, v67, v65
 v_fma_f32 v64, -v71, v67, v64
 v_fma_f32 v65, v71, v66, v65
 v_mfma_f32_32x32x16_bf16 v[146:161], a[148:151], a[192:195], v[146:161]
 ds_read_b128 a[144:147], v14 offset:8192
 s_waitcnt lgkmcnt(4)
 v_fma_f32 v62, v70, v64, v62
 v_fma_f32 v63, v70, v65, v63
 v_fma_f32 v62, -v71, v65, v62
 v_fma_f32 v63, v71, v64, v63
 v_mov_b32 v64, v62
 v_mfma_f32_32x32x16_bf16 v[130:145], a[152:155], a[196:199], v[130:145]
 ds_read_b128 a[148:151], v14 offset:24576
 v_mov_b32 v65, v63
 v_permlane32_swap_b32 v62, v64
 s_nop 0
 v_permlane32_swap_b32 v63, v65
 v_fma_f32 v62, v52, v64, v62
 v_fma_f32 v63, v52, v65, v63
 v_mfma_f32_32x32x16_bf16 v[146:161], a[156:159], a[196:199], v[146:161]
 s_waitcnt lgkmcnt(2)
 ds_read_b128 a[152:155], v15 offset:8192
 v_fma_f32 v62, -v53, v65, v62
 v_fma_f32 v63, v53, v64, v63
 v_fma_f32 v50, v56, v62, v50
 v_fma_f32 v51, v56, v63, v51
 v_fma_f32 v50, -v57, v63, v50
 v_mfma_f32_32x32x16_bf16 v[130:145], a[160:163], a[200:203], v[130:145]
 ds_read_b128 a[156:159], v15 offset:24576
 v_fma_f32 v51, v57, v62, v51
 v_fma_f32 v48, v78, v50, v48
 v_fma_f32 v49, v78, v51, v49
 v_fma_f32 v48, -v79, v51, v48
 v_fma_f32 v49, v79, v50, v49
 v_mfma_f32_32x32x16_bf16 v[146:161], a[164:167], a[200:203], v[146:161]
 ds_read_b128 a[160:163], v14 offset:12288
 v_cndmask_b32 v38, v50, v48, s[84:85]
 v_cndmask_b32 v39, v51, v49, s[84:85]
 v_mul_f32 v36, v76, v38
 v_mul_f32 v37, v76, v39
 v_fma_f32 v36, -v77, v39, v36
 v_mfma_f32_32x32x16_bf16 v[130:145], a[168:171], a[204:207], v[130:145]
 ds_read_b128 a[164:167], v14 offset:28672
 v_fma_f32 v37, v77, v38, v37
 v_fmac_f32 v194, v74, v36
 v_fmac_f32 v210, v74, v37
 v_fma_f32 v194, -v75, v37, v194
 v_fmac_f32 v210, v75, v36
 v_mfma_f32_32x32x16_bf16 v[146:161], a[172:175], a[204:207], v[146:161]
 s_waitcnt lgkmcnt(2)
 ds_read_b128 a[168:171], v15 offset:12288
 v_fmac_f32 v195, v74, v194
 v_fmac_f32 v211, v74, v210
 v_fma_f32 v195, -v75, v210, v195
 v_fmac_f32 v211, v75, v194
 v_fmac_f32 v196, v74, v195
 v_mfma_f32_32x32x16_bf16 a[0:15], a[144:147], a[208:211], a[0:15]
 ds_read_b128 a[172:175], v15 offset:28672
 v_fmac_f32 v212, v74, v211
 v_fma_f32 v196, -v75, v211, v196
 v_fmac_f32 v212, v75, v195
 v_fmac_f32 v197, v74, v196
 v_fmac_f32 v213, v74, v212
 v_mfma_f32_32x32x16_bf16 a[16:31], a[148:151], a[208:211], a[16:31]
 s_barrier
 ds_read_b128 a[144:147], v10 offset:8192
 v_cvt_pk_bf16_f32 v194, v194, v195
 v_cvt_pk_bf16_f32 v210, v210, v211
 v_fma_f32 v197, -v75, v212, v197
 v_fmac_f32 v213, v75, v196
 v_fmac_f32 v198, v74, v197
 v_mfma_f32_32x32x16_bf16 a[0:15], a[152:155], a[212:215], a[0:15]
 ds_read_b128 a[148:151], v10 offset:16384
 v_fmac_f32 v214, v74, v213
 v_fma_f32 v198, -v75, v213, v198
 v_fmac_f32 v214, v75, v197
 v_fmac_f32 v199, v74, v198
 v_fmac_f32 v215, v74, v214
 v_mfma_f32_32x32x16_bf16 a[16:31], a[156:159], a[212:215], a[16:31]
 s_waitcnt lgkmcnt(2)
 ds_read_b128 a[152:155], v11 offset:8192
 v_cvt_pk_bf16_f32 v195, v196, v197
 v_cvt_pk_bf16_f32 v211, v212, v213
 v_fma_f32 v199, -v75, v214, v199
 v_fmac_f32 v215, v75, v198
 v_fmac_f32 v200, v74, v199
 v_mfma_f32_32x32x16_bf16 a[0:15], a[160:163], a[216:219], a[0:15]
 ds_read_b128 a[156:159], v11 offset:16384
 v_fmac_f32 v216, v74, v215
 v_fma_f32 v200, -v75, v215, v200
 v_fmac_f32 v216, v75, v199
 v_fmac_f32 v201, v74, v200
 v_fmac_f32 v217, v74, v216
 v_mfma_f32_32x32x16_bf16 a[16:31], a[164:167], a[216:219], a[16:31]
 s_mov_b32 s72, 0x4000
 ds_read_b128 a[160:163], v10 offset:12288
 s_add_u32 s78, s73, 0x5000
 v_cvt_pk_bf16_f32 v196, v198, v199
 v_cvt_pk_bf16_f32 v212, v214, v215
 v_fma_f32 v201, -v75, v216, v201
 v_fmac_f32 v217, v75, v200
 v_mfma_f32_32x32x16_bf16 a[0:15], a[168:171], a[220:223], a[0:15]
 ds_read_b128 a[164:167], v10 offset:20480
 buffer_load_dwordx2 v[58:59], v21, s[76:79], s72 offen offset:256 sc1
 v_fmac_f32 v202, v74, v201
 v_fmac_f32 v218, v74, v217
 v_fma_f32 v202, -v75, v217, v202
 v_mfma_f32_32x32x16_bf16 a[16:31], a[172:175], a[220:223], a[16:31]
 s_waitcnt lgkmcnt(2)
 ds_read_b128 a[168:171], v11 offset:12288
 v_fmac_f32 v218, v75, v201
 v_fmac_f32 v203, v74, v202
 v_fmac_f32 v219, v74, v218
 v_cvt_pk_bf16_f32 v197, v200, v201
 v_cvt_pk_bf16_f32 v213, v216, v217
 v_mfma_f32_32x32x16_bf16 a[32:47], a[144:147], a[208:211], a[32:47]
 ds_read_b128 a[172:175], v11 offset:20480
 buffer_load_dwordx2 v[60:61], v21, s[76:79], s72 offen offset:768 sc1
 v_fma_f32 v203, -v75, v218, v203
 v_fmac_f32 v219, v75, v202
 v_fmac_f32 v204, v74, v203
 v_mfma_f32_32x32x16_bf16 a[48:63], a[148:151], a[208:211], a[48:63]
 ds_read_b128 a[144:147], v14 offset:32768
 v_fmac_f32 v220, v74, v219
 v_fma_f32 v204, -v75, v219, v204
 v_fmac_f32 v220, v75, v203
 v_fmac_f32 v205, v74, v204
 v_fmac_f32 v221, v74, v220
 v_mfma_f32_32x32x16_bf16 a[32:47], a[152:155], a[212:215], a[32:47]
 ds_read_b128 a[148:151], v14 offset:40960
 v_cvt_pk_bf16_f32 v198, v202, v203
 v_cvt_pk_bf16_f32 v214, v218, v219
 v_fma_f32 v205, -v75, v220, v205
 v_fmac_f32 v221, v75, v204
 v_fmac_f32 v206, v74, v205
 v_mfma_f32_32x32x16_bf16 a[48:63], a[156:159], a[212:215], a[48:63]
 s_waitcnt lgkmcnt(2)
 ds_read_b128 a[152:155], v15 offset:32768
 v_fmac_f32 v222, v74, v221
 v_fma_f32 v206, -v75, v221, v206
 v_fmac_f32 v222, v75, v205
 v_fmac_f32 v207, v74, v206
 v_fmac_f32 v223, v74, v222
 v_mfma_f32_32x32x16_bf16 a[32:47], a[160:163], a[216:219], a[32:47]
 ds_read_b128 a[156:159], v15 offset:40960
 v_cvt_pk_bf16_f32 v199, v204, v205
 v_cvt_pk_bf16_f32 v215, v220, v221
 v_fma_f32 v207, -v75, v222, v207
 v_fmac_f32 v223, v75, v206
 v_fmac_f32 v208, v74, v207
 v_mfma_f32_32x32x16_bf16 a[48:63], a[164:167], a[216:219], a[48:63]
 ds_read_b128 a[160:163], v14 offset:36864
 v_fmac_f32 v224, v74, v223
 v_fma_f32 v208, -v75, v223, v208
 v_fmac_f32 v224, v75, v207
 v_fmac_f32 v209, v74, v208
 v_fmac_f32 v225, v74, v224
 v_mfma_f32_32x32x16_bf16 a[32:47], a[168:171], a[220:223], a[32:47]
 ds_read_b128 a[164:167], v14 offset:45056
 v_cvt_pk_bf16_f32 v200, v206, v207
 v_cvt_pk_bf16_f32 v216, v222, v223
 v_fma_f32 v209, -v75, v224, v209
 v_fmac_f32 v225, v75, v208
 v_cvt_pk_bf16_f32 v201, v208, v209
 v_mfma_f32_32x32x16_bf16 a[48:63], a[172:175], a[220:223], a[48:63]
 s_waitcnt lgkmcnt(2)
 ds_read_b128 a[168:171], v15 offset:36864
 v_cvt_pk_bf16_f32 v217, v224, v225
 v_mfma_f32_32x32x16_bf16 a[64:79], a[144:147], a[208:211], a[64:79]
 s_add_u32 s48, s47, s74
 ds_read_b128 a[172:175], v15 offset:45056
 s_add_u32 m0, s28, 0x4f80
 ds_write_b128 v23, v[194:197] offset:0
 ds_write_b128 v23, v[198:201] offset:16
 v_mfma_f32_32x32x16_bf16 a[80:95], a[148:151], a[208:211], a[80:95]
 s_barrier
 ds_read_b128 a[144:147], v10 offset:24576
 buffer_load_dwordx4 v4, s[12:15], s48 offen offset:128 lds
 ds_write_b128 v23, v[210:213] offset:2560
 v_mfma_f32_32x32x16_bf16 a[64:79], a[152:155], a[212:215], a[64:79]
 ds_read_b128 a[148:151], v14 offset:16384
 ds_write_b128 v23, v[214:217] offset:2576
 ds_read_b64_tr_b16 a[224:225], v3 offset:0
 ds_read_b64_tr_b16 a[226:227], v3 offset:320
 ds_read_b64_tr_b16 a[228:229], v3 offset:1280
 v_mfma_f32_32x32x16_bf16 a[80:95], a[156:159], a[212:215], a[80:95]
 s_waitcnt lgkmcnt(9)
 ds_read_b128 a[152:155], v11 offset:24576
 buffer_load_dwordx4 v5, s[12:15], s48 offen offset:1152 lds
 ds_read_b64_tr_b16 a[230:231], v3 offset:1600
 ds_read_b64_tr_b16 a[232:233], v3 offset:2560
 ds_read_b64_tr_b16 a[234:235], v3 offset:2880
 v_mfma_f32_32x32x16_bf16 a[64:79], a[160:163], a[216:219], a[64:79]
 s_add_u32 s48, s47, s80
 ds_read_b128 a[156:159], v15 offset:16384
 s_add_u32 m0, s28, 0x6f80
 ds_read_b64_tr_b16 a[236:237], v3 offset:3840
 ds_read_b64_tr_b16 a[238:239], v3 offset:4160
 ds_read_b128 v[52:55], v34 offset:9216
 ds_read_b64 v[56:57], v35
 v_mfma_f32_32x32x16_bf16 a[80:95], a[164:167], a[216:219], a[80:95]
 ds_read_b128 a[160:163], v10 offset:28672
 buffer_load_dwordx4 v4, s[12:15], s48 offen offset:128 lds
 v_add_u32 v35, s75, v35
 v_mul_f32 v40, v84, v104
 v_mul_f32 v41, v85, v104
 v_mfma_f32_32x32x16_bf16 a[64:79], a[168:171], a[220:223], a[64:79]
 ds_read_b128 a[164:167], v14 offset:20480
 v_fma_f32 v104, v85, v120, v40
 v_fma_f32 v120, -v84, v120, v41
 v_mul_f32 v40, v84, v105
 v_mul_f32 v41, v85, v105
 v_fma_f32 v105, v85, v121, v40
 v_mfma_f32_32x32x16_bf16 a[80:95], a[172:175], a[220:223], a[80:95]
 s_waitcnt lgkmcnt(6)
 ds_read_b128 a[168:171], v11 offset:28672
 buffer_load_dwordx4 v5, s[12:15], s48 offen offset:1152 lds
 v_fma_f32 v121, -v84, v121, v41
 v_mul_f32 v40, v84, v106
 v_mul_f32 v41, v85, v106
 v_mfma_f32_32x32x16_bf16 a[96:111], a[144:147], a[208:211], a[96:111]
 s_add_u32 s48, s33, s74
 ds_read_b128 a[172:175], v15 offset:20480
 s_add_u32 m0, s28, 0x14f80
 v_fma_f32 v106, v85, v122, v40
 v_fma_f32 v122, -v84, v122, v41
 v_mul_f32 v40, v84, v107
 v_mul_f32 v41, v85, v107
 v_mfma_f32_32x32x16_bf16 a[112:127], a[148:151], a[208:211], a[112:127]
 ds_read_b128 a[144:147], v14 offset:49152
 buffer_load_dwordx4 v4, s[12:15], s48 offen offset:128 lds
 v_fma_f32 v107, v85, v123, v40
 v_fma_f32 v123, -v84, v123, v41
 v_mul_f32 v40, v84, v108
 v_mfma_f32_32x32x16_bf16 a[96:111], a[152:155], a[212:215], a[96:111]
 ds_read_b128 a[148:151], v14 offset:57344
 v_mul_f32 v41, v85, v108
 v_fma_f32 v108, v85, v124, v40
 v_fma_f32 v124, -v84, v124, v41
 v_mul_f32 v40, v84, v109
 v_mul_f32 v41, v85, v109
 v_mfma_f32_32x32x16_bf16 a[112:127], a[156:159], a[212:215], a[112:127]
 s_waitcnt lgkmcnt(2)
 ds_read_b128 a[152:155], v15 offset:49152
 buffer_load_dwordx4 v5, s[12:15], s48 offen offset:1152 lds
 v_fma_f32 v109, v85, v125, v40
 v_fma_f32 v125, -v84, v125, v41
 v_mfma_f32_32x32x16_bf16 a[96:111], a[160:163], a[216:219], a[96:111]
 s_add_u32 s48, s33, s80
 ds_read_b128 a[156:159], v15 offset:57344
 s_add_u32 m0, s28, 0x18f80
 v_mfma_f32_32x32x16_bf16 a[112:127], a[164:167], a[216:219], a[112:127]
 ds_read_b128 a[160:163], v14 offset:53248
 buffer_load_dwordx4 v4, s[12:15], s48 offen offset:128 lds
 v_mfma_f32_32x32x16_bf16 a[96:111], a[168:171], a[220:223], a[96:111]
 ds_read_b128 a[164:167], v14 offset:61440
 v_mfma_f32_32x32x16_bf16 a[112:127], a[172:175], a[220:223], a[112:127]
 s_waitcnt lgkmcnt(2)
 ds_read_b128 a[168:171], v15 offset:53248
 buffer_load_dwordx4 v5, s[12:15], s48 offen offset:1152 lds
 v_mfma_f32_32x32x16_bf16 v[130:145], a[144:147], a[208:211], v[130:145]
 s_add_u32 m0, s28, 0x9000
 ds_read_b128 a[172:175], v15 offset:61440
 v_mfma_f32_32x32x16_bf16 v[146:161], a[148:151], a[208:211], v[146:161]
 s_waitcnt vmcnt(14)
 s_barrier
 ds_read_b128 a[144:147], v8 offset:0
 buffer_load_dwordx4 v6, s[12:15], s36 offen offset:0 lds
 v_mfma_f32_32x32x16_bf16 v[130:145], a[152:155], a[212:215], v[130:145]
 ds_read_b128 a[148:151], v8 offset:32768
 v_mfma_f32_32x32x16_bf16 v[146:161], a[156:159], a[212:215], v[146:161]
 s_waitcnt lgkmcnt(2)
 ds_read_b128 a[152:155], v9 offset:0
 buffer_load_dwordx4 v7, s[12:15], s36 offen offset:1024 lds
 v_mfma_f32_32x32x16_bf16 v[130:145], a[160:163], a[216:219], v[130:145]
 s_add_u32 s48, s36, s74
 ds_read_b128 a[156:159], v9 offset:32768
 s_add_u32 m0, s28, 0x17000
 v_mfma_f32_32x32x16_bf16 v[146:161], a[164:167], a[216:219], v[146:161]
 ds_read_b128 a[160:163], v8 offset:4096
 buffer_load_dwordx4 v4, s[12:15], s48 offen offset:0 lds
 v_mfma_f32_32x32x16_bf16 v[130:145], a[168:171], a[220:223], v[130:145]
 ds_read_b128 a[164:167], v8 offset:36864
 v_mfma_f32_32x32x16_bf16 v[146:161], a[172:175], a[220:223], v[146:161]
 s_waitcnt lgkmcnt(2)
 ds_read_b128 a[168:171], v9 offset:4096
 buffer_load_dwordx4 v5, s[12:15], s48 offen offset:1024 lds
 v_mfma_f32_32x32x16_bf16 a[0:15], a[144:147], a[224:227], a[0:15]
 s_add_u32 s48, s36, s80
 ds_read_b128 a[172:175], v9 offset:36864
 s_add_u32 m0, s28, 0x1b000
 s_waitcnt vmcnt(12)
 v_max_u32 v36, v58, v60
 v_cmp_eq_u32 vcc, -1, v36
 s_nop 1
 s_cmp_lg_u64 vcc, 0
 s_cbranch_scc1 sa4_spin
sa4_back:
 v_mfma_f32_32x32x16_bf16 a[16:31], a[148:151], a[224:227], a[16:31]
 ds_read_b128 a[144:147], v8 offset:40960
 buffer_load_dwordx4 v4, s[12:15], s48 offen offset:0 lds
 v_add_u32 v37, s1, v72
 v_fma_f32 v58, v54, v60, v58
 v_fma_f32 v59, v54, v61, v59
 v_mfma_f32_32x32x16_bf16 a[0:15], a[152:155], a[228:231], a[0:15]
 ds_read_b128 a[148:151], v8 offset:49152
 v_fma_f32 v58, -v55, v61, v58
 v_fma_f32 v59, v55, v60, v59
 v_mfma_f32_32x32x16_bf16 a[16:31], a[156:159], a[228:231], a[16:31]
 s_waitcnt lgkmcnt(2)
 ds_read_b128 a[152:155], v9 offset:40960
 buffer_load_dwordx4 v5, s[12:15], s48 offen offset:1024 lds
 ds_write_b64 v37, v[58:59]
 v_mul_f32 v70, v54, v54
 v_mul_f32 v71, v54, v55
 v_mfma_f32_32x32x16_bf16 a[0:15], a[160:163], a[232:235], a[0:15]
 s_add_u32 s48, s36, s74
 ds_read_b128 a[156:159], v9 offset:49152
 s_add_u32 m0, s28, 0x1cf80
 v_fma_f32 v70, -v55, v55, v70
 v_fma_f32 v71, v55, v54, v71
 s_waitcnt lgkmcnt(1)
 s_barrier
 v_mfma_f32_32x32x16_bf16 a[16:31], a[164:167], a[232:235], a[16:31]
 ds_read_b128 a[160:163], v8 offset:45056
 buffer_load_dwordx4 v4, s[12:15], s48 offen offset:128 lds
 ds_read_b64 v[68:69], v72 offset:15360
 ds_read_b64 v[66:67], v72 offset:10240
 ds_read_b64 v[64:65], v72 offset:5120
 v_mfma_f32_32x32x16_bf16 a[0:15], a[168:171], a[236:239], a[0:15]
 ds_read_b128 a[164:167], v8 offset:53248
 ds_read_b64 v[62:63], v72 offset:0
 s_waitcnt lgkmcnt(3)
 v_fma_f32 v66, v70, v68, v66
 v_fma_f32 v67, v70, v69, v67
 v_fma_f32 v66, -v71, v69, v66
 v_fma_f32 v67, v71, v68, v67
 v_mfma_f32_32x32x16_bf16 a[16:31], a[172:175], a[236:239], a[16:31]
 ds_read_b128 a[168:171], v9 offset:45056
 buffer_load_dwordx4 v5, s[12:15], s48 offen offset:1152 lds
 s_waitcnt lgkmcnt(3)
 v_fma_f32 v64, v70, v66, v64
 v_fma_f32 v65, v70, v67, v65
 v_fma_f32 v64, -v71, v67, v64
 v_mfma_f32_32x32x16_bf16 a[32:47], a[144:147], a[224:227], a[32:47]
 s_add_u32 s48, s36, s80
 ds_read_b128 a[172:175], v9 offset:53248
 s_add_u32 m0, s28, 0x1ef80
 v_fma_f32 v65, v71, v66, v65
 s_waitcnt lgkmcnt(2)
 v_fma_f32 v62, v70, v64, v62
 v_fma_f32 v63, v70, v65, v63
 v_fma_f32 v62, -v71, v65, v62
 v_mfma_f32_32x32x16_bf16 a[48:63], a[148:151], a[224:227], a[48:63]
 s_waitcnt vmcnt(12)
 s_barrier
 ds_read_b128 a[144:147], v8 offset:57344
 buffer_load_dwordx4 v4, s[12:15], s48 offen offset:128 lds
 v_fma_f32 v63, v71, v64, v63
 v_mov_b32 v64, v62
 v_mfma_f32_32x32x16_bf16 a[32:47], a[152:155], a[228:231], a[32:47]
 ds_read_b128 a[148:151], v12 offset:0
 v_mov_b32 v65, v63
 v_permlane32_swap_b32 v62, v64
 s_nop 0
 v_permlane32_swap_b32 v63, v65
 v_fma_f32 v62, v52, v64, v62
 v_fma_f32 v63, v52, v65, v63
 v_mfma_f32_32x32x16_bf16 a[48:63], a[156:159], a[228:231], a[48:63]
 s_waitcnt lgkmcnt(2)
 ds_read_b128 a[152:155], v9 offset:57344
 buffer_load_dwordx4 v5, s[12:15], s48 offen offset:1152 lds
 v_fma_f32 v62, -v53, v65, v62
 v_fma_f32 v63, v53, v64, v63
 v_fma_f32 v46, v56, v62, v46
 v_mfma_f32_32x32x16_bf16 a[32:47], a[160:163], a[232:235], a[32:47]
 s_add_u32 m0, s28, 0x21000
 ds_read_b128 a[156:159], v13 offset:0
 v_fma_f32 v47, v56, v63, v47
 v_fma_f32 v46, -v57, v63, v46
 v_fma_f32 v47, v57, v62, v47
 v_fma_f32 v44, v86, v46, v44
 v_fma_f32 v45, v86, v47, v45
 v_mfma_f32_32x32x16_bf16 a[48:63], a[164:167], a[232:235], a[48:63]
 ds_read_b128 a[160:163], v8 offset:61440
 buffer_load_dwordx4 v6, s[12:15], s37 offen offset:0 lds
 v_fma_f32 v44, -v87, v47, v44
 v_fma_f32 v45, v87, v46, v45
 v_cndmask_b32 v38, v46, v44, s[84:85]
 v_mfma_f32_32x32x16_bf16 a[32:47], a[168:171], a[236:239], a[32:47]
 ds_read_b128 a[164:167], v12 offset:4096
 v_cndmask_b32 v39, v47, v45, s[84:85]
 v_mul_f32 v36, v84, v38
 v_mul_f32 v37, v84, v39
 v_fma_f32 v36, -v85, v39, v36
 v_fma_f32 v37, v85, v38, v37
 v_mfma_f32_32x32x16_bf16 a[48:63], a[172:175], a[236:239], a[48:63]
 s_waitcnt lgkmcnt(2)
 ds_read_b128 a[168:171], v9 offset:61440
 buffer_load_dwordx4 v7, s[12:15], s37 offen offset:1024 lds
 v_fmac_f32 v98, v82, v36
 v_fmac_f32 v114, v82, v37
 v_fma_f32 v98, -v83, v37, v98
 v_mfma_f32_32x32x16_bf16 a[64:79], a[144:147], a[224:227], a[64:79]
 ds_read_b128 a[172:175], v13 offset:4096
 v_fmac_f32 v114, v83, v36
 v_fmac_f32 v99, v82, v98
 v_fmac_f32 v115, v82, v114
 v_fma_f32 v99, -v83, v114, v99
 v_fmac_f32 v115, v83, v98
 v_mfma_f32_32x32x16_bf16 a[80:95], a[148:151], a[224:227], a[80:95]
 ds_read_b128 a[144:147], v8 offset:8192
 v_fmac_f32 v100, v82, v99
 v_fmac_f32 v116, v82, v115
 v_fma_f32 v100, -v83, v115, v100
 v_fmac_f32 v116, v83, v99
 v_fmac_f32 v101, v82, v100
 v_mfma_f32_32x32x16_bf16 a[64:79], a[152:155], a[228:231], a[64:79]
 ds_read_b128 a[148:151], v8 offset:16384
 v_fmac_f32 v117, v82, v116
 v_cvt_pk_bf16_f32 v98, v98, v99
 v_cvt_pk_bf16_f32 v114, v114, v115
 v_fma_f32 v101, -v83, v116, v101
 v_fmac_f32 v117, v83, v100
 v_mfma_f32_32x32x16_bf16 a[80:95], a[156:159], a[228:231], a[80:95]
 s_waitcnt lgkmcnt(2)
 ds_read_b128 a[152:155], v9 offset:8192
 v_fmac_f32 v102, v82, v101
 v_fmac_f32 v118, v82, v117
 v_fma_f32 v102, -v83, v117, v102
 v_fmac_f32 v118, v83, v101
 v_fmac_f32 v103, v82, v102
 v_mfma_f32_32x32x16_bf16 a[64:79], a[160:163], a[232:235], a[64:79]
 ds_read_b128 a[156:159], v9 offset:16384
 v_fmac_f32 v119, v82, v118
 v_cvt_pk_bf16_f32 v99, v100, v101
 v_cvt_pk_bf16_f32 v115, v116, v117
 v_fma_f32 v103, -v83, v118, v103
 v_fmac_f32 v119, v83, v102
 v_mfma_f32_32x32x16_bf16 a[80:95], a[164:167], a[232:235], a[80:95]
 ds_read_b128 a[160:163], v8 offset:12288
 v_fmac_f32 v104, v82, v103
 v_fmac_f32 v120, v82, v119
 v_fma_f32 v104, -v83, v119, v104
 v_fmac_f32 v120, v83, v103
 v_fmac_f32 v105, v82, v104
 v_mfma_f32_32x32x16_bf16 a[64:79], a[168:171], a[236:239], a[64:79]
 ds_read_b128 a[164:167], v8 offset:20480
 v_fmac_f32 v121, v82, v120
 v_cvt_pk_bf16_f32 v100, v102, v103
 v_cvt_pk_bf16_f32 v116, v118, v119
 v_fma_f32 v105, -v83, v120, v105
 v_fmac_f32 v121, v83, v104
 v_mfma_f32_32x32x16_bf16 a[80:95], a[172:175], a[236:239], a[80:95]
 s_waitcnt lgkmcnt(2)
 ds_read_b128 a[168:171], v9 offset:12288
 v_fmac_f32 v106, v82, v105
 v_fmac_f32 v122, v82, v121
 v_fma_f32 v106, -v83, v121, v106
 v_fmac_f32 v122, v83, v105
 v_fmac_f32 v107, v82, v106
 v_mfma_f32_32x32x16_bf16 a[96:111], a[144:147], a[224:227], a[96:111]
 ds_read_b128 a[172:175], v9 offset:20480
 v_fmac_f32 v123, v82, v122
 v_cvt_pk_bf16_f32 v101, v104, v105
 v_cvt_pk_bf16_f32 v117, v120, v121
 v_fma_f32 v107, -v83, v122, v107
 v_fmac_f32 v123, v83, v106
 v_mfma_f32_32x32x16_bf16 a[112:127], a[148:151], a[224:227], a[112:127]
 s_waitcnt vmcnt(12)
 s_barrier
 ds_read_b128 a[144:147], v12 offset:8192
 v_fmac_f32 v108, v82, v107
 v_fmac_f32 v124, v82, v123
 v_fma_f32 v108, -v83, v123, v108
 v_fmac_f32 v124, v83, v107
 v_mfma_f32_32x32x16_bf16 a[96:111], a[152:155], a[228:231], a[96:111]
 ds_read_b128 a[148:151], v12 offset:24576
 v_fmac_f32 v109, v82, v108
 v_fmac_f32 v125, v82, v124
 v_cvt_pk_bf16_f32 v102, v106, v107
 v_cvt_pk_bf16_f32 v118, v122, v123
 v_fma_f32 v109, -v83, v124, v109
 v_mfma_f32_32x32x16_bf16 a[112:127], a[156:159], a[228:231], a[112:127]
 s_waitcnt lgkmcnt(2)
 ds_read_b128 a[152:155], v13 offset:8192
 v_fmac_f32 v125, v83, v108
 v_fmac_f32 v110, v82, v109
 v_fmac_f32 v126, v82, v125
 v_fma_f32 v110, -v83, v125, v110
 v_fmac_f32 v126, v83, v109
 v_mfma_f32_32x32x16_bf16 a[96:111], a[160:163], a[232:235], a[96:111]
 ds_read_b128 a[156:159], v13 offset:24576
 v_fmac_f32 v111, v82, v110
 v_fmac_f32 v127, v82, v126
 v_cvt_pk_bf16_f32 v103, v108, v109
 v_cvt_pk_bf16_f32 v119, v124, v125
 v_fma_f32 v111, -v83, v126, v111
 v_mfma_f32_32x32x16_bf16 a[112:127], a[164:167], a[232:235], a[112:127]
 ds_read_b128 a[160:163], v12 offset:12288
 v_fmac_f32 v127, v83, v110
 v_fmac_f32 v112, v82, v111
 v_fmac_f32 v128, v82, v127
 v_fma_f32 v112, -v83, v127, v112
 v_fmac_f32 v128, v83, v111
 v_mfma_f32_32x32x16_bf16 a[96:111], a[168:171], a[236:239], a[96:111]
 ds_read_b128 a[164:167], v12 offset:28672
 v_fmac_f32 v113, v82, v112
 v_fmac_f32 v129, v82, v128
 v_cvt_pk_bf16_f32 v104, v110, v111
 v_cvt_pk_bf16_f32 v120, v126, v127
 v_fma_f32 v113, -v83, v128, v113
 v_mfma_f32_32x32x16_bf16 a[112:127], a[172:175], a[236:239], a[112:127]
 s_waitcnt lgkmcnt(2)
 ds_read_b128 a[168:171], v13 offset:12288
 v_fmac_f32 v129, v83, v112
 v_cvt_pk_bf16_f32 v105, v112, v113
 v_cvt_pk_bf16_f32 v121, v128, v129
 v_mfma_f32_32x32x16_bf16 v[130:145], a[144:147], a[224:227], v[130:145]
 ds_read_b128 a[172:175], v13 offset:28672
 ds_write_b128 v23, v[98:101] offset:0
 ds_write_b128 v23, v[102:105] offset:16
 v_mfma_f32_32x32x16_bf16 v[146:161], a[148:151], a[224:227], v[146:161]
 ds_read_b128 a[144:147], v14 offset:8192
 ds_write_b128 v23, v[114:117] offset:2560
 ds_write_b128 v23, v[118:121] offset:2576
 ds_read_b64_tr_b16 a[240:241], v3 offset:0
 v_mfma_f32_32x32x16_bf16 v[130:145], a[152:155], a[228:231], v[130:145]
 ds_read_b128 a[148:151], v14 offset:24576
 ds_read_b64_tr_b16 a[242:243], v3 offset:320
 ds_read_b64_tr_b16 a[244:245], v3 offset:1280
 ds_read_b64_tr_b16 a[246:247], v3 offset:1600
 ds_read_b64_tr_b16 a[248:249], v3 offset:2560
 ds_read_b64_tr_b16 a[250:251], v3 offset:2880
 v_mfma_f32_32x32x16_bf16 v[146:161], a[156:159], a[228:231], v[146:161]
 s_waitcnt lgkmcnt(12)
 ds_read_b128 a[152:155], v15 offset:8192
 ds_read_b64_tr_b16 a[252:253], v3 offset:3840
 ds_read_b64_tr_b16 a[254:255], v3 offset:4160
 v_mfma_f32_32x32x16_bf16 v[130:145], a[160:163], a[232:235], v[130:145]
 ds_read_b128 a[156:159], v15 offset:24576
 v_mfma_f32_32x32x16_bf16 v[146:161], a[164:167], a[232:235], v[146:161]
 ds_read_b128 a[160:163], v14 offset:12288
 v_mfma_f32_32x32x16_bf16 v[130:145], a[168:171], a[236:239], v[130:145]
 ds_read_b128 a[164:167], v14 offset:28672
 v_mfma_f32_32x32x16_bf16 v[146:161], a[172:175], a[236:239], v[146:161]
 s_waitcnt lgkmcnt(2)
 ds_read_b128 a[168:171], v15 offset:12288
 v_mfma_f32_32x32x16_bf16 v[130:145], a[144:147], a[240:243], v[130:145]
 ds_read_b128 a[172:175], v15 offset:28672
 v_mfma_f32_32x32x16_bf16 v[146:161], a[148:151], a[240:243], v[146:161]
 s_barrier
 ds_read_b128 a[144:147], v10 offset:0
 v_mfma_f32_32x32x16_bf16 v[130:145], a[152:155], a[244:247], v[130:145]
 ds_read_b128 a[148:151], v10 offset:32768
 v_mfma_f32_32x32x16_bf16 v[146:161], a[156:159], a[244:247], v[146:161]
 s_waitcnt lgkmcnt(2)
 ds_read_b128 a[152:155], v11 offset:0
 v_mfma_f32_32x32x16_bf16 v[130:145], a[160:163], a[248:251], v[130:145]
 ds_read_b128 a[156:159], v11 offset:32768
 v_mfma_f32_32x32x16_bf16 v[146:161], a[164:167], a[248:251], v[146:161]
 ds_read_b128 a[160:163], v10 offset:4096
 v_mfma_f32_32x32x16_bf16 v[130:145], a[168:171], a[252:255], v[130:145]
 ds_read_b128 a[164:167], v10 offset:36864
 v_mfma_f32_32x32x16_bf16 v[146:161], a[172:175], a[252:255], v[146:161]
 s_waitcnt lgkmcnt(2)
 ds_read_b128 a[168:171], v11 offset:4096
 v_mfma_f32_32x32x16_bf16 a[0:15], a[144:147], a[240:243], a[0:15]
 ds_read_b128 a[172:175], v11 offset:36864
 s_nop 5
 v_cvt_pk_bf16_f32 v130, v130, v131
 v_cvt_pk_bf16_f32 v131, v132, v133
 v_cvt_pk_bf16_f32 v132, v134, v135
 v_cvt_pk_bf16_f32 v133, v136, v137
 v_cvt_pk_bf16_f32 v134, v138, v139
 v_mfma_f32_32x32x16_bf16 a[16:31], a[148:151], a[240:243], a[16:31]
 ds_read_b128 a[144:147], v10 offset:40960
 v_cvt_pk_bf16_f32 v135, v140, v141
 v_cvt_pk_bf16_f32 v136, v142, v143
 v_cvt_pk_bf16_f32 v137, v144, v145
 v_mfma_f32_32x32x16_bf16 a[0:15], a[152:155], a[244:247], a[0:15]
 ds_read_b128 a[148:151], v10 offset:49152
 buffer_store_dwordx4 v[130:133], v30, s[4:7], s62 offen offset:0 sc1
 buffer_store_dwordx4 v[134:137], v30, s[4:7], s62 offen offset:1024 sc1
 v_mfma_f32_32x32x16_bf16 a[16:31], a[156:159], a[244:247], a[16:31]
 s_waitcnt lgkmcnt(2)
 ds_read_b128 a[152:155], v11 offset:40960
 v_mfma_f32_32x32x16_bf16 a[0:15], a[160:163], a[248:251], a[0:15]
 ds_read_b128 a[156:159], v11 offset:49152
 v_mfma_f32_32x32x16_bf16 a[16:31], a[164:167], a[248:251], a[16:31]
 ds_read_b128 a[160:163], v10 offset:45056
 v_mfma_f32_32x32x16_bf16 a[0:15], a[168:171], a[252:255], a[0:15]
 ds_read_b128 a[164:167], v10 offset:53248
 v_mfma_f32_32x32x16_bf16 a[16:31], a[172:175], a[252:255], a[16:31]
 s_waitcnt lgkmcnt(2)
 ds_read_b128 a[168:171], v11 offset:45056
 v_mfma_f32_32x32x16_bf16 a[32:47], a[144:147], a[240:243], a[32:47]
 s_add_u32 s48, s37, s74
 ds_read_b128 a[172:175], v11 offset:53248
 s_add_u32 m0, s28, 0x3000
 v_mfma_f32_32x32x16_bf16 a[48:63], a[148:151], a[240:243], a[48:63]
 s_barrier
 ds_read_b128 a[144:147], v10 offset:57344
 buffer_load_dwordx4 v4, s[12:15], s48 offen offset:0 lds
 v_mfma_f32_32x32x16_bf16 a[32:47], a[152:155], a[244:247], a[32:47]
 ds_read_b128 a[148:151], v14 offset:0
 v_cvt_pk_bf16_f32 v146, v146, v147
 v_cvt_pk_bf16_f32 v147, v148, v149
 v_cvt_pk_bf16_f32 v148, v150, v151
 v_cvt_pk_bf16_f32 v149, v152, v153
 v_cvt_pk_bf16_f32 v150, v154, v155
 v_mfma_f32_32x32x16_bf16 a[48:63], a[156:159], a[244:247], a[48:63]
 s_waitcnt lgkmcnt(2)
 ds_read_b128 a[152:155], v11 offset:57344
 buffer_load_dwordx4 v5, s[12:15], s48 offen offset:1024 lds
 v_cvt_pk_bf16_f32 v151, v156, v157
 v_cvt_pk_bf16_f32 v152, v158, v159
 v_cvt_pk_bf16_f32 v153, v160, v161
 v_mfma_f32_32x32x16_bf16 a[32:47], a[160:163], a[248:251], a[32:47]
 s_add_u32 s48, s37, s80
 ds_read_b128 a[156:159], v15 offset:0
 s_add_u32 m0, s28, 0xb000
 buffer_store_dwordx4 v[146:149], v31, s[4:7], s62 offen offset:0 sc1
 buffer_store_dwordx4 v[150:153], v31, s[4:7], s62 offen offset:1024 sc1
 v_mfma_f32_32x32x16_bf16 a[48:63], a[164:167], a[248:251], a[48:63]
 ds_read_b128 a[160:163], v10 offset:61440
 buffer_load_dwordx4 v4, s[12:15], s48 offen offset:0 lds
 v_mfma_f32_32x32x16_bf16 a[32:47], a[168:171], a[252:255], a[32:47]
 ds_read_b128 a[164:167], v14 offset:4096
 v_mfma_f32_32x32x16_bf16 a[48:63], a[172:175], a[252:255], a[48:63]
 s_waitcnt lgkmcnt(2)
 ds_read_b128 a[168:171], v11 offset:61440
 buffer_load_dwordx4 v5, s[12:15], s48 offen offset:1024 lds
 v_mfma_f32_32x32x16_bf16 a[64:79], a[144:147], a[240:243], a[64:79]
 ds_read_b128 a[172:175], v15 offset:4096
 v_mfma_f32_32x32x16_bf16 a[80:95], a[148:151], a[240:243], a[80:95]
 ds_read_b128 a[144:147], v10 offset:8192
 v_mfma_f32_32x32x16_bf16 a[64:79], a[152:155], a[244:247], a[64:79]
 ds_read_b128 a[148:151], v10 offset:16384
 v_mfma_f32_32x32x16_bf16 a[80:95], a[156:159], a[244:247], a[80:95]
 s_waitcnt lgkmcnt(2)
 ds_read_b128 a[152:155], v11 offset:8192
 v_mfma_f32_32x32x16_bf16 a[64:79], a[160:163], a[248:251], a[64:79]
 s_add_u32 s48, s37, s74
 ds_read_b128 a[156:159], v11 offset:16384
 s_add_u32 m0, s28, 0x14f80
 v_accvgpr_read_b32 v202, a0
 v_accvgpr_read_b32 v203, a1
 v_accvgpr_read_b32 v204, a2
 v_accvgpr_read_b32 v205, a3
 v_mfma_f32_32x32x16_bf16 a[80:95], a[164:167], a[248:251], a[80:95]
 ds_read_b128 a[160:163], v10 offset:12288
 buffer_load_dwordx4 v4, s[12:15], s48 offen offset:128 lds
 v_cvt_pk_bf16_f32 v194, v202, v203
 v_accvgpr_read_b32 v206, a4
 v_accvgpr_read_b32 v207, a5
 v_mfma_f32_32x32x16_bf16 a[64:79], a[168:171], a[252:255], a[64:79]
 ds_read_b128 a[164:167], v10 offset:20480
 v_cvt_pk_bf16_f32 v195, v204, v205
 v_accvgpr_read_b32 v208, a6
 v_accvgpr_read_b32 v209, a7
 v_cvt_pk_bf16_f32 v196, v206, v207
 v_accvgpr_read_b32 v202, a8
 v_mfma_f32_32x32x16_bf16 a[80:95], a[172:175], a[252:255], a[80:95]
 s_waitcnt lgkmcnt(2)
 ds_read_b128 a[168:171], v11 offset:12288
 buffer_load_dwordx4 v5, s[12:15], s48 offen offset:1152 lds
 v_accvgpr_read_b32 v203, a9
 v_cvt_pk_bf16_f32 v197, v208, v209
 v_accvgpr_read_b32 v204, a10
 v_mfma_f32_32x32x16_bf16 a[96:111], a[144:147], a[240:243], a[96:111]
 s_add_u32 s48, s37, s80
 ds_read_b128 a[172:175], v11 offset:20480
 s_add_u32 m0, s28, 0xcf80
 v_accvgpr_read_b32 v205, a11
 v_cvt_pk_bf16_f32 v198, v202, v203
 v_accvgpr_read_b32 v206, a12
 v_accvgpr_read_b32 v207, a13
 v_mfma_f32_32x32x16_bf16 a[112:127], a[148:151], a[240:243], a[112:127]
 s_waitcnt vmcnt(16)
 s_barrier
 ds_read_b128 a[144:147], v16 offset:24576
 buffer_load_dwordx4 v4, s[12:15], s48 offen offset:128 lds
 v_cvt_pk_bf16_f32 v199, v204, v205
 v_accvgpr_read_b32 v208, a14
 v_mfma_f32_32x32x16_bf16 a[96:111], a[152:155], a[244:247], a[96:111]
 ds_read_b128 a[148:151], v16 offset:26624
 v_accvgpr_read_b32 v209, a15
 v_cvt_pk_bf16_f32 v200, v206, v207
 v_cvt_pk_bf16_f32 v201, v208, v209
 v_mfma_f32_32x32x16_bf16 a[112:127], a[156:159], a[244:247], a[112:127]
 s_waitcnt lgkmcnt(2)
 ds_read_b128 a[152:155], v16 offset:28672
 buffer_load_dwordx4 v5, s[12:15], s48 offen offset:1152 lds
 buffer_store_dwordx4 v[194:197], v30, s[4:7], s58 offen offset:0 sc1
 v_mfma_f32_32x32x16_bf16 a[96:111], a[160:163], a[248:251], a[96:111]
 ds_read_b128 a[156:159], v16 offset:30720
 buffer_store_dwordx4 v[198:201], v30, s[4:7], s58 offen offset:1024 sc1
 v_mfma_f32_32x32x16_bf16 a[112:127], a[164:167], a[248:251], a[112:127]
 ds_read_b128 a[160:163], v12 offset:16384
 v_mfma_f32_32x32x16_bf16 a[96:111], a[168:171], a[252:255], a[96:111]
 ds_read_b128 a[164:167], v12 offset:32768
 v_accvgpr_read_b32 v218, a16
 v_accvgpr_read_b32 v219, a17
 v_accvgpr_read_b32 v220, a18
 v_accvgpr_read_b32 v221, a19
 v_cvt_pk_bf16_f32 v210, v218, v219
 v_mfma_f32_32x32x16_bf16 a[112:127], a[172:175], a[252:255], a[112:127]
 s_waitcnt lgkmcnt(2)
 ds_read_b128 a[168:171], v13 offset:16384
 v_accvgpr_read_b32 v222, a20
 v_accvgpr_read_b32 v223, a21
 v_cvt_pk_bf16_f32 v211, v220, v221
 v_accvgpr_read_b32 v224, a22
 v_accvgpr_read_b32 v225, a23
 v_mfma_f32_32x32x16_bf16 v[162:177], a[144:147], a[176:179], 0
 ds_read_b128 a[172:175], v13 offset:32768
 v_cvt_pk_bf16_f32 v212, v222, v223
 v_accvgpr_read_b32 v218, a24
 v_accvgpr_read_b32 v219, a25
 v_cvt_pk_bf16_f32 v213, v224, v225
 v_accvgpr_read_b32 v220, a26
 v_mfma_f32_32x32x16_bf16 v[178:193], a[148:151], a[176:179], 0
 s_add_u32 m0, s28, 0xf000
 ds_read_b128 a[144:147], v12 offset:20480
 v_accvgpr_read_b32 v221, a27
 v_cvt_pk_bf16_f32 v214, v218, v219
 v_accvgpr_read_b32 v222, a28
 v_accvgpr_read_b32 v223, a29
 v_cvt_pk_bf16_f32 v215, v220, v221
 v_mfma_f32_32x32x16_bf16 v[162:177], a[152:155], a[184:187], v[162:177]
 ds_read_b128 a[148:151], v12 offset:36864
 buffer_load_dwordx4 v6, s[12:15], s83 offen offset:0 lds
 v_accvgpr_read_b32 v224, a30
 v_accvgpr_read_b32 v225, a31
 v_cvt_pk_bf16_f32 v216, v222, v223
 v_mfma_f32_32x32x16_bf16 v[178:193], a[156:159], a[184:187], v[178:193]
 s_waitcnt lgkmcnt(2)
 ds_read_b128 a[152:155], v13 offset:20480
 v_cvt_pk_bf16_f32 v217, v224, v225
 v_mfma_f32_32x32x16_bf16 v[162:177], a[160:163], a[192:195], v[162:177]
 ds_read_b128 a[156:159], v13 offset:36864
 buffer_load_dwordx4 v7, s[12:15], s83 offen offset:1024 lds
 buffer_store_dwordx4 v[210:213], v31, s[4:7], s58 offen offset:0 sc1
 v_mfma_f32_32x32x16_bf16 v[178:193], a[164:167], a[192:195], v[178:193]
 ds_read_b128 a[160:163], v14 offset:16384
 buffer_store_dwordx4 v[214:217], v31, s[4:7], s58 offen offset:1024 sc1
 v_mfma_f32_32x32x16_bf16 v[162:177], a[168:171], a[196:199], v[162:177]
 ds_read_b128 a[164:167], v14 offset:32768
 v_mfma_f32_32x32x16_bf16 v[178:193], a[172:175], a[196:199], v[178:193]
 s_waitcnt lgkmcnt(2)
 ds_read_b128 a[168:171], v15 offset:16384
 v_mfma_f32_32x32x16_bf16 v[162:177], a[144:147], a[200:203], v[162:177]
 s_add_u32 s48, s83, s74
 ds_read_b128 a[172:175], v15 offset:32768
 s_add_u32 m0, s28, 0x11000
 v_accvgpr_read_b32 v202, a32
 v_accvgpr_read_b32 v203, a33
 v_accvgpr_read_b32 v204, a34
 v_accvgpr_read_b32 v205, a35
 v_mfma_f32_32x32x16_bf16 v[178:193], a[148:151], a[200:203], v[178:193]
 ds_read_b128 a[144:147], v14 offset:20480
 buffer_load_dwordx4 v4, s[12:15], s48 offen offset:0 lds
 v_cvt_pk_bf16_f32 v194, v202, v203
 v_accvgpr_read_b32 v206, a36
 v_accvgpr_read_b32 v207, a37
 v_mfma_f32_32x32x16_bf16 v[162:177], a[152:155], a[204:207], v[162:177]
 ds_read_b128 a[148:151], v14 offset:36864
 v_cvt_pk_bf16_f32 v195, v204, v205
 v_accvgpr_read_b32 v208, a38
 v_accvgpr_read_b32 v209, a39
 v_cvt_pk_bf16_f32 v196, v206, v207
 v_accvgpr_read_b32 v202, a40
 v_mfma_f32_32x32x16_bf16 v[178:193], a[156:159], a[204:207], v[178:193]
 s_waitcnt lgkmcnt(2)
 ds_read_b128 a[152:155], v15 offset:20480
 buffer_load_dwordx4 v5, s[12:15], s48 offen offset:1024 lds
 v_accvgpr_read_b32 v203, a41
 v_cvt_pk_bf16_f32 v197, v208, v209
 v_accvgpr_read_b32 v204, a42
 v_mfma_f32_32x32x16_bf16 v[162:177], a[160:163], a[208:211], v[162:177]
 ds_read_b128 a[156:159], v15 offset:36864
 v_accvgpr_read_b32 v205, a43
 v_cvt_pk_bf16_f32 v198, v202, v203
 v_accvgpr_read_b32 v206, a44
 v_accvgpr_read_b32 v207, a45
 v_cvt_pk_bf16_f32 v199, v204, v205
 v_mfma_f32_32x32x16_bf16 v[178:193], a[164:167], a[208:211], v[178:193]
 s_waitcnt vmcnt(22)
 s_barrier
 ds_read_b128 a[160:163], v12 offset:40960
 v_accvgpr_read_b32 v208, a46
 v_accvgpr_read_b32 v209, a47
 v_cvt_pk_bf16_f32 v200, v206, v207
 v_cvt_pk_bf16_f32 v201, v208, v209
 v_mfma_f32_32x32x16_bf16 v[162:177], a[168:171], a[212:215], v[162:177]
 ds_read_b128 a[164:167], v12 offset:49152
 buffer_store_dwordx4 v[194:197], v30, s[4:7], s59 offen offset:0 sc1
 buffer_store_dwordx4 v[198:201], v30, s[4:7], s59 offen offset:1024 sc1
 v_mfma_f32_32x32x16_bf16 v[178:193], a[172:175], a[212:215], v[178:193]
 s_waitcnt lgkmcnt(2)
 ds_read_b128 a[168:171], v13 offset:40960
 v_mfma_f32_32x32x16_bf16 v[162:177], a[144:147], a[216:219], v[162:177]
 ds_read_b128 a[172:175], v13 offset:49152
 v_mfma_f32_32x32x16_bf16 v[178:193], a[148:151], a[216:219], v[178:193]
 ds_read_b128 a[144:147], v12 offset:45056
 v_mfma_f32_32x32x16_bf16 v[162:177], a[152:155], a[220:223], v[162:177]
 ds_read_b128 a[148:151], v12 offset:53248
 v_accvgpr_read_b32 v218, a48
 v_accvgpr_read_b32 v219, a49
 v_accvgpr_read_b32 v220, a50
 v_accvgpr_read_b32 v221, a51
 v_cvt_pk_bf16_f32 v210, v218, v219
 v_mfma_f32_32x32x16_bf16 v[178:193], a[156:159], a[220:223], v[178:193]
 s_waitcnt lgkmcnt(2)
 ds_read_b128 a[152:155], v13 offset:45056
 v_accvgpr_read_b32 v222, a52
 v_accvgpr_read_b32 v223, a53
 v_cvt_pk_bf16_f32 v211, v220, v221
 v_accvgpr_read_b32 v224, a54
 v_accvgpr_read_b32 v225, a55
 v_mfma_f32_32x32x16_bf16 v[162:177], a[160:163], a[224:227], v[162:177]
 s_waitcnt vmcnt(16)
 buffer_store_dword v28, v29, s[4:7], s62 offen offset:2048 sc1
 ds_read_b128 a[156:159], v13 offset:53248
 v_cvt_pk_bf16_f32 v212, v222, v223
 v_accvgpr_read_b32 v218, a56
 v_accvgpr_read_b32 v219, a57
 v_cvt_pk_bf16_f32 v213, v224, v225
 v_accvgpr_read_b32 v220, a58
 v_mfma_f32_32x32x16_bf16 v[178:193], a[164:167], a[224:227], v[178:193]
 ds_read_b128 a[160:163], v14 offset:40960
 v_accvgpr_read_b32 v221, a59
 v_cvt_pk_bf16_f32 v214, v218, v219
 v_accvgpr_read_b32 v222, a60
 v_accvgpr_read_b32 v223, a61
 v_cvt_pk_bf16_f32 v215, v220, v221
 v_mfma_f32_32x32x16_bf16 v[162:177], a[168:171], a[228:231], v[162:177]
 ds_read_b128 a[164:167], v14 offset:49152
 v_accvgpr_read_b32 v224, a62
 v_accvgpr_read_b32 v225, a63
 v_cvt_pk_bf16_f32 v216, v222, v223
 v_cvt_pk_bf16_f32 v217, v224, v225
 v_mfma_f32_32x32x16_bf16 v[178:193], a[172:175], a[228:231], v[178:193]
 s_waitcnt lgkmcnt(2)
 ds_read_b128 a[168:171], v15 offset:40960
 buffer_store_dwordx4 v[210:213], v31, s[4:7], s59 offen offset:0 sc1
 buffer_store_dwordx4 v[214:217], v31, s[4:7], s59 offen offset:1024 sc1
 v_mfma_f32_32x32x16_bf16 v[162:177], a[144:147], a[232:235], v[162:177]
 ds_read_b128 a[172:175], v15 offset:49152
 v_mfma_f32_32x32x16_bf16 v[178:193], a[148:151], a[232:235], v[178:193]
 ds_read_b128 a[144:147], v14 offset:45056
 v_mfma_f32_32x32x16_bf16 v[162:177], a[152:155], a[236:239], v[162:177]
 s_add_u32 s48, s83, s80
 ds_read_b128 a[148:151], v14 offset:53248
 s_add_u32 m0, s28, 0x5000
 v_mfma_f32_32x32x16_bf16 v[178:193], a[156:159], a[236:239], v[178:193]
 s_waitcnt lgkmcnt(2)
 ds_read_b128 a[152:155], v15 offset:45056
 buffer_load_dwordx4 v4, s[12:15], s48 offen offset:0 lds
 v_mfma_f32_32x32x16_bf16 v[162:177], a[160:163], a[240:243], v[162:177]
 ds_read_b128 a[156:159], v15 offset:53248
 v_accvgpr_read_b32 v202, a64
 v_accvgpr_read_b32 v203, a65
 v_accvgpr_read_b32 v204, a66
 v_accvgpr_read_b32 v205, a67
 v_cvt_pk_bf16_f32 v194, v202, v203
 v_mfma_f32_32x32x16_bf16 v[178:193], a[164:167], a[240:243], v[178:193]
 s_waitcnt vmcnt(18)
 s_barrier
 ds_read_b128 a[160:163], v18 offset:57344
 buffer_load_dwordx4 v5, s[12:15], s48 offen offset:1024 lds
 v_accvgpr_read_b32 v206, a68
 v_accvgpr_read_b32 v207, a69
 v_mfma_f32_32x32x16_bf16 v[162:177], a[168:171], a[244:247], v[162:177]
 s_add_u32 s48, s83, s74
 ds_read_b128 a[164:167], v18 offset:59392
 s_add_u32 m0, s28, 0x6f80
 v_cvt_pk_bf16_f32 v195, v204, v205
 v_accvgpr_read_b32 v208, a70
 v_accvgpr_read_b32 v209, a71
 v_cvt_pk_bf16_f32 v196, v206, v207
 v_mfma_f32_32x32x16_bf16 v[178:193], a[172:175], a[244:247], v[178:193]
 s_waitcnt lgkmcnt(2)
 ds_read_b128 a[168:171], v18 offset:61440
 buffer_load_dwordx4 v4, s[12:15], s48 offen offset:128 lds
 v_accvgpr_read_b32 v202, a72
 v_accvgpr_read_b32 v203, a73
 v_cvt_pk_bf16_f32 v197, v208, v209
 v_mfma_f32_32x32x16_bf16 v[162:177], a[144:147], a[248:251], v[162:177]
 ds_read_b128 a[172:175], v18 offset:63488
 v_accvgpr_read_b32 v204, a74
 v_accvgpr_read_b32 v205, a75
 v_cvt_pk_bf16_f32 v198, v202, v203
 v_accvgpr_read_b32 v206, a76
 v_accvgpr_read_b32 v207, a77
 v_mfma_f32_32x32x16_bf16 v[178:193], a[148:151], a[248:251], v[178:193]
 ds_read_b128 a[144:147], v8 offset:0
 v_cvt_pk_bf16_f32 v199, v204, v205
 v_accvgpr_read_b32 v208, a78
 v_accvgpr_read_b32 v209, a79
 v_cvt_pk_bf16_f32 v200, v206, v207
 v_cvt_pk_bf16_f32 v201, v208, v209
 v_mfma_f32_32x32x16_bf16 v[162:177], a[152:155], a[252:255], v[162:177]
 ds_read_b128 a[148:151], v8 offset:32768
 buffer_store_dwordx4 v[194:197], v30, s[4:7], s60 offen offset:0 sc1
 buffer_store_dwordx4 v[198:201], v30, s[4:7], s60 offen offset:1024 sc1
 v_mfma_f32_32x32x16_bf16 v[178:193], a[156:159], a[252:255], v[178:193]
 s_waitcnt lgkmcnt(2)
 ds_read_b128 a[152:155], v9 offset:0
 v_mfma_f32_32x32x16_bf16 v[130:145], a[160:163], a[176:179], 0
 ds_read_b128 a[156:159], v9 offset:32768
 v_mfma_f32_32x32x16_bf16 v[146:161], a[164:167], a[176:179], 0
 ds_read_b128 a[160:163], v8 offset:4096
 v_mfma_f32_32x32x16_bf16 v[130:145], a[168:171], a[184:187], v[130:145]
 ds_read_b128 a[164:167], v8 offset:36864
 v_accvgpr_read_b32 v218, a80
 v_accvgpr_read_b32 v219, a81
 v_accvgpr_read_b32 v220, a82
 v_accvgpr_read_b32 v221, a83
 v_cvt_pk_bf16_f32 v210, v218, v219
 v_mfma_f32_32x32x16_bf16 v[146:161], a[172:175], a[184:187], v[146:161]
 s_waitcnt lgkmcnt(2)
 ds_read_b128 a[168:171], v9 offset:4096
 v_accvgpr_read_b32 v222, a84
 v_accvgpr_read_b32 v223, a85
 v_cvt_pk_bf16_f32 v211, v220, v221
 v_accvgpr_read_b32 v224, a86
 v_accvgpr_read_b32 v225, a87
 v_mfma_f32_32x32x16_bf16 v[130:145], a[144:147], a[192:195], v[130:145]
 ds_read_b128 a[172:175], v9 offset:36864
 v_cvt_pk_bf16_f32 v212, v222, v223
 v_accvgpr_read_b32 v218, a88
 v_accvgpr_read_b32 v219, a89
 v_cvt_pk_bf16_f32 v213, v224, v225
 v_accvgpr_read_b32 v220, a90
 v_mfma_f32_32x32x16_bf16 v[146:161], a[148:151], a[192:195], v[146:161]
 ds_read_b128 a[144:147], v10 offset:0
 buffer_load_dwordx4 v5, s[12:15], s48 offen offset:1152 lds
 v_accvgpr_read_b32 v221, a91
 v_cvt_pk_bf16_f32 v214, v218, v219
 v_accvgpr_read_b32 v222, a92
 v_mfma_f32_32x32x16_bf16 v[130:145], a[152:155], a[196:199], v[130:145]
 s_add_u32 s48, s83, s80
 ds_read_b128 a[148:151], v10 offset:32768
 s_add_u32 m0, s28, 0x8f80
 v_accvgpr_read_b32 v223, a93
 v_cvt_pk_bf16_f32 v215, v220, v221
 v_accvgpr_read_b32 v224, a94
 v_accvgpr_read_b32 v225, a95
 v_mfma_f32_32x32x16_bf16 v[146:161], a[156:159], a[196:199], v[146:161]
 s_waitcnt lgkmcnt(2)
 ds_read_b128 a[152:155], v11 offset:0
 buffer_load_dwordx4 v4, s[12:15], s48 offen offset:128 lds
 v_cvt_pk_bf16_f32 v216, v222, v223
 v_cvt_pk_bf16_f32 v217, v224, v225
 v_mfma_f32_32x32x16_bf16 v[130:145], a[160:163], a[200:203], v[130:145]
 ds_read_b128 a[156:159], v11 offset:32768
 buffer_store_dwordx4 v[210:213], v31, s[4:7], s60 offen offset:0 sc1
 buffer_store_dwordx4 v[214:217], v31, s[4:7], s60 offen offset:1024 sc1
 v_mfma_f32_32x32x16_bf16 v[146:161], a[164:167], a[200:203], v[146:161]
 s_waitcnt vmcnt(16)
 buffer_store_dword v28, v29, s[4:7], s58 offen offset:2048 sc1
 ds_read_b128 a[160:163], v10 offset:4096
 v_mfma_f32_32x32x16_bf16 v[130:145], a[168:171], a[204:207], v[130:145]
 ds_read_b128 a[164:167], v10 offset:36864
 v_mfma_f32_32x32x16_bf16 v[146:161], a[172:175], a[204:207], v[146:161]
 s_waitcnt lgkmcnt(2)
 ds_read_b128 a[168:171], v11 offset:4096
 v_mfma_f32_32x32x16_bf16 v[130:145], a[144:147], a[208:211], v[130:145]
 ds_read_b128 a[172:175], v11 offset:36864
 v_cvt_pk_bf16_f32 v162, v162, v163
 v_cvt_pk_bf16_f32 v163, v164, v165
 v_cvt_pk_bf16_f32 v164, v166, v167
 v_cvt_pk_bf16_f32 v165, v168, v169
 v_cvt_pk_bf16_f32 v166, v170, v171
 v_mfma_f32_32x32x16_bf16 v[146:161], a[148:151], a[208:211], v[146:161]
 s_barrier
 ds_read_b128 a[144:147], v12 offset:8192
 v_cvt_pk_bf16_f32 v167, v172, v173
 v_cvt_pk_bf16_f32 v168, v174, v175
 v_cvt_pk_bf16_f32 v169, v176, v177
 v_mfma_f32_32x32x16_bf16 v[130:145], a[152:155], a[212:215], v[130:145]
 ds_read_b128 a[148:151], v8 offset:40960
 buffer_load_dwordx4 v5, s[12:15], s48 offen offset:1152 lds
 buffer_store_dwordx4 v[162:165], v30, s[4:7], s63 offen offset:0 sc1
 v_mfma_f32_32x32x16_bf16 v[146:161], a[156:159], a[212:215], v[146:161]
 s_waitcnt lgkmcnt(2)
 ds_read_b128 a[152:155], v13 offset:8192
 buffer_store_dwordx4 v[166:169], v30, s[4:7], s63 offen offset:1024 sc1
 v_mfma_f32_32x32x16_bf16 v[130:145], a[160:163], a[216:219], v[130:145]
 ds_read_b128 a[156:159], v9 offset:40960
 v_mfma_f32_32x32x16_bf16 v[146:161], a[164:167], a[216:219], v[146:161]
 ds_read_b128 a[160:163], v12 offset:12288
 v_mfma_f32_32x32x16_bf16 v[130:145], a[168:171], a[220:223], v[130:145]
 ds_read_b128 a[164:167], v8 offset:45056
 v_mfma_f32_32x32x16_bf16 v[146:161], a[172:175], a[220:223], v[146:161]
 s_waitcnt lgkmcnt(2)
 ds_read_b128 a[168:171], v13 offset:12288
 v_mfma_f32_32x32x16_bf16 v[130:145], a[144:147], a[224:227], v[130:145]
 ds_read_b128 a[172:175], v9 offset:45056
 v_mfma_f32_32x32x16_bf16 v[146:161], a[148:151], a[224:227], v[146:161]
 ds_read_b128 a[144:147], v14 offset:8192
 v_mfma_f32_32x32x16_bf16 v[130:145], a[152:155], a[228:231], v[130:145]
 ds_read_b128 a[148:151], v10 offset:40960
 v_cvt_pk_bf16_f32 v178, v178, v179
 v_cvt_pk_bf16_f32 v179, v180, v181
 v_cvt_pk_bf16_f32 v180, v182, v183
 v_cvt_pk_bf16_f32 v181, v184, v185
 v_cvt_pk_bf16_f32 v182, v186, v187
 v_mfma_f32_32x32x16_bf16 v[146:161], a[156:159], a[228:231], v[146:161]
 s_waitcnt lgkmcnt(2)
 ds_read_b128 a[152:155], v15 offset:8192
 v_cvt_pk_bf16_f32 v183, v188, v189
 v_cvt_pk_bf16_f32 v184, v190, v191
 v_cvt_pk_bf16_f32 v185, v192, v193
 v_mfma_f32_32x32x16_bf16 v[130:145], a[160:163], a[232:235], v[130:145]
 s_add_u32 m0, s28, 0x13000
 ds_read_b128 a[156:159], v11 offset:40960
 buffer_store_dwordx4 v[178:181], v31, s[4:7], s63 offen offset:0 sc1
 buffer_store_dwordx4 v[182:185], v31, s[4:7], s63 offen offset:1024 sc1
 v_mfma_f32_32x32x16_bf16 v[146:161], a[164:167], a[232:235], v[146:161]
 ds_read_b128 a[160:163], v14 offset:12288
 buffer_load_dwordx4 v6, s[12:15], s81 offen offset:0 lds
 v_mfma_f32_32x32x16_bf16 v[130:145], a[168:171], a[236:239], v[130:145]
 ds_read_b128 a[164:167], v10 offset:45056
 buffer_load_dwordx4 v7, s[12:15], s81 offen offset:1024 lds
 v_mfma_f32_32x32x16_bf16 v[146:161], a[172:175], a[236:239], v[146:161]
 s_waitcnt vmcnt(17)
 buffer_store_dword v28, v29, s[4:7], s59 offen offset:2048 sc1
 s_waitcnt lgkmcnt(2)
 ds_read_b128 a[168:171], v15 offset:12288
 v_mfma_f32_32x32x16_bf16 v[130:145], a[144:147], a[240:243], v[130:145]
 s_add_u32 s48, s81, s74
 ds_read_b128 a[172:175], v11 offset:45056
 s_add_u32 m0, s28, 0x3000
 v_mfma_f32_32x32x16_bf16 v[146:161], a[148:151], a[240:243], v[146:161]
 s_waitcnt vmcnt(16)
 s_barrier
 ds_read_b128 a[144:147], v16 offset:49152
 buffer_load_dwordx4 v4, s[12:15], s48 offen offset:0 lds
 v_mfma_f32_32x32x16_bf16 v[130:145], a[152:155], a[244:247], v[130:145]
 ds_read_b128 a[148:151], v16 offset:51200
 v_mfma_f32_32x32x16_bf16 v[146:161], a[156:159], a[244:247], v[146:161]
 s_waitcnt lgkmcnt(2)
 ds_read_b128 a[152:155], v16 offset:53248
 v_mfma_f32_32x32x16_bf16 v[130:145], a[160:163], a[248:251], v[130:145]
 ds_read_b128 a[156:159], v16 offset:55296
 v_accvgpr_read_b32 v202, a96
 v_accvgpr_read_b32 v203, a97
 v_accvgpr_read_b32 v204, a98
 v_accvgpr_read_b32 v205, a99
 v_cvt_pk_bf16_f32 v194, v202, v203
 v_mfma_f32_32x32x16_bf16 v[146:161], a[164:167], a[248:251], v[146:161]
 ds_read_b128 a[160:163], v8 offset:57344
 v_accvgpr_read_b32 v206, a100
 v_accvgpr_read_b32 v207, a101
 v_cvt_pk_bf16_f32 v195, v204, v205
 v_accvgpr_read_b32 v208, a102
 v_accvgpr_read_b32 v209, a103
 v_mfma_f32_32x32x16_bf16 v[130:145], a[168:171], a[252:255], v[130:145]
 ds_read_b128 a[164:167], v8 offset:8192
 v_cvt_pk_bf16_f32 v196, v206, v207
 v_accvgpr_read_b32 v202, a104
 v_accvgpr_read_b32 v203, a105
 v_cvt_pk_bf16_f32 v197, v208, v209
 v_accvgpr_read_b32 v204, a106
 v_mfma_f32_32x32x16_bf16 v[146:161], a[172:175], a[252:255], v[146:161]
 s_waitcnt lgkmcnt(2)
 ds_read_b128 a[168:171], v9 offset:57344
 v_accvgpr_read_b32 v205, a107
 v_cvt_pk_bf16_f32 v198, v202, v203
 v_accvgpr_read_b32 v206, a108
 v_accvgpr_read_b32 v207, a109
 v_cvt_pk_bf16_f32 v199, v204, v205
 v_mfma_f32_32x32x16_bf16 v[162:177], a[144:147], a[176:179], 0
 ds_read_b128 a[172:175], v9 offset:8192
 v_accvgpr_read_b32 v208, a110
 v_accvgpr_read_b32 v209, a111
 v_cvt_pk_bf16_f32 v200, v206, v207
 v_cvt_pk_bf16_f32 v201, v208, v209
 v_mfma_f32_32x32x16_bf16 v[178:193], a[148:151], a[176:179], 0
 ds_read_b128 a[144:147], v8 offset:61440
 buffer_store_dwordx4 v[194:197], v30, s[4:7], s61 offen offset:0 sc1
 buffer_store_dwordx4 v[198:201], v30, s[4:7], s61 offen offset:1024 sc1
 v_mfma_f32_32x32x16_bf16 v[162:177], a[152:155], a[184:187], v[162:177]
 ds_read_b128 a[148:151], v8 offset:12288
 buffer_load_dwordx4 v5, s[12:15], s48 offen offset:1024 lds
 s_add_u32 s48, s81, s80
 s_add_u32 m0, s28, 0xb000
 v_mfma_f32_32x32x16_bf16 v[178:193], a[156:159], a[184:187], v[178:193]
 s_waitcnt lgkmcnt(2)
 ds_read_b128 a[152:155], v9 offset:61440
 buffer_load_dwordx4 v4, s[12:15], s48 offen offset:0 lds
 v_mfma_f32_32x32x16_bf16 v[162:177], a[160:163], a[192:195], v[162:177]
 ds_read_b128 a[156:159], v9 offset:12288
 v_mfma_f32_32x32x16_bf16 v[178:193], a[164:167], a[192:195], v[178:193]
 ds_read_b128 a[160:163], v10 offset:57344
 v_mfma_f32_32x32x16_bf16 v[162:177], a[168:171], a[196:199], v[162:177]
 ds_read_b128 a[164:167], v10 offset:8192
 buffer_load_dwordx4 v5, s[12:15], s48 offen offset:1024 lds
 v_accvgpr_read_b32 v218, a112
 v_accvgpr_read_b32 v219, a113
 v_accvgpr_read_b32 v220, a114
 v_mfma_f32_32x32x16_bf16 v[178:193], a[172:175], a[196:199], v[178:193]
 s_waitcnt lgkmcnt(2)
 ds_read_b128 a[168:171], v11 offset:57344
 v_accvgpr_read_b32 v221, a115
 v_cvt_pk_bf16_f32 v210, v218, v219
 v_accvgpr_read_b32 v222, a116
 v_accvgpr_read_b32 v223, a117
 v_cvt_pk_bf16_f32 v211, v220, v221
 v_mfma_f32_32x32x16_bf16 v[162:177], a[144:147], a[200:203], v[162:177]
 ds_read_b128 a[172:175], v11 offset:8192
 v_accvgpr_read_b32 v224, a118
 v_accvgpr_read_b32 v225, a119
 v_cvt_pk_bf16_f32 v212, v222, v223
 v_accvgpr_read_b32 v218, a120
 v_accvgpr_read_b32 v219, a121
 v_mfma_f32_32x32x16_bf16 v[178:193], a[148:151], a[200:203], v[178:193]
 ds_read_b128 a[144:147], v10 offset:61440
 v_cvt_pk_bf16_f32 v213, v224, v225
 v_accvgpr_read_b32 v220, a122
 v_accvgpr_read_b32 v221, a123
 v_cvt_pk_bf16_f32 v214, v218, v219
 v_accvgpr_read_b32 v222, a124
 v_mfma_f32_32x32x16_bf16 v[162:177], a[152:155], a[204:207], v[162:177]
 ds_read_b128 a[148:151], v10 offset:12288
 v_accvgpr_read_b32 v223, a125
 v_cvt_pk_bf16_f32 v215, v220, v221
 v_accvgpr_read_b32 v224, a126
 v_accvgpr_read_b32 v225, a127
 v_cvt_pk_bf16_f32 v216, v222, v223
 v_mfma_f32_32x32x16_bf16 v[178:193], a[156:159], a[204:207], v[178:193]
 s_waitcnt lgkmcnt(2)
 ds_read_b128 a[152:155], v11 offset:61440
 v_cvt_pk_bf16_f32 v217, v224, v225
 v_mfma_f32_32x32x16_bf16 v[162:177], a[160:163], a[208:211], v[162:177]
 s_waitcnt vmcnt(15)
 buffer_store_dword v28, v29, s[4:7], s60 offen offset:2048 sc1
 s_add_u32 s48, s81, s74
 ds_read_b128 a[156:159], v11 offset:12288
 s_add_u32 m0, s28, 0xcf80
 buffer_store_dwordx4 v[210:213], v31, s[4:7], s61 offen offset:0 sc1
 buffer_store_dwordx4 v[214:217], v31, s[4:7], s61 offen offset:1024 sc1
 v_mfma_f32_32x32x16_bf16 v[178:193], a[164:167], a[208:211], v[178:193]
 s_waitcnt vmcnt(16)
 s_barrier
 ds_read_b128 a[160:163], v8 offset:16384
 buffer_load_dwordx4 v4, s[12:15], s48 offen offset:128 lds
 v_mfma_f32_32x32x16_bf16 v[162:177], a[168:171], a[212:215], v[162:177]
 ds_read_b128 a[164:167], v8 offset:24576
 buffer_load_dwordx4 v5, s[12:15], s48 offen offset:1152 lds
 s_add_u32 s48, s81, s80
 s_add_u32 m0, s28, 0xef80
 v_mfma_f32_32x32x16_bf16 v[178:193], a[172:175], a[212:215], v[178:193]
 s_waitcnt lgkmcnt(2)
 ds_read_b128 a[168:171], v9 offset:16384
 buffer_load_dwordx4 v4, s[12:15], s48 offen offset:128 lds
 v_mfma_f32_32x32x16_bf16 v[162:177], a[144:147], a[216:219], v[162:177]
 ds_read_b128 a[172:175], v9 offset:24576
 buffer_load_dwordx4 v5, s[12:15], s48 offen offset:1152 lds
 v_cvt_pk_bf16_f32 v130, v130, v131
 v_cvt_pk_bf16_f32 v131, v132, v133
 v_cvt_pk_bf16_f32 v132, v134, v135
 v_mfma_f32_32x32x16_bf16 v[178:193], a[148:151], a[216:219], v[178:193]
 ds_read_b128 a[144:147], v8 offset:20480
 v_cvt_pk_bf16_f32 v133, v136, v137
 v_cvt_pk_bf16_f32 v134, v138, v139
 v_cvt_pk_bf16_f32 v135, v140, v141
 v_cvt_pk_bf16_f32 v136, v142, v143
 v_cvt_pk_bf16_f32 v137, v144, v145
 v_mfma_f32_32x32x16_bf16 v[162:177], a[152:155], a[220:223], v[162:177]
 ds_read_b128 a[148:151], v8 offset:28672
 buffer_store_dwordx4 v[130:133], v30, s[4:7], s64 offen offset:0 sc1
 buffer_store_dwordx4 v[134:137], v30, s[4:7], s64 offen offset:1024 sc1
 v_mfma_f32_32x32x16_bf16 v[178:193], a[156:159], a[220:223], v[178:193]
 s_waitcnt lgkmcnt(2)
 ds_read_b128 a[152:155], v9 offset:20480
 v_mfma_f32_32x32x16_bf16 v[162:177], a[160:163], a[224:227], v[162:177]
 ds_read_b128 a[156:159], v9 offset:28672
 v_mfma_f32_32x32x16_bf16 v[178:193], a[164:167], a[224:227], v[178:193]
 ds_read_b128 a[160:163], v10 offset:16384
 v_mfma_f32_32x32x16_bf16 v[162:177], a[168:171], a[228:231], v[162:177]
 ds_read_b128 a[164:167], v10 offset:24576
 v_mfma_f32_32x32x16_bf16 v[178:193], a[172:175], a[228:231], v[178:193]
 s_waitcnt lgkmcnt(2)
 ds_read_b128 a[168:171], v11 offset:16384
 v_mfma_f32_32x32x16_bf16 v[162:177], a[144:147], a[232:235], v[162:177]
 ds_read_b128 a[172:175], v11 offset:24576
 v_mfma_f32_32x32x16_bf16 v[178:193], a[148:151], a[232:235], v[178:193]
 ds_read_b128 a[144:147], v10 offset:20480
 v_mfma_f32_32x32x16_bf16 v[162:177], a[152:155], a[236:239], v[162:177]
 ds_read_b128 a[148:151], v10 offset:28672
 v_cvt_pk_bf16_f32 v146, v146, v147
 v_cvt_pk_bf16_f32 v147, v148, v149
 v_cvt_pk_bf16_f32 v148, v150, v151
 v_cvt_pk_bf16_f32 v149, v152, v153
 v_cvt_pk_bf16_f32 v150, v154, v155
 v_mfma_f32_32x32x16_bf16 v[178:193], a[156:159], a[236:239], v[178:193]
 s_waitcnt lgkmcnt(2)
 ds_read_b128 a[152:155], v11 offset:20480
 v_cvt_pk_bf16_f32 v151, v156, v157
 v_cvt_pk_bf16_f32 v152, v158, v159
 v_cvt_pk_bf16_f32 v153, v160, v161
 v_mfma_f32_32x32x16_bf16 v[162:177], a[160:163], a[240:243], v[162:177]
 s_waitcnt vmcnt(18)
 buffer_store_dword v28, v29, s[4:7], s63 offen offset:2048 sc1
 ds_read_b128 a[156:159], v11 offset:28672
 buffer_store_dwordx4 v[146:149], v31, s[4:7], s64 offen offset:0 sc1
 buffer_store_dwordx4 v[150:153], v31, s[4:7], s64 offen offset:1024 sc1
 v_mfma_f32_32x32x16_bf16 v[178:193], a[164:167], a[240:243], v[178:193]
 s_waitcnt vmcnt(12)
 s_barrier
 ds_read_b128 a[160:163], v18 offset:0
 v_mfma_f32_32x32x16_bf16 v[162:177], a[168:171], a[244:247], v[162:177]
 ds_read_b128 a[164:167], v18 offset:2048
 v_mfma_f32_32x32x16_bf16 v[178:193], a[172:175], a[244:247], v[178:193]
 s_waitcnt lgkmcnt(2)
 ds_read_b128 a[168:171], v18 offset:4096
 v_mfma_f32_32x32x16_bf16 v[162:177], a[144:147], a[248:251], v[162:177]
 ds_read_b128 a[172:175], v18 offset:6144
 v_mfma_f32_32x32x16_bf16 v[178:193], a[148:151], a[248:251], v[178:193]
 ds_read_b128 a[144:147], v8 offset:0
 v_mfma_f32_32x32x16_bf16 v[162:177], a[152:155], a[252:255], v[162:177]
 ds_read_b128 a[148:151], v8 offset:32768
 v_mfma_f32_32x32x16_bf16 v[178:193], a[156:159], a[252:255], v[178:193]
 s_waitcnt lgkmcnt(2)
 ds_read_b128 a[152:155], v9 offset:0
 v_mfma_f32_32x32x16_bf16 v[130:145], a[160:163], a[176:179], 0
 ds_read_b128 a[156:159], v9 offset:32768
 s_nop 5
 v_cvt_pk_bf16_f32 v162, v162, v163
 v_cvt_pk_bf16_f32 v163, v164, v165
 v_cvt_pk_bf16_f32 v164, v166, v167
 v_cvt_pk_bf16_f32 v165, v168, v169
 v_cvt_pk_bf16_f32 v166, v170, v171
 v_mfma_f32_32x32x16_bf16 v[146:161], a[164:167], a[176:179], 0
 ds_read_b128 a[160:163], v8 offset:4096
 v_cvt_pk_bf16_f32 v167, v172, v173
 v_cvt_pk_bf16_f32 v168, v174, v175
 v_cvt_pk_bf16_f32 v169, v176, v177
 v_mfma_f32_32x32x16_bf16 v[130:145], a[168:171], a[184:187], v[130:145]
 ds_read_b128 a[164:167], v8 offset:36864
 buffer_store_dwordx4 v[162:165], v30, s[4:7], s65 offen offset:0 sc1
 buffer_store_dwordx4 v[166:169], v30, s[4:7], s65 offen offset:1024 sc1
 v_mfma_f32_32x32x16_bf16 v[146:161], a[172:175], a[184:187], v[146:161]
 s_waitcnt lgkmcnt(2)
 ds_read_b128 a[168:171], v9 offset:4096
 v_mfma_f32_32x32x16_bf16 v[130:145], a[144:147], a[192:195], v[130:145]
 ds_read_b128 a[172:175], v9 offset:36864
 v_mfma_f32_32x32x16_bf16 v[146:161], a[148:151], a[192:195], v[146:161]
 ds_read_b128 a[144:147], v10 offset:0
 v_mfma_f32_32x32x16_bf16 v[130:145], a[152:155], a[196:199], v[130:145]
 ds_read_b128 a[148:151], v10 offset:32768
 v_mfma_f32_32x32x16_bf16 v[146:161], a[156:159], a[196:199], v[146:161]
 s_waitcnt lgkmcnt(2)
 ds_read_b128 a[152:155], v11 offset:0
 v_mfma_f32_32x32x16_bf16 v[130:145], a[160:163], a[200:203], v[130:145]
 ds_read_b128 a[156:159], v11 offset:32768
 v_mfma_f32_32x32x16_bf16 v[146:161], a[164:167], a[200:203], v[146:161]
 ds_read_b128 a[160:163], v10 offset:4096
 v_mfma_f32_32x32x16_bf16 v[130:145], a[168:171], a[204:207], v[130:145]
 ds_read_b128 a[164:167], v10 offset:36864
 v_cvt_pk_bf16_f32 v178, v178, v179
 v_cvt_pk_bf16_f32 v179, v180, v181
 v_cvt_pk_bf16_f32 v180, v182, v183
 v_cvt_pk_bf16_f32 v181, v184, v185
 v_cvt_pk_bf16_f32 v182, v186, v187
 v_mfma_f32_32x32x16_bf16 v[146:161], a[172:175], a[204:207], v[146:161]
 s_waitcnt lgkmcnt(2)
 ds_read_b128 a[168:171], v11 offset:4096
 v_cvt_pk_bf16_f32 v183, v188, v189
 v_cvt_pk_bf16_f32 v184, v190, v191
 v_cvt_pk_bf16_f32 v185, v192, v193
 v_mfma_f32_32x32x16_bf16 v[130:145], a[144:147], a[208:211], v[130:145]
 ds_read_b128 a[172:175], v11 offset:36864
 buffer_store_dwordx4 v[178:181], v31, s[4:7], s65 offen offset:0 sc1
 buffer_store_dwordx4 v[182:185], v31, s[4:7], s65 offen offset:1024 sc1
 v_mfma_f32_32x32x16_bf16 v[146:161], a[148:151], a[208:211], v[146:161]
 s_waitcnt vmcnt(9)
 s_barrier
 ds_read_b128 a[144:147], v8 offset:40960
 v_mfma_f32_32x32x16_bf16 v[130:145], a[152:155], a[212:215], v[130:145]
 ds_read_b128 a[148:151], v8 offset:49152
 v_mfma_f32_32x32x16_bf16 v[146:161], a[156:159], a[212:215], v[146:161]
 s_waitcnt lgkmcnt(2)
 ds_read_b128 a[152:155], v9 offset:40960
 v_mfma_f32_32x32x16_bf16 v[130:145], a[160:163], a[216:219], v[130:145]
 buffer_store_dword v28, v29, s[4:7], s61 offen offset:2048 sc1
 ds_read_b128 a[156:159], v9 offset:49152
 v_mfma_f32_32x32x16_bf16 v[146:161], a[164:167], a[216:219], v[146:161]
 ds_read_b128 a[160:163], v8 offset:45056
 v_mfma_f32_32x32x16_bf16 v[130:145], a[168:171], a[220:223], v[130:145]
 ds_read_b128 a[164:167], v8 offset:53248
 v_mfma_f32_32x32x16_bf16 v[146:161], a[172:175], a[220:223], v[146:161]
 s_waitcnt lgkmcnt(2)
 ds_read_b128 a[168:171], v9 offset:45056
 v_mfma_f32_32x32x16_bf16 v[130:145], a[144:147], a[224:227], v[130:145]
 ds_read_b128 a[172:175], v9 offset:53248
 v_mfma_f32_32x32x16_bf16 v[146:161], a[148:151], a[224:227], v[146:161]
 ds_read_b128 a[144:147], v10 offset:40960
 v_mfma_f32_32x32x16_bf16 v[130:145], a[152:155], a[228:231], v[130:145]
 ds_read_b128 a[148:151], v10 offset:49152
 v_mfma_f32_32x32x16_bf16 v[146:161], a[156:159], a[228:231], v[146:161]
 s_waitcnt lgkmcnt(2)
 ds_read_b128 a[152:155], v11 offset:40960
 v_mfma_f32_32x32x16_bf16 v[130:145], a[160:163], a[232:235], v[130:145]
 ds_read_b128 a[156:159], v11 offset:49152
 v_mfma_f32_32x32x16_bf16 v[146:161], a[164:167], a[232:235], v[146:161]
 ds_read_b128 a[160:163], v10 offset:45056
 v_mfma_f32_32x32x16_bf16 v[130:145], a[168:171], a[236:239], v[130:145]
 ds_read_b128 a[164:167], v10 offset:53248
 v_mfma_f32_32x32x16_bf16 v[146:161], a[172:175], a[236:239], v[146:161]
 s_waitcnt lgkmcnt(2)
 ds_read_b128 a[168:171], v11 offset:45056
 v_mfma_f32_32x32x16_bf16 v[130:145], a[144:147], a[240:243], v[130:145]
 ds_read_b128 a[172:175], v11 offset:53248
 v_mfma_f32_32x32x16_bf16 v[146:161], a[148:151], a[240:243], v[146:161]
 v_mfma_f32_32x32x16_bf16 v[130:145], a[152:155], a[244:247], v[130:145]
 v_mfma_f32_32x32x16_bf16 v[146:161], a[156:159], a[244:247], v[146:161]
 s_waitcnt lgkmcnt(0)
 v_mfma_f32_32x32x16_bf16 v[130:145], a[160:163], a[248:251], v[130:145]
 s_waitcnt vmcnt(5)
 buffer_store_dword v28, v29, s[4:7], s64 offen offset:2048 sc1
 v_mfma_f32_32x32x16_bf16 v[146:161], a[164:167], a[248:251], v[146:161]
 v_mfma_f32_32x32x16_bf16 v[130:145], a[168:171], a[252:255], v[130:145]
 v_mfma_f32_32x32x16_bf16 v[146:161], a[172:175], a[252:255], v[146:161]
 s_nop 7
 s_nop 2
 v_cvt_pk_bf16_f32 v130, v130, v131
 v_cvt_pk_bf16_f32 v131, v132, v133
 v_cvt_pk_bf16_f32 v132, v134, v135
 v_cvt_pk_bf16_f32 v133, v136, v137
 v_cvt_pk_bf16_f32 v134, v138, v139
 v_cvt_pk_bf16_f32 v135, v140, v141
 v_cvt_pk_bf16_f32 v136, v142, v143
 v_cvt_pk_bf16_f32 v137, v144, v145
 buffer_store_dwordx4 v[130:133], v30, s[4:7], s66 offen offset:0 sc1
 buffer_store_dwordx4 v[134:137], v30, s[4:7], s66 offen offset:1024 sc1
 v_cvt_pk_bf16_f32 v146, v146, v147
 v_cvt_pk_bf16_f32 v147, v148, v149
 v_cvt_pk_bf16_f32 v148, v150, v151
 v_cvt_pk_bf16_f32 v149, v152, v153
 v_cvt_pk_bf16_f32 v150, v154, v155
 v_cvt_pk_bf16_f32 v151, v156, v157
 v_cvt_pk_bf16_f32 v152, v158, v159
 v_cvt_pk_bf16_f32 v153, v160, v161
 buffer_store_dwordx4 v[146:149], v31, s[4:7], s66 offen offset:0 sc1
 buffer_store_dwordx4 v[150:153], v31, s[4:7], s66 offen offset:1024 sc1
 s_waitcnt vmcnt(6)
 buffer_store_dword v28, v29, s[4:7], s65 offen offset:2048 sc1
 s_waitcnt vmcnt(1)
 buffer_store_dword v28, v29, s[4:7], s66 offen offset:2048 sc1
 s_endpgm
mrd_spin:
 s_mov_b32 s68, 100000
mrd_loop:
 global_load_dword v40, v61, s[34:35] sc1
 s_waitcnt vmcnt(0)
 v_cmp_ne_u32 vcc, 0x1010101, v40
 s_nop 1
 s_cmp_lg_u64 vcc, 0
 s_cbranch_scc0 mrd_back
 s_sub_u32 s68, s68, 1
 s_cmp_lg_u32 s68, 0
 s_cbranch_scc1 mrd_loop
 s_branch mrd_back
mh0_spin:
 s_mov_b32 s68, 100000
mh0_loop:
 buffer_load_dword v40, v35, s[4:7], 0 offen offset:0 sc1
 s_waitcnt vmcnt(0)
 v_cmp_eq_u32 vcc, 0, v40
 s_nop 1
 s_cmp_lg_u64 vcc, 0
 s_cbranch_scc0 mh0_back
 s_sub_u32 s68, s68, 1
 s_cmp_lg_u32 s68, 0
 s_cbranch_scc1 mh0_loop
 s_branch mh0_back
mh1_spin:
 s_mov_b32 s68, 100000
mh1_loop:
 buffer_load_dword v40, v35, s[4:7], 0 offen offset:128 sc1
 s_waitcnt vmcnt(0)
 v_cmp_eq_u32 vcc, 0, v40
 s_nop 1
 s_cmp_lg_u64 vcc, 0
 s_cbranch_scc0 mh1_back
 s_sub_u32 s68, s68, 1
 s_cmp_lg_u32 s68, 0
 s_cbranch_scc1 mh1_loop
 s_branch mh1_back
mh2_spin:
 s_mov_b32 s68, 100000
mh2_loop:
 buffer_load_dword v40, v35, s[4:7], 0 offen offset:256 sc1
 s_waitcnt vmcnt(0)
 v_cmp_eq_u32 vcc, 0, v40
 s_nop 1
 s_cmp_lg_u64 vcc, 0
 s_cbranch_scc0 mh2_back
 s_sub_u32 s68, s68, 1
 s_cmp_lg_u32 s68, 0
 s_cbranch_scc1 mh2_loop
 s_branch mh2_back
mh3_spin:
 s_mov_b32 s68, 100000
mh3_loop:
 buffer_load_dword v40, v35, s[4:7], 0 offen offset:384 sc1
 s_waitcnt vmcnt(0)
 v_cmp_eq_u32 vcc, 0, v40
 s_nop 1
 s_cmp_lg_u64 vcc, 0
 s_cbranch_scc0 mh3_back
 s_sub_u32 s68, s68, 1
 s_cmp_lg_u32 s68, 0
 s_cbranch_scc1 mh3_loop
 s_branch mh3_back
mm_spin:
 s_mov_b32 s68, 100000
mm_loop:
 buffer_load_dword v43, v41, s[4:7], 0 offen offset:2048 sc1
 s_waitcnt vmcnt(0)
 v_cmp_eq_u32 vcc, 0, v43
 s_nop 1
 s_and_b32 s69, vcc_lo, 0xf0
 s_cbranch_scc0 mm_back
 s_sub_u32 s68, s68, 1
 s_cmp_lg_u32 s68, 0
 s_cbranch_scc1 mm_loop
 s_branch mm_back
ms_spin:
 s_mov_b32 s68, 100000
ms_loop:
 buffer_load_dword v61, v39, s[4:7], 0 offen offset:2048 sc1
 s_waitcnt vmcnt(0)
 v_cmp_eq_u32 vcc, 0, v61
 s_nop 1
 s_and_b32 s69, vcc_lo, 0x3
 s_cbranch_scc0 ms_back
 s_sub_u32 s68, s68, 1
 s_cmp_lg_u32 s68, 0
 s_cbranch_scc1 ms_loop
 s_branch ms_back
mr_spin:
 s_mov_b32 s68, 100000
 s_waitcnt vmcnt(9)
 v_cmp_eq_u32 vcc, 0, v40
 s_nop 1
 s_cmp_lg_u64 vcc, 0
 s_cbranch_scc0 mr_go
mr_loop:
 buffer_load_dword v40, v38, s[4:7], s72 offen offset:2048 sc1
 s_waitcnt vmcnt(0)
 v_cmp_eq_u32 vcc, 0, v40
 s_nop 1
 s_cmp_lg_u64 vcc, 0
 s_cbranch_scc0 mr_go
 s_sub_u32 s68, s68, 1
 s_cmp_lg_u32 s68, 0
 s_cbranch_scc1 mr_loop
mr_go:
 s_mov_b32 s67, 0x2200
 buffer_load_dwordx4 a[128:131], v37, s[4:7], s67 offen sc1
 s_mov_b32 s67, 0x2a80
 buffer_load_dwordx4 a[132:135], v37, s[4:7], s67 offen sc1
 s_mov_b32 s67, 0x3300
 buffer_load_dwordx4 a[136:139], v37, s[4:7], s67 offen sc1
 s_mov_b32 s67, 0x3b80
 buffer_load_dwordx4 a[140:143], v37, s[4:7], s67 offen sc1
 s_mov_b32 s67, 0x2200
 buffer_load_dwordx4 a[96:99], v36, s[4:7], s67 offen offset:0 sc1
 s_mov_b32 s67, 0x2200
 buffer_load_dwordx4 a[100:103], v36, s[4:7], s67 offen offset:1024 sc1
 s_mov_b32 s67, 0x2a80
 buffer_load_dwordx4 a[104:107], v36, s[4:7], s67 offen offset:0 sc1
 s_mov_b32 s67, 0x2a80
 buffer_load_dwordx4 a[108:111], v36, s[4:7], s67 offen offset:1024 sc1
 s_mov_b32 s67, 0x3300
 buffer_load_dwordx4 a[112:115], v36, s[4:7], s67 offen offset:0 sc1
 s_mov_b32 s67, 0x3300
 buffer_load_dwordx4 a[116:119], v36, s[4:7], s67 offen offset:1024 sc1
 s_mov_b32 s67, 0x3b80
 buffer_load_dwordx4 a[120:123], v36, s[4:7], s67 offen offset:0 sc1
 s_mov_b32 s67, 0x3b80
 buffer_load_dwordx4 a[124:127], v36, s[4:7], s67 offen offset:1024 sc1
 s_branch mr_back
ms2_spin:
 s_mov_b32 s68, 100000
ms2_loop:
 s_mov_b32 s67, 0x1100
 buffer_load_dwordx4 v[112:115], v36, s[4:7], s67 offen offset:0 sc1
 s_mov_b32 s67, 0x1100
 buffer_load_dwordx4 v[116:119], v36, s[4:7], s67 offen offset:1024 sc1
 s_waitcnt vmcnt(0)
 v_max_u32 v60, v112, v116
 v_cmp_eq_u32 vcc, -1, v60
 s_nop 1
 s_cmp_lg_u64 vcc, 0
 s_cbranch_scc0 ms2_back
 s_sub_u32 s68, s68, 1
 s_cmp_lg_u32 s68, 0
 s_cbranch_scc1 ms2_loop
 s_branch ms2_back
sa0_spin:
 s_mov_b32 s68, 100000
sa0_loop:
 buffer_load_dwordx2 v[58:59], v21, s[76:79], s72 offen offset:256 sc1
 buffer_load_dwordx2 v[60:61], v21, s[76:79], s72 offen offset:768 sc1
 s_waitcnt vmcnt(0)
 v_max_u32 v36, v58, v60
 v_cmp_eq_u32 vcc, -1, v36
 s_nop 1
 s_cmp_lg_u64 vcc, 0
 s_cbranch_scc0 sa0_back
 s_sub_u32 s68, s68, 1
 s_cmp_lg_u32 s68, 0
 s_cbranch_scc1 sa0_loop
 s_branch sa0_back
sa1_spin:
 s_mov_b32 s68, 100000
sa1_loop:
 buffer_load_dwordx2 v[58:59], v21, s[76:79], s72 offen offset:256 sc1
 buffer_load_dwordx2 v[60:61], v21, s[76:79], s72 offen offset:768 sc1
 s_waitcnt vmcnt(0)
 v_max_u32 v36, v58, v60
 v_cmp_eq_u32 vcc, -1, v36
 s_nop 1
 s_cmp_lg_u64 vcc, 0
 s_cbranch_scc0 sa1_back
 s_sub_u32 s68, s68, 1
 s_cmp_lg_u32 s68, 0
 s_cbranch_scc1 sa1_loop
 s_branch sa1_back
sa2_spin:
 s_mov_b32 s68, 100000
sa2_loop:
 buffer_load_dwordx2 v[58:59], v21, s[76:79], s72 offen offset:256 sc1
 buffer_load_dwordx2 v[60:61], v21, s[76:79], s72 offen offset:768 sc1
 s_waitcnt vmcnt(0)
 v_max_u32 v36, v58, v60
 v_cmp_eq_u32 vcc, -1, v36
 s_nop 1
 s_cmp_lg_u64 vcc, 0
 s_cbranch_scc0 sa2_back
 s_sub_u32 s68, s68, 1
 s_cmp_lg_u32 s68, 0
 s_cbranch_scc1 sa2_loop
 s_branch sa2_back
sa3_spin:
 s_mov_b32 s68, 100000
sa3_loop:
 buffer_load_dwordx2 v[58:59], v21, s[76:79], s72 offen offset:256 sc1
 buffer_load_dwordx2 v[60:61], v21, s[76:79], s72 offen offset:768 sc1
 s_waitcnt vmcnt(0)
 v_max_u32 v36, v58, v60
 v_cmp_eq_u32 vcc, -1, v36
 s_nop 1
 s_cmp_lg_u64 vcc, 0
 s_cbranch_scc0 sa3_back
 s_sub_u32 s68, s68, 1
 s_cmp_lg_u32 s68, 0
 s_cbranch_scc1 sa3_loop
 s_branch sa3_back
sa4_spin:
 s_mov_b32 s68, 100000
sa4_loop:
 buffer_load_dwordx2 v[58:59], v21, s[76:79], s72 offen offset:256 sc1
 buffer_load_dwordx2 v[60:61], v21, s[76:79], s72 offen offset:768 sc1
 s_waitcnt vmcnt(0)
 v_max_u32 v36, v58, v60
 v_cmp_eq_u32 vcc, -1, v36
 s_nop 1
 s_cmp_lg_u64 vcc, 0
 s_cbranch_scc0 sa4_back
 s_sub_u32 s68, s68, 1
 s_cmp_lg_u32 s68, 0
 s_cbranch_scc1 sa4_loop
 s_branch sa4_back
srd_spin:
 s_mov_b32 s68, 100000
srd_loop:
 global_load_ubyte v59, v33, s[34:35] sc1
 s_waitcnt vmcnt(0)
 v_cmp_eq_u32 vcc, 0, v59
 s_nop 1
 s_cmp_lg_u64 vcc, 0
 s_cbranch_scc0 srd_back
 s_sub_u32 s68, s68, 1
 s_cmp_lg_u32 s68, 0
 s_cbranch_scc1 srd_loop
 s_branch srd_back
kab_end:
 s_endpgm
.fill 1024, 4, 0xbf800000
.section .rodata,"a"
.p2align 6
.amdhsa_kernel recurrent_scan__ssm_conv_s5__dense_activation_gelu__prompt_kernel
  .amdhsa_next_free_vgpr 512
  .amdhsa_next_free_sgpr 102
  .amdhsa_accum_offset 256
  .amdhsa_group_segment_fixed_size 0
  .amdhsa_kernarg_size 136
  .amdhsa_user_sgpr_count 2
  .amdhsa_user_sgpr_kernarg_segment_ptr 1
  .amdhsa_system_sgpr_workgroup_id_x 1
.end_amdhsa_kernel
```
